```python
import torch

def _softmax(x, axis=-1):
    return torch.softmax(x, dim=axis)
def _gelu(x):
    return torch.nn.functional.gelu(x, approximate="tanh")
def _silu(x):
    return torch.nn.functional.silu(x)
def _sigmoid(x):
    return torch.sigmoid(x)
def _layernorm(x, axis=-1, eps=1e-5):
    m = x.mean(dim=axis, keepdim=True)
    v = x.var(dim=axis, keepdim=True, unbiased=False)
    return (x - m) / torch.sqrt(v + eps)
def _scatter_add(tgt, idx, src, axis=0):
    return tgt.clone().index_add_(axis, idx, src)
def _segment_sum(src, seg, n):
    out = torch.zeros((n,) + src.shape[1:], dtype=src.dtype)
    return out.index_add_(0, seg, src)
def _pad(x, pw):
    flat = tuple(v for pair in reversed(pw) for v in pair)
    return torch.nn.functional.pad(x, flat)

kernel_name = 'concat_heads__mha_block_cached__gqa_block_cached__near_ridge'

def setup_inputs():

    _w = (lambda a: (lambda t: t.to(torch.bfloat16) if t.is_floating_point() else t)(torch.as_tensor(a)))
    def _A_setup():
        B, Sq, D = 16, 112, 448
        H, Sk, Dh = 16, 512, 256
        return {
            "x": _w((lambda *s: torch.randn(*s, dtype=torch.bfloat16) * 0.8)(B, Sq, D)),
            "k_cache": _w((lambda *s: torch.randn(*s, dtype=torch.bfloat16) * 0.8)(B, H, Sk, Dh)),
            "v_cache": _w((lambda *s: torch.randn(*s, dtype=torch.bfloat16) * 0.05)(B, H, Sk, Dh)),
            "wq": _w((lambda *s: torch.randn(*s, dtype=torch.bfloat16) * 0.8)(D, H * Dh) * (D ** -0.5)),
            "wo": _w((lambda *s: torch.randn(*s, dtype=torch.bfloat16) * 0.05)(H * Dh, D) * ((H * Dh) ** -0.5)),
        }
    _A_in = _A_setup()

    def _B_setup():
        B, Sq, D = 16, 112, 448
        Hq, Hkv, Sk, Dh = 16, 16, 512, 256
        assert Hq % Hkv == 0, (Hq, Hkv)
        return {
            "x": _w((lambda *s: torch.randn(*s, dtype=torch.bfloat16) * 0.8)(B, Sq, D)),
            "k_cache": _w((lambda *s: torch.randn(*s, dtype=torch.bfloat16) * 0.8)(B, Hkv, Sk, Dh)),
            "v_cache": _w((lambda *s: torch.randn(*s, dtype=torch.bfloat16) * 0.05)(B, Hkv, Sk, Dh)),
            "wq": _w((lambda *s: torch.randn(*s, dtype=torch.bfloat16) * 0.8)(D, Hq * Dh) * (D ** -0.5)),
            "wo": _w((lambda *s: torch.randn(*s, dtype=torch.bfloat16) * 0.05)(Hq * Dh, D) * ((Hq * Dh) ** -0.5)),
        }
    _B_in = _B_setup()

    return {
        "A_x": _A_in["x"],
        "A_k_cache": _A_in["k_cache"],
        "A_v_cache": _A_in["v_cache"],
        "A_wq": _A_in["wq"],
        "A_wo": _A_in["wo"],
        "B_x": _B_in["x"],
        "B_k_cache": _B_in["k_cache"],
        "B_v_cache": _B_in["v_cache"],
        "B_wq": _B_in["wq"],
        "B_wo": _B_in["wo"],
    }

def reference(A_x, A_k_cache, A_v_cache, A_wq, A_wo, B_x, B_k_cache, B_v_cache, B_wq, B_wo):
    def _A_ref(x, k_cache, v_cache, wq, wo):
        B, Sq, D = x.shape
        H, Dh = 16, 256
        q = (lambda x, *d: x.permute(*d))((x @ wq).reshape(B, Sq, H, Dh), 0, 2, 1, 3)
        scores = torch.einsum("bhqd,bhkd->bhqk", q, k_cache) * (Dh ** -0.5)
        p = _softmax(scores, axis=-1)
        o = torch.einsum("bhqk,bhkd->bhqd", p, v_cache)
        return (lambda x, *d: x.permute(*d))(o, 0, 2, 1, 3).reshape(B, Sq, H * Dh) @ wo

    def _B_ref(x, k_cache, v_cache, wq, wo):
        B, Sq, D = x.shape
        Hq, Dh = 16, 256
        Hkv = k_cache.shape[1]
        rep = Hq // Hkv
        q = (lambda x, *d: x.permute(*d))((x @ wq).reshape(B, Sq, Hq, Dh), 0, 2, 1, 3)
        k = (lambda x, n, axis: torch.repeat_interleave(x, n, dim=axis))(k_cache, rep, axis=1)
        v = (lambda x, n, axis: torch.repeat_interleave(x, n, dim=axis))(v_cache, rep, axis=1)
        scores = torch.einsum("bhqd,bhkd->bhqk", q, k) * (Dh ** -0.5)
        p = _softmax(scores, axis=-1)
        o = torch.einsum("bhqk,bhkd->bhqd", p, v)
        return (lambda x, *d: x.permute(*d))(o, 0, 2, 1, 3).reshape(B, Sq, Hq * Dh) @ wo

    a = _A_ref(A_x, A_k_cache, A_v_cache, A_wq, A_wo)
    b = _B_ref(B_x, B_k_cache, B_v_cache, B_wq, B_wo)
    return torch.concatenate([a, b], axis=-1)
```

```asm
; @launch grid=(256,1,1) block=(256,1,1) lds=163840
.amdgcn_target "amdgcn-amd-amdhsa--gfx950"
.macro Mvvv d,a,b
v_mfma_f32_16x16x32_bf16 v[\d:\d+3], v[\a:\a+3], v[\b:\b+3], v[\d:\d+3]
.endm
.macro Mvva d,a,b
v_mfma_f32_16x16x32_bf16 v[\d:\d+3], v[\a:\a+3], a[\b:\b+3], v[\d:\d+3]
.endm
.macro Mvav d,a,b
v_mfma_f32_16x16x32_bf16 v[\d:\d+3], a[\a:\a+3], v[\b:\b+3], v[\d:\d+3]
.endm
.macro Mvaa d,a,b
v_mfma_f32_16x16x32_bf16 v[\d:\d+3], a[\a:\a+3], a[\b:\b+3], v[\d:\d+3]
.endm
.macro Mavv d,a,b
v_mfma_f32_16x16x32_bf16 a[\d:\d+3], v[\a:\a+3], v[\b:\b+3], a[\d:\d+3]
.endm
.macro Mava d,a,b
v_mfma_f32_16x16x32_bf16 a[\d:\d+3], v[\a:\a+3], a[\b:\b+3], a[\d:\d+3]
.endm
.macro Maav d,a,b
v_mfma_f32_16x16x32_bf16 a[\d:\d+3], a[\a:\a+3], v[\b:\b+3], a[\d:\d+3]
.endm
.macro Maaa d,a,b
v_mfma_f32_16x16x32_bf16 a[\d:\d+3], a[\a:\a+3], a[\b:\b+3], a[\d:\d+3]
.endm
.macro Tv d,r,o
ds_read_b64_tr_b16 v[\d:\d+1], v\r offset:\o
.endm
.macro Bv d,r,o
ds_read_b128 v[\d:\d+3], v\r offset:\o
.endm
.macro Ta d,r,o
ds_read_b64_tr_b16 a[\d:\d+1], v\r offset:\o
.endm
.macro Ba d,r,o
ds_read_b128 a[\d:\d+3], v\r offset:\o
.endm
.macro WL n
s_waitcnt lgkmcnt(\n)
.endm
.macro CV d,a,b
v_cvt_pk_bf16_f32 v\d, v\a, v\b
.endm
.macro AR d,a
v_accvgpr_read_b32 v\d, a\a
.endm
.macro AW d,a
v_accvgpr_write_b32 a\d, v\a
.endm
.macro DN v,s,t,o
buffer_load_dwordx4 v\v, s[\s:\s+3], s\t offen offset:\o nt lds
.endm
.macro DD v,s,t,o
buffer_load_dwordx4 v\v, s[\s:\s+3], s\t offen offset:\o lds
.endm
.text
.p2align 8
LB_start:
s_nop 4
v_lshrrev_b32 v3, 5, v2
v_and_b32 v4, 31, v2
s_lshl_b32 s32, s6, 22
s_lshl_b32 s7, s3, 19
s_add_u32 s32, s32, s7
s_lshl_b32 s34, s3, 10
s_mul_i32 s33, s6, 100352
s_mul_i32 s35, s3, 458752
s_and_b32 s7, s3, 1
s_mul_i32 s7, s7, 3
s_add_u32 s7, s7, s47
s_sub_u32 s5, s7, 7
s_cselect_b32 s7, s7, s5
s_lshl_b32 s40, s7, 7
s_add_u32 s7, s40, 128
s_cmp_eq_u32 s7, 896
s_cselect_b32 s41, 0, s7
s_add_u32 s7, s41, 128
s_cmp_eq_u32 s7, 896
s_cselect_b32 s42, 0, s7
s_add_u32 s7, s42, 128
s_cmp_eq_u32 s7, 896
s_cselect_b32 s43, 0, s7
s_add_u32 s7, s43, 128
s_cmp_eq_u32 s7, 896
s_cselect_b32 s44, 0, s7
s_add_u32 s7, s44, 128
s_cmp_eq_u32 s7, 896
s_cselect_b32 s45, 0, s7
s_add_u32 s7, s45, 128
s_cmp_eq_u32 s7, 896
s_cselect_b32 s46, 0, s7
v_lshrrev_b32 v5, 3, v2
v_mul_u32_u24 v5, 896, v5
v_lshrrev_b32 v6, 4, v2
v_and_b32 v7, 7, v2
v_xor_b32 v6, v6, v7
v_lshlrev_b32 v6, 4, v6
v_add_u32 v80, v5, v6
v_xor_b32 v6, 64, v6
v_add_u32 v81, v5, v6
v_add_u32 v81, 6144, v81
v_add_u32 v82, 12288, v80
v_add_u32 v83, 12288, v81
v_lshlrev_b32 v5, 1, v3
v_xor_b32 v5, v4, v5
v_lshlrev_b32 v5, 4, v5
v_lshl_add_u32 v76, v3, 13, v5
v_xor_b32 v77, 64, v76
v_add_u32 v77, 15360, v77
v_xor_b32 v78, 128, v76
v_add_u32 v78, 63488, v78
v_xor_b32 v79, 192, v76
v_add_u32 v79, 78848, v79
v_lshl_add_u32 v72, v3, 9, v5
v_xor_b32 v73, 64, v72
v_xor_b32 v74, 128, v72
v_xor_b32 v75, 192, v72
s_lshl_b32 s98, s58, 12
s_mul_i32 s63, s58, 28672
s_add_u32 s63, s63, s33
s_and_b32 s7, s58, 1
s_lshl_b32 s7, s7, 17
s_add_u32 s99, s34, s7
s_lshr_b32 s7, s58, 1
s_lshl_b32 s7, s7, 15
s_add_u32 s99, s99, s7
WL 0
s_mov_b32 s24, s84
s_mov_b32 s25, s85
s_mov_b32 s26, 1605632
s_mov_b32 s27, 0x20000
s_mov_b32 s16, s90
s_mov_b32 s17, s91
s_mov_b32 s18, 3670016
s_mov_b32 s19, 0x20000
s_add_u32 m0, s98, 81920
s_add_u32 s36, s63, s40
DD 80,24,36,0
DD 81,24,36,1024
s_add_u32 m0, s98, 114688
s_lshl_b32 s36, s40, 12
s_add_u32 s36, s36, s99
DD 76,16,36,0
DD 77,16,36,1024
DD 78,16,36,2048
DD 79,16,36,3072
s_add_u32 m0, s98, 131072
s_lshl_b32 s36, s40, 12
s_add_u32 s36, s36, s99
s_add_u32 s36, s36, 262144
DD 76,16,36,0
DD 77,16,36,1024
DD 78,16,36,2048
DD 79,16,36,3072
s_add_u32 m0, s98, 65536
s_add_u32 s36, s63, s41
DD 80,24,36,0
DD 81,24,36,1024
s_mov_b32 s8, s86
s_mov_b32 s9, s87
s_mov_b32 s10, 67108864
s_mov_b32 s11, 0x20000
s_mov_b32 s12, s88
s_mov_b32 s13, s89
s_mov_b32 s14, 67108864
s_mov_b32 s15, 0x20000
s_mov_b32 s20, s92
s_mov_b32 s21, s93
s_mov_b32 s22, 3670016
s_mov_b32 s23, 0x20000
v_xor_b32 v5, v4, v3
v_lshlrev_b32 v5, 4, v5
v_lshl_add_u32 v64, v3, 9, v5
v_xor_b32 v65, 32, v64
v_xor_b32 v66, 64, v64
v_xor_b32 v67, 96, v64
v_xor_b32 v68, 128, v64
v_xor_b32 v69, 160, v64
v_xor_b32 v70, 192, v64
v_xor_b32 v71, 224, v64
v_min_u32 v5, 1, v2
v_lshlrev_b32 v5, 31, v5
s_lshl_b32 s7, s3, 2
v_add_u32 v84, s7, v5
v_mov_b32 v85, 1
s_mov_b32 s28, s94
s_mov_b32 s29, s95
s_mov_b32 s30, 26738688
s_mov_b32 s31, 0x20000
s_mul_i32 s39, s2, 100352
s_mov_b32 s37, 0x3db8aa3b
s_mov_b32 s38, 0x41000000
s_mov_b32 s49, 0
s_add_u32 s51, s3, s47
s_sub_u32 s5, s51, 7
s_cselect_b32 s51, s51, s5
s_cmp_eq_u32 s3, 7
s_cselect_b32 s50, 7, s51
s_and_b32 s5, s2, 0xf8
s_lshl_b32 s5, s5, 7
s_add_u32 s62, s5, 25690112
v_and_b32 v8, 15, v2
v_lshrrev_b32 v9, 4, v2
s_lshl_b32 s7, s58, 12
v_lshl_add_u32 v244, v2, 4, s7
v_lshrrev_b32 v5, 1, v8
v_xor_b32 v5, v5, v9
v_lshlrev_b32 v5, 4, v5
v_lshl_add_u32 v208, v8, 7, v5
v_add_u32 v208, s7, v208
v_add_u32 v208, 0x8000, v208
v_xor_b32 v209, 64, v208
v_xor_b32 v5, v8, v9
v_lshlrev_b32 v5, 4, v5
v_lshl_add_u32 v224, v8, 9, v5
v_xor_b32 v225, 64, v224
v_xor_b32 v226, 128, v224
v_xor_b32 v227, 192, v224
v_lshrrev_b32 v5, 2, v2
v_lshlrev_b32 v6, 9, v5
v_and_b32 v5, 7, v5
v_lshl_add_u32 v6, v5, 5, v6
v_and_b32 v5, 3, v2
v_lshl_add_u32 v6, v5, 3, v6
v_add_u32 v236, 0x18000, v6
v_add_u32 v228, 0x10000, v6
v_xor_b32 v237, 32, v236
v_xor_b32 v238, 64, v236
v_xor_b32 v239, 96, v236
v_xor_b32 v240, 128, v236
v_xor_b32 v241, 160, v236
v_xor_b32 v242, 192, v236
v_xor_b32 v243, 224, v236
v_xor_b32 v229, 32, v228
v_xor_b32 v230, 64, v228
v_xor_b32 v231, 96, v228
v_xor_b32 v232, 128, v228
v_xor_b32 v233, 160, v228
v_xor_b32 v234, 192, v228
v_xor_b32 v235, 224, v228
s_waitcnt vmcnt(6) lgkmcnt(0)
s_barrier
Ba 128,208,49152
Ba 132,209,49152
Ta 240,236,16384
Ta 242,236,24576
Ta 244,237,16384
Ta 246,237,24576
Ta 248,238,16384
Ta 250,238,24576
Ta 252,239,16384
Ta 254,239,24576
Tv 96,240,16384
Tv 98,240,24576
WL 6
v_mfma_f32_16x16x32_bf16 v[0:3], a[240:243], a[128:131], 0
Tv 100,241,16384
Tv 102,241,24576
s_add_u32 m0, s98, 147456
s_lshl_b32 s36, s41, 12
s_add_u32 s36, s36, s99
DD 76,16,36,0
v_mfma_f32_16x16x32_bf16 v[4:7], a[244:247], a[128:131], 0
Tv 104,242,16384
Tv 106,242,24576
DD 77,16,36,1024
WL 6
v_mfma_f32_16x16x32_bf16 v[8:11], a[248:251], a[128:131], 0
Ta 240,243,16384
Ta 242,243,24576
DD 78,16,36,2048
v_mfma_f32_16x16x32_bf16 v[12:15], a[252:255], a[128:131], 0
Ta 244,236,16640
Ta 246,236,24832
DD 79,16,36,3072
WL 6
v_mfma_f32_16x16x32_bf16 v[16:19], v[96:99], a[128:131], 0
Ta 248,237,16640
Ta 250,237,24832
v_mfma_f32_16x16x32_bf16 v[20:23], v[100:103], a[128:131], 0
Ta 252,238,16640
Ta 254,238,24832
s_add_u32 m0, s98, 49152
s_add_u32 s36, s63, s42
DD 80,24,36,0
WL 6
v_mfma_f32_16x16x32_bf16 v[24:27], v[104:107], a[128:131], 0
Tv 96,239,16640
Tv 98,239,24832
DD 81,24,36,1024
v_mfma_f32_16x16x32_bf16 v[28:31], a[240:243], a[128:131], 0
Tv 100,240,16640
Tv 102,240,24832
s_add_u32 m0, s98, 98304
s_lshl_b32 s36, s41, 12
s_add_u32 s36, s36, s99
s_add_u32 s36, s36, 262144
DD 76,16,36,0
WL 6
v_mfma_f32_16x16x32_bf16 v[32:35], a[244:247], a[128:131], 0
Tv 104,241,16640
Tv 106,241,24832
v_mfma_f32_16x16x32_bf16 v[36:39], a[248:251], a[128:131], 0
Ta 240,242,16640
Ta 242,242,24832
DD 77,16,36,1024
WL 6
v_mfma_f32_16x16x32_bf16 v[40:43], a[252:255], a[128:131], 0
Ta 244,243,16640
Ta 246,243,24832
DD 78,16,36,2048
v_mfma_f32_16x16x32_bf16 v[44:47], v[96:99], a[128:131], 0
DD 79,16,36,3072
WL 4
v_mfma_f32_16x16x32_bf16 v[48:51], v[100:103], a[128:131], 0
v_mfma_f32_16x16x32_bf16 v[52:55], v[104:107], a[128:131], 0
s_waitcnt vmcnt(12) lgkmcnt(0)
s_barrier
Ta 248,236,32768
Ta 250,236,40960
Ta 252,237,32768
Ta 254,237,40960
Tv 96,238,32768
Tv 98,238,40960
v_mfma_f32_16x16x32_bf16 v[56:59], a[240:243], a[128:131], 0
Tv 100,239,32768
Tv 102,239,40960
s_add_u32 m0, s98, 81920
s_add_u32 s36, s63, s43
DD 80,24,36,0
DD 81,24,36,1024
v_mfma_f32_16x16x32_bf16 v[60:63], a[244:247], a[128:131], 0
Tv 104,240,32768
Tv 106,240,40960
s_add_u32 m0, s98, 114688
s_lshl_b32 s36, s42, 12
s_add_u32 s36, s36, s99
DD 76,16,36,0
WL 6
Mvaa 0,248,132
Ta 240,241,32768
Ta 242,241,40960
DD 77,16,36,1024
DD 78,16,36,2048
Mvaa 4,252,132
Ta 244,242,32768
Ta 246,242,40960
DD 79,16,36,3072
WL 6
Mvva 8,96,132
Ta 248,243,32768
Ta 250,243,40960
s_mov_b32 m0, 0
s_add_u32 s36, s32, 0
DN 64,8,36,0
DN 65,8,36,1024
Mvva 12,100,132
Ta 252,236,33024
Ta 254,236,41216
DN 66,8,36,2048
WL 6
Mvva 16,104,132
Tv 96,237,33024
Tv 98,237,41216
DN 67,8,36,3072
s_mov_b32 m0, 4096
s_add_u32 s36, s32, 4096
DN 68,8,36,0
Mvaa 20,240,132
Tv 100,238,33024
Tv 102,238,41216
DN 69,8,36,1024
WL 6
Mvaa 24,244,132
Tv 104,239,33024
Tv 106,239,41216
DN 70,8,36,2048
DN 71,8,36,3072
Mvaa 28,248,132
Ta 240,240,33024
Ta 242,240,41216
s_mov_b32 m0, 8192
s_add_u32 s36, s32, 8192
DN 64,8,36,0
WL 6
Mvaa 32,252,132
Ta 244,241,33024
Ta 246,241,41216
DN 65,8,36,1024
DN 66,8,36,2048
Mvva 36,96,132
Ta 248,242,33024
Ta 250,242,41216
DN 67,8,36,3072
WL 6
Mvva 40,100,132
Ta 252,243,33024
Ta 254,243,41216
s_mov_b32 m0, 12288
s_add_u32 s36, s32, 12288
DN 68,8,36,0
DN 69,8,36,1024
Mvva 44,104,132
DN 70,8,36,2048
WL 4
Mvaa 48,240,132
DN 71,8,36,3072
Mvaa 52,244,132
s_waitcnt vmcnt(28) lgkmcnt(0)
s_barrier
Ba 136,208,32768
Ba 140,209,32768
Tv 96,236,49152
Tv 98,236,57344
Tv 100,237,49152
Tv 102,237,57344
Tv 104,238,49152
Tv 106,238,57344
Mvaa 56,248,132
Ta 240,239,49152
Ta 242,239,57344
s_add_u32 m0, s98, 131072
s_lshl_b32 s36, s42, 12
s_add_u32 s36, s36, s99
s_add_u32 s36, s36, 262144
DD 76,16,36,0
DD 77,16,36,1024
Mvaa 60,252,132
Ta 244,240,49152
Ta 246,240,57344
DD 78,16,36,2048
WL 6
Mvva 0,96,136
Ta 248,241,49152
Ta 250,241,57344
DD 79,16,36,3072
Mvva 4,100,136
Ta 252,242,49152
Ta 254,242,57344
s_mov_b32 m0, 16384
s_add_u32 s36, s32, 16384
DN 64,8,36,0
DN 65,8,36,1024
WL 6
Mvva 8,104,136
Tv 96,243,49152
Tv 98,243,57344
DN 66,8,36,2048
Mvaa 12,240,136
Tv 100,236,49408
Tv 102,236,57600
DN 67,8,36,3072
WL 6
Mvaa 16,244,136
Tv 104,237,49408
Tv 106,237,57600
s_mov_b32 m0, 20480
s_add_u32 s36, s32, 20480
DN 68,8,36,0
DN 69,8,36,1024
Mvaa 20,248,136
Ta 240,238,49408
Ta 242,238,57600
DN 70,8,36,2048
WL 6
Mvaa 24,252,136
Ta 244,239,49408
Ta 246,239,57600
DN 71,8,36,3072
Mvva 28,96,136
Ta 248,240,49408
Ta 250,240,57600
s_mov_b32 m0, 24576
s_add_u32 s36, s32, 24576
DN 64,8,36,0
DN 65,8,36,1024
WL 6
Mvva 32,100,136
Ta 252,241,49408
Ta 254,241,57600
DN 66,8,36,2048
Mvva 36,104,136
Tv 96,242,49408
Tv 98,242,57600
DN 67,8,36,3072
WL 6
Mvaa 40,240,136
Tv 100,243,49408
Tv 102,243,57600
s_mov_b32 m0, 28672
s_add_u32 s36, s32, 28672
DN 68,8,36,0
DN 69,8,36,1024
Mvaa 44,244,136
DN 70,8,36,2048
WL 4
Mvaa 48,248,136
DN 71,8,36,3072
Mvaa 52,252,136
s_waitcnt vmcnt(42) lgkmcnt(0)
s_barrier
Ba 144,208,16384
Ba 148,209,16384
Tv 104,236,0
Tv 106,236,8192
Ta 240,237,0
Ta 242,237,8192
Ta 244,238,0
Ta 246,238,8192
Mvva 56,96,136
Ta 248,239,0
Ta 250,239,8192
s_add_u32 m0, s98, 65536
s_add_u32 s36, s63, s44
DD 80,24,36,0
Mvva 60,100,136
Ta 252,240,0
Ta 254,240,8192
WL 6
Mvva 0,104,140
Tv 96,241,0
Tv 98,241,8192
DD 81,24,36,1024
Mvaa 4,240,140
Tv 100,242,0
Tv 102,242,8192
WL 6
Mvaa 8,244,140
Tv 104,243,0
Tv 106,243,8192
Mvaa 12,248,140
Ta 240,236,256
Ta 242,236,8448
s_add_u32 m0, s98, 147456
s_lshl_b32 s36, s43, 12
s_add_u32 s36, s36, s99
DD 76,16,36,0
WL 6
Mvaa 16,252,140
Ta 244,237,256
Ta 246,237,8448
Mvva 20,96,140
Ta 248,238,256
Ta 250,238,8448
DD 77,16,36,1024
WL 6
Mvva 24,100,140
Ta 252,239,256
Ta 254,239,8448
Mvva 28,104,140
Tv 96,240,256
Tv 98,240,8448
WL 6
Mvaa 32,240,140
Tv 100,241,256
Tv 102,241,8448
DD 78,16,36,2048
Mvaa 36,244,140
Tv 104,242,256
Tv 106,242,8448
WL 6
Mvaa 40,248,140
Ta 240,243,256
Ta 242,243,8448
DD 79,16,36,3072
Mvaa 44,252,140
WL 4
Mvva 48,96,140
Mvva 52,100,140
s_waitcnt vmcnt(42) lgkmcnt(0)
s_barrier
Ba 152,208,49152
Ba 156,209,49152
Ta 244,236,16384
Ta 246,236,24576
Ta 248,237,16384
Ta 250,237,24576
Ta 252,238,16384
Ta 254,238,24576
Mvva 56,104,140
Tv 96,239,16384
Tv 98,239,24576
s_add_u32 m0, s98, 49152
s_add_u32 s36, s63, s45
DD 80,24,36,0
DD 81,24,36,1024
Mvaa 60,240,140
Tv 100,240,16384
Tv 102,240,24576
s_add_u32 m0, s98, 98304
s_lshl_b32 s36, s43, 12
s_add_u32 s36, s36, s99
s_add_u32 s36, s36, 262144
DD 76,16,36,0
WL 6
Mvaa 0,244,144
Tv 104,241,16384
Tv 106,241,24576
DD 77,16,36,1024
DD 78,16,36,2048
Mvaa 4,248,144
Ta 240,242,16384
Ta 242,242,24576
DD 79,16,36,3072
WL 6
Mvaa 8,252,144
Ta 244,243,16384
Ta 246,243,24576
s_mov_b32 m0, 32768
s_add_u32 s36, s32, 0
DN 72,12,36,0
DN 73,12,36,1024
Mvva 12,96,144
Ta 248,236,16640
Ta 250,236,24832
DN 74,12,36,2048
WL 6
Mvva 16,100,144
Ta 252,237,16640
Ta 254,237,24832
DN 75,12,36,3072
s_mov_b32 m0, 36864
s_add_u32 s36, s32, 4096
DN 72,12,36,0
Mvva 20,104,144
Tv 96,238,16640
Tv 98,238,24832
DN 73,12,36,1024
WL 6
Mvaa 24,240,144
Tv 100,239,16640
Tv 102,239,24832
DN 74,12,36,2048
DN 75,12,36,3072
Mvaa 28,244,144
Tv 104,240,16640
Tv 106,240,24832
s_mov_b32 m0, 40960
s_add_u32 s36, s32, 8192
DN 72,12,36,0
WL 6
Mvaa 32,248,144
Ta 240,241,16640
Ta 242,241,24832
DN 73,12,36,1024
DN 74,12,36,2048
Mvaa 36,252,144
Ta 244,242,16640
Ta 246,242,24832
DN 75,12,36,3072
WL 6
Mvva 40,96,144
Ta 248,243,16640
Ta 250,243,24832
s_mov_b32 m0, 45056
s_add_u32 s36, s32, 12288
DN 72,12,36,0
DN 73,12,36,1024
Mvva 44,100,144
DN 74,12,36,2048
WL 4
Mvva 48,104,144
DN 75,12,36,3072
Mvaa 52,240,144
s_waitcnt vmcnt(26) lgkmcnt(0)
s_barrier
Ba 160,208,32768
Ba 164,209,32768
Ta 252,236,32768
Ta 254,236,40960
Tv 96,237,32768
Tv 98,237,40960
Tv 100,238,32768
Tv 102,238,40960
Mvaa 56,244,144
Tv 104,239,32768
Tv 106,239,40960
s_add_u32 m0, s98, 81920
s_add_u32 s36, s63, s46
DD 80,24,36,0
Mvaa 60,248,144
Ta 240,240,32768
Ta 242,240,40960
WL 6
Mvaa 0,252,148
Ta 244,241,32768
Ta 246,241,40960
DD 81,24,36,1024
Mvva 4,96,148
Ta 248,242,32768
Ta 250,242,40960
WL 6
Mvva 8,100,148
Ta 252,243,32768
Ta 254,243,40960
Mvva 12,104,148
Tv 96,236,33024
Tv 98,236,41216
s_add_u32 m0, s98, 114688
s_lshl_b32 s36, s44, 12
s_add_u32 s36, s36, s99
DD 76,16,36,0
WL 6
Mvaa 16,240,148
Tv 100,237,33024
Tv 102,237,41216
Mvaa 20,244,148
Tv 104,238,33024
Tv 106,238,41216
DD 77,16,36,1024
WL 6
Mvaa 24,248,148
Ta 240,239,33024
Ta 242,239,41216
Mvaa 28,252,148
Ta 244,240,33024
Ta 246,240,41216
WL 6
Mvva 32,96,148
Ta 248,241,33024
Ta 250,241,41216
DD 78,16,36,2048
Mvva 36,100,148
Ta 252,242,33024
Ta 254,242,41216
WL 6
Mvva 40,104,148
Tv 96,243,33024
Tv 98,243,41216
DD 79,16,36,3072
Mvaa 44,240,148
WL 4
Mvaa 48,244,148
Mvaa 52,248,148
s_waitcnt vmcnt(26) lgkmcnt(0)
s_barrier
Ba 168,208,16384
Ba 172,209,16384
Tv 100,236,49152
Tv 102,236,57344
Tv 104,237,49152
Tv 106,237,57344
Ta 240,238,49152
Ta 242,238,57344
Mvaa 56,252,148
Ta 244,239,49152
Ta 246,239,57344
s_add_u32 m0, s98, 131072
s_lshl_b32 s36, s44, 12
s_add_u32 s36, s36, s99
s_add_u32 s36, s36, 262144
DD 76,16,36,0
DD 77,16,36,1024
Mvva 60,96,148
Ta 248,240,49152
Ta 250,240,57344
DD 78,16,36,2048
WL 6
Mvva 0,100,152
Ta 252,241,49152
Ta 254,241,57344
DD 79,16,36,3072
Mvva 4,104,152
Tv 96,242,49152
Tv 98,242,57344
s_mov_b32 m0, 65536
s_add_u32 s36, s32, 32768
DN 64,8,36,0
DN 65,8,36,1024
WL 6
Mvaa 8,240,152
Tv 100,243,49152
Tv 102,243,57344
DN 66,8,36,2048
Mvaa 12,244,152
Tv 104,236,49408
Tv 106,236,57600
DN 67,8,36,3072
WL 6
Mvaa 16,248,152
Ta 240,237,49408
Ta 242,237,57600
s_mov_b32 m0, 69632
s_add_u32 s36, s32, 36864
DN 68,8,36,0
DN 69,8,36,1024
Mvaa 20,252,152
Ta 244,238,49408
Ta 246,238,57600
DN 70,8,36,2048
WL 6
Mvva 24,96,152
Ta 248,239,49408
Ta 250,239,57600
DN 71,8,36,3072
Mvva 28,100,152
Ta 252,240,49408
Ta 254,240,57600
s_mov_b32 m0, 73728
s_add_u32 s36, s32, 40960
DN 64,8,36,0
DN 65,8,36,1024
WL 6
Mvva 32,104,152
Tv 96,241,49408
Tv 98,241,57600
DN 66,8,36,2048
Mvaa 36,240,152
Tv 100,242,49408
Tv 102,242,57600
DN 67,8,36,3072
WL 6
Mvaa 40,244,152
Tv 104,243,49408
Tv 106,243,57600
s_mov_b32 m0, 77824
s_add_u32 s36, s32, 45056
DN 68,8,36,0
DN 69,8,36,1024
Mvaa 44,248,152
DN 70,8,36,2048
WL 4
Mvaa 48,252,152
DN 71,8,36,3072
Mvva 52,96,152
s_waitcnt vmcnt(24) lgkmcnt(0)
s_barrier
Ba 176,208,49152
Ba 180,209,49152
Ta 240,236,0
Ta 242,236,8192
Ta 244,237,0
Ta 246,237,8192
Ta 248,238,0
Ta 250,238,8192
Mvva 56,100,152
Ta 252,239,0
Ta 254,239,8192
s_add_u32 m0, s98, 147456
s_lshl_b32 s36, s45, 12
s_add_u32 s36, s36, s99
DD 76,16,36,0
DD 77,16,36,1024
Mvva 60,104,152
Tv 96,240,0
Tv 98,240,8192
DD 78,16,36,2048
WL 6
Mvaa 0,240,156
Tv 100,241,0
Tv 102,241,8192
DD 79,16,36,3072
Mvaa 4,244,156
Tv 104,242,0
Tv 106,242,8192
s_mov_b32 m0, 49152
s_add_u32 s36, s32, 16384
DN 72,12,36,0
DN 73,12,36,1024
WL 6
Mvaa 8,248,156
Ta 240,243,0
Ta 242,243,8192
DN 74,12,36,2048
Mvaa 12,252,156
Ta 244,236,256
Ta 246,236,8448
DN 75,12,36,3072
WL 6
Mvva 16,96,156
Ta 248,237,256
Ta 250,237,8448
s_mov_b32 m0, 53248
s_add_u32 s36, s32, 20480
DN 72,12,36,0
DN 73,12,36,1024
Mvva 20,100,156
Ta 252,238,256
Ta 254,238,8448
DN 74,12,36,2048
WL 6
Mvva 24,104,156
Tv 96,239,256
Tv 98,239,8448
DN 75,12,36,3072
Mvaa 28,240,156
Tv 100,240,256
Tv 102,240,8448
s_mov_b32 m0, 57344
s_add_u32 s36, s32, 24576
DN 72,12,36,0
DN 73,12,36,1024
WL 6
Mvaa 32,244,156
Tv 104,241,256
Tv 106,241,8448
DN 74,12,36,2048
Mvaa 36,248,156
Ta 240,242,256
Ta 242,242,8448
DN 75,12,36,3072
WL 6
Mvaa 40,252,156
Ta 244,243,256
Ta 246,243,8448
s_mov_b32 m0, 61440
s_add_u32 s36, s32, 28672
DN 72,12,36,0
DN 73,12,36,1024
Mvva 44,96,156
DN 74,12,36,2048
WL 4
Mvva 48,100,156
DN 75,12,36,3072
Mvva 52,104,156
s_waitcnt vmcnt(40) lgkmcnt(0)
s_barrier
Ta 248,236,16384
Ta 250,236,24576
Ta 252,237,16384
Ta 254,237,24576
Tv 96,238,16384
Tv 98,238,24576
Mvaa 56,240,156
Tv 100,239,16384
Tv 102,239,24576
s_add_u32 m0, s98, 98304
s_lshl_b32 s36, s45, 12
s_add_u32 s36, s36, s99
s_add_u32 s36, s36, 262144
DD 76,16,36,0
DD 77,16,36,1024
Mvaa 60,244,156
Tv 104,240,16384
Tv 106,240,24576
DD 78,16,36,2048
WL 6
Mvaa 0,248,160
Ta 240,241,16384
Ta 242,241,24576
DD 79,16,36,3072
Mvaa 4,252,160
Ta 244,242,16384
Ta 246,242,24576
s_mov_b32 m0, 81920
s_add_u32 s36, s32, 49152
DN 64,8,36,0
DN 65,8,36,1024
WL 6
Mvva 8,96,160
Ta 248,243,16384
Ta 250,243,24576
DN 66,8,36,2048
Mvva 12,100,160
Ta 252,236,16640
Ta 254,236,24832
DN 67,8,36,3072
WL 6
Mvva 16,104,160
Tv 96,237,16640
Tv 98,237,24832
s_mov_b32 m0, 86016
s_add_u32 s36, s32, 53248
DN 68,8,36,0
DN 69,8,36,1024
Mvaa 20,240,160
Tv 100,238,16640
Tv 102,238,24832
DN 70,8,36,2048
WL 6
Mvaa 24,244,160
Tv 104,239,16640
Tv 106,239,24832
DN 71,8,36,3072
Mvaa 28,248,160
Ta 240,240,16640
Ta 242,240,24832
s_mov_b32 m0, 90112
s_add_u32 s36, s32, 57344
DN 64,8,36,0
DN 65,8,36,1024
WL 6
Mvaa 32,252,160
Ta 244,241,16640
Ta 246,241,24832
DN 66,8,36,2048
Mvva 36,96,160
Ta 248,242,16640
Ta 250,242,24832
DN 67,8,36,3072
WL 6
Mvva 40,100,160
Ta 252,243,16640
Ta 254,243,24832
s_mov_b32 m0, 94208
s_add_u32 s36, s32, 61440
DN 68,8,36,0
DN 69,8,36,1024
Mvva 44,104,160
DN 70,8,36,2048
WL 4
Mvaa 48,240,160
DN 71,8,36,3072
Mvaa 52,244,160
s_waitcnt vmcnt(56) lgkmcnt(0)
s_barrier
Tv 96,236,32768
Tv 98,236,40960
Tv 100,237,32768
Tv 102,237,40960
Tv 104,238,32768
Tv 106,238,40960
Mvaa 56,248,160
Ta 240,239,32768
Ta 242,239,40960
s_add_u32 m0, s98, 114688
s_lshl_b32 s36, s46, 12
s_add_u32 s36, s36, s99
DD 76,16,36,0
Mvaa 60,252,160
Ta 244,240,32768
Ta 246,240,40960
WL 6
Mvva 0,96,164
Ta 248,241,32768
Ta 250,241,40960
Mvva 4,100,164
Ta 252,242,32768
Ta 254,242,40960
DD 77,16,36,1024
WL 6
Mvva 8,104,164
Tv 96,243,32768
Tv 98,243,40960
Mvaa 12,240,164
Tv 100,236,33024
Tv 102,236,41216
WL 6
Mvaa 16,244,164
Tv 104,237,33024
Tv 106,237,41216
Mvaa 20,248,164
Ta 240,238,33024
Ta 242,238,41216
DD 78,16,36,2048
WL 6
Mvaa 24,252,164
Ta 244,239,33024
Ta 246,239,41216
Mvva 28,96,164
Ta 248,240,33024
Ta 250,240,41216
WL 6
Mvva 32,100,164
Ta 252,241,33024
Ta 254,241,41216
Mvva 36,104,164
Tv 96,242,33024
Tv 98,242,41216
DD 79,16,36,3072
WL 6
Mvaa 40,240,164
Tv 100,243,33024
Tv 102,243,41216
Mvaa 44,244,164
WL 4
Mvaa 48,248,164
Mvaa 52,252,164
s_waitcnt vmcnt(40) lgkmcnt(0)
s_barrier
Tv 104,236,49152
Tv 106,236,57344
Ta 240,237,49152
Ta 242,237,57344
Ta 244,238,49152
Ta 246,238,57344
Mvva 56,96,164
Ta 248,239,49152
Ta 250,239,57344
s_add_u32 m0, s98, 131072
s_lshl_b32 s36, s46, 12
s_add_u32 s36, s36, s99
s_add_u32 s36, s36, 262144
DD 76,16,36,0
Mvva 60,100,164
Ta 252,240,49152
Ta 254,240,57344
WL 6
Mvva 0,104,168
Tv 96,241,49152
Tv 98,241,57344
Mvaa 4,240,168
Tv 100,242,49152
Tv 102,242,57344
DD 77,16,36,1024
WL 6
Mvaa 8,244,168
Tv 104,243,49152
Tv 106,243,57344
Mvaa 12,248,168
Ta 240,236,49408
Ta 242,236,57600
WL 6
Mvaa 16,252,168
Ta 244,237,49408
Ta 246,237,57600
Mvva 20,96,168
Ta 248,238,49408
Ta 250,238,57600
DD 78,16,36,2048
WL 6
Mvva 24,100,168
Ta 252,239,49408
Ta 254,239,57600
Mvva 28,104,168
Tv 96,240,49408
Tv 98,240,57600
WL 6
Mvaa 32,240,168
Tv 100,241,49408
Tv 102,241,57600
Mvaa 36,244,168
Tv 104,242,49408
Tv 106,242,57600
DD 79,16,36,3072
WL 6
Mvaa 40,248,168
Ta 240,243,49408
Ta 242,243,57600
Mvaa 44,252,168
WL 4
Mvva 48,96,168
Mvva 52,100,168
s_waitcnt vmcnt(24) lgkmcnt(0)
s_barrier
Ta 244,236,0
Ta 246,236,8192
Ta 248,237,0
Ta 250,237,8192
Ta 252,238,0
Ta 254,238,8192
Mvva 56,104,168
Tv 96,239,0
Tv 98,239,8192
s_mov_b32 m0, 147456
s_add_u32 s36, s32, 32768
DN 72,12,36,0
DN 73,12,36,1024
Mvaa 60,240,168
Tv 100,240,0
Tv 102,240,8192
DN 74,12,36,2048
WL 6
Mvaa 0,244,172
Tv 104,241,0
Tv 106,241,8192
DN 75,12,36,3072
Mvaa 4,248,172
Ta 240,242,0
Ta 242,242,8192
s_mov_b32 m0, 151552
s_add_u32 s36, s32, 36864
DN 72,12,36,0
WL 6
Mvaa 8,252,172
Ta 244,243,0
Ta 246,243,8192
DN 73,12,36,1024
Mvva 12,96,172
Ta 248,236,256
Ta 250,236,8448
DN 74,12,36,2048
WL 6
Mvva 16,100,172
Ta 252,237,256
Ta 254,237,8448
DN 75,12,36,3072
Mvva 20,104,172
Tv 96,238,256
Tv 98,238,8448
s_mov_b32 m0, 155648
s_add_u32 s36, s32, 40960
DN 72,12,36,0
WL 6
Mvaa 24,240,172
Tv 100,239,256
Tv 102,239,8448
DN 73,12,36,1024
Mvaa 28,244,172
Tv 104,240,256
Tv 106,240,8448
DN 74,12,36,2048
WL 6
Mvaa 32,248,172
Ta 240,241,256
Ta 242,241,8448
DN 75,12,36,3072
Mvaa 36,252,172
Ta 244,242,256
Ta 246,242,8448
s_mov_b32 m0, 159744
s_add_u32 s36, s32, 45056
DN 72,12,36,0
WL 6
Mvva 40,96,172
Ta 248,243,256
Ta 250,243,8448
DN 73,12,36,1024
Mvva 44,100,172
DN 74,12,36,2048
WL 4
Mvva 48,104,172
DN 75,12,36,3072
Mvaa 52,240,172
s_waitcnt vmcnt(20) lgkmcnt(0)
s_barrier
Ta 252,236,16384
Ta 254,236,24576
Tv 96,237,16384
Tv 98,237,24576
Tv 100,238,16384
Tv 102,238,24576
Mvaa 56,244,172
Tv 104,239,16384
Tv 106,239,24576
s_mov_b32 m0, 98304
s_add_u32 s36, s32, 65536
DN 64,8,36,0
DN 65,8,36,1024
Mvaa 60,248,172
Ta 240,240,16384
Ta 242,240,24576
DN 66,8,36,2048
WL 6
Mvaa 0,252,176
Ta 244,241,16384
Ta 246,241,24576
DN 67,8,36,3072
Mvva 4,96,176
Ta 248,242,16384
Ta 250,242,24576
s_mov_b32 m0, 102400
s_add_u32 s36, s32, 69632
DN 68,8,36,0
WL 6
Mvva 8,100,176
Ta 252,243,16384
Ta 254,243,24576
DN 69,8,36,1024
Mvva 12,104,176
Tv 96,236,16640
Tv 98,236,24832
DN 70,8,36,2048
WL 6
Mvaa 16,240,176
Tv 100,237,16640
Tv 102,237,24832
DN 71,8,36,3072
Mvaa 20,244,176
Tv 104,238,16640
Tv 106,238,24832
s_mov_b32 m0, 106496
s_add_u32 s36, s32, 73728
DN 64,8,36,0
WL 6
Mvaa 24,248,176
Ta 240,239,16640
Ta 242,239,24832
DN 65,8,36,1024
Mvaa 28,252,176
Ta 244,240,16640
Ta 246,240,24832
DN 66,8,36,2048
WL 6
Mvva 32,96,176
Ta 248,241,16640
Ta 250,241,24832
DN 67,8,36,3072
Mvva 36,100,176
Ta 252,242,16640
Ta 254,242,24832
s_mov_b32 m0, 110592
s_add_u32 s36, s32, 77824
DN 68,8,36,0
WL 6
Mvva 40,104,176
Tv 96,243,16640
Tv 98,243,24832
DN 69,8,36,1024
Mvaa 44,240,176
DN 70,8,36,2048
WL 4
Mvaa 48,244,176
DN 71,8,36,3072
Mvaa 52,248,176
s_waitcnt vmcnt(32) lgkmcnt(0)
s_barrier
Tv 100,236,32768
Tv 102,236,40960
Tv 104,237,32768
Tv 106,237,40960
Ta 240,238,32768
Ta 242,238,40960
Mvaa 56,252,176
Ta 244,239,32768
Ta 246,239,40960
s_mov_b32 m0, 114688
s_add_u32 s36, s32, 49152
DN 72,12,36,0
DN 73,12,36,1024
Mvva 60,96,176
Ta 248,240,32768
Ta 250,240,40960
DN 74,12,36,2048
WL 6
Mvva 0,100,180
Ta 252,241,32768
Ta 254,241,40960
DN 75,12,36,3072
Mvva 4,104,180
Tv 96,242,32768
Tv 98,242,40960
s_mov_b32 m0, 118784
s_add_u32 s36, s32, 53248
DN 72,12,36,0
WL 6
Mvaa 8,240,180
Tv 100,243,32768
Tv 102,243,40960
DN 73,12,36,1024
Mvaa 12,244,180
Tv 104,236,33024
Tv 106,236,41216
DN 74,12,36,2048
WL 6
Mvaa 16,248,180
Ta 240,237,33024
Ta 242,237,41216
DN 75,12,36,3072
Mvaa 20,252,180
Ta 244,238,33024
Ta 246,238,41216
s_mov_b32 m0, 122880
s_add_u32 s36, s32, 57344
DN 72,12,36,0
CV 128,0,1
WL 6
Mvva 24,96,180
Ta 248,239,33024
Ta 250,239,41216
DN 73,12,36,1024
CV 129,2,3
CV 130,4,5
Mvva 28,100,180
Ta 252,240,33024
Ta 254,240,41216
DN 74,12,36,2048
CV 131,6,7
v_permlane32_swap_b32 v128, v130
s_nop 0
v_permlane32_swap_b32 v129, v131
WL 6
Mvva 32,104,180
Tv 96,241,33024
Tv 98,241,41216
DN 75,12,36,3072
v_permlane16_swap_b32 v128, v130
v_permlane16_swap_b32 v129, v131
CV 132,8,9
Mvaa 36,240,180
Tv 100,242,33024
Tv 102,242,41216
s_mov_b32 m0, 126976
s_add_u32 s36, s32, 61440
DN 72,12,36,0
WL 6
Mvaa 40,244,180
Tv 104,243,33024
Tv 106,243,41216
DN 73,12,36,1024
CV 133,10,11
CV 134,12,13
CV 135,14,15
Mvaa 44,248,180
DN 74,12,36,2048
v_permlane32_swap_b32 v132, v134
v_permlane32_swap_b32 v133, v135
s_nop 0
v_permlane16_swap_b32 v132, v134
v_permlane16_swap_b32 v133, v135
CV 136,16,17
WL 4
Mvaa 48,252,180
DN 75,12,36,3072
CV 137,18,19
CV 138,20,21
CV 139,22,23
s_nop 0
v_permlane32_swap_b32 v136, v138
v_permlane32_swap_b32 v137, v139
s_nop 0
v_permlane16_swap_b32 v136, v138
Mvva 52,96,180
s_waitcnt vmcnt(63) lgkmcnt(0)
s_barrier
Ba 240,224,0
Ba 244,224,8192
Ba 248,225,0
v_permlane16_swap_b32 v137, v139
Mvva 56,100,180
Ba 252,225,8192
s_mov_b32 m0, 131072
s_lshl_b32 s48, s40, 12
s_add_u32 s48, s48, s34
s_add_u32 s36, s48, 512
DD 76,16,36,0
DD 77,16,36,1024
Mvva 60,104,180
Bv 96,226,0
DD 78,16,36,2048
CV 140,24,25
CV 141,26,27
CV 142,28,29
WL 3
v_mfma_f32_16x16x32_bf16 v[192:195], a[240:243], v[128:131], 0
Bv 100,226,8192
DD 79,16,36,3072
CV 143,30,31
v_permlane32_swap_b32 v140, v142
s_nop 0
v_permlane32_swap_b32 v141, v143
v_permlane16_swap_b32 v140, v142
v_mfma_f32_16x16x32_bf16 v[196:199], a[244:247], v[128:131], 0
Bv 104,227,0
s_waitcnt vmcnt(23)
s_mov_b32 m0, 135168
s_add_u32 s36, s48, 131584
DD 76,16,36,0
v_permlane16_swap_b32 v141, v143
WL 3
Mvav 192,248,132
Ba 240,227,8192
DD 77,16,36,1024
CV 144,32,33
CV 145,34,35
CV 146,36,37
Mvav 196,252,132
Ba 244,224,256
DD 78,16,36,2048
CV 147,38,39
v_permlane32_swap_b32 v144, v146
WL 3
Mvvv 192,96,136
Ba 248,224,8448
DD 79,16,36,3072
v_permlane32_swap_b32 v145, v147
v_permlane16_swap_b32 v144, v146
s_nop 0
v_permlane16_swap_b32 v145, v147
Mvvv 196,100,136
Ba 252,225,256
s_waitcnt vmcnt(23)
s_mov_b32 m0, 139264
s_add_u32 s36, s48, 33280
DD 76,16,36,0
CV 148,40,41
CV 149,42,43
WL 3
Mvvv 192,104,140
Bv 96,225,8448
DD 77,16,36,1024
CV 150,44,45
CV 151,46,47
s_nop 0
v_permlane32_swap_b32 v148, v150
Mvav 196,240,140
Bv 100,226,256
DD 78,16,36,2048
v_permlane32_swap_b32 v149, v151
v_permlane16_swap_b32 v148, v150
s_nop 0
v_permlane16_swap_b32 v149, v151
WL 3
Mvav 192,244,144
Bv 104,226,8448
DD 79,16,36,3072
CV 152,48,49
CV 153,50,51
CV 154,52,53
CV 155,54,55
Mvav 196,248,144
Ba 240,227,256
s_waitcnt vmcnt(23)
s_mov_b32 m0, 143360
s_add_u32 s36, s48, 164352
DD 76,16,36,0
v_permlane32_swap_b32 v152, v154
WL 3
Mvav 192,252,148
Ba 244,227,8448
DD 77,16,36,1024
v_permlane32_swap_b32 v153, v155
v_permlane16_swap_b32 v152, v154
s_nop 0
v_permlane16_swap_b32 v153, v155
Mvvv 196,96,148
DD 78,16,36,2048
CV 156,56,57
CV 157,58,59
CV 158,60,61
CV 159,62,63
WL 2
Mvvv 192,100,152
DD 79,16,36,3072
v_permlane32_swap_b32 v156, v158
v_permlane32_swap_b32 v157, v159
s_nop 0
v_permlane16_swap_b32 v156, v158
v_permlane16_swap_b32 v157, v159
Mvvv 196,104,152
s_waitcnt vmcnt(63) lgkmcnt(0)
s_barrier
Ba 248,224,16384
Ba 252,224,24576
Bv 96,225,16384
Mvav 192,240,156
Bv 100,225,24576
s_waitcnt vmcnt(23)
s_mov_b32 m0, 0
s_lshl_b32 s48, s40, 12
s_add_u32 s48, s48, s34
s_add_u32 s36, s48, 262656
DD 76,16,36,0
Mvav 196,244,156
Bv 104,226,16384
DD 77,16,36,1024
WL 3
v_mfma_f32_16x16x32_bf16 v[208:211], a[248:251], v[128:131], 0
Ba 240,226,24576
v_mfma_f32_16x16x32_bf16 v[212:215], a[252:255], v[128:131], 0
Ba 244,227,16384
DD 78,16,36,2048
v_mul_f32 v192, s37, v192
v_mul_f32 v193, s37, v193
v_mul_f32 v194, s37, v194
WL 3
Mvvv 208,96,132
Ba 248,227,24576
v_mul_f32 v195, s37, v195
v_mul_f32 v196, s37, v196
v_mul_f32 v197, s37, v197
v_mul_f32 v198, s37, v198
Mvvv 212,100,132
Ba 252,224,16640
DD 79,16,36,3072
v_mul_f32 v199, s37, v199
v_max3_f32 v245, v192, v193, v194
v_max3_f32 v245, v245, v195, v196
WL 3
Mvvv 208,104,136
Bv 96,224,24832
v_max3_f32 v245, v245, v197, v198
v_max_f32 v245, v245, v199
v_mov_b32 v251, v245
s_nop 1
v_permlane32_swap_b32 v245, v251
Mvav 212,240,136
Bv 100,225,16640
s_waitcnt vmcnt(23)
s_mov_b32 m0, 4096
s_add_u32 s36, s48, 393728
DD 76,16,36,0
v_max_f32 v245, v245, v251
WL 3
Mvav 208,244,140
Bv 104,225,24832
v_mov_b32 v251, v245
s_nop 1
v_permlane16_swap_b32 v245, v251
v_max_f32 v245, v245, v251
v_sub_f32 v192, v192, v245
Mvav 212,248,140
Ba 240,226,16640
DD 77,16,36,1024
v_sub_f32 v193, v193, v245
v_sub_f32 v194, v194, v245
v_sub_f32 v195, v195, v245
WL 3
Mvav 208,252,144
Ba 244,226,24832
v_sub_f32 v196, v196, v245
v_sub_f32 v197, v197, v245
v_sub_f32 v198, v198, v245
v_sub_f32 v199, v199, v245
Mvvv 212,96,144
Ba 248,227,16640
DD 78,16,36,2048
v_exp_f32 v192, v192
v_exp_f32 v193, v193
v_mov_b32 v247, v192
WL 3
Mvvv 208,100,148
Ba 252,227,24832
v_exp_f32 v194, v194
v_add_f32 v247, v247, v193
CV 192,192,193
v_exp_f32 v195, v195
Mvvv 212,104,148
v_add_u32 v228, 0xffff0000, v228
v_add_u32 v229, 0xffff0000, v229
v_add_u32 v230, 0xffff0000, v230
v_add_u32 v231, 0xffff0000, v231
v_add_u32 v232, 0xffff0000, v232
v_add_u32 v233, 0xffff0000, v233
v_add_u32 v234, 0xffff0000, v234
v_add_u32 v235, 0xffff0000, v235
Tv 96,228,32768
Tv 98,228,40960
DD 79,16,36,3072
v_add_f32 v247, v247, v194
v_exp_f32 v196, v196
v_add_f32 v247, v247, v195
CV 193,194,195
WL 4
Mvav 208,240,152
Tv 100,229,32768
Tv 102,229,40960
v_exp_f32 v197, v197
v_add_f32 v247, v247, v196
v_exp_f32 v198, v198
Mvav 212,244,152
Tv 104,230,32768
Tv 106,230,40960
s_waitcnt vmcnt(23)
s_mov_b32 m0, 8192
s_add_u32 s36, s48, 295424
DD 76,16,36,0
v_add_f32 v247, v247, v197
CV 194,196,197
WL 6
Mvav 208,248,156
Ta 240,231,32768
Ta 242,231,40960
v_exp_f32 v199, v199
v_add_f32 v247, v247, v198
v_add_f32 v247, v247, v199
CV 195,198,199
Mvav 212,252,156
Ta 244,232,32768
Ta 246,232,40960
DD 77,16,36,1024
WL 6
v_mfma_f32_16x16x32_bf16 v[0:3], v[96:99], v[192:195], 0
Ta 248,233,32768
Ta 250,233,40960
v_mfma_f32_16x16x32_bf16 v[4:7], v[100:103], v[192:195], 0
Ta 252,234,32768
Ta 254,234,40960
DD 78,16,36,2048
WL 6
v_mfma_f32_16x16x32_bf16 v[8:11], v[104:107], v[192:195], 0
Tv 96,235,32768
Tv 98,235,40960
v_fma_f32 v208, v208, s37, -v245
v_fma_f32 v209, v209, s37, -v245
v_mfma_f32_16x16x32_bf16 v[12:15], a[240:243], v[192:195], 0
Tv 100,228,33024
Tv 102,228,41216
DD 79,16,36,3072
WL 6
v_mfma_f32_16x16x32_bf16 v[16:19], a[244:247], v[192:195], 0
Tv 104,229,33024
Tv 106,229,41216
v_fma_f32 v210, v210, s37, -v245
v_mfma_f32_16x16x32_bf16 v[20:23], a[248:251], v[192:195], 0
Ta 240,230,33024
Ta 242,230,41216
s_waitcnt vmcnt(23)
s_mov_b32 m0, 12288
s_add_u32 s36, s48, 426496
DD 76,16,36,0
WL 6
v_mfma_f32_16x16x32_bf16 v[24:27], a[252:255], v[192:195], 0
Ta 244,231,33024
Ta 246,231,41216
v_fma_f32 v211, v211, s37, -v245
v_fma_f32 v212, v212, s37, -v245
v_mfma_f32_16x16x32_bf16 v[28:31], v[96:99], v[192:195], 0
Ta 248,232,33024
Ta 250,232,41216
DD 77,16,36,1024
WL 6
v_mfma_f32_16x16x32_bf16 v[32:35], v[100:103], v[192:195], 0
Ta 252,233,33024
Ta 254,233,41216
v_fma_f32 v213, v213, s37, -v245
v_fma_f32 v214, v214, s37, -v245
v_mfma_f32_16x16x32_bf16 v[36:39], v[104:107], v[192:195], 0
Tv 96,234,33024
Tv 98,234,41216
DD 78,16,36,2048
WL 6
v_mfma_f32_16x16x32_bf16 v[40:43], a[240:243], v[192:195], 0
Tv 100,235,33024
Tv 102,235,41216
v_fma_f32 v215, v215, s37, -v245
v_mfma_f32_16x16x32_bf16 v[44:47], a[244:247], v[192:195], 0
DD 79,16,36,3072
v_max3_f32 v251, v208, v209, v210
v_max3_f32 v252, v211, v212, v213
v_max3_f32 v251, v251, v214, v215
WL 4
v_mfma_f32_16x16x32_bf16 v[48:51], a[248:251], v[192:195], 0
v_max_f32 v251, v251, v252
v_cmp_lt_f32 vcc, s38, v251
s_cbranch_vccnz LB_ra1
LB_rb1:
v_mfma_f32_16x16x32_bf16 v[52:55], a[252:255], v[192:195], 0
s_waitcnt vmcnt(16) lgkmcnt(0)
s_barrier
v_add_u32 v224, 0x10000, v224
v_add_u32 v225, 0x10000, v225
v_add_u32 v226, 0x10000, v226
v_add_u32 v227, 0x10000, v227
Bv 104,224,0
Ba 240,224,8192
Ba 244,225,0
v_mfma_f32_16x16x32_bf16 v[56:59], v[96:99], v[192:195], 0
Ba 248,225,8192
s_waitcnt vmcnt(23)
s_mov_b32 m0, 32768
s_lshl_b32 s48, s41, 12
s_add_u32 s48, s48, s34
s_add_u32 s36, s48, 512
DD 76,16,36,0
v_mfma_f32_16x16x32_bf16 v[60:63], v[100:103], v[192:195], 0
Ba 252,226,0
DD 77,16,36,1024
s_cmp_lg_u32 s49, 0
s_cbranch_scc1 LB_ra2
LB_rb2:
WL 3
v_mfma_f32_16x16x32_bf16 v[192:195], v[104:107], v[128:131], 0
Bv 96,226,8192
DD 78,16,36,2048
v_exp_f32 v208, v208
v_mfma_f32_16x16x32_bf16 v[196:199], a[240:243], v[128:131], 0
Bv 100,227,0
v_exp_f32 v209, v209
v_add_f32 v247, v247, v208
WL 3
Mvav 192,244,132
Bv 104,227,8192
DD 79,16,36,3072
v_exp_f32 v210, v210
Mvav 196,248,132
Ba 240,224,256
s_waitcnt vmcnt(23)
s_mov_b32 m0, 36864
s_add_u32 s36, s48, 131584
DD 76,16,36,0
WL 3
Mvav 192,252,136
Ba 244,224,8448
v_add_f32 v247, v247, v209
CV 208,208,209
v_exp_f32 v211, v211
Mvvv 196,96,136
Ba 248,225,256
DD 77,16,36,1024
v_add_f32 v247, v247, v210
WL 3
Mvvv 192,100,140
Ba 252,225,8448
DD 78,16,36,2048
v_exp_f32 v212, v212
v_add_f32 v247, v247, v211
Mvvv 196,104,140
Bv 96,226,256
CV 209,210,211
v_exp_f32 v213, v213
WL 3
Mvav 192,240,144
Bv 100,226,8448
DD 79,16,36,3072
v_add_f32 v247, v247, v212
Mvav 196,244,144
Bv 104,227,256
s_waitcnt vmcnt(23)
s_mov_b32 m0, 40960
s_add_u32 s36, s48, 33280
DD 76,16,36,0
WL 3
Mvav 192,248,148
Ba 240,227,8448
v_exp_f32 v214, v214
v_add_f32 v247, v247, v213
CV 210,212,213
Mvav 196,252,148
Ta 244,228,49152
Ta 246,228,57344
DD 77,16,36,1024
WL 4
Mvvv 192,96,152
Ta 248,229,49152
Ta 250,229,57344
DD 78,16,36,2048
v_exp_f32 v215, v215
Mvvv 196,100,152
Ta 252,230,49152
Ta 254,230,57344
v_add_f32 v247, v247, v214
v_add_f32 v247, v247, v215
WL 6
Mvvv 192,104,156
Tv 96,231,49152
Tv 98,231,57344
DD 79,16,36,3072
CV 211,214,215
Mvav 196,240,156
Tv 100,232,49152
Tv 102,232,57344
s_waitcnt vmcnt(23)
s_mov_b32 m0, 45056
s_add_u32 s36, s48, 164352
DD 76,16,36,0
WL 6
Mvav 0,244,208
Tv 104,233,49152
Tv 106,233,57344
Mvav 4,248,208
Ta 240,234,49152
Ta 242,234,57344
DD 77,16,36,1024
v_fma_f32 v192, v192, s37, -v245
WL 6
Mvav 8,252,208
Ta 244,235,49152
Ta 246,235,57344
DD 78,16,36,2048
v_fma_f32 v193, v193, s37, -v245
Mvvv 12,96,208
Ta 248,228,49408
Ta 250,228,57600
v_fma_f32 v194, v194, s37, -v245
v_fma_f32 v195, v195, s37, -v245
WL 6
Mvvv 16,100,208
Ta 252,229,49408
Ta 254,229,57600
DD 79,16,36,3072
Mvvv 20,104,208
Tv 96,230,49408
Tv 98,230,57600
s_waitcnt vmcnt(23)
s_mov_b32 m0, 16384
s_add_u32 s36, s32, 81920
DN 64,8,36,0
WL 6
Mvav 24,240,208
Tv 100,231,49408
Tv 102,231,57600
DN 65,8,36,1024
v_fma_f32 v196, v196, s37, -v245
Mvav 28,244,208
Tv 104,232,49408
Tv 106,232,57600
v_fma_f32 v197, v197, s37, -v245
v_fma_f32 v198, v198, s37, -v245
WL 6
Mvav 32,248,208
Ta 240,233,49408
Ta 242,233,57600
DN 66,8,36,2048
v_fma_f32 v199, v199, s37, -v245
Mvav 36,252,208
Ta 244,234,49408
Ta 246,234,57600
DN 67,8,36,3072
v_max3_f32 v251, v192, v193, v194
WL 6
Mvvv 40,96,208
Ta 248,235,49408
Ta 250,235,57600
v_max3_f32 v252, v195, v196, v197
v_max3_f32 v251, v251, v198, v199
Mvvv 44,100,208
Ta 252,236,32768
Ta 254,236,40960
s_waitcnt vmcnt(23)
s_mov_b32 m0, 20480
s_add_u32 s36, s32, 86016
DN 68,8,36,0
WL 6
Mvvv 48,104,208
Tv 96,237,32768
Tv 98,237,40960
DN 69,8,36,1024
Mvav 52,240,208
Tv 100,238,32768
Tv 102,238,40960
v_max_f32 v251, v251, v252
v_cmp_lt_f32 vcc, s38, v251
WL 6
Mvav 56,244,208
Tv 104,239,32768
Tv 106,239,40960
DN 70,8,36,2048
s_cbranch_vccnz LB_ra3
LB_rb3:
Mvav 60,248,208
Ta 240,240,32768
Ta 242,240,40960
DN 71,8,36,3072
s_cmp_lg_u32 s49, 0
s_cbranch_scc1 LB_ra4
LB_rb4:
WL 6
v_mfma_f32_16x16x32_bf16 a[0:3], a[252:255], a[128:131], 0
Ta 244,241,32768
Ta 246,241,40960
v_exp_f32 v192, v192
v_mfma_f32_16x16x32_bf16 a[4:7], v[96:99], a[128:131], 0
Ta 248,242,32768
Ta 250,242,40960
s_waitcnt vmcnt(23)
s_mov_b32 m0, 24576
s_add_u32 s36, s32, 90112
DN 64,8,36,0
WL 6
v_mfma_f32_16x16x32_bf16 a[8:11], v[100:103], a[128:131], 0
Ta 252,243,32768
Ta 254,243,40960
DN 65,8,36,1024
v_mfma_f32_16x16x32_bf16 a[12:15], v[104:107], a[128:131], 0
Tv 96,236,33024
Tv 98,236,41216
v_exp_f32 v193, v193
WL 6
v_mfma_f32_16x16x32_bf16 a[16:19], a[240:243], a[128:131], 0
Tv 100,237,33024
Tv 102,237,41216
DN 66,8,36,2048
v_mfma_f32_16x16x32_bf16 a[20:23], a[244:247], a[128:131], 0
Tv 104,238,33024
Tv 106,238,41216
DN 67,8,36,3072
WL 6
v_mfma_f32_16x16x32_bf16 a[24:27], a[248:251], a[128:131], 0
Ta 240,239,33024
Ta 242,239,41216
v_add_f32 v247, v247, v192
v_mfma_f32_16x16x32_bf16 a[28:31], a[252:255], a[128:131], 0
Ta 244,240,33024
Ta 246,240,41216
s_waitcnt vmcnt(23)
s_mov_b32 m0, 28672
s_add_u32 s36, s32, 94208
DN 68,8,36,0
WL 6
v_mfma_f32_16x16x32_bf16 a[32:35], v[96:99], a[128:131], 0
Ta 248,241,33024
Ta 250,241,41216
DN 69,8,36,1024
v_mfma_f32_16x16x32_bf16 a[36:39], v[100:103], a[128:131], 0
Ta 252,242,33024
Ta 254,242,41216
v_exp_f32 v194, v194
WL 6
v_mfma_f32_16x16x32_bf16 a[40:43], v[104:107], a[128:131], 0
Tv 96,243,33024
Tv 98,243,41216
DN 70,8,36,2048
v_mfma_f32_16x16x32_bf16 a[44:47], a[240:243], a[128:131], 0
DN 71,8,36,3072
v_add_f32 v247, v247, v193
CV 192,192,193
WL 4
v_mfma_f32_16x16x32_bf16 a[48:51], a[244:247], a[128:131], 0
v_exp_f32 v195, v195
v_add_f32 v247, v247, v194
v_exp_f32 v196, v196
v_mfma_f32_16x16x32_bf16 a[52:55], a[248:251], a[128:131], 0
s_waitcnt vmcnt(32) lgkmcnt(0)
s_barrier
Bv 100,224,16384
Bv 104,224,24576
Ba 240,225,16384
v_mfma_f32_16x16x32_bf16 a[56:59], a[252:255], a[128:131], 0
Ba 244,225,24576
s_waitcnt vmcnt(23)
s_mov_b32 m0, 65536
s_add_u32 s36, s32, 65536
DN 72,12,36,0
v_mfma_f32_16x16x32_bf16 a[60:63], v[96:99], a[128:131], 0
Ba 248,226,16384
DN 73,12,36,1024
v_add_f32 v247, v247, v195
WL 3
v_mfma_f32_16x16x32_bf16 v[208:211], v[100:103], v[128:131], 0
Ba 252,226,24576
DN 74,12,36,2048
CV 193,194,195
v_mfma_f32_16x16x32_bf16 v[212:215], v[104:107], v[128:131], 0
Bv 96,227,16384
DN 75,12,36,3072
v_exp_f32 v197, v197
WL 3
Mvav 208,240,132
Bv 100,227,24576
s_waitcnt vmcnt(23)
s_mov_b32 m0, 131072
s_lshl_b32 s48, s41, 12
s_add_u32 s48, s48, s34
s_add_u32 s36, s48, 262656
DD 76,16,36,0
Mvav 212,244,132
Bv 104,224,16640
DD 77,16,36,1024
v_add_f32 v247, v247, v196
WL 3
Mvav 208,248,136
Ba 240,224,24832
DD 78,16,36,2048
v_exp_f32 v198, v198
Mvav 212,252,136
Ba 244,225,16640
DD 79,16,36,3072
WL 3
Mvvv 208,96,140
Ba 248,225,24832
s_waitcnt vmcnt(23)
s_mov_b32 m0, 69632
s_add_u32 s36, s32, 69632
DN 72,12,36,0
Mvvv 212,100,140
Ba 252,226,16640
DN 73,12,36,1024
v_add_f32 v247, v247, v197
CV 194,196,197
WL 3
Mvvv 208,104,144
Bv 96,226,24832
DN 74,12,36,2048
v_exp_f32 v199, v199
Mvav 212,240,144
Bv 100,227,16640
DN 75,12,36,3072
v_add_f32 v247, v247, v198
WL 3
Mvav 208,244,148
Bv 104,227,24832
s_waitcnt vmcnt(23)
s_mov_b32 m0, 135168
s_add_u32 s36, s48, 393728
DD 76,16,36,0
Mvav 212,248,148
v_add_u32 v228, 0x18000, v228
v_add_u32 v229, 0x18000, v229
v_add_u32 v230, 0x18000, v230
v_add_u32 v231, 0x18000, v231
v_add_u32 v232, 0x18000, v232
v_add_u32 v233, 0x18000, v233
v_add_u32 v234, 0x18000, v234
v_add_u32 v235, 0x18000, v235
Ta 240,228,49152
Ta 242,228,57344
DD 77,16,36,1024
WL 4
Mvav 208,252,152
Ta 244,229,49152
Ta 246,229,57344
DD 78,16,36,2048
Mvvv 212,96,152
Ta 248,230,49152
Ta 250,230,57344
v_add_f32 v247, v247, v199
CV 195,198,199
WL 6
Mvvv 208,100,156
Ta 252,231,49152
Ta 254,231,57344
DD 79,16,36,3072
Mvvv 212,104,156
Tv 96,232,49152
Tv 98,232,57344
s_waitcnt vmcnt(23)
s_mov_b32 m0, 73728
s_add_u32 s36, s32, 73728
DN 72,12,36,0
WL 6
Mvav 0,240,192
Tv 100,233,49152
Tv 102,233,57344
DN 73,12,36,1024
Mvav 4,244,192
Tv 104,234,49152
Tv 106,234,57344
DN 74,12,36,2048
v_fma_f32 v208, v208, s37, -v245
WL 6
Mvav 8,248,192
Ta 240,235,49152
Ta 242,235,57344
DN 75,12,36,3072
v_fma_f32 v209, v209, s37, -v245
Mvav 12,252,192
Ta 244,228,49408
Ta 246,228,57600
s_waitcnt vmcnt(23)
s_mov_b32 m0, 77824
s_add_u32 s36, s32, 77824
DN 72,12,36,0
WL 6
Mvvv 16,96,192
Ta 248,229,49408
Ta 250,229,57600
DN 73,12,36,1024
v_fma_f32 v210, v210, s37, -v245
v_fma_f32 v211, v211, s37, -v245
Mvvv 20,100,192
Ta 252,230,49408
Ta 254,230,57600
DN 74,12,36,2048
v_fma_f32 v212, v212, s37, -v245
WL 6
Mvvv 24,104,192
Tv 96,231,49408
Tv 98,231,57600
DN 75,12,36,3072
v_fma_f32 v213, v213, s37, -v245
Mvav 28,240,192
Tv 100,232,49408
Tv 102,232,57600
s_waitcnt vmcnt(23)
s_mov_b32 m0, 139264
s_add_u32 s36, s48, 295424
DD 76,16,36,0
WL 6
Mvav 32,244,192
Tv 104,233,49408
Tv 106,233,57600
DD 77,16,36,1024
v_fma_f32 v214, v214, s37, -v245
Mvav 36,248,192
Ta 240,234,49408
Ta 242,234,57600
DD 78,16,36,2048
v_fma_f32 v215, v215, s37, -v245
WL 6
Mvav 40,252,192
Ta 244,235,49408
Ta 246,235,57600
DD 79,16,36,3072
v_max3_f32 v251, v208, v209, v210
Mvvv 44,96,192
v_add_u32 v236, 0xfffe8000, v236
v_add_u32 v237, 0xfffe8000, v237
v_add_u32 v238, 0xfffe8000, v238
v_add_u32 v239, 0xfffe8000, v239
v_add_u32 v240, 0xfffe8000, v240
v_add_u32 v241, 0xfffe8000, v241
v_add_u32 v242, 0xfffe8000, v242
v_add_u32 v243, 0xfffe8000, v243
Ta 248,236,0
Ta 250,236,8192
s_waitcnt vmcnt(23)
s_mov_b32 m0, 49152
s_add_u32 s36, s32, 98304
DN 64,8,36,0
WL 6
Mvvv 48,100,192
Ta 252,237,0
Ta 254,237,8192
DN 65,8,36,1024
v_max3_f32 v252, v211, v212, v213
v_max3_f32 v251, v251, v214, v215
Mvvv 52,104,192
Tv 96,238,0
Tv 98,238,8192
v_max_f32 v251, v251, v252
v_cmp_lt_f32 vcc, s38, v251
WL 6
Mvav 56,240,192
Tv 100,239,0
Tv 102,239,8192
DN 66,8,36,2048
s_cbranch_vccnz LB_ra5
LB_rb5:
Mvav 60,244,192
Tv 104,240,0
Tv 106,240,8192
DN 67,8,36,3072
s_cmp_lg_u32 s49, 0
s_cbranch_scc1 LB_ra6
LB_rb6:
WL 6
Maaa 0,248,132
Ta 240,241,0
Ta 242,241,8192
s_waitcnt vmcnt(23)
s_mov_b32 m0, 53248
s_add_u32 s36, s32, 102400
DN 68,8,36,0
Maaa 4,252,132
Ta 244,242,0
Ta 246,242,8192
DN 69,8,36,1024
WL 6
Mava 8,96,132
Ta 248,243,0
Ta 250,243,8192
DN 70,8,36,2048
v_exp_f32 v208, v208
Mava 12,100,132
Ta 252,236,256
Ta 254,236,8448
DN 71,8,36,3072
WL 6
Mava 16,104,132
Tv 96,237,256
Tv 98,237,8448
s_waitcnt vmcnt(23)
s_mov_b32 m0, 143360
s_add_u32 s36, s48, 426496
DD 76,16,36,0
Maaa 20,240,132
Tv 100,238,256
Tv 102,238,8448
DD 77,16,36,1024
WL 6
Maaa 24,244,132
Tv 104,239,256
Tv 106,239,8448
DD 78,16,36,2048
v_exp_f32 v209, v209
Maaa 28,248,132
Ta 240,240,256
Ta 242,240,8448
DD 79,16,36,3072
WL 6
Maaa 32,252,132
Ta 244,241,256
Ta 246,241,8448
s_waitcnt vmcnt(23)
s_mov_b32 m0, 57344
s_add_u32 s36, s32, 106496
DN 64,8,36,0
Mava 36,96,132
Ta 248,242,256
Ta 250,242,8448
DN 65,8,36,1024
WL 6
Mava 40,100,132
Ta 252,243,256
Ta 254,243,8448
DN 66,8,36,2048
v_add_f32 v247, v247, v208
Mava 44,104,132
DN 67,8,36,3072
v_exp_f32 v210, v210
v_add_f32 v247, v247, v209
WL 4
Maaa 48,240,132
CV 208,208,209
v_exp_f32 v211, v211
Maaa 52,244,132
s_waitcnt vmcnt(60) lgkmcnt(0)
s_barrier
Bv 96,224,32768
Bv 100,224,40960
Bv 104,225,32768
Maaa 56,248,132
Ba 240,225,40960
s_waitcnt vmcnt(23)
s_mov_b32 m0, 61440
s_add_u32 s36, s32, 110592
DN 68,8,36,0
DN 69,8,36,1024
Maaa 60,252,132
Ba 244,226,32768
DN 70,8,36,2048
v_add_f32 v247, v247, v210
v_exp_f32 v212, v212
WL 3
v_mfma_f32_16x16x32_bf16 v[192:195], v[96:99], v[128:131], 0
Ba 248,226,40960
DN 71,8,36,3072
v_add_f32 v247, v247, v211
v_mfma_f32_16x16x32_bf16 v[196:199], v[100:103], v[128:131], 0
Ba 252,227,32768
s_waitcnt vmcnt(23)
s_mov_b32 m0, 147456
s_lshl_b32 s48, s42, 12
s_add_u32 s48, s48, s34
s_add_u32 s36, s48, 512
DD 76,16,36,0
WL 3
Mvvv 192,104,132
Bv 96,227,40960
DD 77,16,36,1024
CV 209,210,211
Mvav 196,240,132
Bv 100,224,33024
DD 78,16,36,2048
v_exp_f32 v213, v213
WL 3
Mvav 192,244,136
Bv 104,224,41216
DD 79,16,36,3072
v_add_f32 v247, v247, v212
Mvav 196,248,136
Ba 240,225,33024
s_waitcnt vmcnt(23)
s_mov_b32 m0, 81920
s_add_u32 s36, s32, 81920
DN 72,12,36,0
WL 3
Mvav 192,252,140
Ba 244,225,41216
DN 73,12,36,1024
v_exp_f32 v214, v214
Mvvv 196,96,140
Ba 248,226,33024
DN 74,12,36,2048
v_add_f32 v247, v247, v213
CV 210,212,213
WL 3
Mvvv 192,100,144
Ba 252,226,41216
DN 75,12,36,3072
v_exp_f32 v215, v215
Mvvv 196,104,144
Bv 96,227,33024
s_waitcnt vmcnt(23)
s_mov_b32 m0, 86016
s_add_u32 s36, s32, 86016
DN 72,12,36,0
WL 3
Mvav 192,240,148
Bv 100,227,41216
DN 73,12,36,1024
v_add_f32 v247, v247, v214
Mvav 196,244,148
Tv 104,228,16384
Tv 106,228,24576
DN 74,12,36,2048
v_add_f32 v247, v247, v215
WL 4
Mvav 192,248,152
Ta 240,229,16384
Ta 242,229,24576
DN 75,12,36,3072
Mvav 196,252,152
Ta 244,230,16384
Ta 246,230,24576
s_waitcnt vmcnt(23)
s_mov_b32 m0, 151552
s_add_u32 s36, s48, 131584
DD 76,16,36,0
WL 6
Mvvv 192,96,156
Ta 248,231,16384
Ta 250,231,24576
DD 77,16,36,1024
CV 211,214,215
Mvvv 196,100,156
Ta 252,232,16384
Ta 254,232,24576
DD 78,16,36,2048
WL 6
Mvvv 0,104,208
Tv 96,233,16384
Tv 98,233,24576
DD 79,16,36,3072
Mvav 4,240,208
Tv 100,234,16384
Tv 102,234,24576
s_waitcnt vmcnt(23)
s_mov_b32 m0, 90112
s_add_u32 s36, s32, 90112
DN 72,12,36,0
WL 6
Mvav 8,244,208
Tv 104,235,16384
Tv 106,235,24576
DN 73,12,36,1024
v_fma_f32 v192, v192, s37, -v245
Mvav 12,248,208
Ta 240,228,16640
Ta 242,228,24832
DN 74,12,36,2048
v_fma_f32 v193, v193, s37, -v245
v_fma_f32 v194, v194, s37, -v245
WL 6
Mvav 16,252,208
Ta 244,229,16640
Ta 246,229,24832
DN 75,12,36,3072
v_fma_f32 v195, v195, s37, -v245
Mvvv 20,96,208
Ta 248,230,16640
Ta 250,230,24832
s_waitcnt vmcnt(23)
s_mov_b32 m0, 94208
s_add_u32 s36, s32, 94208
DN 72,12,36,0
WL 6
Mvvv 24,100,208
Ta 252,231,16640
Ta 254,231,24832
DN 73,12,36,1024
v_fma_f32 v196, v196, s37, -v245
v_fma_f32 v197, v197, s37, -v245
Mvvv 28,104,208
Tv 96,232,16640
Tv 98,232,24832
DN 74,12,36,2048
v_fma_f32 v198, v198, s37, -v245
WL 6
Mvav 32,240,208
Tv 100,233,16640
Tv 102,233,24832
DN 75,12,36,3072
v_fma_f32 v199, v199, s37, -v245
Mvav 36,244,208
Tv 104,234,16640
Tv 106,234,24832
s_waitcnt vmcnt(23)
s_mov_b32 m0, 155648
s_add_u32 s36, s48, 33280
DD 76,16,36,0
WL 6
Mvav 40,248,208
Ta 240,235,16640
Ta 242,235,24832
DD 77,16,36,1024
v_max3_f32 v251, v192, v193, v194
v_max3_f32 v252, v195, v196, v197
Mvav 44,252,208
Ta 244,236,32768
Ta 246,236,40960
DD 78,16,36,2048
v_max3_f32 v251, v251, v198, v199
WL 6
Mvvv 48,96,208
Ta 248,237,32768
Ta 250,237,40960
DD 79,16,36,3072
v_max_f32 v251, v251, v252
v_cmp_lt_f32 vcc, s38, v251
Mvvv 52,100,208
Ta 252,238,32768
Ta 254,238,40960
s_waitcnt vmcnt(23)
s_mov_b32 m0, 0
s_add_u32 s36, s32, 114688
DN 64,8,36,0
WL 6
Mvvv 56,104,208
Tv 96,239,32768
Tv 98,239,40960
DN 65,8,36,1024
s_cbranch_vccnz LB_ra7
LB_rb7:
Mvav 60,240,208
Tv 100,240,32768
Tv 102,240,40960
DN 66,8,36,2048
s_cmp_lg_u32 s49, 0
s_cbranch_scc1 LB_ra8
LB_rb8:
WL 6
Maaa 0,244,136
Tv 104,241,32768
Tv 106,241,40960
DN 67,8,36,3072
Maaa 4,248,136
Ta 240,242,32768
Ta 242,242,40960
s_waitcnt vmcnt(23)
s_mov_b32 m0, 4096
s_add_u32 s36, s32, 118784
DN 68,8,36,0
WL 6
Maaa 8,252,136
Ta 244,243,32768
Ta 246,243,40960
DN 69,8,36,1024
v_exp_f32 v192, v192
Mava 12,96,136
Ta 248,236,33024
Ta 250,236,41216
DN 70,8,36,2048
WL 6
Mava 16,100,136
Ta 252,237,33024
Ta 254,237,41216
DN 71,8,36,3072
Mava 20,104,136
Tv 96,238,33024
Tv 98,238,41216
s_waitcnt vmcnt(23)
s_mov_b32 m0, 159744
s_add_u32 s36, s48, 164352
DD 76,16,36,0
WL 6
Maaa 24,240,136
Tv 100,239,33024
Tv 102,239,41216
DD 77,16,36,1024
v_exp_f32 v193, v193
Maaa 28,244,136
Tv 104,240,33024
Tv 106,240,41216
DD 78,16,36,2048
WL 6
Maaa 32,248,136
Ta 240,241,33024
Ta 242,241,41216
DD 79,16,36,3072
Maaa 36,252,136
Ta 244,242,33024
Ta 246,242,41216
s_waitcnt vmcnt(23)
s_mov_b32 m0, 8192
s_add_u32 s36, s32, 122880
DN 64,8,36,0
WL 6
Mava 40,96,136
Ta 248,243,33024
Ta 250,243,41216
DN 65,8,36,1024
v_add_f32 v247, v247, v192
Mava 44,100,136
DN 66,8,36,2048
v_exp_f32 v194, v194
WL 4
Mava 48,104,136
DN 67,8,36,3072
v_add_f32 v247, v247, v193
CV 192,192,193
v_exp_f32 v195, v195
Maaa 52,240,136
s_waitcnt vmcnt(52) lgkmcnt(0)
s_barrier
v_add_u32 v224, 0xffff0000, v224
v_add_u32 v225, 0xffff0000, v225
v_add_u32 v226, 0xffff0000, v226
v_add_u32 v227, 0xffff0000, v227
Ba 252,224,16384
Bv 96,224,24576
Bv 100,225,16384
Maaa 56,244,136
Bv 104,225,24576
s_waitcnt vmcnt(23)
s_mov_b32 m0, 12288
s_add_u32 s36, s32, 126976
DN 68,8,36,0
Maaa 60,248,136
Ba 240,226,16384
DN 69,8,36,1024
v_add_f32 v247, v247, v194
WL 3
v_mfma_f32_16x16x32_bf16 v[208:211], a[252:255], v[128:131], 0
Ba 244,226,24576
DN 70,8,36,2048
v_exp_f32 v196, v196
v_mfma_f32_16x16x32_bf16 v[212:215], v[96:99], v[128:131], 0
Ba 248,227,16384
DN 71,8,36,3072
v_add_f32 v247, v247, v195
WL 3
Mvvv 208,100,132
Ba 252,227,24576
s_waitcnt vmcnt(23)
s_mov_b32 m0, 114688
s_lshl_b32 s48, s42, 12
s_add_u32 s48, s48, s34
s_add_u32 s36, s48, 262656
DD 76,16,36,0
Mvvv 212,104,132
Bv 96,224,16640
DD 77,16,36,1024
CV 193,194,195
WL 3
Mvav 208,240,136
Bv 100,224,24832
DD 78,16,36,2048
v_exp_f32 v197, v197
Mvav 212,244,136
Bv 104,225,16640
DD 79,16,36,3072
v_add_f32 v247, v247, v196
WL 3
Mvav 208,248,140
Ba 240,225,24832
s_waitcnt vmcnt(23)
s_mov_b32 m0, 98304
s_add_u32 s36, s32, 98304
DN 72,12,36,0
Mvav 212,252,140
Ba 244,226,16640
DN 73,12,36,1024
v_exp_f32 v198, v198
WL 3
Mvvv 208,96,144
Ba 248,226,24832
DN 74,12,36,2048
v_add_f32 v247, v247, v197
CV 194,196,197
Mvvv 212,100,144
Ba 252,227,16640
DN 75,12,36,3072
v_exp_f32 v199, v199
WL 3
Mvvv 208,104,148
Bv 96,227,24832
s_waitcnt vmcnt(23)
s_mov_b32 m0, 118784
s_add_u32 s36, s48, 393728
DD 76,16,36,0
Mvav 212,240,148
v_add_u32 v228, 0xffff8000, v228
v_add_u32 v229, 0xffff8000, v229
v_add_u32 v230, 0xffff8000, v230
v_add_u32 v231, 0xffff8000, v231
v_add_u32 v232, 0xffff8000, v232
v_add_u32 v233, 0xffff8000, v233
v_add_u32 v234, 0xffff8000, v234
v_add_u32 v235, 0xffff8000, v235
Tv 100,228,0
Tv 102,228,8192
DD 77,16,36,1024
WL 4
Mvav 208,244,152
Tv 104,229,0
Tv 106,229,8192
DD 78,16,36,2048
v_add_f32 v247, v247, v198
Mvav 212,248,152
Ta 240,230,0
Ta 242,230,8192
v_add_f32 v247, v247, v199
WL 6
Mvav 208,252,156
Ta 244,231,0
Ta 246,231,8192
DD 79,16,36,3072
CV 195,198,199
Mvvv 212,96,156
Ta 248,232,0
Ta 250,232,8192
s_waitcnt vmcnt(23)
s_mov_b32 m0, 102400
s_add_u32 s36, s32, 102400
DN 72,12,36,0
WL 6
Mvvv 0,100,192
Ta 252,233,0
Ta 254,233,8192
DN 73,12,36,1024
Mvvv 4,104,192
Tv 96,234,0
Tv 98,234,8192
DN 74,12,36,2048
v_fma_f32 v208, v208, s37, -v245
WL 6
Mvav 8,240,192
Tv 100,235,0
Tv 102,235,8192
DN 75,12,36,3072
v_fma_f32 v209, v209, s37, -v245
Mvav 12,244,192
Tv 104,228,256
Tv 106,228,8448
s_waitcnt vmcnt(23)
s_mov_b32 m0, 106496
s_add_u32 s36, s32, 106496
DN 72,12,36,0
WL 6
Mvav 16,248,192
Ta 240,229,256
Ta 242,229,8448
DN 73,12,36,1024
v_fma_f32 v210, v210, s37, -v245
v_fma_f32 v211, v211, s37, -v245
Mvav 20,252,192
Ta 244,230,256
Ta 246,230,8448
DN 74,12,36,2048
v_fma_f32 v212, v212, s37, -v245
WL 6
Mvvv 24,96,192
Ta 248,231,256
Ta 250,231,8448
DN 75,12,36,3072
v_fma_f32 v213, v213, s37, -v245
Mvvv 28,100,192
Ta 252,232,256
Ta 254,232,8448
s_waitcnt vmcnt(23)
s_mov_b32 m0, 122880
s_add_u32 s36, s48, 295424
DD 76,16,36,0
WL 6
Mvvv 32,104,192
Tv 96,233,256
Tv 98,233,8448
DD 77,16,36,1024
v_fma_f32 v214, v214, s37, -v245
Mvav 36,240,192
Tv 100,234,256
Tv 102,234,8448
DD 78,16,36,2048
v_fma_f32 v215, v215, s37, -v245
WL 6
Mvav 40,244,192
Tv 104,235,256
Tv 106,235,8448
DD 79,16,36,3072
v_max3_f32 v251, v208, v209, v210
Mvav 44,248,192
v_add_u32 v236, 0x18000, v236
v_add_u32 v237, 0x18000, v237
v_add_u32 v238, 0x18000, v238
v_add_u32 v239, 0x18000, v239
v_add_u32 v240, 0x18000, v240
v_add_u32 v241, 0x18000, v241
v_add_u32 v242, 0x18000, v242
v_add_u32 v243, 0x18000, v243
Ta 240,236,32768
Ta 242,236,40960
s_waitcnt vmcnt(23)
s_mov_b32 m0, 110592
s_add_u32 s36, s32, 110592
DN 72,12,36,0
WL 6
Mvav 48,252,192
Ta 244,237,32768
Ta 246,237,40960
DN 73,12,36,1024
v_max3_f32 v252, v211, v212, v213
v_max3_f32 v251, v251, v214, v215
Mvvv 52,96,192
Ta 248,238,32768
Ta 250,238,40960
v_max_f32 v251, v251, v252
v_cmp_lt_f32 vcc, s38, v251
WL 6
Mvvv 56,100,192
Ta 252,239,32768
Ta 254,239,40960
DN 74,12,36,2048
s_cbranch_vccnz LB_ra9
LB_rb9:
Mvvv 60,104,192
Tv 96,240,32768
Tv 98,240,40960
DN 75,12,36,3072
s_cmp_lg_u32 s49, 0
s_cbranch_scc1 LB_ra10
LB_rb10:
WL 6
Maaa 0,240,140
Tv 100,241,32768
Tv 102,241,40960
s_waitcnt vmcnt(23)
s_mov_b32 m0, 32768
s_add_u32 s36, s32, 131072
DN 64,8,36,0
Maaa 4,244,140
Tv 104,242,32768
Tv 106,242,40960
DN 65,8,36,1024
WL 6
Maaa 8,248,140
Ta 240,243,32768
Ta 242,243,40960
DN 66,8,36,2048
v_exp_f32 v208, v208
Maaa 12,252,140
Ta 244,236,33024
Ta 246,236,41216
DN 67,8,36,3072
WL 6
Mava 16,96,140
Ta 248,237,33024
Ta 250,237,41216
s_waitcnt vmcnt(23)
s_mov_b32 m0, 126976
s_add_u32 s36, s48, 426496
DD 76,16,36,0
Mava 20,100,140
Ta 252,238,33024
Ta 254,238,41216
DD 77,16,36,1024
WL 6
Mava 24,104,140
Tv 96,239,33024
Tv 98,239,41216
DD 78,16,36,2048
Maaa 28,240,140
Tv 100,240,33024
Tv 102,240,41216
DD 79,16,36,3072
v_exp_f32 v209, v209
WL 6
Maaa 32,244,140
Tv 104,241,33024
Tv 106,241,41216
s_waitcnt vmcnt(23)
s_mov_b32 m0, 36864
s_add_u32 s36, s32, 135168
DN 68,8,36,0
Maaa 36,248,140
Ta 240,242,33024
Ta 242,242,41216
DN 69,8,36,1024
WL 6
Maaa 40,252,140
Ta 244,243,33024
Ta 246,243,41216
DN 70,8,36,2048
v_add_f32 v247, v247, v208
Mava 44,96,140
DN 71,8,36,3072
v_exp_f32 v210, v210
WL 4
Mava 48,100,140
v_add_f32 v247, v247, v209
CV 208,208,209
v_exp_f32 v211, v211
Mava 52,104,140
s_waitcnt vmcnt(48) lgkmcnt(0)
s_barrier
Ba 248,224,49152
Ba 252,224,57344
Bv 96,225,49152
Maaa 56,240,140
Bv 100,225,57344
s_waitcnt vmcnt(23)
s_mov_b32 m0, 40960
s_add_u32 s36, s32, 139264
DN 64,8,36,0
Maaa 60,244,140
Bv 104,226,49152
DN 65,8,36,1024
v_add_f32 v247, v247, v210
WL 3
v_mfma_f32_16x16x32_bf16 v[192:195], a[248:251], v[128:131], 0
Ba 240,226,57344
DN 66,8,36,2048
v_exp_f32 v212, v212
v_mfma_f32_16x16x32_bf16 v[196:199], a[252:255], v[128:131], 0
Ba 244,227,49152
DN 67,8,36,3072
v_add_f32 v247, v247, v211
WL 3
Mvvv 192,96,132
Ba 248,227,57344
s_waitcnt vmcnt(23)
s_mov_b32 m0, 131072
s_lshl_b32 s48, s43, 12
s_add_u32 s48, s48, s34
s_add_u32 s36, s48, 512
DD 76,16,36,0
Mvvv 196,100,132
Ba 252,224,49408
DD 77,16,36,1024
CV 209,210,211
WL 3
Mvvv 192,104,136
Bv 96,224,57600
DD 78,16,36,2048
v_exp_f32 v213, v213
Mvav 196,240,136
Bv 100,225,49408
DD 79,16,36,3072
v_add_f32 v247, v247, v212
v_exp_f32 v214, v214
WL 3
Mvav 192,244,140
Bv 104,225,57600
s_waitcnt vmcnt(23)
s_mov_b32 m0, 45056
s_add_u32 s36, s32, 143360
DN 68,8,36,0
Mvav 196,248,140
Ba 240,226,49408
DN 69,8,36,1024
v_add_f32 v247, v247, v213
WL 3
Mvav 192,252,144
Ba 244,226,57600
DN 70,8,36,2048
CV 210,212,213
Mvvv 196,96,144
Ba 248,227,49408
DN 71,8,36,3072
v_exp_f32 v215, v215
WL 3
Mvvv 192,100,148
Ba 252,227,57600
s_waitcnt vmcnt(23)
s_mov_b32 m0, 135168
s_add_u32 s36, s48, 131584
DD 76,16,36,0
Mvvv 196,104,148
Tv 96,228,16384
Tv 98,228,24576
DD 77,16,36,1024
WL 4
Mvav 192,240,152
Tv 100,229,16384
Tv 102,229,24576
DD 78,16,36,2048
v_add_f32 v247, v247, v214
Mvav 196,244,152
Tv 104,230,16384
Tv 106,230,24576
v_add_f32 v247, v247, v215
WL 6
Mvav 192,248,156
Ta 240,231,16384
Ta 242,231,24576
DD 79,16,36,3072
CV 211,214,215
Mvav 196,252,156
Ta 244,232,16384
Ta 246,232,24576
s_waitcnt vmcnt(23)
s_mov_b32 m0, 65536
s_add_u32 s36, s32, 114688
DN 72,12,36,0
WL 6
Mvvv 0,96,208
Ta 248,233,16384
Ta 250,233,24576
DN 73,12,36,1024
Mvvv 4,100,208
Ta 252,234,16384
Ta 254,234,24576
DN 74,12,36,2048
v_fma_f32 v192, v192, s37, -v245
WL 6
Mvvv 8,104,208
Tv 96,235,16384
Tv 98,235,24576
DN 75,12,36,3072
v_fma_f32 v193, v193, s37, -v245
Mvav 12,240,208
Tv 100,228,16640
Tv 102,228,24832
s_waitcnt vmcnt(23)
s_mov_b32 m0, 69632
s_add_u32 s36, s32, 118784
DN 72,12,36,0
WL 6
Mvav 16,244,208
Tv 104,229,16640
Tv 106,229,24832
DN 73,12,36,1024
v_fma_f32 v194, v194, s37, -v245
v_fma_f32 v195, v195, s37, -v245
Mvav 20,248,208
Ta 240,230,16640
Ta 242,230,24832
DN 74,12,36,2048
v_fma_f32 v196, v196, s37, -v245
WL 6
Mvav 24,252,208
Ta 244,231,16640
Ta 246,231,24832
DN 75,12,36,3072
v_fma_f32 v197, v197, s37, -v245
Mvvv 28,96,208
Ta 248,232,16640
Ta 250,232,24832
s_waitcnt vmcnt(23)
s_mov_b32 m0, 139264
s_add_u32 s36, s48, 33280
DD 76,16,36,0
WL 6
Mvvv 32,100,208
Ta 252,233,16640
Ta 254,233,24832
DD 77,16,36,1024
v_fma_f32 v198, v198, s37, -v245
Mvvv 36,104,208
Tv 96,234,16640
Tv 98,234,24832
DD 78,16,36,2048
v_fma_f32 v199, v199, s37, -v245
WL 6
Mvav 40,240,208
Tv 100,235,16640
Tv 102,235,24832
DD 79,16,36,3072
v_max3_f32 v251, v192, v193, v194
Mvav 44,244,208
Tv 104,236,49152
Tv 106,236,57344
s_waitcnt vmcnt(23)
s_mov_b32 m0, 73728
s_add_u32 s36, s32, 122880
DN 72,12,36,0
WL 6
Mvav 48,248,208
Ta 240,237,49152
Ta 242,237,57344
DN 73,12,36,1024
v_max3_f32 v252, v195, v196, v197
v_max3_f32 v251, v251, v198, v199
Mvav 52,252,208
Ta 244,238,49152
Ta 246,238,57344
v_max_f32 v251, v251, v252
v_cmp_lt_f32 vcc, s38, v251
WL 6
Mvvv 56,96,208
Ta 248,239,49152
Ta 250,239,57344
DN 74,12,36,2048
s_cbranch_vccnz LB_ra11
LB_rb11:
Mvvv 60,100,208
Ta 252,240,49152
Ta 254,240,57344
DN 75,12,36,3072
s_cmp_lg_u32 s49, 0
s_cbranch_scc1 LB_ra12
LB_rb12:
WL 6
Mava 0,104,144
Tv 96,241,49152
Tv 98,241,57344
s_waitcnt vmcnt(23)
s_mov_b32 m0, 77824
s_add_u32 s36, s32, 126976
DN 72,12,36,0
Maaa 4,240,144
Tv 100,242,49152
Tv 102,242,57344
DN 73,12,36,1024
WL 6
Maaa 8,244,144
Tv 104,243,49152
Tv 106,243,57344
DN 74,12,36,2048
v_exp_f32 v192, v192
Maaa 12,248,144
Ta 240,236,49408
Ta 242,236,57600
DN 75,12,36,3072
WL 6
Maaa 16,252,144
Ta 244,237,49408
Ta 246,237,57600
s_waitcnt vmcnt(23)
s_mov_b32 m0, 143360
s_add_u32 s36, s48, 164352
DD 76,16,36,0
Mava 20,96,144
Ta 248,238,49408
Ta 250,238,57600
DD 77,16,36,1024
WL 6
Mava 24,100,144
Ta 252,239,49408
Ta 254,239,57600
DD 78,16,36,2048
v_exp_f32 v193, v193
Mava 28,104,144
Tv 96,240,49408
Tv 98,240,57600
DD 79,16,36,3072
WL 6
Maaa 32,240,144
Tv 100,241,49408
Tv 102,241,57600
s_waitcnt vmcnt(23)
s_mov_b32 m0, 16384
s_add_u32 s36, s32, 147456
DN 64,8,36,0
Maaa 36,244,144
Tv 104,242,49408
Tv 106,242,57600
DN 65,8,36,1024
WL 6
Maaa 40,248,144
Ta 240,243,49408
Ta 242,243,57600
DN 66,8,36,2048
v_add_f32 v247, v247, v192
Maaa 44,252,144
DN 67,8,36,3072
v_exp_f32 v194, v194
v_add_f32 v247, v247, v193
WL 4
Mava 48,96,144
CV 192,192,193
v_exp_f32 v195, v195
Mava 52,100,144
s_waitcnt vmcnt(48) lgkmcnt(0)
s_barrier
Ba 244,224,0
Ba 248,224,8192
Ba 252,225,0
Mava 56,104,144
Bv 96,225,8192
s_waitcnt vmcnt(23)
s_mov_b32 m0, 20480
s_add_u32 s36, s32, 151552
DN 68,8,36,0
DN 69,8,36,1024
Maaa 60,240,144
Bv 100,226,0
DN 70,8,36,2048
v_add_f32 v247, v247, v194
v_exp_f32 v196, v196
WL 3
v_mfma_f32_16x16x32_bf16 v[208:211], a[244:247], v[128:131], 0
Bv 104,226,8192
DN 71,8,36,3072
v_add_f32 v247, v247, v195
v_mfma_f32_16x16x32_bf16 v[212:215], a[248:251], v[128:131], 0
Ba 240,227,0
s_waitcnt vmcnt(23)
s_mov_b32 m0, 147456
s_lshl_b32 s48, s43, 12
s_add_u32 s48, s48, s34
s_add_u32 s36, s48, 262656
DD 76,16,36,0
WL 3
Mvav 208,252,132
Ba 244,227,8192
DD 77,16,36,1024
CV 193,194,195
Mvvv 212,96,132
Ba 248,224,256
DD 78,16,36,2048
v_exp_f32 v197, v197
WL 3
Mvvv 208,100,136
Ba 252,224,8448
DD 79,16,36,3072
v_add_f32 v247, v247, v196
Mvvv 212,104,136
Bv 96,225,256
s_waitcnt vmcnt(23)
s_mov_b32 m0, 24576
s_add_u32 s36, s32, 155648
DN 64,8,36,0
WL 3
Mvav 208,240,140
Bv 100,225,8448
DN 65,8,36,1024
v_exp_f32 v198, v198
Mvav 212,244,140
Bv 104,226,256
DN 66,8,36,2048
v_add_f32 v247, v247, v197
CV 194,196,197
WL 3
Mvav 208,248,144
Ba 240,226,8448
DN 67,8,36,3072
v_exp_f32 v199, v199
Mvav 212,252,144
Ba 244,227,256
s_waitcnt vmcnt(23)
s_mov_b32 m0, 28672
s_add_u32 s36, s32, 159744
DN 68,8,36,0
WL 3
Mvvv 208,96,148
Ba 248,227,8448
DN 69,8,36,1024
v_add_f32 v247, v247, v198
Mvvv 212,100,148
Ta 252,228,32768
Ta 254,228,40960
DN 70,8,36,2048
v_add_f32 v247, v247, v199
WL 4
Mvvv 208,104,152
Tv 96,229,32768
Tv 98,229,40960
DN 71,8,36,3072
Mvav 212,240,152
Tv 100,230,32768
Tv 102,230,40960
s_waitcnt vmcnt(23)
s_mov_b32 m0, 151552
s_add_u32 s36, s48, 393728
DD 76,16,36,0
WL 6
Mvav 208,244,156
Tv 104,231,32768
Tv 106,231,40960
DD 77,16,36,1024
CV 195,198,199
Mvav 212,248,156
Ta 240,232,32768
Ta 242,232,40960
DD 78,16,36,2048
WL 6
Mvav 0,252,192
Ta 244,233,32768
Ta 246,233,40960
DD 79,16,36,3072
Mvvv 4,96,192
Ta 248,234,32768
Ta 250,234,40960
s_waitcnt vmcnt(23)
s_mov_b32 m0, 81920
s_add_u32 s36, s32, 131072
DN 72,12,36,0
WL 6
Mvvv 8,100,192
Ta 252,235,32768
Ta 254,235,40960
DN 73,12,36,1024
v_fma_f32 v208, v208, s37, -v245
Mvvv 12,104,192
Tv 96,228,33024
Tv 98,228,41216
DN 74,12,36,2048
v_fma_f32 v209, v209, s37, -v245
v_fma_f32 v210, v210, s37, -v245
WL 6
Mvav 16,240,192
Tv 100,229,33024
Tv 102,229,41216
DN 75,12,36,3072
v_fma_f32 v211, v211, s37, -v245
Mvav 20,244,192
Tv 104,230,33024
Tv 106,230,41216
s_waitcnt vmcnt(23)
s_mov_b32 m0, 86016
s_add_u32 s36, s32, 135168
DN 72,12,36,0
WL 6
Mvav 24,248,192
Ta 240,231,33024
Ta 242,231,41216
DN 73,12,36,1024
v_fma_f32 v212, v212, s37, -v245
v_fma_f32 v213, v213, s37, -v245
Mvav 28,252,192
Ta 244,232,33024
Ta 246,232,41216
DN 74,12,36,2048
v_fma_f32 v214, v214, s37, -v245
WL 6
Mvvv 32,96,192
Ta 248,233,33024
Ta 250,233,41216
DN 75,12,36,3072
v_fma_f32 v215, v215, s37, -v245
Mvvv 36,100,192
Ta 252,234,33024
Ta 254,234,41216
s_waitcnt vmcnt(23)
s_mov_b32 m0, 155648
s_add_u32 s36, s48, 295424
DD 76,16,36,0
WL 6
Mvvv 40,104,192
Tv 96,235,33024
Tv 98,235,41216
DD 77,16,36,1024
v_max3_f32 v251, v208, v209, v210
v_max3_f32 v252, v211, v212, v213
Mvav 44,240,192
Tv 100,236,16384
Tv 102,236,24576
DD 78,16,36,2048
v_max3_f32 v251, v251, v214, v215
WL 6
Mvav 48,244,192
Tv 104,237,16384
Tv 106,237,24576
DD 79,16,36,3072
v_max_f32 v251, v251, v252
v_cmp_lt_f32 vcc, s38, v251
Mvav 52,248,192
Ta 240,238,16384
Ta 242,238,24576
s_waitcnt vmcnt(23)
s_mov_b32 m0, 90112
s_add_u32 s36, s32, 139264
DN 72,12,36,0
WL 6
Mvav 56,252,192
Ta 244,239,16384
Ta 246,239,24576
DN 73,12,36,1024
s_cbranch_vccnz LB_ra13
LB_rb13:
Mvvv 60,96,192
Ta 248,240,16384
Ta 250,240,24576
DN 74,12,36,2048
s_cmp_lg_u32 s49, 0
s_cbranch_scc1 LB_ra14
LB_rb14:
WL 6
Mava 0,100,148
Ta 252,241,16384
Ta 254,241,24576
DN 75,12,36,3072
Mava 4,104,148
Tv 96,242,16384
Tv 98,242,24576
s_waitcnt vmcnt(23)
s_mov_b32 m0, 94208
s_add_u32 s36, s32, 143360
DN 72,12,36,0
WL 6
Maaa 8,240,148
Tv 100,243,16384
Tv 102,243,24576
DN 73,12,36,1024
v_exp_f32 v208, v208
Maaa 12,244,148
Tv 104,236,16640
Tv 106,236,24832
DN 74,12,36,2048
WL 6
Maaa 16,248,148
Ta 240,237,16640
Ta 242,237,24832
DN 75,12,36,3072
Maaa 20,252,148
Ta 244,238,16640
Ta 246,238,24832
s_waitcnt vmcnt(23)
s_mov_b32 m0, 159744
s_add_u32 s36, s48, 426496
DD 76,16,36,0
WL 6
Mava 24,96,148
Ta 248,239,16640
Ta 250,239,24832
DD 77,16,36,1024
v_exp_f32 v209, v209
Mava 28,100,148
Ta 252,240,16640
Ta 254,240,24832
DD 78,16,36,2048
WL 6
Mava 32,104,148
Tv 96,241,16640
Tv 98,241,24832
DD 79,16,36,3072
Maaa 36,240,148
Tv 100,242,16640
Tv 102,242,24832
s_waitcnt vmcnt(23)
s_mov_b32 m0, 49152
s_add_u32 s36, s32, 163840
DN 64,8,36,0
WL 6
Maaa 40,244,148
Tv 104,243,16640
Tv 106,243,24832
DN 65,8,36,1024
v_add_f32 v247, v247, v208
Maaa 44,248,148
DN 66,8,36,2048
v_exp_f32 v210, v210
WL 4
Maaa 48,252,148
DN 67,8,36,3072
v_add_f32 v247, v247, v209
CV 208,208,209
v_exp_f32 v211, v211
Mava 52,96,148
s_waitcnt vmcnt(52) lgkmcnt(0)
s_barrier
Ba 240,224,32768
Ba 244,224,40960
Ba 248,225,32768
Mava 56,100,148
Ba 252,225,40960
s_waitcnt vmcnt(23)
s_mov_b32 m0, 53248
s_add_u32 s36, s32, 167936
DN 68,8,36,0
Mava 60,104,148
Bv 96,226,32768
DN 69,8,36,1024
v_add_f32 v247, v247, v210
WL 3
v_mfma_f32_16x16x32_bf16 v[192:195], a[240:243], v[128:131], 0
Bv 100,226,40960
DN 70,8,36,2048
v_exp_f32 v212, v212
v_mfma_f32_16x16x32_bf16 v[196:199], a[244:247], v[128:131], 0
Bv 104,227,32768
DN 71,8,36,3072
v_add_f32 v247, v247, v211
WL 3
Mvav 192,248,132
Ba 240,227,40960
s_waitcnt vmcnt(23)
s_mov_b32 m0, 114688
s_lshl_b32 s48, s44, 12
s_add_u32 s48, s48, s34
s_add_u32 s36, s48, 512
DD 76,16,36,0
Mvav 196,252,132
Ba 244,224,33024
DD 77,16,36,1024
CV 209,210,211
WL 3
Mvvv 192,96,136
Ba 248,224,41216
DD 78,16,36,2048
v_exp_f32 v213, v213
Mvvv 196,100,136
Ba 252,225,33024
DD 79,16,36,3072
v_add_f32 v247, v247, v212
WL 3
Mvvv 192,104,140
Bv 96,225,41216
s_waitcnt vmcnt(23)
s_mov_b32 m0, 57344
s_add_u32 s36, s32, 172032
DN 64,8,36,0
Mvav 196,240,140
Bv 100,226,33024
DN 65,8,36,1024
v_exp_f32 v214, v214
WL 3
Mvav 192,244,144
Bv 104,226,41216
DN 66,8,36,2048
v_add_f32 v247, v247, v213
CV 210,212,213
Mvav 196,248,144
Ba 240,227,33024
DN 67,8,36,3072
v_exp_f32 v215, v215
WL 3
Mvav 192,252,148
Ba 244,227,41216
s_waitcnt vmcnt(23)
s_mov_b32 m0, 118784
s_add_u32 s36, s48, 131584
DD 76,16,36,0
Mvvv 196,96,148
Ta 248,228,0
Ta 250,228,8192
DD 77,16,36,1024
WL 4
Mvvv 192,100,152
Ta 252,229,0
Ta 254,229,8192
DD 78,16,36,2048
v_add_f32 v247, v247, v214
Mvvv 196,104,152
Tv 96,230,0
Tv 98,230,8192
v_add_f32 v247, v247, v215
WL 6
Mvav 192,240,156
Tv 100,231,0
Tv 102,231,8192
DD 79,16,36,3072
CV 211,214,215
Mvav 196,244,156
Tv 104,232,0
Tv 106,232,8192
s_waitcnt vmcnt(23)
s_mov_b32 m0, 61440
s_add_u32 s36, s32, 176128
DN 68,8,36,0
WL 6
Mvav 0,248,208
Ta 240,233,0
Ta 242,233,8192
DN 69,8,36,1024
Mvav 4,252,208
Ta 244,234,0
Ta 246,234,8192
DN 70,8,36,2048
v_fma_f32 v192, v192, s37, -v245
WL 6
Mvvv 8,96,208
Ta 248,235,0
Ta 250,235,8192
DN 71,8,36,3072
v_fma_f32 v193, v193, s37, -v245
Mvvv 12,100,208
Ta 252,228,256
Ta 254,228,8448
s_waitcnt vmcnt(23)
s_mov_b32 m0, 98304
s_add_u32 s36, s32, 147456
DN 72,12,36,0
WL 6
Mvvv 16,104,208
Tv 96,229,256
Tv 98,229,8448
DN 73,12,36,1024
v_fma_f32 v194, v194, s37, -v245
v_fma_f32 v195, v195, s37, -v245
Mvav 20,240,208
Tv 100,230,256
Tv 102,230,8448
DN 74,12,36,2048
v_fma_f32 v196, v196, s37, -v245
WL 6
Mvav 24,244,208
Tv 104,231,256
Tv 106,231,8448
DN 75,12,36,3072
v_fma_f32 v197, v197, s37, -v245
Mvav 28,248,208
Ta 240,232,256
Ta 242,232,8448
s_waitcnt vmcnt(23)
s_mov_b32 m0, 122880
s_add_u32 s36, s48, 33280
DD 76,16,36,0
WL 6
Mvav 32,252,208
Ta 244,233,256
Ta 246,233,8448
DD 77,16,36,1024
v_fma_f32 v198, v198, s37, -v245
Mvvv 36,96,208
Ta 248,234,256
Ta 250,234,8448
DD 78,16,36,2048
v_fma_f32 v199, v199, s37, -v245
WL 6
Mvvv 40,100,208
Ta 252,235,256
Ta 254,235,8448
DD 79,16,36,3072
v_max3_f32 v251, v192, v193, v194
Mvvv 44,104,208
Tv 96,236,32768
Tv 98,236,40960
s_waitcnt vmcnt(23)
s_mov_b32 m0, 102400
s_add_u32 s36, s32, 151552
DN 72,12,36,0
WL 6
Mvav 48,240,208
Tv 100,237,32768
Tv 102,237,40960
DN 73,12,36,1024
v_max3_f32 v252, v195, v196, v197
v_max3_f32 v251, v251, v198, v199
Mvav 52,244,208
Tv 104,238,32768
Tv 106,238,40960
v_max_f32 v251, v251, v252
v_cmp_lt_f32 vcc, s38, v251
WL 6
Mvav 56,248,208
Ta 240,239,32768
Ta 242,239,40960
DN 74,12,36,2048
s_cbranch_vccnz LB_ra15
LB_rb15:
Mvav 60,252,208
Ta 244,240,32768
Ta 246,240,40960
DN 75,12,36,3072
s_cmp_lg_u32 s49, 0
s_cbranch_scc1 LB_ra16
LB_rb16:
WL 6
Mava 0,96,152
Ta 248,241,32768
Ta 250,241,40960
s_waitcnt vmcnt(23)
s_mov_b32 m0, 106496
s_add_u32 s36, s32, 155648
DN 72,12,36,0
Mava 4,100,152
Ta 252,242,32768
Ta 254,242,40960
DN 73,12,36,1024
WL 6
Mava 8,104,152
Tv 96,243,32768
Tv 98,243,40960
DN 74,12,36,2048
v_exp_f32 v192, v192
Maaa 12,240,152
Tv 100,236,33024
Tv 102,236,41216
DN 75,12,36,3072
WL 6
Maaa 16,244,152
Tv 104,237,33024
Tv 106,237,41216
s_waitcnt vmcnt(23)
s_mov_b32 m0, 126976
s_add_u32 s36, s48, 164352
DD 76,16,36,0
Maaa 20,248,152
Ta 240,238,33024
Ta 242,238,41216
DD 77,16,36,1024
WL 6
Maaa 24,252,152
Ta 244,239,33024
Ta 246,239,41216
DD 78,16,36,2048
Mava 28,96,152
Ta 248,240,33024
Ta 250,240,41216
DD 79,16,36,3072
v_exp_f32 v193, v193
WL 6
Mava 32,100,152
Ta 252,241,33024
Ta 254,241,41216
s_waitcnt vmcnt(23)
s_mov_b32 m0, 110592
s_add_u32 s36, s32, 159744
DN 72,12,36,0
Mava 36,104,152
Tv 96,242,33024
Tv 98,242,41216
DN 73,12,36,1024
WL 6
Maaa 40,240,152
Tv 100,243,33024
Tv 102,243,41216
DN 74,12,36,2048
v_add_f32 v247, v247, v192
Maaa 44,244,152
DN 75,12,36,3072
v_exp_f32 v194, v194
WL 4
Maaa 48,248,152
v_add_f32 v247, v247, v193
CV 192,192,193
v_exp_f32 v195, v195
Maaa 52,252,152
s_waitcnt vmcnt(48) lgkmcnt(0)
s_barrier
Bv 104,224,16384
Ba 240,224,24576
Ba 244,225,16384
Mava 56,96,152
Ba 248,225,24576
s_waitcnt vmcnt(23)
s_mov_b32 m0, 0
s_add_u32 s36, s32, 180224
DN 64,8,36,0
Mava 60,100,152
Ba 252,226,16384
DN 65,8,36,1024
v_add_f32 v247, v247, v194
WL 3
v_mfma_f32_16x16x32_bf16 v[208:211], v[104:107], v[128:131], 0
Bv 96,226,24576
DN 66,8,36,2048
v_exp_f32 v196, v196
v_mfma_f32_16x16x32_bf16 v[212:215], a[240:243], v[128:131], 0
Bv 100,227,16384
DN 67,8,36,3072
v_add_f32 v247, v247, v195
WL 3
Mvav 208,244,132
Bv 104,227,24576
s_waitcnt vmcnt(23)
s_mov_b32 m0, 131072
s_lshl_b32 s48, s44, 12
s_add_u32 s48, s48, s34
s_add_u32 s36, s48, 262656
DD 76,16,36,0
Mvav 212,248,132
Ba 240,224,16640
DD 77,16,36,1024
CV 193,194,195
WL 3
Mvav 208,252,136
Ba 244,224,24832
DD 78,16,36,2048
v_exp_f32 v197, v197
Mvvv 212,96,136
Ba 248,225,16640
DD 79,16,36,3072
v_add_f32 v247, v247, v196
v_exp_f32 v198, v198
WL 3
Mvvv 208,100,140
Ba 252,225,24832
s_waitcnt vmcnt(23)
s_mov_b32 m0, 4096
s_add_u32 s36, s32, 184320
DN 68,8,36,0
Mvvv 212,104,140
Bv 96,226,16640
DN 69,8,36,1024
v_add_f32 v247, v247, v197
WL 3
Mvav 208,240,144
Bv 100,226,24832
DN 70,8,36,2048
CV 194,196,197
Mvav 212,244,144
Bv 104,227,16640
DN 71,8,36,3072
v_exp_f32 v199, v199
WL 3
Mvav 208,248,148
Ba 240,227,24832
s_waitcnt vmcnt(23)
s_mov_b32 m0, 135168
s_add_u32 s36, s48, 393728
DD 76,16,36,0
Mvav 212,252,148
Ta 244,228,16384
Ta 246,228,24576
DD 77,16,36,1024
WL 4
Mvvv 208,96,152
Ta 248,229,16384
Ta 250,229,24576
DD 78,16,36,2048
v_add_f32 v247, v247, v198
Mvvv 212,100,152
Ta 252,230,16384
Ta 254,230,24576
v_add_f32 v247, v247, v199
WL 6
Mvvv 208,104,156
Tv 96,231,16384
Tv 98,231,24576
DD 79,16,36,3072
CV 195,198,199
Mvav 212,240,156
Tv 100,232,16384
Tv 102,232,24576
s_waitcnt vmcnt(23)
s_mov_b32 m0, 8192
s_add_u32 s36, s32, 188416
DN 64,8,36,0
WL 6
Mvav 0,244,192
Tv 104,233,16384
Tv 106,233,24576
DN 65,8,36,1024
Mvav 4,248,192
Ta 240,234,16384
Ta 242,234,24576
DN 66,8,36,2048
v_fma_f32 v208, v208, s37, -v245
WL 6
Mvav 8,252,192
Ta 244,235,16384
Ta 246,235,24576
DN 67,8,36,3072
v_fma_f32 v209, v209, s37, -v245
Mvvv 12,96,192
Ta 248,228,16640
Ta 250,228,24832
s_waitcnt vmcnt(23)
s_mov_b32 m0, 12288
s_add_u32 s36, s32, 192512
DN 68,8,36,0
WL 6
Mvvv 16,100,192
Ta 252,229,16640
Ta 254,229,24832
DN 69,8,36,1024
v_fma_f32 v210, v210, s37, -v245
v_fma_f32 v211, v211, s37, -v245
Mvvv 20,104,192
Tv 96,230,16640
Tv 98,230,24832
DN 70,8,36,2048
v_fma_f32 v212, v212, s37, -v245
WL 6
Mvav 24,240,192
Tv 100,231,16640
Tv 102,231,24832
DN 71,8,36,3072
v_fma_f32 v213, v213, s37, -v245
Mvav 28,244,192
Tv 104,232,16640
Tv 106,232,24832
s_waitcnt vmcnt(23)
s_mov_b32 m0, 139264
s_add_u32 s36, s48, 295424
DD 76,16,36,0
WL 6
Mvav 32,248,192
Ta 240,233,16640
Ta 242,233,24832
DD 77,16,36,1024
v_fma_f32 v214, v214, s37, -v245
Mvav 36,252,192
Ta 244,234,16640
Ta 246,234,24832
DD 78,16,36,2048
v_fma_f32 v215, v215, s37, -v245
WL 6
Mvvv 40,96,192
Ta 248,235,16640
Ta 250,235,24832
DD 79,16,36,3072
v_max3_f32 v251, v208, v209, v210
Mvvv 44,100,192
Ta 252,236,49152
Ta 254,236,57344
s_waitcnt vmcnt(23)
s_mov_b32 m0, 65536
s_add_u32 s36, s32, 163840
DN 72,12,36,0
WL 6
Mvvv 48,104,192
Tv 96,237,49152
Tv 98,237,57344
DN 73,12,36,1024
v_max3_f32 v252, v211, v212, v213
v_max3_f32 v251, v251, v214, v215
Mvav 52,240,192
Tv 100,238,49152
Tv 102,238,57344
v_max_f32 v251, v251, v252
v_cmp_lt_f32 vcc, s38, v251
WL 6
Mvav 56,244,192
Tv 104,239,49152
Tv 106,239,57344
DN 74,12,36,2048
s_cbranch_vccnz LB_ra17
LB_rb17:
Mvav 60,248,192
Ta 240,240,49152
Ta 242,240,57344
DN 75,12,36,3072
s_cmp_lg_u32 s49, 0
s_cbranch_scc1 LB_ra18
LB_rb18:
WL 6
Maaa 0,252,156
Ta 244,241,49152
Ta 246,241,57344
s_waitcnt vmcnt(23)
s_mov_b32 m0, 69632
s_add_u32 s36, s32, 167936
DN 72,12,36,0
Mava 4,96,156
Ta 248,242,49152
Ta 250,242,57344
DN 73,12,36,1024
WL 6
Mava 8,100,156
Ta 252,243,49152
Ta 254,243,57344
DN 74,12,36,2048
v_exp_f32 v208, v208
Mava 12,104,156
Tv 96,236,49408
Tv 98,236,57600
DN 75,12,36,3072
WL 6
Maaa 16,240,156
Tv 100,237,49408
Tv 102,237,57600
s_waitcnt vmcnt(23)
s_mov_b32 m0, 143360
s_add_u32 s36, s48, 426496
DD 76,16,36,0
Maaa 20,244,156
Tv 104,238,49408
Tv 106,238,57600
DD 77,16,36,1024
WL 6
Maaa 24,248,156
Ta 240,239,49408
Ta 242,239,57600
DD 78,16,36,2048
v_exp_f32 v209, v209
Maaa 28,252,156
Ta 244,240,49408
Ta 246,240,57600
DD 79,16,36,3072
WL 6
Mava 32,96,156
Ta 248,241,49408
Ta 250,241,57600
s_waitcnt vmcnt(23)
s_mov_b32 m0, 73728
s_add_u32 s36, s32, 172032
DN 72,12,36,0
Mava 36,100,156
Ta 252,242,49408
Ta 254,242,57600
DN 73,12,36,1024
WL 6
Mava 40,104,156
Tv 96,243,49408
Tv 98,243,57600
DN 74,12,36,2048
v_add_f32 v247, v247, v208
Maaa 44,240,156
DN 75,12,36,3072
v_exp_f32 v210, v210
v_add_f32 v247, v247, v209
WL 4
Maaa 48,244,156
CV 208,208,209
v_exp_f32 v211, v211
Maaa 52,248,156
s_waitcnt vmcnt(44) lgkmcnt(0)
s_barrier
Bv 100,224,49152
Bv 104,224,57344
Ba 240,225,49152
Maaa 56,252,156
Ba 244,225,57344
s_waitcnt vmcnt(23)
s_mov_b32 m0, 77824
s_add_u32 s36, s32, 176128
DN 72,12,36,0
DN 73,12,36,1024
Mava 60,96,156
Ba 248,226,49152
DN 74,12,36,2048
v_add_f32 v247, v247, v210
v_exp_f32 v212, v212
WL 3
v_mfma_f32_16x16x32_bf16 v[192:195], v[100:103], v[128:131], 0
Ba 252,226,57344
DN 75,12,36,3072
v_add_f32 v247, v247, v211
v_mfma_f32_16x16x32_bf16 v[196:199], v[104:107], v[128:131], 0
Bv 96,227,49152
s_waitcnt vmcnt(23)
s_mov_b32 m0, 147456
s_lshl_b32 s48, s45, 12
s_add_u32 s48, s48, s34
s_add_u32 s36, s48, 512
DD 76,16,36,0
WL 3
Mvav 192,240,132
Bv 100,227,57344
DD 77,16,36,1024
CV 209,210,211
Mvav 196,244,132
Bv 104,224,49408
DD 78,16,36,2048
v_exp_f32 v213, v213
WL 3
Mvav 192,248,136
Ba 240,224,57600
DD 79,16,36,3072
v_add_f32 v247, v247, v212
Mvav 196,252,136
Ba 244,225,49408
s_waitcnt vmcnt(23)
s_mov_b32 m0, 16384
s_add_u32 s36, s32, 196608
DN 64,8,36,0
WL 3
Mvvv 192,96,140
Ba 248,225,57600
DN 65,8,36,1024
v_exp_f32 v214, v214
Mvvv 196,100,140
Ba 252,226,49408
DN 66,8,36,2048
v_add_f32 v247, v247, v213
CV 210,212,213
WL 3
Mvvv 192,104,144
Bv 96,226,57600
DN 67,8,36,3072
v_exp_f32 v215, v215
Mvav 196,240,144
Bv 100,227,49408
s_waitcnt vmcnt(23)
s_mov_b32 m0, 20480
s_add_u32 s36, s32, 200704
DN 68,8,36,0
WL 3
Mvav 192,244,148
Bv 104,227,57600
DN 69,8,36,1024
v_add_f32 v247, v247, v214
Mvav 196,248,148
Ta 240,228,32768
Ta 242,228,40960
DN 70,8,36,2048
v_add_f32 v247, v247, v215
WL 4
Mvav 192,252,152
Ta 244,229,32768
Ta 246,229,40960
DN 71,8,36,3072
Mvvv 196,96,152
Ta 248,230,32768
Ta 250,230,40960
s_waitcnt vmcnt(23)
s_mov_b32 m0, 151552
s_add_u32 s36, s48, 131584
DD 76,16,36,0
WL 6
Mvvv 192,100,156
Ta 252,231,32768
Ta 254,231,40960
DD 77,16,36,1024
CV 211,214,215
Mvvv 196,104,156
Tv 96,232,32768
Tv 98,232,40960
DD 78,16,36,2048
WL 6
Mvav 0,240,208
Tv 100,233,32768
Tv 102,233,40960
DD 79,16,36,3072
Mvav 4,244,208
Tv 104,234,32768
Tv 106,234,40960
s_waitcnt vmcnt(23)
s_mov_b32 m0, 24576
s_add_u32 s36, s32, 204800
DN 64,8,36,0
WL 6
Mvav 8,248,208
Ta 240,235,32768
Ta 242,235,40960
DN 65,8,36,1024
v_fma_f32 v192, v192, s37, -v245
Mvav 12,252,208
Ta 244,228,33024
Ta 246,228,41216
DN 66,8,36,2048
v_fma_f32 v193, v193, s37, -v245
v_fma_f32 v194, v194, s37, -v245
WL 6
Mvvv 16,96,208
Ta 248,229,33024
Ta 250,229,41216
DN 67,8,36,3072
v_fma_f32 v195, v195, s37, -v245
Mvvv 20,100,208
Ta 252,230,33024
Ta 254,230,41216
s_waitcnt vmcnt(23)
s_mov_b32 m0, 28672
s_add_u32 s36, s32, 208896
DN 68,8,36,0
WL 6
Mvvv 24,104,208
Tv 96,231,33024
Tv 98,231,41216
DN 69,8,36,1024
v_fma_f32 v196, v196, s37, -v245
v_fma_f32 v197, v197, s37, -v245
Mvav 28,240,208
Tv 100,232,33024
Tv 102,232,41216
DN 70,8,36,2048
v_fma_f32 v198, v198, s37, -v245
WL 6
Mvav 32,244,208
Tv 104,233,33024
Tv 106,233,41216
DN 71,8,36,3072
v_fma_f32 v199, v199, s37, -v245
Mvav 36,248,208
Ta 240,234,33024
Ta 242,234,41216
s_waitcnt vmcnt(23)
s_mov_b32 m0, 155648
s_add_u32 s36, s48, 33280
DD 76,16,36,0
WL 6
Mvav 40,252,208
Ta 244,235,33024
Ta 246,235,41216
DD 77,16,36,1024
v_max3_f32 v251, v192, v193, v194
v_max3_f32 v252, v195, v196, v197
Mvvv 44,96,208
Ta 248,236,16384
Ta 250,236,24576
DD 78,16,36,2048
v_max3_f32 v251, v251, v198, v199
WL 6
Mvvv 48,100,208
Ta 252,237,16384
Ta 254,237,24576
DD 79,16,36,3072
v_max_f32 v251, v251, v252
v_cmp_lt_f32 vcc, s38, v251
Mvvv 52,104,208
Tv 96,238,16384
Tv 98,238,24576
s_waitcnt vmcnt(23)
s_mov_b32 m0, 81920
s_add_u32 s36, s32, 180224
DN 72,12,36,0
WL 6
Mvav 56,240,208
Tv 100,239,16384
Tv 102,239,24576
DN 73,12,36,1024
s_cbranch_vccnz LB_ra19
LB_rb19:
Mvav 60,244,208
Tv 104,240,16384
Tv 106,240,24576
DN 74,12,36,2048
s_cmp_lg_u32 s49, 0
s_cbranch_scc1 LB_ra20
LB_rb20:
WL 6
Maaa 0,248,160
Ta 240,241,16384
Ta 242,241,24576
DN 75,12,36,3072
Maaa 4,252,160
Ta 244,242,16384
Ta 246,242,24576
s_waitcnt vmcnt(23)
s_mov_b32 m0, 86016
s_add_u32 s36, s32, 184320
DN 72,12,36,0
WL 6
Mava 8,96,160
Ta 248,243,16384
Ta 250,243,24576
DN 73,12,36,1024
v_exp_f32 v192, v192
Mava 12,100,160
Ta 252,236,16640
Ta 254,236,24832
DN 74,12,36,2048
WL 6
Mava 16,104,160
Tv 96,237,16640
Tv 98,237,24832
DN 75,12,36,3072
Maaa 20,240,160
Tv 100,238,16640
Tv 102,238,24832
s_waitcnt vmcnt(23)
s_mov_b32 m0, 159744
s_add_u32 s36, s48, 164352
DD 76,16,36,0
WL 6
Maaa 24,244,160
Tv 104,239,16640
Tv 106,239,24832
DD 77,16,36,1024
v_exp_f32 v193, v193
Maaa 28,248,160
Ta 240,240,16640
Ta 242,240,24832
DD 78,16,36,2048
WL 6
Maaa 32,252,160
Ta 244,241,16640
Ta 246,241,24832
DD 79,16,36,3072
Mava 36,96,160
Ta 248,242,16640
Ta 250,242,24832
s_waitcnt vmcnt(23)
s_mov_b32 m0, 90112
s_add_u32 s36, s32, 188416
DN 72,12,36,0
WL 6
Mava 40,100,160
Ta 252,243,16640
Ta 254,243,24832
DN 73,12,36,1024
v_add_f32 v247, v247, v192
Mava 44,104,160
DN 74,12,36,2048
v_exp_f32 v194, v194
WL 4
Maaa 48,240,160
DN 75,12,36,3072
v_add_f32 v247, v247, v193
CV 192,192,193
v_exp_f32 v195, v195
Maaa 52,244,160
s_waitcnt vmcnt(44) lgkmcnt(0)
s_barrier
Bv 96,224,0
Bv 100,224,8192
Bv 104,225,0
Maaa 56,248,160
Ba 240,225,8192
s_waitcnt vmcnt(23)
s_mov_b32 m0, 94208
s_add_u32 s36, s32, 192512
DN 72,12,36,0
Maaa 60,252,160
Ba 244,226,0
DN 73,12,36,1024
v_add_f32 v247, v247, v194
WL 3
v_mfma_f32_16x16x32_bf16 v[208:211], v[96:99], v[128:131], 0
Ba 248,226,8192
DN 74,12,36,2048
v_exp_f32 v196, v196
v_mfma_f32_16x16x32_bf16 v[212:215], v[100:103], v[128:131], 0
Ba 252,227,0
DN 75,12,36,3072
v_add_f32 v247, v247, v195
WL 3
Mvvv 208,104,132
Bv 96,227,8192
s_waitcnt vmcnt(23)
s_mov_b32 m0, 114688
s_lshl_b32 s48, s45, 12
s_add_u32 s48, s48, s34
s_add_u32 s36, s48, 262656
DD 76,16,36,0
Mvav 212,240,132
Bv 100,224,256
DD 77,16,36,1024
CV 193,194,195
WL 3
Mvav 208,244,136
Bv 104,224,8448
DD 78,16,36,2048
v_exp_f32 v197, v197
Mvav 212,248,136
Ba 240,225,256
DD 79,16,36,3072
v_add_f32 v247, v247, v196
WL 3
Mvav 208,252,140
Ba 244,225,8448
s_waitcnt vmcnt(23)
s_mov_b32 m0, 32768
s_add_u32 s36, s32, 212992
DN 64,8,36,0
Mvvv 212,96,140
Ba 248,226,256
DN 65,8,36,1024
v_exp_f32 v198, v198
WL 3
Mvvv 208,100,144
Ba 252,226,8448
DN 66,8,36,2048
v_add_f32 v247, v247, v197
CV 194,196,197
Mvvv 212,104,144
Bv 96,227,256
DN 67,8,36,3072
v_exp_f32 v199, v199
WL 3
Mvav 208,240,148
Bv 100,227,8448
s_waitcnt vmcnt(23)
s_mov_b32 m0, 118784
s_add_u32 s36, s48, 393728
DD 76,16,36,0
Mvav 212,244,148
Tv 104,228,0
Tv 106,228,8192
DD 77,16,36,1024
WL 4
Mvav 208,248,152
Ta 240,229,0
Ta 242,229,8192
DD 78,16,36,2048
v_add_f32 v247, v247, v198
Mvav 212,252,152
Ta 244,230,0
Ta 246,230,8192
v_add_f32 v247, v247, v199
WL 6
Mvvv 208,96,156
Ta 248,231,0
Ta 250,231,8192
DD 79,16,36,3072
CV 195,198,199
Mvvv 212,100,156
Ta 252,232,0
Ta 254,232,8192
s_waitcnt vmcnt(23)
s_mov_b32 m0, 36864
s_add_u32 s36, s32, 217088
DN 68,8,36,0
WL 6
Mvvv 0,104,192
Tv 96,233,0
Tv 98,233,8192
DN 69,8,36,1024
Mvav 4,240,192
Tv 100,234,0
Tv 102,234,8192
DN 70,8,36,2048
v_fma_f32 v208, v208, s37, -v245
WL 6
Mvav 8,244,192
Tv 104,235,0
Tv 106,235,8192
DN 71,8,36,3072
v_fma_f32 v209, v209, s37, -v245
Mvav 12,248,192
Ta 240,228,256
Ta 242,228,8448
s_waitcnt vmcnt(23)
s_mov_b32 m0, 40960
s_add_u32 s36, s32, 221184
DN 64,8,36,0
WL 6
Mvav 16,252,192
Ta 244,229,256
Ta 246,229,8448
DN 65,8,36,1024
v_fma_f32 v210, v210, s37, -v245
v_fma_f32 v211, v211, s37, -v245
Mvvv 20,96,192
Ta 248,230,256
Ta 250,230,8448
DN 66,8,36,2048
v_fma_f32 v212, v212, s37, -v245
WL 6
Mvvv 24,100,192
Ta 252,231,256
Ta 254,231,8448
DN 67,8,36,3072
v_fma_f32 v213, v213, s37, -v245
Mvvv 28,104,192
Tv 96,232,256
Tv 98,232,8448
s_waitcnt vmcnt(23)
s_mov_b32 m0, 122880
s_add_u32 s36, s48, 295424
DD 76,16,36,0
WL 6
Mvav 32,240,192
Tv 100,233,256
Tv 102,233,8448
DD 77,16,36,1024
v_fma_f32 v214, v214, s37, -v245
Mvav 36,244,192
Tv 104,234,256
Tv 106,234,8448
DD 78,16,36,2048
v_fma_f32 v215, v215, s37, -v245
WL 6
Mvav 40,248,192
Ta 240,235,256
Ta 242,235,8448
DD 79,16,36,3072
v_max3_f32 v251, v208, v209, v210
Mvav 44,252,192
Ta 244,236,32768
Ta 246,236,40960
s_waitcnt vmcnt(23)
s_mov_b32 m0, 45056
s_add_u32 s36, s32, 225280
DN 68,8,36,0
WL 6
Mvvv 48,96,192
Ta 248,237,32768
Ta 250,237,40960
DN 69,8,36,1024
v_max3_f32 v252, v211, v212, v213
v_max3_f32 v251, v251, v214, v215
Mvvv 52,100,192
Ta 252,238,32768
Ta 254,238,40960
v_max_f32 v251, v251, v252
v_cmp_lt_f32 vcc, s38, v251
WL 6
Mvvv 56,104,192
Tv 96,239,32768
Tv 98,239,40960
DN 70,8,36,2048
s_cbranch_vccnz LB_ra21
LB_rb21:
Mvav 60,240,192
Tv 100,240,32768
Tv 102,240,40960
DN 71,8,36,3072
s_cmp_lg_u32 s49, 0
s_cbranch_scc1 LB_ra22
LB_rb22:
WL 6
Maaa 0,244,164
Tv 104,241,32768
Tv 106,241,40960
s_waitcnt vmcnt(23)
s_mov_b32 m0, 98304
s_add_u32 s36, s32, 196608
DN 72,12,36,0
Maaa 4,248,164
Ta 240,242,32768
Ta 242,242,40960
DN 73,12,36,1024
WL 6
Maaa 8,252,164
Ta 244,243,32768
Ta 246,243,40960
DN 74,12,36,2048
v_exp_f32 v208, v208
Mava 12,96,164
Ta 248,236,33024
Ta 250,236,41216
DN 75,12,36,3072
WL 6
Mava 16,100,164
Ta 252,237,33024
Ta 254,237,41216
s_waitcnt vmcnt(23)
s_mov_b32 m0, 126976
s_add_u32 s36, s48, 426496
DD 76,16,36,0
Mava 20,104,164
Tv 96,238,33024
Tv 98,238,41216
DD 77,16,36,1024
WL 6
Maaa 24,240,164
Tv 100,239,33024
Tv 102,239,41216
DD 78,16,36,2048
Maaa 28,244,164
Tv 104,240,33024
Tv 106,240,41216
DD 79,16,36,3072
v_exp_f32 v209, v209
WL 6
Maaa 32,248,164
Ta 240,241,33024
Ta 242,241,41216
s_waitcnt vmcnt(23)
s_mov_b32 m0, 102400
s_add_u32 s36, s32, 200704
DN 72,12,36,0
Maaa 36,252,164
Ta 244,242,33024
Ta 246,242,41216
DN 73,12,36,1024
WL 6
Mava 40,96,164
Ta 248,243,33024
Ta 250,243,41216
DN 74,12,36,2048
v_add_f32 v247, v247, v208
Mava 44,100,164
DN 75,12,36,3072
v_exp_f32 v210, v210
WL 4
Mava 48,104,164
v_add_f32 v247, v247, v209
CV 208,208,209
v_exp_f32 v211, v211
Maaa 52,240,164
s_waitcnt vmcnt(40) lgkmcnt(0)
s_barrier
Ba 252,224,16384
Bv 96,224,24576
Bv 100,225,16384
Maaa 56,244,164
Bv 104,225,24576
s_waitcnt vmcnt(23)
s_mov_b32 m0, 106496
s_add_u32 s36, s32, 204800
DN 72,12,36,0
Maaa 60,248,164
Ba 240,226,16384
DN 73,12,36,1024
v_add_f32 v247, v247, v210
WL 3
v_mfma_f32_16x16x32_bf16 v[192:195], a[252:255], v[128:131], 0
Ba 244,226,24576
DN 74,12,36,2048
v_exp_f32 v212, v212
v_mfma_f32_16x16x32_bf16 v[196:199], v[96:99], v[128:131], 0
Ba 248,227,16384
DN 75,12,36,3072
v_add_f32 v247, v247, v211
WL 3
Mvvv 192,100,132
Ba 252,227,24576
s_waitcnt vmcnt(23)
s_mov_b32 m0, 131072
s_lshl_b32 s48, s46, 12
s_add_u32 s48, s48, s34
s_add_u32 s36, s48, 512
DD 76,16,36,0
Mvvv 196,104,132
Bv 96,224,16640
DD 77,16,36,1024
CV 209,210,211
WL 3
Mvav 192,240,136
Bv 100,224,24832
DD 78,16,36,2048
v_exp_f32 v213, v213
Mvav 196,244,136
Bv 104,225,16640
DD 79,16,36,3072
v_add_f32 v247, v247, v212
v_exp_f32 v214, v214
WL 3
Mvav 192,248,140
Ba 240,225,24832
s_waitcnt vmcnt(23)
s_mov_b32 m0, 110592
s_add_u32 s36, s32, 208896
DN 72,12,36,0
Mvav 196,252,140
Ba 244,226,16640
DN 73,12,36,1024
v_add_f32 v247, v247, v213
WL 3
Mvvv 192,96,144
Ba 248,226,24832
DN 74,12,36,2048
CV 210,212,213
Mvvv 196,100,144
Ba 252,227,16640
DN 75,12,36,3072
v_exp_f32 v215, v215
WL 3
Mvvv 192,104,148
Bv 96,227,24832
s_waitcnt vmcnt(23)
s_mov_b32 m0, 135168
s_add_u32 s36, s48, 131584
DD 76,16,36,0
Mvav 196,240,148
Tv 100,228,16384
Tv 102,228,24576
DD 77,16,36,1024
WL 4
Mvav 192,244,152
Tv 104,229,16384
Tv 106,229,24576
DD 78,16,36,2048
v_add_f32 v247, v247, v214
Mvav 196,248,152
Ta 240,230,16384
Ta 242,230,24576
v_add_f32 v247, v247, v215
WL 6
Mvav 192,252,156
Ta 244,231,16384
Ta 246,231,24576
DD 79,16,36,3072
CV 211,214,215
Mvvv 196,96,156
Ta 248,232,16384
Ta 250,232,24576
s_waitcnt vmcnt(23)
s_mov_b32 m0, 0
s_add_u32 s36, s32, 229376
DN 64,8,36,0
WL 6
Mvvv 0,100,208
Ta 252,233,16384
Ta 254,233,24576
DN 65,8,36,1024
Mvvv 4,104,208
Tv 96,234,16384
Tv 98,234,24576
DN 66,8,36,2048
v_fma_f32 v192, v192, s37, -v245
WL 6
Mvav 8,240,208
Tv 100,235,16384
Tv 102,235,24576
DN 67,8,36,3072
v_fma_f32 v193, v193, s37, -v245
Mvav 12,244,208
Tv 104,228,16640
Tv 106,228,24832
s_waitcnt vmcnt(23)
s_mov_b32 m0, 4096
s_add_u32 s36, s32, 233472
DN 68,8,36,0
WL 6
Mvav 16,248,208
Ta 240,229,16640
Ta 242,229,24832
DN 69,8,36,1024
v_fma_f32 v194, v194, s37, -v245
v_fma_f32 v195, v195, s37, -v245
Mvav 20,252,208
Ta 244,230,16640
Ta 246,230,24832
DN 70,8,36,2048
v_fma_f32 v196, v196, s37, -v245
WL 6
Mvvv 24,96,208
Ta 248,231,16640
Ta 250,231,24832
DN 71,8,36,3072
v_fma_f32 v197, v197, s37, -v245
Mvvv 28,100,208
Ta 252,232,16640
Ta 254,232,24832
s_waitcnt vmcnt(23)
s_mov_b32 m0, 139264
s_add_u32 s36, s48, 33280
DD 76,16,36,0
WL 6
Mvvv 32,104,208
Tv 96,233,16640
Tv 98,233,24832
DD 77,16,36,1024
v_fma_f32 v198, v198, s37, -v245
Mvav 36,240,208
Tv 100,234,16640
Tv 102,234,24832
DD 78,16,36,2048
v_fma_f32 v199, v199, s37, -v245
WL 6
Mvav 40,244,208
Tv 104,235,16640
Tv 106,235,24832
DD 79,16,36,3072
v_max3_f32 v251, v192, v193, v194
Mvav 44,248,208
Ta 240,236,49152
Ta 242,236,57344
s_waitcnt vmcnt(23)
s_mov_b32 m0, 8192
s_add_u32 s36, s32, 237568
DN 64,8,36,0
WL 6
Mvav 48,252,208
Ta 244,237,49152
Ta 246,237,57344
DN 65,8,36,1024
v_max3_f32 v252, v195, v196, v197
v_max3_f32 v251, v251, v198, v199
Mvvv 52,96,208
Ta 248,238,49152
Ta 250,238,57344
v_max_f32 v251, v251, v252
v_cmp_lt_f32 vcc, s38, v251
WL 6
Mvvv 56,100,208
Ta 252,239,49152
Ta 254,239,57344
DN 66,8,36,2048
s_cbranch_vccnz LB_ra23
LB_rb23:
Mvvv 60,104,208
Tv 96,240,49152
Tv 98,240,57344
DN 67,8,36,3072
s_cmp_lg_u32 s49, 0
s_cbranch_scc1 LB_ra24
LB_rb24:
WL 6
Maaa 0,240,168
Tv 100,241,49152
Tv 102,241,57344
s_waitcnt vmcnt(23)
s_mov_b32 m0, 12288
s_add_u32 s36, s32, 241664
DN 68,8,36,0
Maaa 4,244,168
Tv 104,242,49152
Tv 106,242,57344
DN 69,8,36,1024
WL 6
Maaa 8,248,168
Ta 240,243,49152
Ta 242,243,57344
DN 70,8,36,2048
v_exp_f32 v192, v192
Maaa 12,252,168
Ta 244,236,49408
Ta 246,236,57600
DN 71,8,36,3072
WL 6
Mava 16,96,168
Ta 248,237,49408
Ta 250,237,57600
s_waitcnt vmcnt(23)
s_mov_b32 m0, 143360
s_add_u32 s36, s48, 164352
DD 76,16,36,0
Mava 20,100,168
Ta 252,238,49408
Ta 254,238,57600
DD 77,16,36,1024
WL 6
Mava 24,104,168
Tv 96,239,49408
Tv 98,239,57600
DD 78,16,36,2048
v_exp_f32 v193, v193
Maaa 28,240,168
Tv 100,240,49408
Tv 102,240,57600
DD 79,16,36,3072
WL 6
Maaa 32,244,168
Tv 104,241,49408
Tv 106,241,57600
s_waitcnt vmcnt(23)
s_mov_b32 m0, 65536
s_add_u32 s36, s32, 212992
DN 72,12,36,0
Maaa 36,248,168
Ta 240,242,49408
Ta 242,242,57600
DN 73,12,36,1024
WL 6
Maaa 40,252,168
Ta 244,243,49408
Ta 246,243,57600
DN 74,12,36,2048
v_add_f32 v247, v247, v192
Mava 44,96,168
DN 75,12,36,3072
v_exp_f32 v194, v194
v_add_f32 v247, v247, v193
WL 4
Mava 48,100,168
CV 192,192,193
v_exp_f32 v195, v195
Mava 52,104,168
s_waitcnt vmcnt(32) lgkmcnt(0)
s_barrier
Ba 248,224,32768
Ba 252,224,40960
Bv 96,225,32768
Maaa 56,240,168
Bv 100,225,40960
s_waitcnt vmcnt(23)
s_mov_b32 m0, 69632
s_add_u32 s36, s32, 217088
DN 72,12,36,0
DN 73,12,36,1024
Maaa 60,244,168
Bv 104,226,32768
DN 74,12,36,2048
v_add_f32 v247, v247, v194
v_exp_f32 v196, v196
WL 3
v_mfma_f32_16x16x32_bf16 v[208:211], a[248:251], v[128:131], 0
Ba 240,226,40960
DN 75,12,36,3072
v_add_f32 v247, v247, v195
v_mfma_f32_16x16x32_bf16 v[212:215], a[252:255], v[128:131], 0
Ba 244,227,32768
s_waitcnt vmcnt(23)
s_mov_b32 m0, 147456
s_lshl_b32 s48, s46, 12
s_add_u32 s48, s48, s34
s_add_u32 s36, s48, 262656
DD 76,16,36,0
WL 3
Mvvv 208,96,132
Ba 248,227,40960
DD 77,16,36,1024
CV 193,194,195
Mvvv 212,100,132
Ba 252,224,33024
DD 78,16,36,2048
v_exp_f32 v197, v197
WL 3
Mvvv 208,104,136
Bv 96,224,41216
DD 79,16,36,3072
v_add_f32 v247, v247, v196
Mvav 212,240,136
Bv 100,225,33024
s_waitcnt vmcnt(23)
s_mov_b32 m0, 73728
s_add_u32 s36, s32, 221184
DN 72,12,36,0
WL 3
Mvav 208,244,140
Bv 104,225,41216
DN 73,12,36,1024
v_exp_f32 v198, v198
Mvav 212,248,140
Ba 240,226,33024
DN 74,12,36,2048
v_add_f32 v247, v247, v197
CV 194,196,197
WL 3
Mvav 208,252,144
Ba 244,226,41216
DN 75,12,36,3072
v_exp_f32 v199, v199
Mvvv 212,96,144
Ba 248,227,33024
s_waitcnt vmcnt(23)
s_mov_b32 m0, 77824
s_add_u32 s36, s32, 225280
DN 72,12,36,0
WL 3
Mvvv 208,100,148
Ba 252,227,41216
DN 73,12,36,1024
v_add_f32 v247, v247, v198
Mvvv 212,104,148
Tv 96,228,32768
Tv 98,228,40960
DN 74,12,36,2048
v_add_f32 v247, v247, v199
WL 4
Mvav 208,240,152
Tv 100,229,32768
Tv 102,229,40960
DN 75,12,36,3072
Mvav 212,244,152
Tv 104,230,32768
Tv 106,230,40960
s_waitcnt vmcnt(23)
s_mov_b32 m0, 151552
s_add_u32 s36, s48, 393728
DD 76,16,36,0
WL 6
Mvav 208,248,156
Ta 240,231,32768
Ta 242,231,40960
DD 77,16,36,1024
CV 195,198,199
Mvav 212,252,156
Ta 244,232,32768
Ta 246,232,40960
DD 78,16,36,2048
WL 6
Mvvv 0,96,192
Ta 248,233,32768
Ta 250,233,40960
DD 79,16,36,3072
Mvvv 4,100,192
Ta 252,234,32768
Ta 254,234,40960
s_waitcnt vmcnt(23)
s_mov_b32 m0, 16384
s_add_u32 s36, s32, 245760
DN 64,8,36,0
WL 6
Mvvv 8,104,192
Tv 96,235,32768
Tv 98,235,40960
DN 65,8,36,1024
v_fma_f32 v208, v208, s37, -v245
Mvav 12,240,192
Tv 100,228,33024
Tv 102,228,41216
DN 66,8,36,2048
v_fma_f32 v209, v209, s37, -v245
v_fma_f32 v210, v210, s37, -v245
WL 6
Mvav 16,244,192
Tv 104,229,33024
Tv 106,229,41216
DN 67,8,36,3072
v_fma_f32 v211, v211, s37, -v245
Mvav 20,248,192
Ta 240,230,33024
Ta 242,230,41216
s_waitcnt vmcnt(23)
s_mov_b32 m0, 20480
s_add_u32 s36, s32, 249856
DN 68,8,36,0
WL 6
Mvav 24,252,192
Ta 244,231,33024
Ta 246,231,41216
DN 69,8,36,1024
v_fma_f32 v212, v212, s37, -v245
v_fma_f32 v213, v213, s37, -v245
Mvvv 28,96,192
Ta 248,232,33024
Ta 250,232,41216
DN 70,8,36,2048
v_fma_f32 v214, v214, s37, -v245
WL 6
Mvvv 32,100,192
Ta 252,233,33024
Ta 254,233,41216
DN 71,8,36,3072
v_fma_f32 v215, v215, s37, -v245
Mvvv 36,104,192
Tv 96,234,33024
Tv 98,234,41216
s_waitcnt vmcnt(23)
s_mov_b32 m0, 155648
s_add_u32 s36, s48, 295424
DD 76,16,36,0
WL 6
Mvav 40,240,192
Tv 100,235,33024
Tv 102,235,41216
DD 77,16,36,1024
v_max3_f32 v251, v208, v209, v210
v_max3_f32 v252, v211, v212, v213
Mvav 44,244,192
Tv 104,236,16384
Tv 106,236,24576
DD 78,16,36,2048
v_max3_f32 v251, v251, v214, v215
WL 6
Mvav 48,248,192
Ta 240,237,16384
Ta 242,237,24576
DD 79,16,36,3072
v_max_f32 v251, v251, v252
v_cmp_lt_f32 vcc, s38, v251
Mvav 52,252,192
Ta 244,238,16384
Ta 246,238,24576
s_waitcnt vmcnt(23)
s_mov_b32 m0, 24576
s_add_u32 s36, s32, 253952
DN 64,8,36,0
WL 6
Mvvv 56,96,192
Ta 248,239,16384
Ta 250,239,24576
DN 65,8,36,1024
s_cbranch_vccnz LB_ra25
LB_rb25:
Mvvv 60,100,192
Ta 252,240,16384
Ta 254,240,24576
DN 66,8,36,2048
s_cmp_lg_u32 s49, 0
s_cbranch_scc1 LB_ra26
LB_rb26:
WL 6
Mava 0,104,172
Tv 96,241,16384
Tv 98,241,24576
DN 67,8,36,3072
Maaa 4,240,172
Tv 100,242,16384
Tv 102,242,24576
s_waitcnt vmcnt(23)
s_mov_b32 m0, 28672
s_add_u32 s36, s32, 258048
DN 68,8,36,0
WL 6
Maaa 8,244,172
Tv 104,243,16384
Tv 106,243,24576
DN 69,8,36,1024
Maaa 12,248,172
Ta 240,236,16640
Ta 242,236,24832
DN 70,8,36,2048
WL 6
Maaa 16,252,172
Ta 244,237,16640
Ta 246,237,24832
DN 71,8,36,3072
v_exp_f32 v208, v208
Mava 20,96,172
Ta 248,238,16640
Ta 250,238,24832
s_waitcnt vmcnt(23)
s_mov_b32 m0, 159744
s_add_u32 s36, s48, 426496
DD 76,16,36,0
WL 6
Mava 24,100,172
Ta 252,239,16640
Ta 254,239,24832
DD 77,16,36,1024
Mava 28,104,172
Tv 96,240,16640
Tv 98,240,24832
DD 78,16,36,2048
WL 6
Maaa 32,240,172
Tv 100,241,16640
Tv 102,241,24832
DD 79,16,36,3072
Maaa 36,244,172
Tv 104,242,16640
Tv 106,242,24832
s_waitcnt vmcnt(23)
s_mov_b32 m0, 81920
s_add_u32 s36, s32, 229376
DN 72,12,36,0
v_mbcnt_lo_u32_b32 v253, -1, 0
v_mbcnt_hi_u32_b32 v253, -1, v253
v_lshrrev_b32 v254, 3, v253
v_and_b32 v254, 6, v254
v_xor_b32 v254, v253, v254
v_and_b32 v254, 7, v254
v_lshlrev_b32 v254, 4, v254
v_lshrrev_b32 v76, 3, v253
v_mul_u32_u24 v76, 896, v76
v_add_u32 v76, v76, v254
v_add_u32 v77, 6144, v76
v_add_u32 v78, 6144, v77
v_add_u32 v79, 6144, v78
s_mov_b32 s7, s51
s_add_u32 s7, s7, 1
s_sub_u32 s5, s7, 7
s_cselect_b32 s7, s7, s5
s_lshl_b32 s46, s7, 7
s_add_u32 s7, s7, 1
s_sub_u32 s5, s7, 7
s_cselect_b32 s7, s7, s5
s_lshl_b32 s45, s7, 7
s_add_u32 s7, s7, 1
s_sub_u32 s5, s7, 7
s_cselect_b32 s7, s7, s5
s_lshl_b32 s40, s7, 7
s_add_u32 s7, s7, 1
s_sub_u32 s5, s7, 7
s_cselect_b32 s7, s7, s5
s_lshl_b32 s44, s7, 7
s_add_u32 s7, s7, 1
s_sub_u32 s5, s7, 7
s_cselect_b32 s7, s7, s5
s_lshl_b32 s41, s7, 7
s_add_u32 s7, s7, 1
s_sub_u32 s5, s7, 7
s_cselect_b32 s7, s7, s5
s_lshl_b32 s43, s7, 7
s_add_u32 s7, s7, 1
s_sub_u32 s5, s7, 7
s_cselect_b32 s7, s7, s5
s_lshl_b32 s42, s7, 7
WL 6
Maaa 40,248,172
Ta 240,243,16640
Ta 242,243,24832
DN 73,12,36,1024
Maaa 44,252,172
DN 74,12,36,2048
v_exp_f32 v209, v209
v_add_f32 v247, v247, v208
WL 4
Mava 48,96,172
DN 75,12,36,3072
v_exp_f32 v210, v210
Mava 52,100,172
s_waitcnt vmcnt(32) lgkmcnt(0)
s_barrier
Ba 244,224,0
Ba 248,224,8192
Ba 252,225,0
Mava 56,104,172
Bv 96,225,8192
s_waitcnt vmcnt(23)
s_mov_b32 m0, 86016
s_add_u32 s36, s32, 233472
DN 72,12,36,0
Maaa 60,240,172
Bv 100,226,0
DN 73,12,36,1024
v_add_f32 v247, v247, v209
WL 3
v_mfma_f32_16x16x32_bf16 v[192:195], a[244:247], v[128:131], 0
Bv 104,226,8192
CV 208,208,209
v_exp_f32 v211, v211
v_mfma_f32_16x16x32_bf16 v[196:199], a[248:251], v[128:131], 0
Ba 240,227,0
DN 74,12,36,2048
v_add_f32 v247, v247, v210
WL 3
Mvav 192,252,132
Ba 244,227,8192
v_exp_f32 v212, v212
Mvvv 196,96,132
Ba 248,224,256
DN 75,12,36,3072
v_add_f32 v247, v247, v211
WL 3
Mvvv 192,100,136
Ba 252,224,8448
s_waitcnt vmcnt(23)
s_mov_b32 m0, 90112
s_add_u32 s36, s32, 237568
DN 72,12,36,0
Mvvv 196,104,136
Bv 96,225,256
CV 209,210,211
v_exp_f32 v213, v213
WL 3
Mvav 192,240,140
Bv 100,225,8448
DN 73,12,36,1024
v_add_f32 v247, v247, v212
Mvav 196,244,140
Bv 104,226,256
v_exp_f32 v214, v214
WL 3
Mvav 192,248,144
Ba 240,226,8448
DN 74,12,36,2048
v_add_f32 v247, v247, v213
CV 210,212,213
Mvav 196,252,144
Ba 244,227,256
DN 75,12,36,3072
WL 3
Mvvv 192,96,148
Ba 248,227,8448
v_exp_f32 v215, v215
v_add_f32 v247, v247, v214
Mvvv 196,100,148
Ta 252,228,0
Ta 254,228,8192
s_waitcnt vmcnt(23)
s_mov_b32 m0, 94208
s_add_u32 s36, s32, 241664
DN 72,12,36,0
WL 4
Mvvv 192,104,152
Tv 96,229,0
Tv 98,229,8192
v_add_f32 v247, v247, v215
Mvav 196,240,152
Tv 100,230,0
Tv 102,230,8192
DN 73,12,36,1024
CV 211,214,215
WL 6
Mvav 192,244,156
Tv 104,231,0
Tv 106,231,8192
DN 74,12,36,2048
Mvav 196,248,156
Ta 240,232,0
Ta 242,232,8192
WL 6
Mvav 0,252,208
Ta 244,233,0
Ta 246,233,8192
DN 75,12,36,3072
Mvvv 4,96,208
Ta 248,234,0
Ta 250,234,8192
v_fma_f32 v192, v192, s37, -v245
v_fma_f32 v193, v193, s37, -v245
WL 6
Mvvv 8,100,208
Ta 252,235,0
Ta 254,235,8192
s_waitcnt vmcnt(23)
s_mov_b32 m0, 32768
s_add_u32 s36, s32, 262144
DN 64,8,36,0
Mvvv 12,104,208
Tv 96,228,256
Tv 98,228,8448
DN 65,8,36,1024
WL 6
Mvav 16,240,208
Tv 100,229,256
Tv 102,229,8448
v_fma_f32 v194, v194, s37, -v245
v_fma_f32 v195, v195, s37, -v245
Mvav 20,244,208
Tv 104,230,256
Tv 106,230,8448
DN 66,8,36,2048
v_fma_f32 v196, v196, s37, -v245
WL 6
Mvav 24,248,208
Ta 240,231,256
Ta 242,231,8448
v_fma_f32 v197, v197, s37, -v245
Mvav 28,252,208
Ta 244,232,256
Ta 246,232,8448
DN 67,8,36,3072
v_fma_f32 v198, v198, s37, -v245
WL 6
Mvvv 32,96,208
Ta 248,233,256
Ta 250,233,8448
s_waitcnt vmcnt(23)
s_mov_b32 m0, 36864
s_add_u32 s36, s32, 266240
DN 68,8,36,0
Mvvv 36,100,208
Ta 252,234,256
Ta 254,234,8448
v_fma_f32 v199, v199, s37, -v245
v_max3_f32 v251, v192, v193, v194
WL 6
Mvvv 40,104,208
Tv 96,235,256
Tv 98,235,8448
DN 69,8,36,1024
Mvav 44,240,208
Tv 100,236,32768
Tv 102,236,40960
v_max3_f32 v252, v195, v196, v197
v_max3_f32 v251, v251, v198, v199
WL 6
Mvav 48,244,208
Tv 104,237,32768
Tv 106,237,40960
DN 70,8,36,2048
v_max_f32 v251, v251, v252
Mvav 52,248,208
Ta 240,238,32768
Ta 242,238,40960
DN 71,8,36,3072
WL 6
Mvav 56,252,208
Ta 244,239,32768
Ta 246,239,40960
v_cmp_lt_f32 vcc, s38, v251
s_cbranch_vccnz LB_ra27
LB_rb27:
Mvvv 60,96,208
Ta 248,240,32768
Ta 250,240,40960
s_waitcnt vmcnt(23)
s_mov_b32 m0, 40960
s_add_u32 s36, s32, 270336
DN 64,8,36,0
s_cmp_lg_u32 s49, 0
s_cbranch_scc1 LB_ra28
LB_rb28:
WL 6
Mava 0,100,176
Ta 252,241,32768
Ta 254,241,40960
v_exp_f32 v192, v192
Mava 4,104,176
Tv 96,242,32768
Tv 98,242,40960
DN 65,8,36,1024
WL 6
Maaa 8,240,176
Tv 100,243,32768
Tv 102,243,40960
DN 66,8,36,2048
Maaa 12,244,176
Tv 104,236,33024
Tv 106,236,41216
v_exp_f32 v193, v193
WL 6
Maaa 16,248,176
Ta 240,237,33024
Ta 242,237,41216
DN 67,8,36,3072
Maaa 20,252,176
Ta 244,238,33024
Ta 246,238,41216
v_add_f32 v247, v247, v192
WL 6
Mava 24,96,176
Ta 248,239,33024
Ta 250,239,41216
s_waitcnt vmcnt(23)
s_mov_b32 m0, 45056
s_add_u32 s36, s32, 274432
DN 68,8,36,0
Mava 28,100,176
Ta 252,240,33024
Ta 254,240,41216
DN 69,8,36,1024
v_exp_f32 v194, v194
WL 6
Mava 32,104,176
Tv 96,241,33024
Tv 98,241,41216
v_add_f32 v247, v247, v193
Maaa 36,240,176
Tv 100,242,33024
Tv 102,242,41216
DN 70,8,36,2048
WL 6
Maaa 40,244,176
Tv 104,243,33024
Tv 106,243,41216
CV 192,192,193
Maaa 44,248,176
DN 71,8,36,3072
v_exp_f32 v195, v195
v_add_f32 v247, v247, v194
WL 4
Maaa 48,252,176
v_exp_f32 v196, v196
v_add_f32 v247, v247, v195
Mava 52,96,176
s_waitcnt vmcnt(16) lgkmcnt(0)
s_barrier
Ba 240,224,16384
Ba 244,224,24576
Ba 248,225,16384
Mava 56,100,176
Ba 252,225,24576
s_waitcnt vmcnt(23)
s_mov_b32 m0, 65536
s_add_u32 s36, s32, 245760
DN 72,12,36,0
DN 73,12,36,1024
Mava 60,104,176
Bv 96,226,16384
DN 74,12,36,2048
CV 193,194,195
WL 3
v_mfma_f32_16x16x32_bf16 v[208:211], a[240:243], v[128:131], 0
Bv 100,226,24576
DN 75,12,36,3072
v_exp_f32 v197, v197
v_mfma_f32_16x16x32_bf16 v[212:215], a[244:247], v[128:131], 0
Bv 104,227,16384
s_waitcnt vmcnt(23)
s_mov_b32 m0, 114688
s_add_u32 s48, s35, s40
s_add_u32 s36, s48, 0
DD 76,20,36,0
WL 3
Mvav 208,248,132
Ba 240,227,24576
DD 77,20,36,1024
v_add_f32 v247, v247, v196
Mvav 212,252,132
Ba 244,224,16640
DD 78,20,36,2048
DD 79,20,36,3072
v_exp_f32 v198, v198
WL 3
Mvvv 208,96,136
Ba 248,224,24832
s_waitcnt vmcnt(23)
s_mov_b32 m0, 69632
s_add_u32 s36, s32, 249856
DN 72,12,36,0
Mvvv 212,100,136
Ba 252,225,16640
DN 73,12,36,1024
v_add_f32 v247, v247, v197
WL 3
Mvvv 208,104,140
Bv 96,225,24832
DN 74,12,36,2048
CV 194,196,197
Mvav 212,240,140
Bv 100,226,16640
DN 75,12,36,3072
v_exp_f32 v199, v199
WL 3
Mvav 208,244,144
Bv 104,226,24832
s_waitcnt vmcnt(23)
s_mov_b32 m0, 73728
s_add_u32 s36, s32, 253952
DN 72,12,36,0
DN 73,12,36,1024
Mvav 212,248,144
Ba 240,227,16640
DN 74,12,36,2048
v_add_f32 v247, v247, v198
WL 3
Mvav 208,252,148
Ba 244,227,24832
DN 75,12,36,3072
v_add_f32 v247, v247, v199
CV 195,198,199
Mvvv 212,96,148
Ta 248,228,16384
Ta 250,228,24576
s_waitcnt vmcnt(23)
s_mov_b32 m0, 118784
s_add_u32 s36, s48, 28672
DD 76,20,36,0
WL 4
Mvvv 208,100,152
Ta 252,229,16384
Ta 254,229,24576
DD 77,20,36,1024
Mvvv 212,104,152
Tv 96,230,16384
Tv 98,230,24576
DD 78,20,36,2048
DD 79,20,36,3072
WL 6
Mvav 208,240,156
Tv 100,231,16384
Tv 102,231,24576
s_waitcnt vmcnt(23)
s_mov_b32 m0, 77824
s_add_u32 s36, s32, 258048
DN 72,12,36,0
Mvav 212,244,156
Tv 104,232,16384
Tv 106,232,24576
DN 73,12,36,1024
WL 6
Mvav 0,248,192
Ta 240,233,16384
Ta 242,233,24576
DN 74,12,36,2048
Mvav 4,252,192
Ta 244,234,16384
Ta 246,234,24576
DN 75,12,36,3072
v_fma_f32 v208, v208, s37, -v245
v_fma_f32 v209, v209, s37, -v245
WL 6
Mvvv 8,96,192
Ta 248,235,16384
Ta 250,235,24576
s_waitcnt vmcnt(23)
s_mov_b32 m0, 0
s_add_u32 s36, s32, 278528
DN 64,8,36,0
DN 65,8,36,1024
Mvvv 12,100,192
Ta 252,228,16640
Ta 254,228,24832
DN 66,8,36,2048
v_fma_f32 v210, v210, s37, -v245
WL 6
Mvvv 16,104,192
Tv 96,229,16640
Tv 98,229,24832
DN 67,8,36,3072
v_fma_f32 v211, v211, s37, -v245
v_fma_f32 v212, v212, s37, -v245
Mvav 20,240,192
Tv 100,230,16640
Tv 102,230,24832
s_waitcnt vmcnt(23)
s_mov_b32 m0, 4096
s_add_u32 s36, s32, 282624
DN 68,8,36,0
WL 6
Mvav 24,244,192
Tv 104,231,16640
Tv 106,231,24832
DN 69,8,36,1024
v_fma_f32 v213, v213, s37, -v245
Mvav 28,248,192
Ta 240,232,16640
Ta 242,232,24832
DN 70,8,36,2048
v_fma_f32 v214, v214, s37, -v245
v_fma_f32 v215, v215, s37, -v245
WL 6
Mvav 32,252,192
Ta 244,233,16640
Ta 246,233,24832
DN 71,8,36,3072
s_waitcnt vmcnt(23)
s_mov_b32 m0, 122880
s_add_u32 s36, s48, 57344
DD 76,20,36,0
Mvvv 36,96,192
Ta 248,234,16640
Ta 250,234,24832
DD 77,20,36,1024
v_max3_f32 v251, v208, v209, v210
WL 6
Mvvv 40,100,192
Ta 252,235,16640
Ta 254,235,24832
DD 78,20,36,2048
v_max3_f32 v252, v211, v212, v213
v_max3_f32 v251, v251, v214, v215
Mvvv 44,104,192
Tv 96,236,49152
Tv 98,236,57344
DD 79,20,36,3072
v_max_f32 v251, v251, v252
WL 6
Mvav 48,240,192
Tv 100,237,49152
Tv 102,237,57344
s_waitcnt vmcnt(23)
s_mov_b32 m0, 8192
s_add_u32 s36, s32, 286720
DN 64,8,36,0
Mvav 52,244,192
Tv 104,238,49152
Tv 106,238,57344
DN 65,8,36,1024
DN 66,8,36,2048
v_cmp_lt_f32 vcc, s38, v251
WL 6
Mvav 56,248,192
Ta 240,239,49152
Ta 242,239,57344
DN 67,8,36,3072
s_cbranch_vccnz LB_ra29
LB_rb29:
Mvav 60,252,192
Ta 244,240,49152
Ta 246,240,57344
s_waitcnt vmcnt(23)
s_mov_b32 m0, 12288
s_add_u32 s36, s32, 290816
DN 68,8,36,0
s_cmp_lg_u32 s49, 0
s_cbranch_scc1 LB_ra30
LB_rb30:
v_exp_f32 v208, v208
WL 6
Mava 0,96,180
Ta 248,241,49152
Ta 250,241,57344
DN 69,8,36,1024
v_exp_f32 v209, v209
v_add_f32 v247, v247, v208
v_exp_f32 v210, v210
Mava 4,100,180
Ta 252,242,49152
Ta 254,242,57344
DN 70,8,36,2048
v_add_f32 v247, v247, v209
CV 208,208,209
v_exp_f32 v211, v211
v_add_f32 v247, v247, v210
WL 6
Mava 8,104,180
Tv 96,243,49152
Tv 98,243,57344
DN 71,8,36,3072
s_waitcnt vmcnt(23)
s_mov_b32 m0, 126976
s_add_u32 s36, s48, 86016
DD 76,20,36,0
v_exp_f32 v212, v212
Maaa 12,240,180
Tv 100,236,49408
Tv 102,236,57600
DD 77,20,36,1024
v_add_f32 v247, v247, v211
CV 209,210,211
v_exp_f32 v213, v213
v_add_f32 v247, v247, v212
WL 6
Maaa 16,244,180
Tv 104,237,49408
Tv 106,237,57600
DD 78,20,36,2048
v_exp_f32 v214, v214
v_add_f32 v247, v247, v213
CV 210,212,213
v_exp_f32 v215, v215
Maaa 20,248,180
Ta 240,238,49408
Ta 242,238,57600
DD 79,20,36,3072
AR 128,0
AR 253,1
CV 128,128,253
AR 129,2
AR 254,3
CV 129,129,254
WL 6
Maaa 24,252,180
Ta 244,239,49408
Ta 246,239,57600
s_waitcnt vmcnt(23)
s_mov_b32 m0, 98304
s_add_u32 s36, s32, 262144
DN 72,12,36,0
AR 130,4
AR 253,5
CV 130,130,253
AR 131,6
AR 254,7
Mava 28,96,180
Ta 248,240,49408
Ta 250,240,57600
DN 73,12,36,1024
DN 74,12,36,2048
CV 131,131,254
v_permlane32_swap_b32 v128, v130
s_nop 0
v_permlane32_swap_b32 v129, v131
v_permlane16_swap_b32 v128, v130
s_nop 0
v_permlane16_swap_b32 v129, v131
WL 6
Mava 32,100,180
Ta 252,241,49408
Ta 254,241,57600
DN 75,12,36,3072
AR 132,8
AR 253,9
CV 132,132,253
AR 133,10
AR 254,11
CV 133,133,254
Mava 36,104,180
Tv 96,242,49408
Tv 98,242,57600
s_waitcnt vmcnt(23)
s_mov_b32 m0, 102400
s_add_u32 s36, s32, 266240
DN 72,12,36,0
AR 134,12
AR 253,13
CV 134,134,253
AR 135,14
WL 6
Maaa 40,240,180
Tv 100,243,49408
Tv 102,243,57600
DN 73,12,36,1024
AR 254,15
CV 135,135,254
v_permlane32_swap_b32 v132, v134
s_nop 0
v_permlane32_swap_b32 v133, v135
v_permlane16_swap_b32 v132, v134
s_nop 0
v_permlane16_swap_b32 v133, v135
Maaa 44,244,180
DN 74,12,36,2048
AR 136,16
AR 253,17
CV 136,136,253
AR 137,18
AR 254,19
CV 137,137,254
AR 138,20
v_add_f32 v247, v247, v214
WL 4
Maaa 48,248,180
DN 75,12,36,3072
AR 253,21
CV 138,138,253
AR 139,22
AR 254,23
CV 139,139,254
v_permlane32_swap_b32 v136, v138
v_add_f32 v247, v247, v215
Maaa 52,252,180
s_waitcnt vmcnt(32) lgkmcnt(0)
s_barrier
Bv 104,224,32768
Ba 240,224,40960
Ba 244,225,32768
v_permlane32_swap_b32 v137, v139
v_permlane16_swap_b32 v136, v138
s_nop 0
v_permlane16_swap_b32 v137, v139
Mava 56,96,180
Ba 248,225,40960
s_waitcnt vmcnt(23)
s_mov_b32 m0, 106496
s_add_u32 s36, s32, 270336
DN 72,12,36,0
DN 73,12,36,1024
AR 140,24
AR 253,25
CV 140,140,253
AR 141,26
AR 254,27
Mava 60,100,180
Ba 252,226,32768
DN 74,12,36,2048
DN 75,12,36,3072
CV 141,141,254
AR 142,28
AR 253,29
CV 142,142,253
AR 143,30
AR 254,31
CV 143,143,254
WL 3
v_mfma_f32_16x16x32_bf16 v[192:195], v[104:107], v[128:131], 0
Bv 96,226,40960
s_waitcnt vmcnt(23)
s_mov_b32 m0, 131072
s_add_u32 s48, s35, s40
s_add_u32 s36, s48, 114688
DD 76,20,36,0
DD 77,20,36,1024
v_permlane32_swap_b32 v140, v142
v_permlane32_swap_b32 v141, v143
s_nop 0
v_permlane16_swap_b32 v140, v142
v_permlane16_swap_b32 v141, v143
v_mfma_f32_16x16x32_bf16 v[196:199], a[240:243], v[128:131], 0
Bv 100,227,32768
DD 78,20,36,2048
AR 144,32
AR 253,33
CV 144,144,253
AR 145,34
AR 254,35
CV 145,145,254
AR 146,36
WL 3
Mvav 192,244,132
Bv 104,227,40960
DD 79,20,36,3072
s_waitcnt vmcnt(23)
s_mov_b32 m0, 110592
s_add_u32 s36, s32, 274432
DN 72,12,36,0
AR 253,37
CV 146,146,253
AR 147,38
CV 211,214,215
Mvav 196,248,132
Ba 240,224,33024
DN 73,12,36,1024
DN 74,12,36,2048
AR 254,39
CV 147,147,254
v_permlane32_swap_b32 v144, v146
s_nop 0
v_permlane32_swap_b32 v145, v147
v_permlane16_swap_b32 v144, v146
s_nop 0
v_permlane16_swap_b32 v145, v147
WL 3
Mvav 192,252,136
Ba 244,224,41216
DN 75,12,36,3072
AR 148,40
AR 253,41
CV 148,148,253
AR 149,42
AR 254,43
CV 149,149,254
AR 150,44
Mvvv 196,96,136
Ba 248,225,33024
s_waitcnt vmcnt(23)
s_mov_b32 m0, 16384
s_add_u32 s36, s32, 294912
DN 64,8,36,0
DN 65,8,36,1024
AR 253,45
CV 150,150,253
AR 151,46
WL 3
Mvvv 192,100,140
Ba 252,225,41216
DN 66,8,36,2048
DN 67,8,36,3072
AR 254,47
CV 151,151,254
v_permlane32_swap_b32 v148, v150
s_nop 0
v_permlane32_swap_b32 v149, v151
v_permlane16_swap_b32 v148, v150
s_nop 0
v_permlane16_swap_b32 v149, v151
Mvvv 196,104,140
Bv 96,226,33024
s_waitcnt vmcnt(23)
s_mov_b32 m0, 135168
s_add_u32 s36, s48, 143360
DD 76,20,36,0
AR 152,48
AR 253,49
CV 152,152,253
AR 153,50
AR 254,51
WL 3
Mvav 192,240,144
Bv 100,226,41216
DD 77,20,36,1024
DD 78,20,36,2048
CV 153,153,254
AR 154,52
AR 253,53
CV 154,154,253
AR 155,54
AR 254,55
CV 155,155,254
Mvav 196,244,144
Bv 104,227,33024
DD 79,20,36,3072
s_waitcnt vmcnt(23)
s_mov_b32 m0, 20480
s_add_u32 s36, s32, 299008
DN 68,8,36,0
v_permlane32_swap_b32 v152, v154
v_permlane32_swap_b32 v153, v155
s_nop 0
v_permlane16_swap_b32 v152, v154
v_permlane16_swap_b32 v153, v155
WL 3
Mvav 192,248,148
Ba 240,227,41216
DN 69,8,36,1024
AR 156,56
AR 253,57
CV 156,156,253
AR 157,58
AR 254,59
CV 157,157,254
AR 158,60
Mvav 196,252,148
Ta 244,228,0
Ta 246,228,8192
DN 70,8,36,2048
DN 71,8,36,3072
AR 253,61
CV 158,158,253
AR 159,62
AR 254,63
CV 159,159,254
v_permlane32_swap_b32 v156, v158
WL 4
Mvvv 192,96,152
Ta 248,229,0
Ta 250,229,8192
s_waitcnt vmcnt(23)
s_mov_b32 m0, 24576
s_add_u32 s36, s32, 303104
DN 64,8,36,0
DN 65,8,36,1024
v_permlane32_swap_b32 v157, v159
v_permlane16_swap_b32 v156, v158
s_nop 0
v_permlane16_swap_b32 v157, v159
Mvvv 196,100,152
Ta 252,230,0
Ta 254,230,8192
DN 66,8,36,2048
v_mov_b32 v251, v247
s_nop 1
v_permlane32_swap_b32 v247, v251
v_add_f32 v247, v247, v251
v_mov_b32 v251, v247
s_nop 1
v_permlane16_swap_b32 v247, v251
v_add_f32 v247, v247, v251
WL 6
Mvvv 192,104,156
Tv 96,231,0
Tv 98,231,8192
DN 67,8,36,3072
s_waitcnt vmcnt(23)
s_mov_b32 m0, 139264
s_add_u32 s36, s48, 172032
DD 76,20,36,0
v_rcp_f32 v249, v247
Mvav 196,240,156
Tv 100,232,0
Tv 102,232,8192
DD 77,20,36,1024
DD 78,20,36,2048
WL 6
Mvav 0,244,208
Tv 104,233,0
Tv 106,233,8192
DD 79,20,36,3072
Mvav 4,248,208
Ta 240,234,0
Ta 242,234,8192
s_waitcnt vmcnt(23)
s_mov_b32 m0, 28672
s_add_u32 s36, s32, 307200
DN 68,8,36,0
DN 69,8,36,1024
v_mul_f32 v192, s37, v192
v_mul_f32 v193, s37, v193
v_mul_f32 v194, s37, v194
v_mul_f32 v195, s37, v195
WL 6
Mvav 8,252,208
Ta 244,235,0
Ta 246,235,8192
DN 70,8,36,2048
DN 71,8,36,3072
v_mul_f32 v196, s37, v196
v_mul_f32 v197, s37, v197
v_mul_f32 v198, s37, v198
v_mul_f32 v199, s37, v199
v_max3_f32 v245, v192, v193, v194
v_max3_f32 v245, v245, v195, v196
Mvvv 12,96,208
Ta 248,228,256
Ta 250,228,8448
s_waitcnt vmcnt(23)
s_mov_b32 m0, 81920
s_add_u32 s36, s32, 278528
DN 72,12,36,0
v_max3_f32 v245, v245, v197, v198
v_max_f32 v245, v245, v199
v_mov_b32 v251, v245
s_nop 1
v_permlane32_swap_b32 v245, v251
WL 6
Mvvv 16,100,208
v_mbcnt_lo_u32_b32 v253, -1, 0
v_mbcnt_hi_u32_b32 v253, -1, v253
v_lshrrev_b32 v236, 2, v253
v_lshlrev_b32 v236, 7, v236
v_and_b32 v254, 24, v253
v_lshl_add_u32 v236, v254, 2, v236
v_and_b32 v254, 3, v253
v_lshl_add_u32 v236, v254, 3, v236
v_xor_b32 v237, 32, v236
v_xor_b32 v238, 64, v236
v_xor_b32 v239, 96, v236
Ta 252,229,256
Ta 254,229,8448
DN 73,12,36,1024
DN 74,12,36,2048
Mvvv 20,104,208
Tv 96,230,256
Tv 98,230,8448
DN 75,12,36,3072
s_waitcnt vmcnt(23)
s_mov_b32 m0, 143360
s_add_u32 s36, s48, 200704
DD 76,20,36,0
v_mul_f32 v0, v0, v249
v_mul_f32 v1, v1, v249
v_mul_f32 v2, v2, v249
v_mul_f32 v3, v3, v249
v_mul_f32 v4, v4, v249
v_mul_f32 v5, v5, v249
v_mul_f32 v6, v6, v249
WL 6
Mvav 24,240,208
Tv 100,231,256
Tv 102,231,8448
DD 77,20,36,1024
v_mul_f32 v7, v7, v249
CV 0,0,1
CV 2,2,3
CV 4,4,5
CV 6,6,7
AW 128,0
AW 129,2
AW 130,4
AW 131,6
Mvav 28,244,208
Tv 104,232,256
Tv 106,232,8448
DD 78,20,36,2048
DD 79,20,36,3072
v_mul_f32 v8, v8, v249
v_mul_f32 v9, v9, v249
v_mul_f32 v10, v10, v249
v_mul_f32 v11, v11, v249
v_mul_f32 v12, v12, v249
v_mul_f32 v13, v13, v249
WL 6
Mvav 32,248,208
Ta 240,233,256
Ta 242,233,8448
s_waitcnt vmcnt(23)
s_mov_b32 m0, 86016
s_add_u32 s36, s32, 282624
DN 72,12,36,0
DN 73,12,36,1024
v_mul_f32 v14, v14, v249
v_mul_f32 v15, v15, v249
CV 8,8,9
v_max_f32 v245, v245, v251
Mvav 36,252,208
Ta 244,234,256
Ta 246,234,8448
DN 74,12,36,2048
CV 10,10,11
CV 12,12,13
CV 14,14,15
AW 132,8
AW 133,10
AW 134,12
AW 135,14
WL 6
Mvvv 40,96,208
Ta 248,235,256
Ta 250,235,8448
DN 75,12,36,3072
s_waitcnt vmcnt(23)
s_mov_b32 m0, 90112
s_add_u32 s36, s32, 286720
DN 72,12,36,0
v_mul_f32 v16, v16, v249
v_mul_f32 v17, v17, v249
v_mov_b32 v251, v245
s_nop 1
v_permlane16_swap_b32 v245, v251
Mvvv 44,100,208
DN 73,12,36,1024
DN 74,12,36,2048
v_mul_f32 v18, v18, v249
v_mul_f32 v19, v19, v249
v_mul_f32 v20, v20, v249
v_mul_f32 v21, v21, v249
v_mul_f32 v22, v22, v249
v_max_f32 v245, v245, v251
v_sub_f32 v192, v192, v245
v_sub_f32 v193, v193, v245
WL 4
Mvvv 48,104,208
DN 75,12,36,3072
v_mul_f32 v23, v23, v249
CV 16,16,17
CV 18,18,19
CV 20,20,21
CV 22,22,23
AW 136,16
AW 137,18
v_sub_f32 v194, v194, v245
Mvav 52,240,208
s_waitcnt vmcnt(40) lgkmcnt(0)
s_barrier
Ba 252,224,0
Bv 96,224,8192
Bv 100,225,0
AW 138,20
AW 139,22
v_sub_f32 v195, v195, v245
v_sub_f32 v196, v196, v245
v_sub_f32 v197, v197, v245
Mvav 56,244,208
Bv 104,225,8192
s_waitcnt vmcnt(23)
s_mov_b32 m0, 94208
s_add_u32 s36, s32, 290816
DN 72,12,36,0
DN 73,12,36,1024
v_mul_f32 v24, v24, v249
v_mul_f32 v25, v25, v249
v_mul_f32 v26, v26, v249
v_sub_f32 v198, v198, v245
v_sub_f32 v199, v199, v245
Mvav 60,248,208
Ba 240,226,0
DN 74,12,36,2048
v_mul_f32 v27, v27, v249
v_mul_f32 v28, v28, v249
v_mul_f32 v29, v29, v249
v_mul_f32 v30, v30, v249
v_mul_f32 v31, v31, v249
CV 24,24,25
CV 26,26,27
WL 3
v_mfma_f32_16x16x32_bf16 v[208:211], a[252:255], v[128:131], 0
Ba 244,226,8192
DN 75,12,36,3072
CV 28,28,29
CV 30,30,31
AW 140,24
AW 141,26
AW 142,28
AW 143,30
v_exp_f32 v192, v192
v_mfma_f32_16x16x32_bf16 v[212:215], v[96:99], v[128:131], 0
Ba 248,227,0
s_waitcnt vmcnt(23)
s_mov_b32 m0, 147456
s_add_u32 s48, s35, s41
s_add_u32 s36, s48, 0
DD 76,20,36,0
DD 77,20,36,1024
v_mul_f32 v32, v32, v249
v_mul_f32 v33, v33, v249
v_mul_f32 v34, v34, v249
v_exp_f32 v193, v193
WL 3
Mvvv 208,100,132
Ba 252,227,8192
DD 78,20,36,2048
v_mul_f32 v35, v35, v249
v_mul_f32 v36, v36, v249
v_mul_f32 v37, v37, v249
v_mul_f32 v38, v38, v249
v_mul_f32 v39, v39, v249
CV 32,32,33
v_mov_b32 v247, v192
Mvvv 212,104,132
Bv 96,224,256
DD 79,20,36,3072
CV 34,34,35
CV 36,36,37
CV 38,38,39
AW 144,32
AW 145,34
AW 146,36
AW 147,38
WL 3
Mvav 208,240,136
Bv 100,224,8448
s_waitcnt vmcnt(23)
s_mov_b32 m0, 32768
s_add_u32 s36, s32, 311296
DN 64,8,36,0
v_mul_f32 v40, v40, v249
v_mul_f32 v41, v41, v249
v_mul_f32 v42, v42, v249
v_exp_f32 v194, v194
v_add_f32 v247, v247, v193
CV 192,192,193
Mvav 212,244,136
Bv 104,225,256
DN 65,8,36,1024
DN 66,8,36,2048
v_mul_f32 v43, v43, v249
v_mul_f32 v44, v44, v249
v_mul_f32 v45, v45, v249
v_mul_f32 v46, v46, v249
v_mul_f32 v47, v47, v249
v_exp_f32 v195, v195
WL 3
Mvav 208,248,140
Ba 240,225,8448
DN 67,8,36,3072
CV 40,40,41
CV 42,42,43
CV 44,44,45
CV 46,46,47
AW 148,40
v_add_f32 v247, v247, v194
v_exp_f32 v196, v196
Mvav 212,252,140
Ba 244,226,256
s_waitcnt vmcnt(23)
s_mov_b32 m0, 36864
s_add_u32 s36, s32, 315392
DN 68,8,36,0
AW 149,42
AW 150,44
AW 151,46
v_add_f32 v247, v247, v195
CV 193,194,195
WL 3
Mvvv 208,96,144
Ba 248,226,8448
DN 69,8,36,1024
DN 70,8,36,2048
v_mul_f32 v48, v48, v249
v_mul_f32 v49, v49, v249
v_mul_f32 v50, v50, v249
v_mul_f32 v51, v51, v249
v_mul_f32 v52, v52, v249
v_exp_f32 v197, v197
Mvvv 212,100,144
Ba 252,227,256
DN 71,8,36,3072
v_mul_f32 v53, v53, v249
v_mul_f32 v54, v54, v249
v_mul_f32 v55, v55, v249
CV 48,48,49
CV 50,50,51
CV 52,52,53
CV 54,54,55
WL 3
Mvvv 208,104,148
Bv 96,227,8448
s_waitcnt vmcnt(23)
s_mov_b32 m0, 40960
s_add_u32 s36, s32, 319488
DN 64,8,36,0
AW 152,48
AW 153,50
AW 154,52
AW 155,54
v_add_f32 v247, v247, v196
v_exp_f32 v198, v198
Mvav 212,240,148
Tv 100,228,32768
Tv 102,228,40960
DN 65,8,36,1024
v_mul_f32 v56, v56, v249
v_mul_f32 v57, v57, v249
v_mul_f32 v58, v58, v249
v_mul_f32 v59, v59, v249
v_mul_f32 v60, v60, v249
v_add_f32 v247, v247, v197
WL 4
Mvav 208,244,152
Tv 104,229,32768
Tv 106,229,40960
DN 66,8,36,2048
DN 67,8,36,3072
v_mul_f32 v61, v61, v249
v_mul_f32 v62, v62, v249
v_mul_f32 v63, v63, v249
CV 56,56,57
CV 194,196,197
Mvav 212,248,152
Ta 240,230,32768
Ta 242,230,40960
s_waitcnt vmcnt(23)
s_mov_b32 m0, 151552
s_add_u32 s36, s48, 28672
DD 76,20,36,0
CV 58,58,59
CV 60,60,61
v_exp_f32 v199, v199
v_add_f32 v247, v247, v198
WL 6
Mvav 208,252,156
Ta 244,231,32768
Ta 246,231,40960
DD 77,20,36,1024
CV 62,62,63
AW 156,56
AW 157,58
AW 158,60
AW 159,62
v_add_f32 v247, v247, v199
CV 195,198,199
Mvvv 212,96,156
Ta 248,232,32768
Ta 250,232,40960
DD 78,20,36,2048
WL 6
v_mfma_f32_16x16x32_bf16 v[0:3], v[100:103], v[192:195], 0
Ta 252,233,32768
Ta 254,233,40960
DD 79,20,36,3072
s_waitcnt vmcnt(23)
s_mov_b32 m0, 45056
s_add_u32 s36, s32, 323584
DN 68,8,36,0
v_mfma_f32_16x16x32_bf16 v[4:7], v[104:107], v[192:195], 0
Tv 96,234,32768
Tv 98,234,40960
DN 69,8,36,1024
v_fma_f32 v208, v208, s37, -v245
v_fma_f32 v209, v209, s37, -v245
WL 6
v_mfma_f32_16x16x32_bf16 v[8:11], a[240:243], v[192:195], 0
Tv 100,235,32768
Tv 102,235,40960
DN 70,8,36,2048
v_fma_f32 v210, v210, s37, -v245
v_mfma_f32_16x16x32_bf16 v[12:15], a[244:247], v[192:195], 0
Tv 104,228,33024
Tv 106,228,41216
DN 71,8,36,3072
s_waitcnt vmcnt(23)
s_mov_b32 m0, 65536
s_add_u32 s36, s32, 294912
DN 72,12,36,0
WL 6
v_mfma_f32_16x16x32_bf16 v[16:19], a[248:251], v[192:195], 0
Ta 240,229,33024
Ta 242,229,41216
DN 73,12,36,1024
v_fma_f32 v211, v211, s37, -v245
v_fma_f32 v212, v212, s37, -v245
v_mfma_f32_16x16x32_bf16 v[20:23], a[252:255], v[192:195], 0
Ta 244,230,33024
Ta 246,230,41216
DN 74,12,36,2048
v_fma_f32 v213, v213, s37, -v245
WL 6
v_mfma_f32_16x16x32_bf16 v[24:27], v[96:99], v[192:195], 0
Ta 248,231,33024
Ta 250,231,41216
DN 75,12,36,3072
v_fma_f32 v214, v214, s37, -v245
v_fma_f32 v215, v215, s37, -v245
v_mfma_f32_16x16x32_bf16 v[28:31], v[100:103], v[192:195], 0
Ta 252,232,33024
Ta 254,232,41216
s_waitcnt vmcnt(23)
s_mov_b32 m0, 155648
s_add_u32 s36, s48, 57344
DD 76,20,36,0
DD 77,20,36,1024
WL 6
v_mfma_f32_16x16x32_bf16 v[32:35], v[104:107], v[192:195], 0
Tv 96,233,33024
Tv 98,233,41216
DD 78,20,36,2048
v_max3_f32 v251, v208, v209, v210
v_mfma_f32_16x16x32_bf16 v[36:39], a[240:243], v[192:195], 0
Tv 100,234,33024
Tv 102,234,41216
DD 79,20,36,3072
v_max3_f32 v252, v211, v212, v213
v_max3_f32 v251, v251, v214, v215
WL 6
v_mfma_f32_16x16x32_bf16 v[40:43], a[244:247], v[192:195], 0
Tv 104,235,33024
Tv 106,235,41216
s_waitcnt vmcnt(23)
s_mov_b32 m0, 69632
s_add_u32 s36, s32, 299008
DN 72,12,36,0
DN 73,12,36,1024
v_mfma_f32_16x16x32_bf16 v[44:47], a[248:251], v[192:195], 0
v_add_u32 v236, 0x18000, v236
v_add_u32 v237, 0x18000, v237
v_add_u32 v238, 0x18000, v238
v_add_u32 v239, 0x18000, v239
Ta 240,236,16384
Ta 242,236,18432
DN 74,12,36,2048
v_max_f32 v251, v251, v252
WL 6
v_mfma_f32_16x16x32_bf16 v[48:51], a[252:255], v[192:195], 0
Ta 244,237,16384
Ta 246,237,18432
DN 75,12,36,3072
v_cmp_lt_f32 vcc, s38, v251
s_cbranch_vccnz LB_ra31
LB_rb31:
v_mfma_f32_16x16x32_bf16 v[52:55], v[96:99], v[192:195], 0
Ta 248,238,16384
Ta 250,238,18432
s_waitcnt vmcnt(23)
s_mov_b32 m0, 73728
s_add_u32 s36, s32, 303104
DN 72,12,36,0
WL 6
v_mfma_f32_16x16x32_bf16 v[56:59], v[100:103], v[192:195], 0
Ta 252,239,16384
Ta 254,239,18432
DN 73,12,36,1024
DN 74,12,36,2048
v_mfma_f32_16x16x32_bf16 v[60:63], v[104:107], v[192:195], 0
Tv 96,236,20480
Tv 98,236,22528
DN 75,12,36,3072
s_cmp_lg_u32 s49, 0
s_cbranch_scc1 LB_ra32
LB_rb32:
WL 6
v_mfma_f32_16x16x32_bf16 a[0:3], a[240:243], a[128:131], 0
Tv 100,237,20480
Tv 102,237,22528
s_waitcnt vmcnt(23)
s_mov_b32 m0, 77824
s_add_u32 s36, s32, 307200
DN 72,12,36,0
v_mfma_f32_16x16x32_bf16 a[4:7], a[244:247], a[128:131], 0
Tv 104,238,20480
Tv 106,238,22528
DN 73,12,36,1024
WL 6
v_mfma_f32_16x16x32_bf16 a[8:11], a[248:251], a[128:131], 0
Ta 240,239,20480
Ta 242,239,22528
DN 74,12,36,2048
DN 75,12,36,3072
v_mfma_f32_16x16x32_bf16 a[12:15], a[252:255], a[128:131], 0
Ta 244,236,24576
Ta 246,236,26624
s_waitcnt vmcnt(23)
s_mov_b32 m0, 159744
s_add_u32 s36, s48, 86016
DD 76,20,36,0
WL 6
Mava 0,96,132
Ta 248,237,24576
Ta 250,237,26624
DD 77,20,36,1024
v_exp_f32 v208, v208
Mava 4,100,132
Ta 252,238,24576
Ta 254,238,26624
DD 78,20,36,2048
DD 79,20,36,3072
WL 6
Mava 8,104,132
Tv 96,239,24576
Tv 98,239,26624
s_waitcnt vmcnt(23)
s_mov_b32 m0, 49152
s_add_u32 s36, s32, 327680
DN 64,8,36,0
Maaa 12,240,132
Tv 100,236,28672
Tv 102,236,30720
DN 65,8,36,1024
WL 6
Maaa 0,244,136
Tv 104,237,28672
Tv 106,237,30720
DN 66,8,36,2048
Maaa 4,248,136
Ta 240,238,28672
Ta 242,238,30720
DN 67,8,36,3072
s_waitcnt vmcnt(23)
s_mov_b32 m0, 53248
s_add_u32 s36, s32, 331776
DN 68,8,36,0
WL 6
Maaa 8,252,136
Ta 244,239,28672
Ta 246,239,30720
DN 69,8,36,1024
v_exp_f32 v209, v209
Mava 12,96,136
DN 70,8,36,2048
v_add_f32 v247, v247, v208
v_exp_f32 v210, v210
WL 4
Mava 0,100,140
DN 71,8,36,3072
v_add_f32 v247, v247, v209
CV 208,208,209
Mava 4,104,140
s_waitcnt vmcnt(56) lgkmcnt(0)
s_barrier
Ba 248,224,16384
Ba 252,224,24576
Bv 96,225,16384
Maaa 8,240,140
Bv 100,225,24576
s_waitcnt vmcnt(23)
s_mov_b32 m0, 57344
s_add_u32 s36, s32, 335872
DN 64,8,36,0
Maaa 12,244,140
Bv 104,226,16384
DN 65,8,36,1024
v_exp_f32 v211, v211
WL 3
v_mfma_f32_16x16x32_bf16 v[192:195], a[248:251], v[128:131], 0
Ba 240,226,24576
DN 66,8,36,2048
v_add_f32 v247, v247, v210
v_mfma_f32_16x16x32_bf16 v[196:199], a[252:255], v[128:131], 0
Ba 244,227,16384
DN 67,8,36,3072
v_exp_f32 v212, v212
WL 3
Mvvv 192,96,132
Ba 248,227,24576
s_waitcnt vmcnt(23)
s_mov_b32 m0, 114688
s_add_u32 s48, s35, s41
s_add_u32 s36, s48, 114688
DD 76,20,36,0
Mvvv 196,100,132
Ba 252,224,16640
DD 77,20,36,1024
v_add_f32 v247, v247, v211
CV 209,210,211
WL 3
Mvvv 192,104,136
Bv 96,224,24832
DD 78,20,36,2048
v_exp_f32 v213, v213
Mvav 196,240,136
Bv 100,225,16640
DD 79,20,36,3072
v_add_f32 v247, v247, v212
WL 3
Mvav 192,244,140
Bv 104,225,24832
s_waitcnt vmcnt(23)
s_mov_b32 m0, 61440
s_add_u32 s36, s32, 339968
DN 68,8,36,0
Mvav 196,248,140
Ba 240,226,16640
DN 69,8,36,1024
v_exp_f32 v214, v214
WL 3
Mvav 192,252,144
Ba 244,226,24832
DN 70,8,36,2048
v_add_f32 v247, v247, v213
CV 210,212,213
Mvvv 196,96,144
Ba 248,227,16640
DN 71,8,36,3072
v_exp_f32 v215, v215
WL 3
Mvvv 192,100,148
Ba 252,227,24832
s_waitcnt vmcnt(23)
s_mov_b32 m0, 118784
s_add_u32 s36, s48, 143360
DD 76,20,36,0
Mvvv 196,104,148
Tv 96,228,16384
Tv 98,228,24576
DD 77,20,36,1024
WL 4
Mvav 192,240,152
Tv 100,229,16384
Tv 102,229,24576
DD 78,20,36,2048
v_add_f32 v247, v247, v214
Mvav 196,244,152
Tv 104,230,16384
Tv 106,230,24576
v_add_f32 v247, v247, v215
WL 6
Mvav 192,248,156
Ta 240,231,16384
Ta 242,231,24576
DD 79,20,36,3072
CV 211,214,215
Mvav 196,252,156
Ta 244,232,16384
Ta 246,232,24576
s_waitcnt vmcnt(23)
s_mov_b32 m0, 98304
s_add_u32 s36, s32, 311296
DN 72,12,36,0
WL 6
Mvvv 0,96,208
Ta 248,233,16384
Ta 250,233,24576
DN 73,12,36,1024
Mvvv 4,100,208
Ta 252,234,16384
Ta 254,234,24576
DN 74,12,36,2048
v_fma_f32 v192, v192, s37, -v245
WL 6
Mvvv 8,104,208
Tv 96,235,16384
Tv 98,235,24576
DN 75,12,36,3072
v_fma_f32 v193, v193, s37, -v245
Mvav 12,240,208
Tv 100,228,16640
Tv 102,228,24832
s_waitcnt vmcnt(23)
s_mov_b32 m0, 102400
s_add_u32 s36, s32, 315392
DN 72,12,36,0
WL 6
Mvav 16,244,208
Tv 104,229,16640
Tv 106,229,24832
DN 73,12,36,1024
v_fma_f32 v194, v194, s37, -v245
v_fma_f32 v195, v195, s37, -v245
Mvav 20,248,208
Ta 240,230,16640
Ta 242,230,24832
DN 74,12,36,2048
v_fma_f32 v196, v196, s37, -v245
WL 6
Mvav 24,252,208
Ta 244,231,16640
Ta 246,231,24832
DN 75,12,36,3072
v_fma_f32 v197, v197, s37, -v245
Mvvv 28,96,208
Ta 248,232,16640
Ta 250,232,24832
s_waitcnt vmcnt(23)
s_mov_b32 m0, 122880
s_add_u32 s36, s48, 172032
DD 76,20,36,0
WL 6
Mvvv 32,100,208
Ta 252,233,16640
Ta 254,233,24832
DD 77,20,36,1024
v_fma_f32 v198, v198, s37, -v245
Mvvv 36,104,208
Tv 96,234,16640
Tv 98,234,24832
DD 78,20,36,2048
v_fma_f32 v199, v199, s37, -v245
WL 6
Mvav 40,240,208
Tv 100,235,16640
Tv 102,235,24832
DD 79,20,36,3072
v_max3_f32 v251, v192, v193, v194
Mvav 44,244,208
Tv 104,236,32768
Tv 106,236,34816
s_waitcnt vmcnt(23)
s_mov_b32 m0, 106496
s_add_u32 s36, s32, 319488
DN 72,12,36,0
WL 6
Mvav 48,248,208
Ta 240,237,32768
Ta 242,237,34816
DN 73,12,36,1024
v_max3_f32 v252, v195, v196, v197
v_max3_f32 v251, v251, v198, v199
Mvav 52,252,208
Ta 244,238,32768
Ta 246,238,34816
v_max_f32 v251, v251, v252
v_cmp_lt_f32 vcc, s38, v251
WL 6
Mvvv 56,96,208
Ta 248,239,32768
Ta 250,239,34816
DN 74,12,36,2048
s_cbranch_vccnz LB_ra33
LB_rb33:
Mvvv 60,100,208
Ta 252,236,36864
Ta 254,236,38912
DN 75,12,36,3072
s_cmp_lg_u32 s49, 0
s_cbranch_scc1 LB_ra34
LB_rb34:
WL 6
Mava 0,104,144
Tv 96,237,36864
Tv 98,237,38912
s_waitcnt vmcnt(23)
s_mov_b32 m0, 110592
s_add_u32 s36, s32, 323584
DN 72,12,36,0
Maaa 4,240,144
Tv 100,238,36864
Tv 102,238,38912
DN 73,12,36,1024
WL 6
Maaa 8,244,144
Tv 104,239,36864
Tv 106,239,38912
DN 74,12,36,2048
v_exp_f32 v192, v192
Maaa 12,248,144
Ta 240,236,40960
Ta 242,236,43008
DN 75,12,36,3072
WL 6
Maaa 0,252,148
Ta 244,237,40960
Ta 246,237,43008
s_waitcnt vmcnt(23)
s_mov_b32 m0, 126976
s_add_u32 s36, s48, 200704
DD 76,20,36,0
Mava 4,96,148
Ta 248,238,40960
Ta 250,238,43008
DD 77,20,36,1024
WL 6
Mava 8,100,148
Ta 252,239,40960
Ta 254,239,43008
DD 78,20,36,2048
v_exp_f32 v193, v193
Mava 12,104,148
Tv 96,236,45056
Tv 98,236,47104
DD 79,20,36,3072
WL 6
Maaa 0,240,152
Tv 100,237,45056
Tv 102,237,47104
s_waitcnt vmcnt(23)
s_mov_b32 m0, 0
s_add_u32 s36, s32, 344064
DN 64,8,36,0
Maaa 4,244,152
Tv 104,238,45056
Tv 106,238,47104
DN 65,8,36,1024
WL 6
Maaa 8,248,152
Ta 240,239,45056
Ta 242,239,47104
DN 66,8,36,2048
v_add_f32 v247, v247, v192
Maaa 12,252,152
DN 67,8,36,3072
v_exp_f32 v194, v194
v_add_f32 v247, v247, v193
WL 4
Mava 0,96,156
CV 192,192,193
v_exp_f32 v195, v195
Mava 4,100,156
s_waitcnt vmcnt(52) lgkmcnt(0)
s_barrier
Ba 244,224,32768
Ba 248,224,40960
Ba 252,225,32768
Mava 8,104,156
Bv 96,225,40960
s_waitcnt vmcnt(23)
s_mov_b32 m0, 4096
s_add_u32 s36, s32, 348160
DN 68,8,36,0
DN 69,8,36,1024
Maaa 12,240,156
Bv 100,226,32768
DN 70,8,36,2048
v_add_f32 v247, v247, v194
v_exp_f32 v196, v196
WL 3
v_mfma_f32_16x16x32_bf16 v[208:211], a[244:247], v[128:131], 0
Bv 104,226,40960
DN 71,8,36,3072
v_add_f32 v247, v247, v195
v_mfma_f32_16x16x32_bf16 v[212:215], a[248:251], v[128:131], 0
Ba 240,227,32768
s_waitcnt vmcnt(23)
s_mov_b32 m0, 131072
s_add_u32 s48, s35, s42
s_add_u32 s36, s48, 0
DD 76,20,36,0
WL 3
Mvav 208,252,132
Ba 244,227,40960
DD 77,20,36,1024
CV 193,194,195
AR 253,0
AR 254,1
Mvvv 212,96,132
Ba 248,224,33024
DD 78,20,36,2048
v_exp_f32 v197, v197
WL 3
Mvvv 208,100,136
Ba 252,224,41216
DD 79,20,36,3072
v_add_f32 v247, v247, v196
Mvvv 212,104,136
Bv 96,225,33024
s_waitcnt vmcnt(23)
s_mov_b32 m0, 8192
s_add_u32 s36, s32, 352256
DN 64,8,36,0
WL 3
Mvav 208,240,140
Bv 100,225,41216
DN 65,8,36,1024
v_exp_f32 v198, v198
Mvav 212,244,140
Bv 104,226,33024
DN 66,8,36,2048
v_add_f32 v247, v247, v197
CV 194,196,197
CV 253,253,254
AW 192,253
WL 3
Mvav 208,248,144
Ba 240,226,41216
DN 67,8,36,3072
v_exp_f32 v199, v199
Mvav 212,252,144
Ba 244,227,33024
s_waitcnt vmcnt(23)
s_mov_b32 m0, 12288
s_add_u32 s36, s32, 356352
DN 68,8,36,0
WL 3
Mvvv 208,96,148
Ba 248,227,41216
DN 69,8,36,1024
v_add_f32 v247, v247, v198
Mvvv 212,100,148
Ta 252,228,0
Ta 254,228,8192
DN 70,8,36,2048
v_add_f32 v247, v247, v199
WL 4
Mvvv 208,104,152
Tv 96,229,0
Tv 98,229,8192
DN 71,8,36,3072
AR 253,2
AR 254,3
Mvav 212,240,152
Tv 100,230,0
Tv 102,230,8192
s_waitcnt vmcnt(23)
s_mov_b32 m0, 135168
s_add_u32 s36, s48, 28672
DD 76,20,36,0
WL 6
Mvav 208,244,156
Tv 104,231,0
Tv 106,231,8192
DD 77,20,36,1024
CV 195,198,199
Mvav 212,248,156
Ta 240,232,0
Ta 242,232,8192
DD 78,20,36,2048
CV 253,253,254
AW 193,253
WL 6
Mvav 0,252,192
Ta 244,233,0
Ta 246,233,8192
DD 79,20,36,3072
Mvvv 4,96,192
Ta 248,234,0
Ta 250,234,8192
s_waitcnt vmcnt(23)
s_mov_b32 m0, 81920
s_add_u32 s36, s32, 327680
DN 72,12,36,0
WL 6
Mvvv 8,100,192
Ta 252,235,0
Ta 254,235,8192
DN 73,12,36,1024
v_fma_f32 v208, v208, s37, -v245
Mvvv 12,104,192
Tv 96,228,256
Tv 98,228,8448
DN 74,12,36,2048
v_fma_f32 v209, v209, s37, -v245
v_fma_f32 v210, v210, s37, -v245
WL 6
Mvav 16,240,192
Tv 100,229,256
Tv 102,229,8448
DN 75,12,36,3072
v_fma_f32 v211, v211, s37, -v245
Mvav 20,244,192
Tv 104,230,256
Tv 106,230,8448
s_waitcnt vmcnt(23)
s_mov_b32 m0, 86016
s_add_u32 s36, s32, 331776
DN 72,12,36,0
WL 6
Mvav 24,248,192
Ta 240,231,256
Ta 242,231,8448
DN 73,12,36,1024
v_fma_f32 v212, v212, s37, -v245
v_fma_f32 v213, v213, s37, -v245
Mvav 28,252,192
Ta 244,232,256
Ta 246,232,8448
DN 74,12,36,2048
v_fma_f32 v214, v214, s37, -v245
WL 6
Mvvv 32,96,192
Ta 248,233,256
Ta 250,233,8448
DN 75,12,36,3072
v_fma_f32 v215, v215, s37, -v245
AR 253,4
AR 254,5
Mvvv 36,100,192
Ta 252,234,256
Ta 254,234,8448
s_waitcnt vmcnt(23)
s_mov_b32 m0, 139264
s_add_u32 s36, s48, 57344
DD 76,20,36,0
WL 6
Mvvv 40,104,192
Tv 96,235,256
Tv 98,235,8448
DD 77,20,36,1024
v_max3_f32 v251, v208, v209, v210
v_max3_f32 v252, v211, v212, v213
Mvav 44,240,192
Tv 100,236,49152
Tv 102,236,51200
DD 78,20,36,2048
v_max3_f32 v251, v251, v214, v215
WL 6
Mvav 48,244,192
Tv 104,237,49152
Tv 106,237,51200
DD 79,20,36,3072
v_max_f32 v251, v251, v252
v_cmp_lt_f32 vcc, s38, v251
Mvav 52,248,192
Ta 240,238,49152
Ta 242,238,51200
s_waitcnt vmcnt(23)
s_mov_b32 m0, 90112
s_add_u32 s36, s32, 335872
DN 72,12,36,0
WL 6
Mvav 56,252,192
Ta 244,239,49152
Ta 246,239,51200
DN 73,12,36,1024
s_cbranch_vccnz LB_ra35
LB_rb35:
Mvvv 60,96,192
Ta 248,236,53248
Ta 250,236,55296
DN 74,12,36,2048
s_cmp_lg_u32 s49, 0
s_cbranch_scc1 LB_ra36
LB_rb36:
WL 6
v_mfma_f32_16x16x32_bf16 a[16:19], v[100:103], a[128:131], 0
Ta 252,237,53248
Ta 254,237,55296
DN 75,12,36,3072
v_mfma_f32_16x16x32_bf16 a[20:23], v[104:107], a[128:131], 0
Tv 96,238,53248
Tv 98,238,55296
s_waitcnt vmcnt(23)
s_mov_b32 m0, 94208
s_add_u32 s36, s32, 339968
DN 72,12,36,0
WL 6
v_mfma_f32_16x16x32_bf16 a[24:27], a[240:243], a[128:131], 0
Tv 100,239,53248
Tv 102,239,55296
DN 73,12,36,1024
v_exp_f32 v208, v208
v_mfma_f32_16x16x32_bf16 a[28:31], a[244:247], a[128:131], 0
Tv 104,236,57344
Tv 106,236,59392
DN 74,12,36,2048
CV 253,253,254
AW 194,253
WL 6
Maaa 16,248,132
Ta 240,237,57344
Ta 242,237,59392
DN 75,12,36,3072
Maaa 20,252,132
Ta 244,238,57344
Ta 246,238,59392
s_waitcnt vmcnt(23)
s_mov_b32 m0, 143360
s_add_u32 s36, s48, 86016
DD 76,20,36,0
WL 6
Mava 24,96,132
Ta 248,239,57344
Ta 250,239,59392
DD 77,20,36,1024
v_exp_f32 v209, v209
Mava 28,100,132
Ta 252,236,61440
Ta 254,236,63488
DD 78,20,36,2048
AR 253,6
AR 254,7
WL 6
Mava 16,104,136
Tv 96,237,61440
Tv 98,237,63488
DD 79,20,36,3072
v_add_f32 v247, v247, v208
Maaa 20,240,136
Tv 100,238,61440
Tv 102,238,63488
s_waitcnt vmcnt(23)
s_mov_b32 m0, 16384
s_add_u32 s36, s32, 360448
DN 64,8,36,0
WL 6
Maaa 24,244,136
Tv 104,239,61440
Tv 106,239,63488
DN 65,8,36,1024
CV 253,253,254
AW 195,253
Maaa 28,248,136
DN 66,8,36,2048
v_exp_f32 v210, v210
v_add_f32 v247, v247, v209
WL 4
Maaa 16,252,140
DN 67,8,36,3072
CV 208,208,209
v_exp_f32 v211, v211
Mava 20,96,140
s_waitcnt vmcnt(52) lgkmcnt(0)
s_barrier
Ba 240,224,49152
Ba 244,224,57344
Ba 248,225,49152
Mava 24,100,140
Ba 252,225,57344
s_waitcnt vmcnt(23)
s_mov_b32 m0, 20480
s_add_u32 s36, s32, 364544
DN 68,8,36,0
DN 69,8,36,1024
Mava 28,104,140
Bv 96,226,49152
DN 70,8,36,2048
v_add_f32 v247, v247, v210
AR 253,8
AR 254,9
WL 3
v_mfma_f32_16x16x32_bf16 v[192:195], a[240:243], v[128:131], 0
Bv 100,226,57344
DN 71,8,36,3072
v_exp_f32 v212, v212
v_mfma_f32_16x16x32_bf16 v[196:199], a[244:247], v[128:131], 0
Bv 104,227,49152
s_waitcnt vmcnt(23)
s_mov_b32 m0, 147456
s_add_u32 s48, s35, s42
s_add_u32 s36, s48, 114688
DD 76,20,36,0
WL 3
Mvav 192,248,132
Ba 240,227,57344
DD 77,20,36,1024
v_add_f32 v247, v247, v211
CV 209,210,211
Mvav 196,252,132
Ba 244,224,49408
DD 78,20,36,2048
v_exp_f32 v213, v213
WL 3
Mvvv 192,96,136
Ba 248,224,57600
DD 79,20,36,3072
v_add_f32 v247, v247, v212
Mvvv 196,100,136
Ba 252,225,49408
s_waitcnt vmcnt(23)
s_mov_b32 m0, 24576
s_add_u32 s36, s32, 368640
DN 64,8,36,0
WL 3
Mvvv 192,104,140
Bv 96,225,57600
DN 65,8,36,1024
v_exp_f32 v214, v214
CV 253,253,254
AW 196,253
Mvav 196,240,140
Bv 100,226,49408
DN 66,8,36,2048
v_add_f32 v247, v247, v213
CV 210,212,213
WL 3
Mvav 192,244,144
Bv 104,226,57600
DN 67,8,36,3072
v_exp_f32 v215, v215
Mvav 196,248,144
Ba 240,227,49408
s_waitcnt vmcnt(23)
s_mov_b32 m0, 28672
s_add_u32 s36, s32, 372736
DN 68,8,36,0
WL 3
Mvav 192,252,148
Ba 244,227,57600
DN 69,8,36,1024
v_add_f32 v247, v247, v214
Mvvv 196,96,148
Ta 248,228,32768
Ta 250,228,40960
DN 70,8,36,2048
v_add_f32 v247, v247, v215
WL 4
Mvvv 192,100,152
Ta 252,229,32768
Ta 254,229,40960
DN 71,8,36,3072
AR 253,10
AR 254,11
Mvvv 196,104,152
Tv 96,230,32768
Tv 98,230,40960
s_waitcnt vmcnt(23)
s_mov_b32 m0, 151552
s_add_u32 s36, s48, 143360
DD 76,20,36,0
WL 6
Mvav 192,240,156
Tv 100,231,32768
Tv 102,231,40960
DD 77,20,36,1024
CV 211,214,215
Mvav 196,244,156
Tv 104,232,32768
Tv 106,232,40960
DD 78,20,36,2048
CV 253,253,254
AW 197,253
WL 6
Mvav 0,248,208
Ta 240,233,32768
Ta 242,233,40960
DD 79,20,36,3072
Mvav 4,252,208
Ta 244,234,32768
Ta 246,234,40960
s_waitcnt vmcnt(23)
s_mov_b32 m0, 65536
s_add_u32 s36, s32, 344064
DN 72,12,36,0
WL 6
Mvvv 8,96,208
Ta 248,235,32768
Ta 250,235,40960
DN 73,12,36,1024
v_fma_f32 v192, v192, s37, -v245
Mvvv 12,100,208
Ta 252,228,33024
Ta 254,228,41216
DN 74,12,36,2048
v_fma_f32 v193, v193, s37, -v245
v_fma_f32 v194, v194, s37, -v245
WL 6
Mvvv 16,104,208
Tv 96,229,33024
Tv 98,229,41216
DN 75,12,36,3072
v_fma_f32 v195, v195, s37, -v245
Mvav 20,240,208
Tv 100,230,33024
Tv 102,230,41216
s_waitcnt vmcnt(23)
s_mov_b32 m0, 69632
s_add_u32 s36, s32, 348160
DN 72,12,36,0
WL 6
Mvav 24,244,208
Tv 104,231,33024
Tv 106,231,41216
DN 73,12,36,1024
v_fma_f32 v196, v196, s37, -v245
v_fma_f32 v197, v197, s37, -v245
Mvav 28,248,208
Ta 240,232,33024
Ta 242,232,41216
DN 74,12,36,2048
v_fma_f32 v198, v198, s37, -v245
AR 253,12
AR 254,13
WL 6
Mvav 32,252,208
Ta 244,233,33024
Ta 246,233,41216
DN 75,12,36,3072
v_fma_f32 v199, v199, s37, -v245
Mvvv 36,96,208
Ta 248,234,33024
Ta 250,234,41216
s_waitcnt vmcnt(23)
s_mov_b32 m0, 155648
s_add_u32 s36, s48, 172032
DD 76,20,36,0
WL 6
Mvvv 40,100,208
Ta 252,235,33024
Ta 254,235,41216
DD 77,20,36,1024
v_max3_f32 v251, v192, v193, v194
v_max3_f32 v252, v195, v196, v197
Mvvv 44,104,208
Tv 96,236,16384
Tv 98,236,18432
DD 78,20,36,2048
v_max3_f32 v251, v251, v198, v199
WL 6
Mvav 48,240,208
Tv 100,237,16384
Tv 102,237,18432
DD 79,20,36,3072
v_max_f32 v251, v251, v252
v_cmp_lt_f32 vcc, s38, v251
Mvav 52,244,208
Tv 104,238,16384
Tv 106,238,18432
s_waitcnt vmcnt(23)
s_mov_b32 m0, 73728
s_add_u32 s36, s32, 352256
DN 72,12,36,0
WL 6
Mvav 56,248,208
Ta 240,239,16384
Ta 242,239,18432
DN 73,12,36,1024
s_cbranch_vccnz LB_ra37
LB_rb37:
Mvav 60,252,208
Ta 244,236,20480
Ta 246,236,22528
DN 74,12,36,2048
s_cmp_lg_u32 s49, 0
s_cbranch_scc1 LB_ra38
LB_rb38:
WL 6
Mava 16,96,144
Ta 248,237,20480
Ta 250,237,22528
DN 75,12,36,3072
Mava 20,100,144
Ta 252,238,20480
Ta 254,238,22528
s_waitcnt vmcnt(23)
s_mov_b32 m0, 77824
s_add_u32 s36, s32, 356352
DN 72,12,36,0
WL 6
Mava 24,104,144
Tv 96,239,20480
Tv 98,239,22528
DN 73,12,36,1024
v_exp_f32 v192, v192
Maaa 28,240,144
Tv 100,236,24576
Tv 102,236,26624
DN 74,12,36,2048
CV 253,253,254
AW 198,253
WL 6
Maaa 16,244,148
Tv 104,237,24576
Tv 106,237,26624
DN 75,12,36,3072
AR 253,14
AR 254,15
Maaa 20,248,148
Ta 240,238,24576
Ta 242,238,26624
s_waitcnt vmcnt(23)
s_mov_b32 m0, 159744
s_add_u32 s36, s48, 200704
DD 76,20,36,0
WL 6
Maaa 24,252,148
Ta 244,239,24576
Ta 246,239,26624
DD 77,20,36,1024
v_exp_f32 v193, v193
Mava 28,96,148
Ta 248,236,28672
Ta 250,236,30720
DD 78,20,36,2048
WL 6
Mava 16,100,152
Ta 252,237,28672
Ta 254,237,30720
DD 79,20,36,3072
v_add_f32 v247, v247, v192
Mava 20,104,152
Tv 96,238,28672
Tv 98,238,30720
s_waitcnt vmcnt(23)
s_mov_b32 m0, 32768
s_add_u32 s36, s32, 376832
DN 64,8,36,0
WL 6
Maaa 24,240,152
Tv 100,239,28672
Tv 102,239,30720
DN 65,8,36,1024
CV 253,253,254
AW 199,253
Maaa 28,244,152
DN 66,8,36,2048
v_exp_f32 v194, v194
v_add_f32 v247, v247, v193
WL 4
Maaa 16,248,156
DN 67,8,36,3072
CV 192,192,193
v_exp_f32 v195, v195
Maaa 20,252,156
s_waitcnt vmcnt(52) lgkmcnt(0)
s_barrier
Bv 104,224,0
Ba 240,224,8192
Ba 244,225,0
Mava 24,96,156
Ba 248,225,8192
s_waitcnt vmcnt(23)
s_mov_b32 m0, 36864
s_add_u32 s36, s32, 380928
DN 68,8,36,0
DN 69,8,36,1024
Mava 28,100,156
Ba 252,226,0
DN 70,8,36,2048
v_add_f32 v247, v247, v194
WL 3
v_mfma_f32_16x16x32_bf16 v[208:211], v[104:107], v[128:131], 0
Bv 96,226,8192
DN 71,8,36,3072
v_exp_f32 v196, v196
v_mfma_f32_16x16x32_bf16 v[212:215], a[240:243], v[128:131], 0
Bv 100,227,0
s_waitcnt vmcnt(23)
s_mov_b32 m0, 114688
s_add_u32 s48, s35, s43
s_add_u32 s36, s48, 0
DD 76,20,36,0
WL 3
Mvav 208,244,132
Bv 104,227,8192
DD 77,20,36,1024
v_add_f32 v247, v247, v195
CV 193,194,195
Mvav 212,248,132
Ba 240,224,256
DD 78,20,36,2048
v_exp_f32 v197, v197
WL 3
Mvav 208,252,136
Ba 244,224,8448
DD 79,20,36,3072
v_add_f32 v247, v247, v196
AR 253,16
AR 254,17
Mvvv 212,96,136
Ba 248,225,256
s_waitcnt vmcnt(23)
s_mov_b32 m0, 40960
s_add_u32 s36, s32, 385024
DN 64,8,36,0
WL 3
Mvvv 208,100,140
Ba 252,225,8448
DN 65,8,36,1024
v_exp_f32 v198, v198
Mvvv 212,104,140
Bv 96,226,256
DN 66,8,36,2048
v_add_f32 v247, v247, v197
CV 194,196,197
WL 3
Mvav 208,240,144
Bv 100,226,8448
DN 67,8,36,3072
v_exp_f32 v199, v199
Mvav 212,244,144
Bv 104,227,256
s_waitcnt vmcnt(23)
s_mov_b32 m0, 45056
s_add_u32 s36, s32, 389120
DN 68,8,36,0
WL 3
Mvav 208,248,148
Ba 240,227,8448
DN 69,8,36,1024
v_add_f32 v247, v247, v198
CV 253,253,254
AW 200,253
Mvav 212,252,148
Ta 244,228,16384
Ta 246,228,24576
DN 70,8,36,2048
v_add_f32 v247, v247, v199
WL 4
Mvvv 208,96,152
Ta 248,229,16384
Ta 250,229,24576
DN 71,8,36,3072
Mvvv 212,100,152
Ta 252,230,16384
Ta 254,230,24576
s_waitcnt vmcnt(23)
s_mov_b32 m0, 118784
s_add_u32 s36, s48, 28672
DD 76,20,36,0
WL 6
Mvvv 208,104,156
Tv 96,231,16384
Tv 98,231,24576
DD 77,20,36,1024
CV 195,198,199
Mvav 212,240,156
Tv 100,232,16384
Tv 102,232,24576
DD 78,20,36,2048
AR 253,18
AR 254,19
WL 6
Mvav 0,244,192
Tv 104,233,16384
Tv 106,233,24576
DD 79,20,36,3072
Mvav 4,248,192
Ta 240,234,16384
Ta 242,234,24576
s_waitcnt vmcnt(23)
s_mov_b32 m0, 98304
s_add_u32 s36, s32, 360448
DN 72,12,36,0
WL 6
Mvav 8,252,192
Ta 244,235,16384
Ta 246,235,24576
DN 73,12,36,1024
v_fma_f32 v208, v208, s37, -v245
Mvvv 12,96,192
Ta 248,228,16640
Ta 250,228,24832
DN 74,12,36,2048
v_fma_f32 v209, v209, s37, -v245
v_fma_f32 v210, v210, s37, -v245
WL 6
Mvvv 16,100,192
Ta 252,229,16640
Ta 254,229,24832
DN 75,12,36,3072
v_fma_f32 v211, v211, s37, -v245
CV 253,253,254
AW 201,253
Mvvv 20,104,192
Tv 96,230,16640
Tv 98,230,24832
s_waitcnt vmcnt(23)
s_mov_b32 m0, 102400
s_add_u32 s36, s32, 364544
DN 72,12,36,0
WL 6
Mvav 24,240,192
Tv 100,231,16640
Tv 102,231,24832
DN 73,12,36,1024
v_fma_f32 v212, v212, s37, -v245
v_fma_f32 v213, v213, s37, -v245
Mvav 28,244,192
Tv 104,232,16640
Tv 106,232,24832
DN 74,12,36,2048
v_fma_f32 v214, v214, s37, -v245
WL 6
Mvav 32,248,192
Ta 240,233,16640
Ta 242,233,24832
DN 75,12,36,3072
v_fma_f32 v215, v215, s37, -v245
Mvav 36,252,192
Ta 244,234,16640
Ta 246,234,24832
s_waitcnt vmcnt(23)
s_mov_b32 m0, 122880
s_add_u32 s36, s48, 57344
DD 76,20,36,0
WL 6
Mvvv 40,96,192
Ta 248,235,16640
Ta 250,235,24832
DD 77,20,36,1024
v_max3_f32 v251, v208, v209, v210
v_max3_f32 v252, v211, v212, v213
Mvvv 44,100,192
Ta 252,236,32768
Ta 254,236,34816
DD 78,20,36,2048
v_max3_f32 v251, v251, v214, v215
WL 6
Mvvv 48,104,192
Tv 96,237,32768
Tv 98,237,34816
DD 79,20,36,3072
v_max_f32 v251, v251, v252
v_cmp_lt_f32 vcc, s38, v251
Mvav 52,240,192
Tv 100,238,32768
Tv 102,238,34816
s_waitcnt vmcnt(23)
s_mov_b32 m0, 106496
s_add_u32 s36, s32, 368640
DN 72,12,36,0
WL 6
Mvav 56,244,192
Tv 104,239,32768
Tv 106,239,34816
DN 73,12,36,1024
s_cbranch_vccnz LB_ra39
LB_rb39:
Mvav 60,248,192
Ta 240,236,36864
Ta 242,236,38912
DN 74,12,36,2048
s_cmp_lg_u32 s49, 0
s_cbranch_scc1 LB_ra40
LB_rb40:
WL 6
v_mfma_f32_16x16x32_bf16 a[32:35], a[252:255], a[128:131], 0
Ta 244,237,36864
Ta 246,237,38912
DN 75,12,36,3072
v_mfma_f32_16x16x32_bf16 a[36:39], v[96:99], a[128:131], 0
Ta 248,238,36864
Ta 250,238,38912
s_waitcnt vmcnt(23)
s_mov_b32 m0, 110592
s_add_u32 s36, s32, 372736
DN 72,12,36,0
WL 6
v_mfma_f32_16x16x32_bf16 a[40:43], v[100:103], a[128:131], 0
Ta 252,239,36864
Ta 254,239,38912
DN 73,12,36,1024
v_exp_f32 v208, v208
v_mfma_f32_16x16x32_bf16 a[44:47], v[104:107], a[128:131], 0
Tv 96,236,40960
Tv 98,236,43008
DN 74,12,36,2048
AR 253,20
AR 254,21
WL 6
Maaa 32,240,132
Tv 100,237,40960
Tv 102,237,43008
DN 75,12,36,3072
CV 253,253,254
AW 202,253
Maaa 36,244,132
Tv 104,238,40960
Tv 106,238,43008
s_waitcnt vmcnt(23)
s_mov_b32 m0, 126976
s_add_u32 s36, s48, 86016
DD 76,20,36,0
WL 6
Maaa 40,248,132
Ta 240,239,40960
Ta 242,239,43008
DD 77,20,36,1024
v_exp_f32 v209, v209
Maaa 44,252,132
Ta 244,236,45056
Ta 246,236,47104
DD 78,20,36,2048
WL 6
Mava 32,96,136
Ta 248,237,45056
Ta 250,237,47104
DD 79,20,36,3072
AR 253,22
AR 254,23
Mava 36,100,136
Ta 252,238,45056
Ta 254,238,47104
s_waitcnt vmcnt(23)
s_mov_b32 m0, 49152
s_add_u32 s36, s32, 393216
DN 64,8,36,0
WL 6
Mava 40,104,136
Tv 96,239,45056
Tv 98,239,47104
DN 65,8,36,1024
v_add_f32 v247, v247, v208
Maaa 44,240,136
DN 66,8,36,2048
v_exp_f32 v210, v210
WL 4
Maaa 32,244,140
DN 67,8,36,3072
v_add_f32 v247, v247, v209
CV 208,208,209
v_exp_f32 v211, v211
Maaa 36,248,140
s_waitcnt vmcnt(52) lgkmcnt(0)
s_barrier
Bv 100,224,16384
Bv 104,224,24576
Ba 240,225,16384
Maaa 40,252,140
Ba 244,225,24576
s_waitcnt vmcnt(23)
s_mov_b32 m0, 53248
s_add_u32 s36, s32, 397312
DN 68,8,36,0
Mava 44,96,140
Ba 248,226,16384
DN 69,8,36,1024
v_add_f32 v247, v247, v210
CV 253,253,254
AW 203,253
WL 3
v_mfma_f32_16x16x32_bf16 v[192:195], v[100:103], v[128:131], 0
Ba 252,226,24576
DN 70,8,36,2048
v_exp_f32 v212, v212
v_mfma_f32_16x16x32_bf16 v[196:199], v[104:107], v[128:131], 0
Bv 96,227,16384
DN 71,8,36,3072
v_add_f32 v247, v247, v211
AR 253,24
AR 254,25
WL 3
Mvav 192,240,132
Bv 100,227,24576
s_waitcnt vmcnt(23)
s_mov_b32 m0, 131072
s_add_u32 s48, s35, s43
s_add_u32 s36, s48, 114688
DD 76,20,36,0
Mvav 196,244,132
Bv 104,224,16640
DD 77,20,36,1024
CV 209,210,211
WL 3
Mvav 192,248,136
Ba 240,224,24832
DD 78,20,36,2048
v_exp_f32 v213, v213
Mvav 196,252,136
Ba 244,225,16640
DD 79,20,36,3072
v_add_f32 v247, v247, v212
CV 253,253,254
AW 204,253
WL 3
Mvvv 192,96,140
Ba 248,225,24832
s_waitcnt vmcnt(23)
s_mov_b32 m0, 57344
s_add_u32 s36, s32, 401408
DN 64,8,36,0
Mvvv 196,100,140
Ba 252,226,16640
DN 65,8,36,1024
v_exp_f32 v214, v214
WL 3
Mvvv 192,104,144
Bv 96,226,24832
DN 66,8,36,2048
v_add_f32 v247, v247, v213
CV 210,212,213
Mvav 196,240,144
Bv 100,227,16640
DN 67,8,36,3072
v_exp_f32 v215, v215
WL 3
Mvav 192,244,148
Bv 104,227,24832
s_waitcnt vmcnt(23)
s_mov_b32 m0, 135168
s_add_u32 s36, s48, 143360
DD 76,20,36,0
Mvav 196,248,148
Ta 240,228,0
Ta 242,228,8192
DD 77,20,36,1024
AR 253,26
AR 254,27
WL 4
Mvav 192,252,152
Ta 244,229,0
Ta 246,229,8192
DD 78,20,36,2048
v_add_f32 v247, v247, v214
Mvvv 196,96,152
Ta 248,230,0
Ta 250,230,8192
v_add_f32 v247, v247, v215
WL 6
Mvvv 192,100,156
Ta 252,231,0
Ta 254,231,8192
DD 79,20,36,3072
CV 211,214,215
Mvvv 196,104,156
Tv 96,232,0
Tv 98,232,8192
s_waitcnt vmcnt(23)
s_mov_b32 m0, 61440
s_add_u32 s36, s32, 405504
DN 68,8,36,0
WL 6
Mvav 0,240,208
Tv 100,233,0
Tv 102,233,8192
DN 69,8,36,1024
CV 253,253,254
AW 205,253
Mvav 4,244,208
Tv 104,234,0
Tv 106,234,8192
DN 70,8,36,2048
v_fma_f32 v192, v192, s37, -v245
WL 6
Mvav 8,248,208
Ta 240,235,0
Ta 242,235,8192
DN 71,8,36,3072
v_fma_f32 v193, v193, s37, -v245
Mvav 12,252,208
Ta 244,228,256
Ta 246,228,8448
s_waitcnt vmcnt(23)
s_mov_b32 m0, 81920
s_add_u32 s36, s32, 376832
DN 72,12,36,0
WL 6
Mvvv 16,96,208
Ta 248,229,256
Ta 250,229,8448
DN 73,12,36,1024
v_fma_f32 v194, v194, s37, -v245
v_fma_f32 v195, v195, s37, -v245
Mvvv 20,100,208
Ta 252,230,256
Ta 254,230,8448
DN 74,12,36,2048
v_fma_f32 v196, v196, s37, -v245
WL 6
Mvvv 24,104,208
Tv 96,231,256
Tv 98,231,8448
DN 75,12,36,3072
v_fma_f32 v197, v197, s37, -v245
Mvav 28,240,208
Tv 100,232,256
Tv 102,232,8448
s_waitcnt vmcnt(23)
s_mov_b32 m0, 139264
s_add_u32 s36, s48, 172032
DD 76,20,36,0
WL 6
Mvav 32,244,208
Tv 104,233,256
Tv 106,233,8448
DD 77,20,36,1024
v_fma_f32 v198, v198, s37, -v245
Mvav 36,248,208
Ta 240,234,256
Ta 242,234,8448
DD 78,20,36,2048
v_fma_f32 v199, v199, s37, -v245
WL 6
Mvav 40,252,208
Ta 244,235,256
Ta 246,235,8448
DD 79,20,36,3072
v_max3_f32 v251, v192, v193, v194
Mvvv 44,96,208
Ta 248,236,49152
Ta 250,236,51200
s_waitcnt vmcnt(23)
s_mov_b32 m0, 86016
s_add_u32 s36, s32, 380928
DN 72,12,36,0
WL 6
Mvvv 48,100,208
Ta 252,237,49152
Ta 254,237,51200
DN 73,12,36,1024
v_max3_f32 v252, v195, v196, v197
v_max3_f32 v251, v251, v198, v199
Mvvv 52,104,208
Tv 96,238,49152
Tv 98,238,51200
v_max_f32 v251, v251, v252
v_cmp_lt_f32 vcc, s38, v251
WL 6
Mvav 56,240,208
Tv 100,239,49152
Tv 102,239,51200
DN 74,12,36,2048
s_cbranch_vccnz LB_ra41
LB_rb41:
Mvav 60,244,208
Tv 104,236,53248
Tv 106,236,55296
DN 75,12,36,3072
s_cmp_lg_u32 s49, 0
s_cbranch_scc1 LB_ra42
LB_rb42:
WL 6
Maaa 32,248,144
Ta 240,237,53248
Ta 242,237,55296
s_waitcnt vmcnt(23)
s_mov_b32 m0, 90112
s_add_u32 s36, s32, 385024
DN 72,12,36,0
Maaa 36,252,144
Ta 244,238,53248
Ta 246,238,55296
DN 73,12,36,1024
AR 253,28
AR 254,29
WL 6
Mava 40,96,144
Ta 248,239,53248
Ta 250,239,55296
DN 74,12,36,2048
v_exp_f32 v192, v192
Mava 44,100,144
Ta 252,236,57344
Ta 254,236,59392
DN 75,12,36,3072
CV 253,253,254
AW 206,253
WL 6
Mava 32,104,148
Tv 96,237,57344
Tv 98,237,59392
s_waitcnt vmcnt(23)
s_mov_b32 m0, 143360
s_add_u32 s36, s48, 200704
DD 76,20,36,0
Maaa 36,240,148
Tv 100,238,57344
Tv 102,238,59392
DD 77,20,36,1024
WL 6
Maaa 40,244,148
Tv 104,239,57344
Tv 106,239,59392
DD 78,20,36,2048
v_exp_f32 v193, v193
Maaa 44,248,148
Ta 240,236,61440
Ta 242,236,63488
DD 79,20,36,3072
AR 253,30
AR 254,31
WL 6
Maaa 32,252,152
Ta 244,237,61440
Ta 246,237,63488
s_waitcnt vmcnt(23)
s_mov_b32 m0, 94208
s_add_u32 s36, s32, 389120
DN 72,12,36,0
Mava 36,96,152
Ta 248,238,61440
Ta 250,238,63488
DN 73,12,36,1024
WL 6
Mava 40,100,152
Ta 252,239,61440
Ta 254,239,63488
DN 74,12,36,2048
v_add_f32 v247, v247, v192
Mava 44,104,152
DN 75,12,36,3072
v_exp_f32 v194, v194
v_add_f32 v247, v247, v193
WL 4
Maaa 32,240,156
CV 192,192,193
v_exp_f32 v195, v195
CV 253,253,254
AW 207,253
Maaa 36,244,156
s_waitcnt vmcnt(48) lgkmcnt(0)
s_barrier
Bv 96,224,32768
Bv 100,224,40960
Bv 104,225,32768
Maaa 40,248,156
Ba 240,225,40960
s_waitcnt vmcnt(23)
s_mov_b32 m0, 0
s_add_u32 s36, s32, 409600
DN 64,8,36,0
DN 65,8,36,1024
Maaa 44,252,156
Ba 244,226,32768
DN 66,8,36,2048
v_add_f32 v247, v247, v194
v_exp_f32 v196, v196
WL 3
v_mfma_f32_16x16x32_bf16 v[208:211], v[96:99], v[128:131], 0
Ba 248,226,40960
DN 67,8,36,3072
v_add_f32 v247, v247, v195
v_mfma_f32_16x16x32_bf16 v[212:215], v[100:103], v[128:131], 0
Ba 252,227,32768
s_waitcnt vmcnt(23)
s_mov_b32 m0, 147456
s_add_u32 s48, s35, s44
s_add_u32 s36, s48, 0
DD 76,20,36,0
WL 3
Mvvv 208,104,132
Bv 96,227,40960
DD 77,20,36,1024
CV 193,194,195
AR 253,32
AR 254,33
Mvav 212,240,132
Bv 100,224,33024
DD 78,20,36,2048
v_exp_f32 v197, v197
WL 3
Mvav 208,244,136
Bv 104,224,41216
DD 79,20,36,3072
v_add_f32 v247, v247, v196
Mvav 212,248,136
Ba 240,225,33024
s_waitcnt vmcnt(23)
s_mov_b32 m0, 4096
s_add_u32 s36, s32, 413696
DN 68,8,36,0
WL 3
Mvav 208,252,140
Ba 244,225,41216
DN 69,8,36,1024
v_exp_f32 v198, v198
Mvvv 212,96,140
Ba 248,226,33024
DN 70,8,36,2048
v_add_f32 v247, v247, v197
CV 194,196,197
WL 3
Mvvv 208,100,144
Ba 252,226,41216
DN 71,8,36,3072
v_exp_f32 v199, v199
CV 253,253,254
AW 208,253
Mvvv 212,104,144
Bv 96,227,33024
s_waitcnt vmcnt(23)
s_mov_b32 m0, 8192
s_add_u32 s36, s32, 417792
DN 64,8,36,0
WL 3
Mvav 208,240,148
Bv 100,227,41216
DN 65,8,36,1024
v_add_f32 v247, v247, v198
Mvav 212,244,148
Tv 104,228,32768
Tv 106,228,40960
DN 66,8,36,2048
v_add_f32 v247, v247, v199
WL 4
Mvav 208,248,152
Ta 240,229,32768
Ta 242,229,40960
DN 67,8,36,3072
AR 253,34
AR 254,35
Mvav 212,252,152
Ta 244,230,32768
Ta 246,230,40960
s_waitcnt vmcnt(23)
s_mov_b32 m0, 151552
s_add_u32 s36, s48, 28672
DD 76,20,36,0
WL 6
Mvvv 208,96,156
Ta 248,231,32768
Ta 250,231,40960
DD 77,20,36,1024
CV 195,198,199
Mvvv 212,100,156
Ta 252,232,32768
Ta 254,232,40960
DD 78,20,36,2048
CV 253,253,254
AW 209,253
WL 6
Mvvv 0,104,192
Tv 96,233,32768
Tv 98,233,40960
DD 79,20,36,3072
Mvav 4,240,192
Tv 100,234,32768
Tv 102,234,40960
s_waitcnt vmcnt(23)
s_mov_b32 m0, 12288
s_add_u32 s36, s32, 421888
DN 68,8,36,0
WL 6
Mvav 8,244,192
Tv 104,235,32768
Tv 106,235,40960
DN 69,8,36,1024
v_fma_f32 v208, v208, s37, -v245
Mvav 12,248,192
Ta 240,228,33024
Ta 242,228,41216
DN 70,8,36,2048
v_fma_f32 v209, v209, s37, -v245
v_fma_f32 v210, v210, s37, -v245
WL 6
Mvav 16,252,192
Ta 244,229,33024
Ta 246,229,41216
DN 71,8,36,3072
v_fma_f32 v211, v211, s37, -v245
Mvvv 20,96,192
Ta 248,230,33024
Ta 250,230,41216
s_waitcnt vmcnt(23)
s_mov_b32 m0, 65536
s_add_u32 s36, s32, 393216
DN 72,12,36,0
WL 6
Mvvv 24,100,192
Ta 252,231,33024
Ta 254,231,41216
DN 73,12,36,1024
v_fma_f32 v212, v212, s37, -v245
v_fma_f32 v213, v213, s37, -v245
Mvvv 28,104,192
Tv 96,232,33024
Tv 98,232,41216
DN 74,12,36,2048
v_fma_f32 v214, v214, s37, -v245
WL 6
Mvav 32,240,192
Tv 100,233,33024
Tv 102,233,41216
DN 75,12,36,3072
v_fma_f32 v215, v215, s37, -v245
Mvav 36,244,192
Tv 104,234,33024
Tv 106,234,41216
s_waitcnt vmcnt(23)
s_mov_b32 m0, 155648
s_add_u32 s36, s48, 57344
DD 76,20,36,0
WL 6
Mvav 40,248,192
Ta 240,235,33024
Ta 242,235,41216
DD 77,20,36,1024
v_max3_f32 v251, v208, v209, v210
v_max3_f32 v252, v211, v212, v213
Mvav 44,252,192
Ta 244,236,16384
Ta 246,236,18432
DD 78,20,36,2048
v_max3_f32 v251, v251, v214, v215
WL 6
Mvvv 48,96,192
Ta 248,237,16384
Ta 250,237,18432
DD 79,20,36,3072
v_max_f32 v251, v251, v252
v_cmp_lt_f32 vcc, s38, v251
Mvvv 52,100,192
Ta 252,238,16384
Ta 254,238,18432
s_waitcnt vmcnt(23)
s_mov_b32 m0, 69632
s_add_u32 s36, s32, 397312
DN 72,12,36,0
WL 6
Mvvv 56,104,192
Tv 96,239,16384
Tv 98,239,18432
DN 73,12,36,1024
s_cbranch_vccnz LB_ra43
LB_rb43:
AR 253,36
AR 254,37
Mvav 60,240,192
Tv 100,236,20480
Tv 102,236,22528
DN 74,12,36,2048
s_cmp_lg_u32 s49, 0
s_cbranch_scc1 LB_ra44
LB_rb44:
WL 6
v_mfma_f32_16x16x32_bf16 a[48:51], a[244:247], a[128:131], 0
Tv 104,237,20480
Tv 106,237,22528
DN 75,12,36,3072
v_mfma_f32_16x16x32_bf16 a[52:55], a[248:251], a[128:131], 0
Ta 240,238,20480
Ta 242,238,22528
s_waitcnt vmcnt(23)
s_mov_b32 m0, 73728
s_add_u32 s36, s32, 401408
DN 72,12,36,0
WL 6
v_mfma_f32_16x16x32_bf16 a[56:59], a[252:255], a[128:131], 0
Ta 244,239,20480
Ta 246,239,22528
DN 73,12,36,1024
v_exp_f32 v208, v208
v_mfma_f32_16x16x32_bf16 a[60:63], v[96:99], a[128:131], 0
Ta 248,236,24576
Ta 250,236,26624
DN 74,12,36,2048
CV 253,253,254
AW 210,253
WL 6
Mava 48,100,132
Ta 252,237,24576
Ta 254,237,26624
DN 75,12,36,3072
Mava 52,104,132
Tv 96,238,24576
Tv 98,238,26624
s_waitcnt vmcnt(23)
s_mov_b32 m0, 159744
s_add_u32 s36, s48, 86016
DD 76,20,36,0
WL 6
Maaa 56,240,132
Tv 100,239,24576
Tv 102,239,26624
DD 77,20,36,1024
v_exp_f32 v209, v209
Maaa 60,244,132
Tv 104,236,28672
Tv 106,236,30720
DD 78,20,36,2048
AR 253,38
AR 254,39
WL 6
Maaa 48,248,136
Ta 240,237,28672
Ta 242,237,30720
DD 79,20,36,3072
v_add_f32 v247, v247, v208
Maaa 52,252,136
Ta 244,238,28672
Ta 246,238,30720
s_waitcnt vmcnt(23)
s_mov_b32 m0, 77824
s_add_u32 s36, s32, 405504
DN 72,12,36,0
WL 6
Mava 56,96,136
Ta 248,239,28672
Ta 250,239,30720
DN 73,12,36,1024
CV 253,253,254
AW 211,253
Mava 60,100,136
DN 74,12,36,2048
v_exp_f32 v210, v210
v_add_f32 v247, v247, v209
WL 4
Mava 48,104,140
DN 75,12,36,3072
CV 208,208,209
v_exp_f32 v211, v211
Maaa 52,240,140
s_waitcnt vmcnt(48) lgkmcnt(0)
s_barrier
Ba 252,224,49152
Bv 96,224,57344
Bv 100,225,49152
Maaa 56,244,140
Bv 104,225,57344
s_waitcnt vmcnt(23)
s_mov_b32 m0, 16384
s_add_u32 s36, s32, 425984
DN 64,8,36,0
DN 65,8,36,1024
Maaa 60,248,140
Ba 240,226,49152
DN 66,8,36,2048
v_add_f32 v247, v247, v210
WL 3
v_mfma_f32_16x16x32_bf16 v[192:195], a[252:255], v[128:131], 0
Ba 244,226,57344
DN 67,8,36,3072
v_exp_f32 v212, v212
v_mfma_f32_16x16x32_bf16 v[196:199], v[96:99], v[128:131], 0
Ba 248,227,49152
s_waitcnt vmcnt(23)
s_mov_b32 m0, 114688
s_add_u32 s48, s35, s44
s_add_u32 s36, s48, 114688
DD 76,20,36,0
WL 3
Mvvv 192,100,132
Ba 252,227,57344
DD 77,20,36,1024
v_add_f32 v247, v247, v211
CV 209,210,211
Mvvv 196,104,132
Bv 96,224,49408
DD 78,20,36,2048
v_exp_f32 v213, v213
WL 3
Mvav 192,240,136
Bv 100,224,57600
DD 79,20,36,3072
v_add_f32 v247, v247, v212
AR 253,40
AR 254,41
Mvav 196,244,136
Bv 104,225,49408
s_waitcnt vmcnt(23)
s_mov_b32 m0, 20480
s_add_u32 s36, s32, 430080
DN 68,8,36,0
WL 3
Mvav 192,248,140
Ba 240,225,57600
DN 69,8,36,1024
v_exp_f32 v214, v214
Mvav 196,252,140
Ba 244,226,49408
DN 70,8,36,2048
v_add_f32 v247, v247, v213
CV 210,212,213
WL 3
Mvvv 192,96,144
Ba 248,226,57600
DN 71,8,36,3072
v_exp_f32 v215, v215
Mvvv 196,100,144
Ba 252,227,49408
s_waitcnt vmcnt(23)
s_mov_b32 m0, 24576
s_add_u32 s36, s32, 434176
DN 64,8,36,0
WL 3
Mvvv 192,104,148
Bv 96,227,57600
DN 65,8,36,1024
v_add_f32 v247, v247, v214
CV 253,253,254
AW 212,253
Mvav 196,240,148
Tv 100,228,16384
Tv 102,228,24576
DN 66,8,36,2048
v_add_f32 v247, v247, v215
WL 4
Mvav 192,244,152
Tv 104,229,16384
Tv 106,229,24576
DN 67,8,36,3072
AR 253,42
AR 254,43
Mvav 196,248,152
Ta 240,230,16384
Ta 242,230,24576
s_waitcnt vmcnt(23)
s_mov_b32 m0, 118784
s_add_u32 s36, s48, 143360
DD 76,20,36,0
WL 6
Mvav 192,252,156
Ta 244,231,16384
Ta 246,231,24576
DD 77,20,36,1024
CV 211,214,215
Mvvv 196,96,156
Ta 248,232,16384
Ta 250,232,24576
DD 78,20,36,2048
WL 6
Mvvv 0,100,208
Ta 252,233,16384
Ta 254,233,24576
DD 79,20,36,3072
CV 253,253,254
AW 213,253
Mvvv 4,104,208
Tv 96,234,16384
Tv 98,234,24576
s_waitcnt vmcnt(23)
s_mov_b32 m0, 28672
s_add_u32 s36, s32, 438272
DN 68,8,36,0
WL 6
Mvav 8,240,208
Tv 100,235,16384
Tv 102,235,24576
DN 69,8,36,1024
v_fma_f32 v192, v192, s37, -v245
Mvav 12,244,208
Tv 104,228,16640
Tv 106,228,24832
DN 70,8,36,2048
v_fma_f32 v193, v193, s37, -v245
v_fma_f32 v194, v194, s37, -v245
WL 6
Mvav 16,248,208
Ta 240,229,16640
Ta 242,229,24832
DN 71,8,36,3072
v_fma_f32 v195, v195, s37, -v245
Mvav 20,252,208
Ta 244,230,16640
Ta 246,230,24832
s_waitcnt vmcnt(23)
s_mov_b32 m0, 98304
s_add_u32 s36, s32, 409600
DN 72,12,36,0
WL 6
Mvvv 24,96,208
Ta 248,231,16640
Ta 250,231,24832
DN 73,12,36,1024
v_fma_f32 v196, v196, s37, -v245
v_fma_f32 v197, v197, s37, -v245
Mvvv 28,100,208
Ta 252,232,16640
Ta 254,232,24832
DN 74,12,36,2048
v_fma_f32 v198, v198, s37, -v245
WL 6
Mvvv 32,104,208
Tv 96,233,16640
Tv 98,233,24832
DN 75,12,36,3072
v_fma_f32 v199, v199, s37, -v245
Mvav 36,240,208
Tv 100,234,16640
Tv 102,234,24832
s_waitcnt vmcnt(23)
s_mov_b32 m0, 122880
s_add_u32 s36, s48, 172032
DD 76,20,36,0
WL 6
Mvav 40,244,208
Tv 104,235,16640
Tv 106,235,24832
DD 77,20,36,1024
v_max3_f32 v251, v192, v193, v194
v_max3_f32 v252, v195, v196, v197
Mvav 44,248,208
Ta 240,236,32768
Ta 242,236,34816
DD 78,20,36,2048
v_max3_f32 v251, v251, v198, v199
WL 6
Mvav 48,252,208
Ta 244,237,32768
Ta 246,237,34816
DD 79,20,36,3072
v_max_f32 v251, v251, v252
v_cmp_lt_f32 vcc, s38, v251
Mvvv 52,96,208
Ta 248,238,32768
Ta 250,238,34816
s_waitcnt vmcnt(23)
s_mov_b32 m0, 102400
s_add_u32 s36, s32, 413696
DN 72,12,36,0
WL 6
Mvvv 56,100,208
Ta 252,239,32768
Ta 254,239,34816
DN 73,12,36,1024
s_cbranch_vccnz LB_ra45
LB_rb45:
Mvvv 60,104,208
Tv 96,236,36864
Tv 98,236,38912
DN 74,12,36,2048
s_cmp_lg_u32 s49, 0
s_cbranch_scc1 LB_ra46
LB_rb46:
WL 6
Maaa 48,240,144
Tv 100,237,36864
Tv 102,237,38912
DN 75,12,36,3072
AR 253,44
AR 254,45
Maaa 52,244,144
Tv 104,238,36864
Tv 106,238,38912
s_waitcnt vmcnt(23)
s_mov_b32 m0, 106496
s_add_u32 s36, s32, 417792
DN 72,12,36,0
WL 6
Maaa 56,248,144
Ta 240,239,36864
Ta 242,239,38912
DN 73,12,36,1024
v_exp_f32 v192, v192
Maaa 60,252,144
Ta 244,236,40960
Ta 246,236,43008
DN 74,12,36,2048
CV 253,253,254
AW 214,253
WL 6
Mava 48,96,148
Ta 248,237,40960
Ta 250,237,43008
DN 75,12,36,3072
Mava 52,100,148
Ta 252,238,40960
Ta 254,238,43008
s_waitcnt vmcnt(23)
s_mov_b32 m0, 126976
s_add_u32 s36, s48, 200704
DD 76,20,36,0
WL 6
Mava 56,104,148
Tv 96,239,40960
Tv 98,239,43008
DD 77,20,36,1024
v_exp_f32 v193, v193
Maaa 60,240,148
Tv 100,236,45056
Tv 102,236,47104
DD 78,20,36,2048
AR 253,46
AR 254,47
WL 6
Maaa 48,244,152
Tv 104,237,45056
Tv 106,237,47104
DD 79,20,36,3072
Maaa 52,248,152
Ta 240,238,45056
Ta 242,238,47104
s_waitcnt vmcnt(23)
s_mov_b32 m0, 110592
s_add_u32 s36, s32, 421888
DN 72,12,36,0
WL 6
Maaa 56,252,152
Ta 244,239,45056
Ta 246,239,47104
DN 73,12,36,1024
v_add_f32 v247, v247, v192
Mava 60,96,152
DN 74,12,36,2048
v_exp_f32 v194, v194
CV 253,253,254
AW 215,253
WL 4
Mava 48,100,156
DN 75,12,36,3072
v_add_f32 v247, v247, v193
CV 192,192,193
v_exp_f32 v195, v195
Mava 52,104,156
s_waitcnt vmcnt(48) lgkmcnt(0)
s_barrier
Ba 248,224,0
Ba 252,224,8192
Bv 96,225,0
Maaa 56,240,156
Bv 100,225,8192
s_waitcnt vmcnt(23)
s_mov_b32 m0, 32768
s_add_u32 s36, s32, 442368
DN 64,8,36,0
Maaa 60,244,156
Bv 104,226,0
DN 65,8,36,1024
v_add_f32 v247, v247, v194
WL 3
v_mfma_f32_16x16x32_bf16 v[208:211], a[248:251], v[128:131], 0
Ba 240,226,8192
DN 66,8,36,2048
v_exp_f32 v196, v196
v_mfma_f32_16x16x32_bf16 v[212:215], a[252:255], v[128:131], 0
Ba 244,227,0
DN 67,8,36,3072
v_add_f32 v247, v247, v195
WL 3
Mvvv 208,96,132
Ba 248,227,8192
s_waitcnt vmcnt(23)
s_mov_b32 m0, 131072
s_add_u32 s48, s35, s45
s_add_u32 s36, s48, 0
DD 76,20,36,0
Mvvv 212,100,132
Ba 252,224,256
DD 77,20,36,1024
CV 193,194,195
WL 3
Mvvv 208,104,136
Bv 96,224,8448
DD 78,20,36,2048
v_exp_f32 v197, v197
Mvav 212,240,136
Bv 100,225,256
DD 79,20,36,3072
v_add_f32 v247, v247, v196
WL 3
Mvav 208,244,140
Bv 104,225,8448
s_waitcnt vmcnt(23)
s_mov_b32 m0, 36864
s_add_u32 s36, s32, 446464
DN 68,8,36,0
Mvav 212,248,140
Ba 240,226,256
DN 69,8,36,1024
v_exp_f32 v198, v198
WL 3
Mvav 208,252,144
Ba 244,226,8448
DN 70,8,36,2048
v_add_f32 v247, v247, v197
CV 194,196,197
Mvvv 212,96,144
Ba 248,227,256
DN 71,8,36,3072
v_exp_f32 v199, v199
WL 3
Mvvv 208,100,148
Ba 252,227,8448
s_waitcnt vmcnt(23)
s_mov_b32 m0, 135168
s_add_u32 s36, s48, 28672
DD 76,20,36,0
Mvvv 212,104,148
Tv 96,228,0
Tv 98,228,8192
DD 77,20,36,1024
WL 4
Mvav 208,240,152
Tv 100,229,0
Tv 102,229,8192
DD 78,20,36,2048
v_add_f32 v247, v247, v198
Mvav 212,244,152
Tv 104,230,0
Tv 106,230,8192
v_add_f32 v247, v247, v199
WL 6
Mvav 208,248,156
Ta 240,231,0
Ta 242,231,8192
DD 79,20,36,3072
CV 195,198,199
Mvav 212,252,156
Ta 244,232,0
Ta 246,232,8192
s_waitcnt vmcnt(23)
s_mov_b32 m0, 40960
s_add_u32 s36, s32, 450560
DN 64,8,36,0
WL 6
Mvvv 0,96,192
Ta 248,233,0
Ta 250,233,8192
DN 65,8,36,1024
Mvvv 4,100,192
Ta 252,234,0
Ta 254,234,8192
DN 66,8,36,2048
v_fma_f32 v208, v208, s37, -v245
WL 6
Mvvv 8,104,192
Tv 96,235,0
Tv 98,235,8192
DN 67,8,36,3072
v_fma_f32 v209, v209, s37, -v245
Mvav 12,240,192
Tv 100,228,256
Tv 102,228,8448
s_waitcnt vmcnt(23)
s_mov_b32 m0, 45056
s_add_u32 s36, s32, 454656
DN 68,8,36,0
WL 6
Mvav 16,244,192
Tv 104,229,256
Tv 106,229,8448
DN 69,8,36,1024
v_fma_f32 v210, v210, s37, -v245
v_fma_f32 v211, v211, s37, -v245
Mvav 20,248,192
Ta 240,230,256
Ta 242,230,8448
DN 70,8,36,2048
v_fma_f32 v212, v212, s37, -v245
WL 6
Mvav 24,252,192
Ta 244,231,256
Ta 246,231,8448
DN 71,8,36,3072
v_fma_f32 v213, v213, s37, -v245
Mvvv 28,96,192
Ta 248,232,256
Ta 250,232,8448
s_waitcnt vmcnt(23)
s_mov_b32 m0, 139264
s_add_u32 s36, s48, 57344
DD 76,20,36,0
WL 6
Mvvv 32,100,192
Ta 252,233,256
Ta 254,233,8448
DD 77,20,36,1024
v_fma_f32 v214, v214, s37, -v245
Mvvv 36,104,192
Tv 96,234,256
Tv 98,234,8448
DD 78,20,36,2048
v_fma_f32 v215, v215, s37, -v245
WL 6
Mvav 40,240,192
Tv 100,235,256
Tv 102,235,8448
DD 79,20,36,3072
v_max3_f32 v251, v208, v209, v210
Mvav 44,244,192
Tv 104,236,49152
Tv 106,236,51200
s_waitcnt vmcnt(23)
s_mov_b32 m0, 81920
s_add_u32 s36, s32, 425984
DN 72,12,36,0
WL 6
Mvav 48,248,192
Ta 240,237,49152
Ta 242,237,51200
DN 73,12,36,1024
v_max3_f32 v252, v211, v212, v213
v_max3_f32 v251, v251, v214, v215
Mvav 52,252,192
Ta 244,238,49152
Ta 246,238,51200
v_max_f32 v251, v251, v252
v_cmp_lt_f32 vcc, s38, v251
WL 6
Mvvv 56,96,192
Ta 248,239,49152
Ta 250,239,51200
DN 74,12,36,2048
s_cbranch_vccnz LB_ra47
LB_rb47:
Mvvv 60,100,192
Ta 252,236,53248
Ta 254,236,55296
DN 75,12,36,3072
s_cmp_lg_u32 s49, 0
s_cbranch_scc1 LB_ra48
LB_rb48:
WL 6
v_mfma_f32_16x16x32_bf16 a[0:3], v[104:107], a[128:131], 0
Tv 96,237,53248
Tv 98,237,55296
s_waitcnt vmcnt(23)
s_mov_b32 m0, 86016
s_add_u32 s36, s32, 430080
DN 72,12,36,0
v_mfma_f32_16x16x32_bf16 a[4:7], a[240:243], a[128:131], 0
Tv 100,238,53248
Tv 102,238,55296
DN 73,12,36,1024
WL 6
v_mfma_f32_16x16x32_bf16 a[8:11], a[244:247], a[128:131], 0
Tv 104,239,53248
Tv 106,239,55296
DN 74,12,36,2048
v_exp_f32 v208, v208
v_mfma_f32_16x16x32_bf16 a[12:15], a[248:251], a[128:131], 0
Ta 240,236,57344
Ta 242,236,59392
DN 75,12,36,3072
WL 6
Maaa 0,252,132
Ta 244,237,57344
Ta 246,237,59392
s_waitcnt vmcnt(23)
s_mov_b32 m0, 143360
s_add_u32 s36, s48, 86016
DD 76,20,36,0
Mava 4,96,132
Ta 248,238,57344
Ta 250,238,59392
DD 77,20,36,1024
WL 6
Mava 8,100,132
Ta 252,239,57344
Ta 254,239,59392
DD 78,20,36,2048
v_exp_f32 v209, v209
Mava 12,104,132
Tv 96,236,61440
Tv 98,236,63488
DD 79,20,36,3072
WL 6
Maaa 0,240,136
Tv 100,237,61440
Tv 102,237,63488
s_waitcnt vmcnt(23)
s_mov_b32 m0, 90112
s_add_u32 s36, s32, 434176
DN 72,12,36,0
Maaa 4,244,136
Tv 104,238,61440
Tv 106,238,63488
DN 73,12,36,1024
WL 6
Maaa 8,248,136
Ta 240,239,61440
Ta 242,239,63488
DN 74,12,36,2048
v_add_f32 v247, v247, v208
Maaa 12,252,136
DN 75,12,36,3072
v_exp_f32 v210, v210
v_add_f32 v247, v247, v209
WL 4
Mava 0,96,140
CV 208,208,209
v_exp_f32 v211, v211
Mava 4,100,140
s_waitcnt vmcnt(44) lgkmcnt(0)
s_barrier
Ba 244,224,16384
Ba 248,224,24576
Ba 252,225,16384
Mava 8,104,140
Bv 96,225,24576
s_waitcnt vmcnt(23)
s_mov_b32 m0, 94208
s_add_u32 s36, s32, 438272
DN 72,12,36,0
DN 73,12,36,1024
Maaa 12,240,140
Bv 100,226,16384
DN 74,12,36,2048
v_add_f32 v247, v247, v210
v_exp_f32 v212, v212
WL 3
v_mfma_f32_16x16x32_bf16 v[192:195], a[244:247], v[128:131], 0
Bv 104,226,24576
DN 75,12,36,3072
v_add_f32 v247, v247, v211
v_mfma_f32_16x16x32_bf16 v[196:199], a[248:251], v[128:131], 0
Ba 240,227,16384
s_waitcnt vmcnt(23)
s_mov_b32 m0, 147456
s_add_u32 s48, s35, s45
s_add_u32 s36, s48, 114688
DD 76,20,36,0
WL 3
Mvav 192,252,132
Ba 244,227,24576
DD 77,20,36,1024
CV 209,210,211
Mvvv 196,96,132
Ba 248,224,16640
DD 78,20,36,2048
v_exp_f32 v213, v213
WL 3
Mvvv 192,100,136
Ba 252,224,24832
DD 79,20,36,3072
v_add_f32 v247, v247, v212
Mvvv 196,104,136
Bv 96,225,16640
s_waitcnt vmcnt(23)
s_mov_b32 m0, 0
s_add_u32 s36, s32, 458752
DN 64,8,36,0
WL 3
Mvav 192,240,140
Bv 100,225,24832
DN 65,8,36,1024
v_exp_f32 v214, v214
Mvav 196,244,140
Bv 104,226,16640
DN 66,8,36,2048
v_add_f32 v247, v247, v213
CV 210,212,213
WL 3
Mvav 192,248,144
Ba 240,226,24832
DN 67,8,36,3072
v_exp_f32 v215, v215
Mvav 196,252,144
Ba 244,227,16640
s_waitcnt vmcnt(23)
s_mov_b32 m0, 4096
s_add_u32 s36, s32, 462848
DN 68,8,36,0
WL 3
Mvvv 192,96,148
Ba 248,227,24832
DN 69,8,36,1024
v_add_f32 v247, v247, v214
Mvvv 196,100,148
Ta 252,228,32768
Ta 254,228,40960
DN 70,8,36,2048
v_add_f32 v247, v247, v215
WL 4
Mvvv 192,104,152
Tv 96,229,32768
Tv 98,229,40960
DN 71,8,36,3072
Mvav 196,240,152
Tv 100,230,32768
Tv 102,230,40960
s_waitcnt vmcnt(23)
s_mov_b32 m0, 151552
s_add_u32 s36, s48, 143360
DD 76,20,36,0
WL 6
Mvav 192,244,156
Tv 104,231,32768
Tv 106,231,40960
DD 77,20,36,1024
CV 211,214,215
Mvav 196,248,156
Ta 240,232,32768
Ta 242,232,40960
DD 78,20,36,2048
WL 6
Mvav 0,252,208
Ta 244,233,32768
Ta 246,233,40960
DD 79,20,36,3072
Mvvv 4,96,208
Ta 248,234,32768
Ta 250,234,40960
s_waitcnt vmcnt(23)
s_mov_b32 m0, 8192
s_add_u32 s36, s32, 466944
DN 64,8,36,0
WL 6
Mvvv 8,100,208
Ta 252,235,32768
Ta 254,235,40960
DN 65,8,36,1024
v_fma_f32 v192, v192, s37, -v245
Mvvv 12,104,208
Tv 96,228,33024
Tv 98,228,41216
DN 66,8,36,2048
v_fma_f32 v193, v193, s37, -v245
v_fma_f32 v194, v194, s37, -v245
WL 6
Mvav 16,240,208
Tv 100,229,33024
Tv 102,229,41216
DN 67,8,36,3072
v_fma_f32 v195, v195, s37, -v245
Mvav 20,244,208
Tv 104,230,33024
Tv 106,230,41216
s_waitcnt vmcnt(23)
s_mov_b32 m0, 12288
s_add_u32 s36, s32, 471040
DN 68,8,36,0
WL 6
Mvav 24,248,208
Ta 240,231,33024
Ta 242,231,41216
DN 69,8,36,1024
v_fma_f32 v196, v196, s37, -v245
v_fma_f32 v197, v197, s37, -v245
Mvav 28,252,208
Ta 244,232,33024
Ta 246,232,41216
DN 70,8,36,2048
v_fma_f32 v198, v198, s37, -v245
WL 6
Mvvv 32,96,208
Ta 248,233,33024
Ta 250,233,41216
DN 71,8,36,3072
v_fma_f32 v199, v199, s37, -v245
Mvvv 36,100,208
Ta 252,234,33024
Ta 254,234,41216
s_waitcnt vmcnt(23)
s_mov_b32 m0, 155648
s_add_u32 s36, s48, 172032
DD 76,20,36,0
WL 6
Mvvv 40,104,208
Tv 96,235,33024
Tv 98,235,41216
DD 77,20,36,1024
v_max3_f32 v251, v192, v193, v194
v_max3_f32 v252, v195, v196, v197
Mvav 44,240,208
Tv 100,236,16384
Tv 102,236,18432
DD 78,20,36,2048
v_max3_f32 v251, v251, v198, v199
WL 6
Mvav 48,244,208
Tv 104,237,16384
Tv 106,237,18432
DD 79,20,36,3072
v_max_f32 v251, v251, v252
v_cmp_lt_f32 vcc, s38, v251
Mvav 52,248,208
Ta 240,238,16384
Ta 242,238,18432
s_waitcnt vmcnt(23)
s_mov_b32 m0, 65536
s_add_u32 s36, s32, 442368
DN 72,12,36,0
WL 6
Mvav 56,252,208
Ta 244,239,16384
Ta 246,239,18432
DN 73,12,36,1024
s_cbranch_vccnz LB_ra49
LB_rb49:
Mvvv 60,96,208
Ta 248,236,20480
Ta 250,236,22528
DN 74,12,36,2048
s_cmp_lg_u32 s49, 0
s_cbranch_scc1 LB_ra50
LB_rb50:
WL 6
Mava 0,100,144
Ta 252,237,20480
Ta 254,237,22528
DN 75,12,36,3072
Mava 4,104,144
Tv 96,238,20480
Tv 98,238,22528
s_waitcnt vmcnt(23)
s_mov_b32 m0, 69632
s_add_u32 s36, s32, 446464
DN 72,12,36,0
WL 6
Maaa 8,240,144
Tv 100,239,20480
Tv 102,239,22528
DN 73,12,36,1024
v_exp_f32 v192, v192
Maaa 12,244,144
Tv 104,236,24576
Tv 106,236,26624
DN 74,12,36,2048
WL 6
Maaa 0,248,148
Ta 240,237,24576
Ta 242,237,26624
DN 75,12,36,3072
Maaa 4,252,148
Ta 244,238,24576
Ta 246,238,26624
s_waitcnt vmcnt(23)
s_mov_b32 m0, 159744
s_add_u32 s36, s48, 200704
DD 76,20,36,0
WL 6
Mava 8,96,148
Ta 248,239,24576
Ta 250,239,26624
DD 77,20,36,1024
v_exp_f32 v193, v193
Mava 12,100,148
Ta 252,236,28672
Ta 254,236,30720
DD 78,20,36,2048
WL 6
Mava 0,104,152
Tv 96,237,28672
Tv 98,237,30720
DD 79,20,36,3072
Maaa 4,240,152
Tv 100,238,28672
Tv 102,238,30720
s_waitcnt vmcnt(23)
s_mov_b32 m0, 73728
s_add_u32 s36, s32, 450560
DN 72,12,36,0
WL 6
Maaa 8,244,152
Tv 104,239,28672
Tv 106,239,30720
DN 73,12,36,1024
v_add_f32 v247, v247, v192
Maaa 12,248,152
DN 74,12,36,2048
v_exp_f32 v194, v194
WL 4
Maaa 0,252,156
DN 75,12,36,3072
v_add_f32 v247, v247, v193
CV 192,192,193
v_exp_f32 v195, v195
Mava 4,96,156
s_waitcnt vmcnt(44) lgkmcnt(0)
s_barrier
Ba 240,224,32768
Ba 244,224,40960
Ba 248,225,32768
Mava 8,100,156
Ba 252,225,40960
s_waitcnt vmcnt(23)
s_mov_b32 m0, 77824
s_add_u32 s36, s32, 454656
DN 72,12,36,0
Mava 12,104,156
Bv 96,226,32768
DN 73,12,36,1024
v_add_f32 v247, v247, v194
WL 3
v_mfma_f32_16x16x32_bf16 v[208:211], a[240:243], v[128:131], 0
Bv 100,226,40960
DN 74,12,36,2048
v_exp_f32 v196, v196
v_mfma_f32_16x16x32_bf16 v[212:215], a[244:247], v[128:131], 0
Bv 104,227,32768
DN 75,12,36,3072
v_add_f32 v247, v247, v195
WL 3
Mvav 208,248,132
Ba 240,227,40960
s_waitcnt vmcnt(23)
s_mov_b32 m0, 114688
s_add_u32 s48, s35, s46
s_add_u32 s36, s48, 0
DD 76,20,36,0
Mvav 212,252,132
Ba 244,224,33024
DD 77,20,36,1024
CV 193,194,195
WL 3
Mvvv 208,96,136
Ba 248,224,41216
DD 78,20,36,2048
v_exp_f32 v197, v197
Mvvv 212,100,136
Ba 252,225,33024
DD 79,20,36,3072
v_add_f32 v247, v247, v196
WL 3
Mvvv 208,104,140
Bv 96,225,41216
s_waitcnt vmcnt(23)
s_mov_b32 m0, 16384
s_add_u32 s36, s32, 475136
DN 64,8,36,0
Mvav 212,240,140
Bv 100,226,33024
DN 65,8,36,1024
v_exp_f32 v198, v198
WL 3
Mvav 208,244,144
Bv 104,226,41216
DN 66,8,36,2048
v_add_f32 v247, v247, v197
CV 194,196,197
Mvav 212,248,144
Ba 240,227,33024
DN 67,8,36,3072
v_exp_f32 v199, v199
WL 3
Mvav 208,252,148
Ba 244,227,41216
s_waitcnt vmcnt(23)
s_mov_b32 m0, 118784
s_add_u32 s36, s48, 28672
DD 76,20,36,0
Mvvv 212,96,148
Ta 248,228,16384
Ta 250,228,24576
DD 77,20,36,1024
WL 4
Mvvv 208,100,152
Ta 252,229,16384
Ta 254,229,24576
DD 78,20,36,2048
v_add_f32 v247, v247, v198
Mvvv 212,104,152
Tv 96,230,16384
Tv 98,230,24576
v_add_f32 v247, v247, v199
WL 6
Mvav 208,240,156
Tv 100,231,16384
Tv 102,231,24576
DD 79,20,36,3072
CV 195,198,199
Mvav 212,244,156
Tv 104,232,16384
Tv 106,232,24576
s_waitcnt vmcnt(23)
s_mov_b32 m0, 20480
s_add_u32 s36, s32, 479232
DN 68,8,36,0
WL 6
Mvav 0,248,192
Ta 240,233,16384
Ta 242,233,24576
DN 69,8,36,1024
Mvav 4,252,192
Ta 244,234,16384
Ta 246,234,24576
DN 70,8,36,2048
v_fma_f32 v208, v208, s37, -v245
WL 6
Mvvv 8,96,192
Ta 248,235,16384
Ta 250,235,24576
DN 71,8,36,3072
v_fma_f32 v209, v209, s37, -v245
Mvvv 12,100,192
Ta 252,228,16640
Ta 254,228,24832
s_waitcnt vmcnt(23)
s_mov_b32 m0, 24576
s_add_u32 s36, s32, 483328
DN 64,8,36,0
WL 6
Mvvv 16,104,192
Tv 96,229,16640
Tv 98,229,24832
DN 65,8,36,1024
v_fma_f32 v210, v210, s37, -v245
v_fma_f32 v211, v211, s37, -v245
Mvav 20,240,192
Tv 100,230,16640
Tv 102,230,24832
DN 66,8,36,2048
v_fma_f32 v212, v212, s37, -v245
WL 6
Mvav 24,244,192
Tv 104,231,16640
Tv 106,231,24832
DN 67,8,36,3072
v_fma_f32 v213, v213, s37, -v245
Mvav 28,248,192
Ta 240,232,16640
Ta 242,232,24832
s_waitcnt vmcnt(23)
s_mov_b32 m0, 122880
s_add_u32 s36, s48, 57344
DD 76,20,36,0
WL 6
Mvav 32,252,192
Ta 244,233,16640
Ta 246,233,24832
DD 77,20,36,1024
v_fma_f32 v214, v214, s37, -v245
Mvvv 36,96,192
Ta 248,234,16640
Ta 250,234,24832
DD 78,20,36,2048
v_fma_f32 v215, v215, s37, -v245
WL 6
Mvvv 40,100,192
Ta 252,235,16640
Ta 254,235,24832
DD 79,20,36,3072
v_max3_f32 v251, v208, v209, v210
Mvvv 44,104,192
Tv 96,236,32768
Tv 98,236,34816
s_waitcnt vmcnt(23)
s_mov_b32 m0, 28672
s_add_u32 s36, s32, 487424
DN 68,8,36,0
WL 6
Mvav 48,240,192
Tv 100,237,32768
Tv 102,237,34816
DN 69,8,36,1024
v_max3_f32 v252, v211, v212, v213
v_max3_f32 v251, v251, v214, v215
Mvav 52,244,192
Tv 104,238,32768
Tv 106,238,34816
v_max_f32 v251, v251, v252
v_cmp_lt_f32 vcc, s38, v251
WL 6
Mvav 56,248,192
Ta 240,239,32768
Ta 242,239,34816
DN 70,8,36,2048
s_cbranch_vccnz LB_ra51
LB_rb51:
Mvav 60,252,192
Ta 244,236,36864
Ta 246,236,38912
DN 71,8,36,3072
s_cmp_lg_u32 s49, 0
s_cbranch_scc1 LB_ra52
LB_rb52:
WL 6
v_mfma_f32_16x16x32_bf16 a[16:19], v[96:99], a[128:131], 0
Ta 248,237,36864
Ta 250,237,38912
s_waitcnt vmcnt(23)
s_mov_b32 m0, 98304
s_add_u32 s36, s32, 458752
DN 72,12,36,0
v_mfma_f32_16x16x32_bf16 a[20:23], v[100:103], a[128:131], 0
Ta 252,238,36864
Ta 254,238,38912
DN 73,12,36,1024
WL 6
v_mfma_f32_16x16x32_bf16 a[24:27], v[104:107], a[128:131], 0
Tv 96,239,36864
Tv 98,239,38912
DN 74,12,36,2048
v_exp_f32 v208, v208
v_mfma_f32_16x16x32_bf16 a[28:31], a[240:243], a[128:131], 0
Tv 100,236,40960
Tv 102,236,43008
DN 75,12,36,3072
WL 6
Maaa 16,244,132
Tv 104,237,40960
Tv 106,237,43008
s_waitcnt vmcnt(23)
s_mov_b32 m0, 126976
s_add_u32 s36, s48, 86016
DD 76,20,36,0
Maaa 20,248,132
Ta 240,238,40960
Ta 242,238,43008
DD 77,20,36,1024
WL 6
Maaa 24,252,132
Ta 244,239,40960
Ta 246,239,43008
DD 78,20,36,2048
Mava 28,96,132
Ta 248,236,45056
Ta 250,236,47104
DD 79,20,36,3072
v_exp_f32 v209, v209
WL 6
Mava 16,100,136
Ta 252,237,45056
Ta 254,237,47104
s_waitcnt vmcnt(23)
s_mov_b32 m0, 102400
s_add_u32 s36, s32, 462848
DN 72,12,36,0
Mava 20,104,136
Tv 96,238,45056
Tv 98,238,47104
DN 73,12,36,1024
WL 6
Maaa 24,240,136
Tv 100,239,45056
Tv 102,239,47104
DN 74,12,36,2048
v_add_f32 v247, v247, v208
Maaa 28,244,136
DN 75,12,36,3072
v_exp_f32 v210, v210
WL 4
Maaa 16,248,140
v_add_f32 v247, v247, v209
CV 208,208,209
v_exp_f32 v211, v211
Maaa 20,252,140
s_waitcnt vmcnt(40) lgkmcnt(0)
s_barrier
Bv 104,224,0
Ba 240,224,8192
Ba 244,225,0
Mava 24,96,140
Ba 248,225,8192
s_waitcnt vmcnt(23)
s_mov_b32 m0, 106496
s_add_u32 s36, s32, 466944
DN 72,12,36,0
Mava 28,100,140
Ba 252,226,0
DN 73,12,36,1024
v_add_f32 v247, v247, v210
WL 3
v_mfma_f32_16x16x32_bf16 v[192:195], v[104:107], v[128:131], 0
Bv 96,226,8192
DN 74,12,36,2048
v_exp_f32 v212, v212
v_mfma_f32_16x16x32_bf16 v[196:199], a[240:243], v[128:131], 0
Bv 100,227,0
DN 75,12,36,3072
v_add_f32 v247, v247, v211
WL 3
Mvav 192,244,132
Bv 104,227,8192
s_waitcnt vmcnt(23)
s_mov_b32 m0, 131072
s_add_u32 s48, s35, s46
s_add_u32 s36, s48, 114688
DD 76,20,36,0
Mvav 196,248,132
Ba 240,224,256
DD 77,20,36,1024
CV 209,210,211
WL 3
Mvav 192,252,136
Ba 244,224,8448
DD 78,20,36,2048
v_exp_f32 v213, v213
Mvvv 196,96,136
Ba 248,225,256
DD 79,20,36,3072
v_add_f32 v247, v247, v212
v_exp_f32 v214, v214
WL 3
Mvvv 192,100,140
Ba 252,225,8448
s_waitcnt vmcnt(23)
s_mov_b32 m0, 110592
s_add_u32 s36, s32, 471040
DN 72,12,36,0
Mvvv 196,104,140
Bv 96,226,256
DN 73,12,36,1024
v_add_f32 v247, v247, v213
WL 3
Mvav 192,240,144
Bv 100,226,8448
DN 74,12,36,2048
CV 210,212,213
Mvav 196,244,144
Bv 104,227,256
DN 75,12,36,3072
v_exp_f32 v215, v215
WL 3
Mvav 192,248,148
Ba 240,227,8448
s_waitcnt vmcnt(23)
s_mov_b32 m0, 135168
s_add_u32 s36, s48, 143360
DD 76,20,36,0
Mvav 196,252,148
Ta 244,228,0
Ta 246,228,8192
DD 77,20,36,1024
WL 4
Mvvv 192,96,152
Ta 248,229,0
Ta 250,229,8192
DD 78,20,36,2048
v_add_f32 v247, v247, v214
Mvvv 196,100,152
Ta 252,230,0
Ta 254,230,8192
v_add_f32 v247, v247, v215
WL 6
Mvvv 192,104,156
Tv 96,231,0
Tv 98,231,8192
DD 79,20,36,3072
CV 211,214,215
Mvav 196,240,156
Tv 100,232,0
Tv 102,232,8192
s_waitcnt vmcnt(23)
s_mov_b32 m0, 32768
s_add_u32 s36, s32, 491520
DN 64,8,36,0
WL 6
Mvav 0,244,208
Tv 104,233,0
Tv 106,233,8192
DN 65,8,36,1024
Mvav 4,248,208
Ta 240,234,0
Ta 242,234,8192
DN 66,8,36,2048
v_fma_f32 v192, v192, s37, -v245
WL 6
Mvav 8,252,208
Ta 244,235,0
Ta 246,235,8192
DN 67,8,36,3072
v_fma_f32 v193, v193, s37, -v245
Mvvv 12,96,208
Ta 248,228,256
Ta 250,228,8448
s_waitcnt vmcnt(23)
s_mov_b32 m0, 36864
s_add_u32 s36, s32, 495616
DN 68,8,36,0
WL 6
Mvvv 16,100,208
Ta 252,229,256
Ta 254,229,8448
DN 69,8,36,1024
v_fma_f32 v194, v194, s37, -v245
v_fma_f32 v195, v195, s37, -v245
Mvvv 20,104,208
Tv 96,230,256
Tv 98,230,8448
DN 70,8,36,2048
v_fma_f32 v196, v196, s37, -v245
WL 6
Mvav 24,240,208
Tv 100,231,256
Tv 102,231,8448
DN 71,8,36,3072
v_fma_f32 v197, v197, s37, -v245
Mvav 28,244,208
Tv 104,232,256
Tv 106,232,8448
s_waitcnt vmcnt(23)
s_mov_b32 m0, 139264
s_add_u32 s36, s48, 172032
DD 76,20,36,0
WL 6
Mvav 32,248,208
Ta 240,233,256
Ta 242,233,8448
DD 77,20,36,1024
v_fma_f32 v198, v198, s37, -v245
Mvav 36,252,208
Ta 244,234,256
Ta 246,234,8448
DD 78,20,36,2048
v_fma_f32 v199, v199, s37, -v245
WL 6
Mvvv 40,96,208
Ta 248,235,256
Ta 250,235,8448
DD 79,20,36,3072
v_max3_f32 v251, v192, v193, v194
Mvvv 44,100,208
Ta 252,236,49152
Ta 254,236,51200
s_waitcnt vmcnt(23)
s_mov_b32 m0, 40960
s_add_u32 s36, s32, 499712
DN 64,8,36,0
WL 6
Mvvv 48,104,208
Tv 96,237,49152
Tv 98,237,51200
DN 65,8,36,1024
v_max3_f32 v252, v195, v196, v197
v_max3_f32 v251, v251, v198, v199
Mvav 52,240,208
Tv 100,238,49152
Tv 102,238,51200
v_max_f32 v251, v251, v252
v_cmp_lt_f32 vcc, s38, v251
WL 6
Mvav 56,244,208
Tv 104,239,49152
Tv 106,239,51200
DN 66,8,36,2048
s_cbranch_vccnz LB_ra53
LB_rb53:
Mvav 60,248,208
Ta 240,236,53248
Ta 242,236,55296
DN 67,8,36,3072
s_cmp_lg_u32 s49, 0
s_cbranch_scc1 LB_ra54
LB_rb54:
WL 6
Maaa 16,252,144
Ta 244,237,53248
Ta 246,237,55296
s_waitcnt vmcnt(23)
s_mov_b32 m0, 45056
s_add_u32 s36, s32, 503808
DN 68,8,36,0
Mava 20,96,144
Ta 248,238,53248
Ta 250,238,55296
DN 69,8,36,1024
WL 6
Mava 24,100,144
Ta 252,239,53248
Ta 254,239,55296
DN 70,8,36,2048
v_exp_f32 v192, v192
Mava 28,104,144
Tv 96,236,57344
Tv 98,236,59392
DN 71,8,36,3072
WL 6
Maaa 16,240,148
Tv 100,237,57344
Tv 102,237,59392
s_waitcnt vmcnt(23)
s_mov_b32 m0, 143360
s_add_u32 s36, s48, 200704
DD 76,20,36,0
Maaa 20,244,148
Tv 104,238,57344
Tv 106,238,59392
DD 77,20,36,1024
WL 6
Maaa 24,248,148
Ta 240,239,57344
Ta 242,239,59392
DD 78,20,36,2048
v_exp_f32 v193, v193
Maaa 28,252,148
Ta 244,236,61440
Ta 246,236,63488
DD 79,20,36,3072
WL 6
Mava 16,96,152
Ta 248,237,61440
Ta 250,237,63488
s_waitcnt vmcnt(23)
s_mov_b32 m0, 81920
s_add_u32 s36, s32, 475136
DN 72,12,36,0
Mava 20,100,152
Ta 252,238,61440
Ta 254,238,63488
DN 73,12,36,1024
WL 6
Mava 24,104,152
Tv 96,239,61440
Tv 98,239,63488
DN 74,12,36,2048
v_add_f32 v247, v247, v192
Maaa 28,240,152
DN 75,12,36,3072
v_exp_f32 v194, v194
v_add_f32 v247, v247, v193
WL 4
Maaa 16,244,156
CV 192,192,193
v_exp_f32 v195, v195
Maaa 20,248,156
s_waitcnt vmcnt(32) lgkmcnt(0)
s_barrier
Bv 100,224,16384
Bv 104,224,24576
Ba 240,225,16384
Maaa 24,252,156
Ba 244,225,24576
s_waitcnt vmcnt(23)
s_mov_b32 m0, 86016
s_add_u32 s36, s32, 479232
DN 72,12,36,0
DN 73,12,36,1024
Mava 28,96,156
Ba 248,226,16384
DN 74,12,36,2048
v_add_f32 v247, v247, v194
v_exp_f32 v196, v196
WL 3
v_mfma_f32_16x16x32_bf16 v[208:211], v[100:103], v[128:131], 0
Ba 252,226,24576
DN 75,12,36,3072
v_add_f32 v247, v247, v195
v_mfma_f32_16x16x32_bf16 v[212:215], v[104:107], v[128:131], 0
Bv 96,227,16384
s_waitcnt vmcnt(23)
s_mov_b32 m0, 147456
s_add_u32 s48, s35, s46
s_add_u32 s36, s48, 229376
DD 76,20,36,0
WL 3
Mvav 208,240,132
Bv 100,227,24576
DD 77,20,36,1024
CV 193,194,195
Mvav 212,244,132
Bv 104,224,16640
DD 78,20,36,2048
v_exp_f32 v197, v197
WL 3
Mvav 208,248,136
Ba 240,224,24832
DD 79,20,36,3072
v_add_f32 v247, v247, v196
Mvav 212,252,136
Ba 244,225,16640
s_waitcnt vmcnt(23)
s_mov_b32 m0, 90112
s_add_u32 s36, s32, 483328
DN 72,12,36,0
WL 3
Mvvv 208,96,140
Ba 248,225,24832
DN 73,12,36,1024
v_exp_f32 v198, v198
Mvvv 212,100,140
Ba 252,226,16640
DN 74,12,36,2048
v_add_f32 v247, v247, v197
CV 194,196,197
WL 3
Mvvv 208,104,144
Bv 96,226,24832
DN 75,12,36,3072
v_exp_f32 v199, v199
Mvav 212,240,144
Bv 100,227,16640
s_waitcnt vmcnt(23)
s_mov_b32 m0, 94208
s_add_u32 s36, s32, 487424
DN 72,12,36,0
WL 3
Mvav 208,244,148
Bv 104,227,24832
DN 73,12,36,1024
v_add_f32 v247, v247, v198
Mvav 212,248,148
Ta 240,228,32768
Ta 242,228,40960
DN 74,12,36,2048
v_add_f32 v247, v247, v199
WL 4
Mvav 208,252,152
Ta 244,229,32768
Ta 246,229,40960
DN 75,12,36,3072
Mvvv 212,96,152
Ta 248,230,32768
Ta 250,230,40960
s_waitcnt vmcnt(23)
s_mov_b32 m0, 151552
s_add_u32 s36, s48, 258048
DD 76,20,36,0
WL 6
Mvvv 208,100,156
Ta 252,231,32768
Ta 254,231,40960
DD 77,20,36,1024
CV 195,198,199
Mvvv 212,104,156
Tv 96,232,32768
Tv 98,232,40960
DD 78,20,36,2048
WL 6
Mvav 0,240,192
Tv 100,233,32768
Tv 102,233,40960
DD 79,20,36,3072
Mvav 4,244,192
Tv 104,234,32768
Tv 106,234,40960
s_waitcnt vmcnt(23)
s_mov_b32 m0, 0
s_add_u32 s36, s32, 507904
DN 64,8,36,0
WL 6
Mvav 8,248,192
Ta 240,235,32768
Ta 242,235,40960
DN 65,8,36,1024
v_fma_f32 v208, v208, s37, -v245
Mvav 12,252,192
Ta 244,228,33024
Ta 246,228,41216
DN 66,8,36,2048
v_fma_f32 v209, v209, s37, -v245
v_fma_f32 v210, v210, s37, -v245
WL 6
Mvvv 16,96,192
Ta 248,229,33024
Ta 250,229,41216
DN 67,8,36,3072
v_fma_f32 v211, v211, s37, -v245
Mvvv 20,100,192
Ta 252,230,33024
Ta 254,230,41216
s_waitcnt vmcnt(23)
s_mov_b32 m0, 4096
s_add_u32 s36, s32, 512000
DN 68,8,36,0
WL 6
Mvvv 24,104,192
Tv 96,231,33024
Tv 98,231,41216
DN 69,8,36,1024
v_fma_f32 v212, v212, s37, -v245
v_fma_f32 v213, v213, s37, -v245
Mvav 28,240,192
Tv 100,232,33024
Tv 102,232,41216
DN 70,8,36,2048
v_fma_f32 v214, v214, s37, -v245
WL 6
Mvav 32,244,192
Tv 104,233,33024
Tv 106,233,41216
DN 71,8,36,3072
v_fma_f32 v215, v215, s37, -v245
Mvav 36,248,192
Ta 240,234,33024
Ta 242,234,41216
s_waitcnt vmcnt(23)
s_mov_b32 m0, 155648
s_add_u32 s36, s48, 286720
DD 76,20,36,0
WL 6
Mvav 40,252,192
Ta 244,235,33024
Ta 246,235,41216
DD 77,20,36,1024
v_max3_f32 v251, v208, v209, v210
v_max3_f32 v252, v211, v212, v213
Mvvv 44,96,192
Ta 248,236,16384
Ta 250,236,18432
DD 78,20,36,2048
v_max3_f32 v251, v251, v214, v215
WL 6
Mvvv 48,100,192
Ta 252,237,16384
Ta 254,237,18432
DD 79,20,36,3072
v_max_f32 v251, v251, v252
v_cmp_lt_f32 vcc, s38, v251
Mvvv 52,104,192
Tv 96,238,16384
Tv 98,238,18432
s_waitcnt vmcnt(23)
s_mov_b32 m0, 8192
s_add_u32 s36, s32, 516096
DN 64,8,36,0
WL 6
Mvav 56,240,192
Tv 100,239,16384
Tv 102,239,18432
DN 65,8,36,1024
s_cbranch_vccnz LB_ra55
LB_rb55:
Mvav 60,244,192
Tv 104,236,20480
Tv 106,236,22528
DN 66,8,36,2048
s_cmp_lg_u32 s49, 0
s_cbranch_scc1 LB_ra56
LB_rb56:
WL 6
v_mfma_f32_16x16x32_bf16 a[32:35], a[248:251], a[128:131], 0
Ta 240,237,20480
Ta 242,237,22528
DN 67,8,36,3072
v_mfma_f32_16x16x32_bf16 a[36:39], a[252:255], a[128:131], 0
Ta 244,238,20480
Ta 246,238,22528
s_waitcnt vmcnt(23)
s_mov_b32 m0, 12288
s_add_u32 s36, s32, 520192
DN 68,8,36,0
WL 6
v_mfma_f32_16x16x32_bf16 a[40:43], v[96:99], a[128:131], 0
Ta 248,239,20480
Ta 250,239,22528
DN 69,8,36,1024
v_exp_f32 v208, v208
v_mfma_f32_16x16x32_bf16 a[44:47], v[100:103], a[128:131], 0
Ta 252,236,24576
Ta 254,236,26624
DN 70,8,36,2048
WL 6
Mava 32,104,132
Tv 96,237,24576
Tv 98,237,26624
DN 71,8,36,3072
Maaa 36,240,132
Tv 100,238,24576
Tv 102,238,26624
s_waitcnt vmcnt(23)
s_mov_b32 m0, 159744
s_add_u32 s36, s48, 315392
DD 76,20,36,0
WL 6
Maaa 40,244,132
Tv 104,239,24576
Tv 106,239,26624
DD 77,20,36,1024
v_exp_f32 v209, v209
Maaa 44,248,132
Ta 240,236,28672
Ta 242,236,30720
DD 78,20,36,2048
WL 6
Maaa 32,252,136
Ta 244,237,28672
Ta 246,237,30720
DD 79,20,36,3072
Mava 36,96,136
Ta 248,238,28672
Ta 250,238,30720
s_waitcnt vmcnt(23)
s_mov_b32 m0, 65536
s_add_u32 s36, s32, 491520
DN 72,12,36,0
WL 6
Mava 40,100,136
Ta 252,239,28672
Ta 254,239,30720
DN 73,12,36,1024
v_add_f32 v247, v247, v208
Mava 44,104,136
DN 74,12,36,2048
v_exp_f32 v210, v210
WL 4
Maaa 32,240,140
DN 75,12,36,3072
v_add_f32 v247, v247, v209
CV 208,208,209
v_exp_f32 v211, v211
Maaa 36,244,140
s_waitcnt vmcnt(32) lgkmcnt(0)
s_barrier
Bv 96,224,32768
Bv 100,224,40960
Bv 104,225,32768
Maaa 40,248,140
Ba 240,225,40960
s_waitcnt vmcnt(23)
s_mov_b32 m0, 69632
s_add_u32 s36, s32, 495616
DN 72,12,36,0
Maaa 44,252,140
Ba 244,226,32768
DN 73,12,36,1024
v_add_f32 v247, v247, v210
WL 3
v_mfma_f32_16x16x32_bf16 v[192:195], v[96:99], v[128:131], 0
Ba 248,226,40960
DN 74,12,36,2048
v_exp_f32 v212, v212
v_mfma_f32_16x16x32_bf16 v[196:199], v[100:103], v[128:131], 0
Ba 252,227,32768
DN 75,12,36,3072
v_add_f32 v247, v247, v211
WL 3
Mvvv 192,104,132
Bv 96,227,40960
s_waitcnt vmcnt(23)
s_mov_b32 m0, 114688
s_add_u32 s48, s35, s46
s_add_u32 s36, s48, 344064
DD 76,20,36,0
Mvav 196,240,132
Bv 100,224,33024
DD 77,20,36,1024
CV 209,210,211
WL 3
Mvav 192,244,136
Bv 104,224,41216
DD 78,20,36,2048
v_exp_f32 v213, v213
Mvav 196,248,136
Ba 240,225,33024
DD 79,20,36,3072
v_add_f32 v247, v247, v212
WL 3
Mvav 192,252,140
Ba 244,225,41216
s_waitcnt vmcnt(23)
s_mov_b32 m0, 73728
s_add_u32 s36, s32, 499712
DN 72,12,36,0
Mvvv 196,96,140
Ba 248,226,33024
DN 73,12,36,1024
v_exp_f32 v214, v214
WL 3
Mvvv 192,100,144
Ba 252,226,41216
DN 74,12,36,2048
v_add_f32 v247, v247, v213
CV 210,212,213
Mvvv 196,104,144
Bv 96,227,33024
DN 75,12,36,3072
v_exp_f32 v215, v215
WL 3
Mvav 192,240,148
Bv 100,227,41216
s_waitcnt vmcnt(23)
s_mov_b32 m0, 118784
s_add_u32 s36, s48, 372736
DD 76,20,36,0
Mvav 196,244,148
Tv 104,228,16384
Tv 106,228,24576
DD 77,20,36,1024
WL 4
Mvav 192,248,152
Ta 240,229,16384
Ta 242,229,24576
DD 78,20,36,2048
v_add_f32 v247, v247, v214
Mvav 196,252,152
Ta 244,230,16384
Ta 246,230,24576
v_add_f32 v247, v247, v215
WL 6
Mvvv 192,96,156
Ta 248,231,16384
Ta 250,231,24576
DD 79,20,36,3072
CV 211,214,215
Mvvv 196,100,156
Ta 252,232,16384
Ta 254,232,24576
s_waitcnt vmcnt(23)
s_mov_b32 m0, 77824
s_add_u32 s36, s32, 503808
DN 72,12,36,0
WL 6
Mvvv 0,104,208
Tv 96,233,16384
Tv 98,233,24576
DN 73,12,36,1024
Mvav 4,240,208
Tv 100,234,16384
Tv 102,234,24576
DN 74,12,36,2048
v_fma_f32 v192, v192, s37, -v245
WL 6
Mvav 8,244,208
Tv 104,235,16384
Tv 106,235,24576
DN 75,12,36,3072
v_fma_f32 v193, v193, s37, -v245
Mvav 12,248,208
Ta 240,228,16640
Ta 242,228,24832
s_waitcnt vmcnt(23)
s_mov_b32 m0, 98304
s_add_u32 s36, s32, 507904
DN 72,12,36,0
WL 6
Mvav 16,252,208
Ta 244,229,16640
Ta 246,229,24832
DN 73,12,36,1024
v_fma_f32 v194, v194, s37, -v245
v_fma_f32 v195, v195, s37, -v245
Mvvv 20,96,208
Ta 248,230,16640
Ta 250,230,24832
DN 74,12,36,2048
v_fma_f32 v196, v196, s37, -v245
WL 6
Mvvv 24,100,208
Ta 252,231,16640
Ta 254,231,24832
DN 75,12,36,3072
v_fma_f32 v197, v197, s37, -v245
Mvvv 28,104,208
Tv 96,232,16640
Tv 98,232,24832
s_waitcnt vmcnt(23)
s_mov_b32 m0, 122880
s_add_u32 s36, s48, 401408
DD 76,20,36,0
WL 6
Mvav 32,240,208
Tv 100,233,16640
Tv 102,233,24832
DD 77,20,36,1024
v_fma_f32 v198, v198, s37, -v245
Mvav 36,244,208
Tv 104,234,16640
Tv 106,234,24832
DD 78,20,36,2048
v_fma_f32 v199, v199, s37, -v245
WL 6
Mvav 40,248,208
Ta 240,235,16640
Ta 242,235,24832
DD 79,20,36,3072
v_max3_f32 v251, v192, v193, v194
Mvav 44,252,208
Ta 244,236,32768
Ta 246,236,34816
s_waitcnt vmcnt(23)
s_mov_b32 m0, 102400
s_add_u32 s36, s32, 512000
DN 72,12,36,0
WL 6
Mvvv 48,96,208
Ta 248,237,32768
Ta 250,237,34816
DN 73,12,36,1024
v_max3_f32 v252, v195, v196, v197
v_max3_f32 v251, v251, v198, v199
Mvvv 52,100,208
Ta 252,238,32768
Ta 254,238,34816
v_max_f32 v251, v251, v252
v_cmp_lt_f32 vcc, s38, v251
WL 6
Mvvv 56,104,208
Tv 96,239,32768
Tv 98,239,34816
DN 74,12,36,2048
s_cbranch_vccnz LB_ra57
LB_rb57:
Mvav 60,240,208
Tv 100,236,36864
Tv 102,236,38912
DN 75,12,36,3072
s_cmp_lg_u32 s49, 0
s_cbranch_scc1 LB_ra58
LB_rb58:
WL 6
Maaa 32,244,144
Tv 104,237,36864
Tv 106,237,38912
s_waitcnt vmcnt(23)
s_mov_b32 m0, 106496
s_add_u32 s36, s32, 516096
DN 72,12,36,0
Maaa 36,248,144
Ta 240,238,36864
Ta 242,238,38912
DN 73,12,36,1024
WL 6
Maaa 40,252,144
Ta 244,239,36864
Ta 246,239,38912
DN 74,12,36,2048
v_exp_f32 v192, v192
Mava 44,96,144
Ta 248,236,40960
Ta 250,236,43008
DN 75,12,36,3072
WL 6
Mava 32,100,148
Ta 252,237,40960
Ta 254,237,43008
s_waitcnt vmcnt(23)
s_mov_b32 m0, 126976
s_add_u32 s36, s48, 430080
DD 76,20,36,0
Mava 36,104,148
Tv 96,238,40960
Tv 98,238,43008
DD 77,20,36,1024
WL 6
Maaa 40,240,148
Tv 100,239,40960
Tv 102,239,43008
DD 78,20,36,2048
v_exp_f32 v193, v193
Maaa 44,244,148
Tv 104,236,45056
Tv 106,236,47104
DD 79,20,36,3072
WL 6
Maaa 32,248,152
Ta 240,237,45056
Ta 242,237,47104
s_waitcnt vmcnt(23)
s_mov_b32 m0, 110592
s_add_u32 s36, s32, 520192
DN 72,12,36,0
Maaa 36,252,152
Ta 244,238,45056
Ta 246,238,47104
DN 73,12,36,1024
WL 6
Mava 40,96,152
Ta 248,239,45056
Ta 250,239,47104
DN 74,12,36,2048
v_add_f32 v247, v247, v192
Mava 44,100,152
DN 75,12,36,3072
v_exp_f32 v194, v194
v_add_f32 v247, v247, v193
WL 4
Mava 32,104,156
CV 192,192,193
v_exp_f32 v195, v195
Maaa 36,240,156
s_waitcnt vmcnt(24) lgkmcnt(0)
s_barrier
Ba 252,224,0
Bv 96,224,8192
Bv 100,225,0
Maaa 40,244,156
Bv 104,225,8192
s_waitcnt vmcnt(23)
s_mov_b32 m0, 131072
s_add_u32 s48, s35, s45
s_add_u32 s36, s48, 229376
DD 76,20,36,0
Maaa 44,248,156
Ba 240,226,0
DD 77,20,36,1024
v_add_f32 v247, v247, v194
v_exp_f32 v196, v196
WL 3
v_mfma_f32_16x16x32_bf16 v[208:211], a[252:255], v[128:131], 0
Ba 244,226,8192
DD 78,20,36,2048
v_add_f32 v247, v247, v195
v_mfma_f32_16x16x32_bf16 v[212:215], v[96:99], v[128:131], 0
Ba 248,227,0
DD 79,20,36,3072
CV 193,194,195
WL 3
Mvvv 208,100,132
Ba 252,227,8192
s_waitcnt vmcnt(23)
s_mov_b32 m0, 135168
s_add_u32 s36, s48, 258048
DD 76,20,36,0
Mvvv 212,104,132
Bv 96,224,256
DD 77,20,36,1024
v_exp_f32 v197, v197
WL 3
Mvav 208,240,136
Bv 100,224,8448
DD 78,20,36,2048
v_add_f32 v247, v247, v196
Mvav 212,244,136
Bv 104,225,256
DD 79,20,36,3072
v_exp_f32 v198, v198
WL 3
Mvav 208,248,140
Ba 240,225,8448
s_waitcnt vmcnt(23)
s_mov_b32 m0, 139264
s_add_u32 s36, s48, 286720
DD 76,20,36,0
Mvav 212,252,140
Ba 244,226,256
DD 77,20,36,1024
v_add_f32 v247, v247, v197
CV 194,196,197
WL 3
Mvvv 208,96,144
Ba 248,226,8448
DD 78,20,36,2048
v_exp_f32 v199, v199
Mvvv 212,100,144
Ba 252,227,256
DD 79,20,36,3072
v_add_f32 v247, v247, v198
WL 3
Mvvv 208,104,148
Bv 96,227,8448
s_waitcnt vmcnt(23)
s_mov_b32 m0, 143360
s_add_u32 s36, s48, 315392
DD 76,20,36,0
Mvav 212,240,148
Tv 100,228,0
Tv 102,228,8192
DD 77,20,36,1024
v_add_f32 v247, v247, v199
WL 4
Mvav 208,244,152
Tv 104,229,0
Tv 106,229,8192
DD 78,20,36,2048
Mvav 212,248,152
Ta 240,230,0
Ta 242,230,8192
DD 79,20,36,3072
CV 195,198,199
WL 6
Mvav 208,252,156
Ta 244,231,0
Ta 246,231,8192
s_waitcnt vmcnt(23)
s_mov_b32 m0, 81920
s_add_u32 s48, s35, s45
s_add_u32 s36, s48, 344064
DD 76,20,36,0
Mvvv 212,96,156
Ta 248,232,0
Ta 250,232,8192
DD 77,20,36,1024
WL 6
Mvvv 0,100,192
Ta 252,233,0
Ta 254,233,8192
DD 78,20,36,2048
Mvvv 4,104,192
Tv 96,234,0
Tv 98,234,8192
DD 79,20,36,3072
v_fma_f32 v208, v208, s37, -v245
v_fma_f32 v209, v209, s37, -v245
v_fma_f32 v210, v210, s37, -v245
WL 6
Mvav 8,240,192
Tv 100,235,0
Tv 102,235,8192
s_waitcnt vmcnt(23)
s_mov_b32 m0, 86016
s_add_u32 s36, s48, 372736
DD 76,20,36,0
v_fma_f32 v211, v211, s37, -v245
Mvav 12,244,192
Tv 104,228,256
Tv 106,228,8448
DD 77,20,36,1024
v_fma_f32 v212, v212, s37, -v245
v_fma_f32 v213, v213, s37, -v245
v_fma_f32 v214, v214, s37, -v245
WL 6
Mvav 16,248,192
Ta 240,229,256
Ta 242,229,8448
DD 78,20,36,2048
v_fma_f32 v215, v215, s37, -v245
v_max3_f32 v251, v208, v209, v210
v_max3_f32 v252, v211, v212, v213
Mvav 20,252,192
Ta 244,230,256
Ta 246,230,8448
DD 79,20,36,3072
v_max3_f32 v251, v251, v214, v215
v_max_f32 v251, v251, v252
v_cmp_lt_f32 vcc, s38, v251
WL 6
Mvvv 24,96,192
Ta 248,231,256
Ta 250,231,8448
s_waitcnt vmcnt(23)
s_mov_b32 m0, 90112
s_add_u32 s36, s48, 401408
DD 76,20,36,0
s_cbranch_vccnz LB_ra59
LB_rb59:
Mvvv 28,100,192
Ta 252,232,256
Ta 254,232,8448
DD 77,20,36,1024
v_exp_f32 v208, v208
WL 6
Mvvv 32,104,192
Tv 96,233,256
Tv 98,233,8448
DD 78,20,36,2048
v_exp_f32 v209, v209
Mvav 36,240,192
Tv 100,234,256
Tv 102,234,8448
DD 79,20,36,3072
v_add_f32 v247, v247, v208
v_exp_f32 v210, v210
WL 6
Mvav 40,244,192
Tv 104,235,256
Tv 106,235,8448
s_waitcnt vmcnt(23)
s_mov_b32 m0, 94208
s_add_u32 s36, s48, 430080
DD 76,20,36,0
Mvav 44,248,192
DD 77,20,36,1024
v_add_f32 v247, v247, v209
v_exp_f32 v211, v211
v_add_f32 v247, v247, v210
WL 4
Mvav 48,252,192
DD 78,20,36,2048
v_exp_f32 v212, v212
v_add_f32 v247, v247, v211
Mvvv 52,96,192
DD 79,20,36,3072
v_exp_f32 v213, v213
v_add_f32 v247, v247, v212
v_exp_f32 v214, v214
WL 2
Mvvv 56,100,192
v_add_f32 v247, v247, v213
v_exp_f32 v215, v215
v_add_f32 v247, v247, v214
v_add_f32 v247, v247, v215
WL 0
Mvvv 60,104,192
s_cmp_lg_u32 s49, 0
s_cbranch_scc1 LB_ra60
LB_rb60:
v_mov_b32 v251, v247
s_nop 1
v_permlane32_swap_b32 v247, v251
v_add_f32 v247, v247, v251
v_mov_b32 v251, v247
s_nop 1
v_permlane16_swap_b32 v247, v251
v_add_f32 v247, v247, v251
v_rcp_f32 v249, v247
s_nop 0
v_mul_f32 v208, v208, v249
v_mul_f32 v209, v209, v249
v_mul_f32 v210, v210, v249
v_mul_f32 v211, v211, v249
v_mul_f32 v212, v212, v249
v_mul_f32 v213, v213, v249
v_mul_f32 v214, v214, v249
v_mul_f32 v215, v215, v249
CV 208,208,209
CV 209,210,211
CV 210,212,213
CV 211,214,215
v_pk_mul_f32 v[0:1], v[0:1], v[248:249] op_sel:[0,1] op_sel_hi:[1,1]
v_pk_mul_f32 v[2:3], v[2:3], v[248:249] op_sel:[0,1] op_sel_hi:[1,1]
v_pk_mul_f32 v[4:5], v[4:5], v[248:249] op_sel:[0,1] op_sel_hi:[1,1]
v_pk_mul_f32 v[6:7], v[6:7], v[248:249] op_sel:[0,1] op_sel_hi:[1,1]
v_pk_mul_f32 v[8:9], v[8:9], v[248:249] op_sel:[0,1] op_sel_hi:[1,1]
v_pk_mul_f32 v[10:11], v[10:11], v[248:249] op_sel:[0,1] op_sel_hi:[1,1]
v_pk_mul_f32 v[12:13], v[12:13], v[248:249] op_sel:[0,1] op_sel_hi:[1,1]
v_pk_mul_f32 v[14:15], v[14:15], v[248:249] op_sel:[0,1] op_sel_hi:[1,1]
v_pk_mul_f32 v[16:17], v[16:17], v[248:249] op_sel:[0,1] op_sel_hi:[1,1]
v_pk_mul_f32 v[18:19], v[18:19], v[248:249] op_sel:[0,1] op_sel_hi:[1,1]
v_pk_mul_f32 v[20:21], v[20:21], v[248:249] op_sel:[0,1] op_sel_hi:[1,1]
v_pk_mul_f32 v[22:23], v[22:23], v[248:249] op_sel:[0,1] op_sel_hi:[1,1]
v_pk_mul_f32 v[24:25], v[24:25], v[248:249] op_sel:[0,1] op_sel_hi:[1,1]
v_pk_mul_f32 v[26:27], v[26:27], v[248:249] op_sel:[0,1] op_sel_hi:[1,1]
v_pk_mul_f32 v[28:29], v[28:29], v[248:249] op_sel:[0,1] op_sel_hi:[1,1]
v_pk_mul_f32 v[30:31], v[30:31], v[248:249] op_sel:[0,1] op_sel_hi:[1,1]
v_pk_mul_f32 v[32:33], v[32:33], v[248:249] op_sel:[0,1] op_sel_hi:[1,1]
v_pk_mul_f32 v[34:35], v[34:35], v[248:249] op_sel:[0,1] op_sel_hi:[1,1]
v_pk_mul_f32 v[36:37], v[36:37], v[248:249] op_sel:[0,1] op_sel_hi:[1,1]
v_pk_mul_f32 v[38:39], v[38:39], v[248:249] op_sel:[0,1] op_sel_hi:[1,1]
v_pk_mul_f32 v[40:41], v[40:41], v[248:249] op_sel:[0,1] op_sel_hi:[1,1]
v_pk_mul_f32 v[42:43], v[42:43], v[248:249] op_sel:[0,1] op_sel_hi:[1,1]
v_pk_mul_f32 v[44:45], v[44:45], v[248:249] op_sel:[0,1] op_sel_hi:[1,1]
v_pk_mul_f32 v[46:47], v[46:47], v[248:249] op_sel:[0,1] op_sel_hi:[1,1]
v_pk_mul_f32 v[48:49], v[48:49], v[248:249] op_sel:[0,1] op_sel_hi:[1,1]
v_pk_mul_f32 v[50:51], v[50:51], v[248:249] op_sel:[0,1] op_sel_hi:[1,1]
v_pk_mul_f32 v[52:53], v[52:53], v[248:249] op_sel:[0,1] op_sel_hi:[1,1]
v_pk_mul_f32 v[54:55], v[54:55], v[248:249] op_sel:[0,1] op_sel_hi:[1,1]
v_pk_mul_f32 v[56:57], v[56:57], v[248:249] op_sel:[0,1] op_sel_hi:[1,1]
v_pk_mul_f32 v[58:59], v[58:59], v[248:249] op_sel:[0,1] op_sel_hi:[1,1]
v_pk_mul_f32 v[60:61], v[60:61], v[248:249] op_sel:[0,1] op_sel_hi:[1,1]
v_pk_mul_f32 v[62:63], v[62:63], v[248:249] op_sel:[0,1] op_sel_hi:[1,1]
s_waitcnt vmcnt(32) lgkmcnt(0)
s_barrier
Ta 240,228,32768
Ta 242,228,40960
Ta 244,229,32768
Ta 246,229,40960
Ta 248,230,32768
Ta 250,230,40960
Ta 252,231,32768
Ta 254,231,40960
Tv 96,232,32768
Tv 98,232,40960
WL 6
Mvav 0,240,208
Tv 100,233,32768
Tv 102,233,40960
s_waitcnt vmcnt(23)
s_mov_b32 m0, 65536
s_add_u32 s48, s35, s40
s_add_u32 s36, s48, 229376
DD 76,20,36,0
DD 77,20,36,1024
DD 78,20,36,2048
Mvav 4,244,208
Tv 104,234,32768
Tv 106,234,40960
DD 79,20,36,3072
s_waitcnt vmcnt(23)
s_mov_b32 m0, 69632
s_add_u32 s36, s48, 258048
DD 76,20,36,0
WL 6
Mvav 8,248,208
Ta 240,235,32768
Ta 242,235,40960
DD 77,20,36,1024
DD 78,20,36,2048
DD 79,20,36,3072
Mvav 12,252,208
Ta 244,228,33024
Ta 246,228,41216
s_waitcnt vmcnt(23)
s_mov_b32 m0, 73728
s_add_u32 s36, s48, 286720
DD 76,20,36,0
DD 77,20,36,1024
WL 6
Mvvv 16,96,208
Ta 248,229,33024
Ta 250,229,41216
DD 78,20,36,2048
DD 79,20,36,3072
s_waitcnt vmcnt(23)
s_mov_b32 m0, 77824
s_add_u32 s36, s48, 315392
DD 76,20,36,0
CV 128,0,1
Mvvv 20,100,208
Ta 252,230,33024
Ta 254,230,41216
DD 77,20,36,1024
DD 78,20,36,2048
CV 129,2,3
CV 130,4,5
CV 131,6,7
WL 6
Mvvv 24,104,208
Tv 96,231,33024
Tv 98,231,41216
DD 79,20,36,3072
s_waitcnt vmcnt(23)
s_mov_b32 m0, 49152
s_add_u32 s48, s35, s40
s_add_u32 s36, s48, 344064
DD 76,20,36,0
DD 77,20,36,1024
Mvav 28,240,208
Tv 100,232,33024
Tv 102,232,41216
DD 78,20,36,2048
DD 79,20,36,3072
CV 132,8,9
CV 133,10,11
CV 134,12,13
WL 6
Mvav 32,244,208
Tv 104,233,33024
Tv 106,233,41216
s_waitcnt vmcnt(23)
s_mov_b32 m0, 53248
s_add_u32 s36, s48, 372736
DD 76,20,36,0
DD 77,20,36,1024
DD 78,20,36,2048
Mvav 36,248,208
Ta 240,234,33024
Ta 242,234,41216
DD 79,20,36,3072
s_waitcnt vmcnt(23)
s_mov_b32 m0, 57344
s_add_u32 s36, s48, 401408
DD 76,20,36,0
CV 135,14,15
WL 6
Mvav 40,252,208
Ta 244,235,33024
Ta 246,235,41216
DD 77,20,36,1024
DD 78,20,36,2048
DD 79,20,36,3072
Mvvv 44,96,208
s_waitcnt vmcnt(23)
s_mov_b32 m0, 61440
s_add_u32 s36, s48, 430080
DD 76,20,36,0
DD 77,20,36,1024
CV 136,16,17
WL 4
Mvvv 48,100,208
DD 78,20,36,2048
DD 79,20,36,3072
CV 137,18,19
CV 138,20,21
CV 139,22,23
Mvvv 52,104,208
s_waitcnt vmcnt(63) lgkmcnt(0)
s_barrier
Ta 248,236,49152
Ta 250,236,51200
Ta 252,237,49152
Ta 254,237,51200
Tv 96,238,49152
Tv 98,238,51200
Mvav 56,240,208
Tv 100,239,49152
Tv 102,239,51200
s_waitcnt vmcnt(23)
s_mov_b32 m0, 98304
s_add_u32 s48, s35, s44
s_add_u32 s36, s48, 229376
DD 76,20,36,0
DD 77,20,36,1024
CV 140,24,25
Mvav 60,244,208
Tv 104,236,53248
Tv 106,236,55296
DD 78,20,36,2048
DD 79,20,36,3072
CV 141,26,27
CV 142,28,29
CV 143,30,31
WL 6
Maav 32,248,128
Ta 240,237,53248
Ta 242,237,55296
s_mov_b32 m0, 102400
s_add_u32 s36, s48, 258048
DD 76,20,36,0
Maav 36,252,128
Ta 244,238,53248
Ta 246,238,55296
DD 77,20,36,1024
DD 78,20,36,2048
CV 144,32,33
CV 145,34,35
WL 6
Mavv 40,96,128
Ta 248,239,53248
Ta 250,239,55296
DD 79,20,36,3072
CV 146,36,37
CV 147,38,39
Mavv 44,100,128
Ta 252,236,57344
Ta 254,236,59392
s_mov_b32 m0, 106496
s_add_u32 s36, s48, 286720
DD 76,20,36,0
DD 77,20,36,1024
WL 6
Mavv 32,104,132
Tv 96,237,57344
Tv 98,237,59392
DD 78,20,36,2048
CV 148,40,41
CV 149,42,43
CV 150,44,45
CV 151,46,47
Maav 36,240,132
Tv 100,238,57344
Tv 102,238,59392
DD 79,20,36,3072
s_mov_b32 m0, 110592
s_add_u32 s36, s48, 315392
DD 76,20,36,0
WL 6
Maav 40,244,132
Tv 104,239,57344
Tv 106,239,59392
DD 77,20,36,1024
CV 152,48,49
CV 153,50,51
CV 154,52,53
Maav 44,248,132
Ta 240,236,61440
Ta 242,236,63488
DD 78,20,36,2048
DD 79,20,36,3072
CV 155,54,55
WL 6
Maav 32,252,136
Ta 244,237,61440
Ta 246,237,63488
s_mov_b32 m0, 32768
s_add_u32 s48, s35, s44
s_add_u32 s36, s48, 344064
DD 76,20,36,0
DD 77,20,36,1024
Mavv 36,96,136
Ta 248,238,61440
Ta 250,238,63488
DD 78,20,36,2048
CV 156,56,57
CV 157,58,59
WL 6
Mavv 40,100,136
Ta 252,239,61440
Ta 254,239,63488
DD 79,20,36,3072
s_mov_b32 m0, 36864
s_add_u32 s36, s48, 372736
DD 76,20,36,0
Mavv 44,104,136
Tv 96,236,16384
Tv 98,236,18432
DD 77,20,36,1024
CV 158,60,61
CV 159,62,63
WL 6
Maav 32,240,140
Tv 100,237,16384
Tv 102,237,18432
DD 78,20,36,2048
DD 79,20,36,3072
v_mbcnt_lo_u32_b32 v253, -1, 0
v_mbcnt_hi_u32_b32 v253, -1, v253
v_lshrrev_b32 v254, 3, v253
Maav 36,244,140
Tv 104,238,16384
Tv 106,238,18432
s_mov_b32 m0, 40960
s_add_u32 s36, s48, 401408
DD 76,20,36,0
v_min_u32 v254, 1, v254
v_lshlrev_b32 v254, 31, v254
WL 6
Maav 40,248,140
Ta 240,239,16384
Ta 242,239,18432
DD 77,20,36,1024
DD 78,20,36,2048
v_lshl_add_u32 v224, v253, 2, v254
v_and_b32 v254, 15, v253
s_lshl_b32 s4, s58, 5
Maav 44,252,140
Ta 244,236,20480
Ta 246,236,22528
DD 79,20,36,3072
v_add_u32 v254, s4, v254
v_mul_u32_u24 v254, 1792, v254
v_and_b32 v226, 48, v253
v_add_u32 v226, v226, v254
WL 6
Mavv 32,96,144
Ta 248,237,20480
Ta 250,237,22528
s_mov_b32 m0, 45056
s_add_u32 s36, s48, 430080
DD 76,20,36,0
DD 77,20,36,1024
v_and_b32 v254, 1, v253
Mavv 36,100,144
Ta 252,238,20480
Ta 254,238,22528
DD 78,20,36,2048
v_lshlrev_b32 v254, 4, v254
v_mov_b32 v228, 0x3f80
v_lshlrev_b32 v228, v254, v228
v_lshrrev_b32 v254, 3, v253
WL 6
Mavv 40,104,144
Tv 96,239,20480
Tv 98,239,22528
DD 79,20,36,3072
s_mov_b32 m0, 16384
s_add_u32 s48, s35, s41
s_add_u32 s36, s48, 229376
DD 76,20,36,0
Maav 44,240,144
Tv 100,236,24576
Tv 102,236,26624
DD 77,20,36,1024
DD 78,20,36,2048
v_and_b32 v254, 6, v254
v_bfe_u32 v253, v253, 1, 3
WL 6
Maav 32,244,148
Tv 104,237,24576
Tv 106,237,26624
DD 79,20,36,3072
v_cmp_eq_u32 vcc, v253, v254
v_or_b32 v254, 1, v254
v_mov_b32 v229, 0
v_cndmask_b32 v230, 0, v228, vcc
Maav 36,248,148
Ta 240,238,24576
Ta 242,238,26624
s_mov_b32 m0, 20480
s_add_u32 s36, s48, 258048
DD 76,20,36,0
DD 77,20,36,1024
v_cmp_eq_u32 vcc, v253, v254
v_mov_b32 v232, 0
v_mov_b32 v233, 0
v_cndmask_b32 v231, 0, v228, vcc
WL 6
Maav 40,252,148
Ta 244,239,24576
Ta 246,239,26624
DD 78,20,36,2048
v_mov_b32 v228, 0
s_lshl_b32 s16, s50, 7
s_add_u32 s16, s16, s62
Mavv 44,96,148
Ta 248,236,28672
Ta 250,236,30720
DD 79,20,36,3072
s_mov_b32 m0, 24576
s_add_u32 s36, s48, 286720
DD 76,20,36,0
s_mov_b32 s8, s80
WL 6
Mavv 32,100,152
Ta 252,237,28672
Ta 254,237,30720
DD 77,20,36,1024
s_mov_b32 s9, s81
s_mov_b32 s10, 3211264
s_mov_b32 s11, 0x20000
s_bfe_u32 s6, s2, 0x40003
Mavv 36,104,152
Tv 96,238,28672
Tv 98,238,30720
DD 78,20,36,2048
DD 79,20,36,3072
s_mul_i32 s12, s6, 200704
s_lshr_b32 s4, s2, 7
s_mul_i32 s4, s4, 896
WL 6
Maav 40,240,152
Tv 100,239,28672
Tv 102,239,30720
s_mov_b32 m0, 28672
s_add_u32 s36, s48, 315392
DD 76,20,36,0
s_add_u32 s12, s12, s4
s_lshl_b32 s4, s50, 7
Maav 44,244,152
DD 77,20,36,1024
DD 78,20,36,2048
s_add_u32 s12, s12, s4
s_add_u32 s13, s12, 28672
s_and_b32 s19, s2, 0xf8
s_mul_i32 s19, s19, 100352
s_mul_i32 s4, s50, 14336
WL 4
Maav 32,248,156
DD 79,20,36,3072
s_add_u32 s19, s19, s4
s_mov_b32 s14, 0x40000
s_and_b32 s17, s2, 7
s_cmp_eq_u32 s17, 7
s_cselect_b32 s15, -1, 0
s_cselect_b32 s19, 0x7f000000, s19
Maav 36,252,156
s_waitcnt vmcnt(63) lgkmcnt(0)
s_barrier
Tv 104,236,32768
Tv 106,236,34816
Ta 240,237,32768
Ta 242,237,34816
Ta 244,238,32768
Ta 246,238,34816
Mavv 40,96,156
Ta 248,239,32768
Ta 250,239,34816
s_mov_b32 m0, 114688
s_add_u32 s48, s35, s41
s_add_u32 s36, s48, 344064
DD 76,20,36,0
DD 77,20,36,1024
Mavv 44,100,156
Ta 252,236,36864
Ta 254,236,38912
DD 78,20,36,2048
DD 79,20,36,3072
AR 1,192
v_lshlrev_b32 v0, 16, v1
WL 6
Mavv 16,104,128
Tv 96,237,36864
Tv 98,237,38912
s_mov_b32 m0, 118784
s_add_u32 s36, s48, 372736
DD 76,20,36,0
Maav 20,240,128
Tv 100,238,36864
Tv 102,238,38912
DD 77,20,36,1024
DD 78,20,36,2048
AR 48,32
v_and_b32 v1, 0xffff0000, v1
WL 6
Maav 24,244,128
Tv 104,239,36864
Tv 106,239,38912
DD 79,20,36,3072
AR 49,33
CV 48,48,49
AR 3,193
Maav 28,248,128
Ta 240,236,40960
Ta 242,236,43008
s_mov_b32 m0, 122880
s_add_u32 s36, s48, 401408
DD 76,20,36,0
DD 77,20,36,1024
WL 6
Maav 16,252,132
Ta 244,237,40960
Ta 246,237,43008
DD 78,20,36,2048
AR 50,34
AR 51,35
CV 49,50,51
Mavv 20,96,132
Ta 248,238,40960
Ta 250,238,43008
DD 79,20,36,3072
s_mov_b32 m0, 126976
s_add_u32 s36, s48, 430080
DD 76,20,36,0
WL 6
Mavv 24,100,132
Ta 252,239,40960
Ta 254,239,43008
DD 77,20,36,1024
AR 52,36
AR 53,37
v_lshlrev_b32 v2, 16, v3
Mavv 28,104,132
Tv 96,236,45056
Tv 98,236,47104
DD 78,20,36,2048
DD 79,20,36,3072
CV 50,52,53
WL 6
Maav 16,240,136
Tv 100,237,45056
Tv 102,237,47104
s_mov_b32 m0, 147456
s_add_u32 s48, s35, s43
s_add_u32 s36, s48, 229376
DD 76,20,36,0
DD 77,20,36,1024
Maav 20,244,136
Tv 104,238,45056
Tv 106,238,47104
DD 78,20,36,2048
AR 54,38
AR 55,39
v_and_b32 v3, 0xffff0000, v3
WL 6
Maav 24,248,136
Ta 240,239,45056
Ta 242,239,47104
DD 79,20,36,3072
s_mov_b32 m0, 151552
s_add_u32 s36, s48, 258048
DD 76,20,36,0
Maav 28,252,136
v_add_u32 v236, 0xffff8000, v236
v_add_u32 v237, 0xffff8000, v237
v_add_u32 v238, 0xffff8000, v238
v_add_u32 v239, 0xffff8000, v239
Ta 244,236,16384
Ta 246,236,18432
DD 77,20,36,1024
CV 51,54,55
AR 5,194
v_lshlrev_b32 v4, 16, v5
WL 6
Mavv 16,96,140
Ta 248,237,16384
Ta 250,237,18432
DD 78,20,36,2048
DD 79,20,36,3072
s_mul_i32 s61, s46, 112
s_add_u32 s61, s61, s39
buffer_store_dwordx4 v[48:51], v244, s[28:31], s61 offen offset:0 sc1
Mavv 20,100,140
Ta 252,238,16384
Ta 254,238,18432
s_mov_b32 m0, 155648
s_add_u32 s36, s48, 286720
DD 76,20,36,0
v_and_b32 v5, 0xffff0000, v5
WL 6
Mavv 24,104,140
Tv 96,239,16384
Tv 98,239,18432
DD 77,20,36,1024
DD 78,20,36,2048
AR 56,40
Maav 28,240,140
Tv 100,236,20480
Tv 102,236,22528
DD 79,20,36,3072
AR 57,41
CV 56,56,57
AR 7,195
WL 6
Maav 16,244,144
Tv 104,237,20480
Tv 106,237,22528
s_mov_b32 m0, 159744
s_add_u32 s36, s48, 315392
DD 76,20,36,0
DD 77,20,36,1024
Maav 20,248,144
Ta 240,238,20480
Ta 242,238,22528
DD 78,20,36,2048
AR 58,42
AR 59,43
v_lshlrev_b32 v6, 16, v7
WL 6
Maav 24,252,144
Ta 244,239,20480
Ta 246,239,22528
DD 79,20,36,3072
s_mov_b32 m0, 0
s_add_u32 s48, s35, s43
s_add_u32 s36, s48, 344064
DD 76,20,36,0
Mavv 28,96,144
Ta 248,236,24576
Ta 250,236,26624
DD 77,20,36,1024
DD 78,20,36,2048
CV 57,58,59
v_and_b32 v7, 0xffff0000, v7
WL 6
Mavv 16,100,148
Ta 252,237,24576
Ta 254,237,26624
DD 79,20,36,3072
AR 60,44
AR 61,45
CV 58,60,61
Mavv 20,104,148
Tv 96,238,24576
Tv 98,238,26624
s_mov_b32 m0, 4096
s_add_u32 s36, s48, 372736
DD 76,20,36,0
DD 77,20,36,1024
WL 6
Maav 24,240,148
Tv 100,239,24576
Tv 102,239,26624
DD 78,20,36,2048
AR 62,46
AR 63,47
Maav 28,244,148
Tv 104,236,28672
Tv 106,236,30720
DD 79,20,36,3072
s_mov_b32 m0, 8192
s_add_u32 s36, s48, 401408
DD 76,20,36,0
WL 6
Maav 16,248,152
Ta 240,237,28672
Ta 242,237,30720
DD 77,20,36,1024
CV 59,62,63
buffer_store_dwordx4 v[56:59], v244, s[28:31], s61 offen offset:1024 sc1
AR 9,196
Maav 20,252,152
Ta 244,238,28672
Ta 246,238,30720
DD 78,20,36,2048
DD 79,20,36,3072
v_lshlrev_b32 v8, 16, v9
v_and_b32 v9, 0xffff0000, v9
WL 6
Mavv 24,96,152
Ta 248,239,28672
Ta 250,239,30720
s_mov_b32 m0, 12288
s_add_u32 s36, s48, 430080
DD 76,20,36,0
AR 11,197
Mavv 28,100,152
DD 77,20,36,1024
DD 78,20,36,2048
v_lshlrev_b32 v10, 16, v11
v_and_b32 v11, 0xffff0000, v11
AR 13,198
WL 4
Mavv 16,104,156
DD 79,20,36,3072
v_lshlrev_b32 v12, 16, v13
v_and_b32 v13, 0xffff0000, v13
AR 15,199
v_lshlrev_b32 v14, 16, v15
v_and_b32 v15, 0xffff0000, v15
Maav 20,240,156
s_waitcnt vmcnt(63) lgkmcnt(0)
s_barrier
Ta 252,236,0
Ta 254,236,2048
Tv 96,237,0
Tv 98,237,2048
Tv 100,238,0
Tv 102,238,2048
Maav 24,244,156
Tv 104,239,0
Tv 106,239,2048
s_mov_b32 m0, 131072
s_add_u32 s48, s35, s42
s_add_u32 s36, s48, 229376
DD 76,20,36,0
DD 77,20,36,1024
Maav 28,248,156
Ta 240,236,4096
Ta 242,236,6144
DD 78,20,36,2048
WL 6
Mvav 0,252,128
Ta 244,237,4096
Ta 246,237,6144
DD 79,20,36,3072
Mvvv 4,96,128
Ta 248,238,4096
Ta 250,238,6144
s_mov_b32 m0, 135168
s_add_u32 s36, s48, 258048
DD 76,20,36,0
WL 6
Mvvv 8,100,128
Ta 252,239,4096
Ta 254,239,6144
DD 77,20,36,1024
AR 32,16
AR 33,17
Mvvv 12,104,128
Tv 96,236,8192
Tv 98,236,10240
DD 78,20,36,2048
CV 32,32,33
WL 6
Mvav 0,240,132
Tv 100,237,8192
Tv 102,237,10240
DD 79,20,36,3072
AR 34,18
AR 35,19
Mvav 4,244,132
Tv 104,238,8192
Tv 106,238,10240
s_mov_b32 m0, 139264
s_add_u32 s36, s48, 286720
DD 76,20,36,0
WL 6
Mvav 8,248,132
Ta 240,239,8192
Ta 242,239,10240
DD 77,20,36,1024
CV 33,34,35
Mvav 12,252,132
Ta 244,236,12288
Ta 246,236,14336
DD 78,20,36,2048
AR 36,20
AR 37,21
WL 6
Mvvv 0,96,136
Ta 248,237,12288
Ta 250,237,14336
DD 79,20,36,3072
CV 34,36,37
Mvvv 4,100,136
Ta 252,238,12288
Ta 254,238,14336
s_mov_b32 m0, 143360
s_add_u32 s36, s48, 315392
DD 76,20,36,0
WL 6
Mvvv 8,104,136
Tv 96,239,12288
Tv 98,239,14336
DD 77,20,36,1024
AR 38,22
AR 39,23
Mvav 12,240,136
v_add_u32 v236, 0xffff0000, v236
v_add_u32 v237, 0xffff0000, v237
v_add_u32 v238, 0xffff0000, v238
v_add_u32 v239, 0xffff0000, v239
Tv 100,236,49152
Tv 102,236,51200
DD 78,20,36,2048
CV 35,38,39
WL 6
Mvav 0,244,140
Tv 104,237,49152
Tv 106,237,51200
DD 79,20,36,3072
s_mul_i32 s61, s45, 112
s_add_u32 s61, s61, s39
buffer_store_dwordx4 v[32:35], v244, s[28:31], s61 offen offset:0 sc1
Mvav 4,248,140
Ta 240,238,49152
Ta 242,238,51200
s_mov_b32 m0, 81920
s_add_u32 s48, s35, s42
s_add_u32 s36, s48, 344064
DD 76,20,36,0
WL 6
Mvav 8,252,140
Ta 244,239,49152
Ta 246,239,51200
DD 77,20,36,1024
AR 40,24
Mvvv 12,96,140
Ta 248,236,53248
Ta 250,236,55296
DD 78,20,36,2048
AR 41,25
WL 6
Mvvv 0,100,144
Ta 252,237,53248
Ta 254,237,55296
DD 79,20,36,3072
CV 40,40,41
AR 42,26
Mvvv 4,104,144
Tv 96,238,53248
Tv 98,238,55296
s_mov_b32 m0, 86016
s_add_u32 s36, s48, 372736
DD 76,20,36,0
WL 6
Mvav 8,240,144
Tv 100,239,53248
Tv 102,239,55296
DD 77,20,36,1024
AR 43,27
Mvav 12,244,144
Tv 104,236,57344
Tv 106,236,59392
DD 78,20,36,2048
CV 41,42,43
AR 44,28
WL 6
Mvav 0,248,148
Ta 240,237,57344
Ta 242,237,59392
DD 79,20,36,3072
AR 45,29
Mvav 4,252,148
Ta 244,238,57344
Ta 246,238,59392
s_mov_b32 m0, 90112
s_add_u32 s36, s48, 401408
DD 76,20,36,0
WL 6
Mvvv 8,96,148
Ta 248,239,57344
Ta 250,239,59392
DD 77,20,36,1024
CV 42,44,45
AR 46,30
Mvvv 12,100,148
Ta 252,236,61440
Ta 254,236,63488
DD 78,20,36,2048
AR 47,31
WL 6
Mvvv 0,104,152
Tv 96,237,61440
Tv 98,237,63488
DD 79,20,36,3072
CV 43,46,47
buffer_store_dwordx4 v[40:43], v244, s[28:31], s61 offen offset:1024 sc1
Mvav 4,240,152
Tv 100,238,61440
Tv 102,238,63488
s_mov_b32 m0, 94208
s_add_u32 s36, s48, 430080
DD 76,20,36,0
WL 6
Mvav 8,244,152
Tv 104,239,61440
Tv 106,239,63488
DD 77,20,36,1024
Mvav 12,248,152
DD 78,20,36,2048
AR 17,200
v_lshlrev_b32 v16, 16, v17
WL 4
Mvav 0,252,156
DD 79,20,36,3072
v_and_b32 v17, 0xffff0000, v17
AR 19,201
Mvvv 4,96,156
s_waitcnt vmcnt(40) lgkmcnt(0)
s_barrier
s_add_u32 s5, s62, s46
buffer_store_dword v85, v84, s[28:31], s5 offen sc1
v_add_u32 v236, 0x18000, v236
v_add_u32 v237, 0x18000, v237
v_add_u32 v238, 0x18000, v238
v_add_u32 v239, 0x18000, v239
Ta 240,236,0
Ta 242,236,2048
Ta 244,237,0
Ta 246,237,2048
Ta 248,238,0
Ta 250,238,2048
Mvvv 8,100,156
Ta 252,239,0
Ta 254,239,2048
v_lshlrev_b32 v18, 16, v19
Mvvv 12,104,156
Tv 96,236,4096
Tv 98,236,6144
WL 6
Maav 0,240,128
Tv 100,237,4096
Tv 102,237,6144
v_and_b32 v19, 0xffff0000, v19
Maav 4,244,128
Tv 104,238,4096
Tv 106,238,6144
CV 0,0,1
WL 6
Maav 8,248,128
Ta 240,239,4096
Ta 242,239,6144
AR 21,202
Maav 12,252,128
Ta 244,236,8192
Ta 246,236,10240
CV 1,2,3
WL 6
Mavv 0,96,132
Ta 248,237,8192
Ta 250,237,10240
v_lshlrev_b32 v20, 16, v21
Mavv 4,100,132
Ta 252,238,8192
Ta 254,238,10240
CV 2,4,5
WL 6
Mavv 8,104,132
Tv 96,239,8192
Tv 98,239,10240
v_and_b32 v21, 0xffff0000, v21
Maav 12,240,132
Tv 100,236,12288
Tv 102,236,14336
CV 3,6,7
WL 6
Maav 0,244,136
Tv 104,237,12288
Tv 106,237,14336
AR 23,203
Maav 4,248,136
Ta 240,238,12288
Ta 242,238,14336
WL 6
Maav 8,252,136
Ta 244,239,12288
Ta 246,239,14336
v_lshlrev_b32 v22, 16, v23
Mavv 12,96,136
v_add_u32 v236, 0xfffe8000, v236
v_add_u32 v237, 0xfffe8000, v237
v_add_u32 v238, 0xfffe8000, v238
v_add_u32 v239, 0xfffe8000, v239
Ta 248,236,32768
Ta 250,236,34816
s_mul_i32 s61, s40, 112
s_add_u32 s61, s61, s39
buffer_store_dwordx4 v[0:3], v244, s[28:31], s61 offen offset:0 sc1
WL 6
Mavv 0,100,140
Ta 252,237,32768
Ta 254,237,34816
v_and_b32 v23, 0xffff0000, v23
Mavv 4,104,140
Tv 96,238,32768
Tv 98,238,34816
AR 25,204
WL 6
Maav 8,240,140
Tv 100,239,32768
Tv 102,239,34816
v_lshlrev_b32 v24, 16, v25
Maav 12,244,140
Tv 104,236,36864
Tv 106,236,38912
CV 8,8,9
WL 6
Maav 0,248,144
Ta 240,237,36864
Ta 242,237,38912
v_and_b32 v25, 0xffff0000, v25
Maav 4,252,144
Ta 244,238,36864
Ta 246,238,38912
CV 9,10,11
WL 6
Mavv 8,96,144
Ta 248,239,36864
Ta 250,239,38912
Mavv 12,100,144
Ta 252,236,40960
Ta 254,236,43008
CV 10,12,13
WL 6
Mavv 0,104,148
Tv 96,237,40960
Tv 98,237,43008
AR 27,205
Maav 4,240,148
Tv 100,238,40960
Tv 102,238,43008
CV 11,14,15
WL 6
Maav 8,244,148
Tv 104,239,40960
Tv 106,239,43008
v_lshlrev_b32 v26, 16, v27
Maav 12,248,148
Ta 240,236,45056
Ta 242,236,47104
buffer_store_dwordx4 v[8:11], v244, s[28:31], s61 offen offset:1024 sc1
WL 6
Maav 0,252,152
Ta 244,237,45056
Ta 246,237,47104
v_and_b32 v27, 0xffff0000, v27
Mavv 4,96,152
Ta 248,238,45056
Ta 250,238,47104
AR 29,206
WL 6
Mavv 8,100,152
Ta 252,239,45056
Ta 254,239,47104
v_lshlrev_b32 v28, 16, v29
Mavv 12,104,152
s_mov_b32 s23, 0
s_and_b32 s22, s2, 7
WL 4
Maav 0,240,156
v_and_b32 v29, 0xffff0000, v29
AR 31,207
v_lshlrev_b32 v30, 16, v31
Maav 4,244,156
s_waitcnt vmcnt(7) lgkmcnt(0)
s_barrier
s_add_u32 s5, s62, s45
buffer_store_dword v85, v84, s[28:31], s5 offen sc1
Tv 96,236,16384
Tv 98,236,18432
Tv 100,237,16384
Tv 102,237,18432
Tv 104,238,16384
Tv 106,238,18432
Maav 8,248,156
Ta 240,239,16384
Ta 242,239,18432
v_and_b32 v31, 0xffff0000, v31
Maav 12,252,156
Ta 244,236,20480
Ta 246,236,22528
WL 6
Mvvv 16,96,128
Ta 248,237,20480
Ta 250,237,22528
buffer_load_dword v225, v224, s[28:31], s16 offen sc1
Mvvv 20,100,128
Ta 252,238,20480
Ta 254,238,22528
AR 48,0
WL 6
Mvvv 24,104,128
Tv 96,239,20480
Tv 98,239,22528
AR 49,1
Mvav 28,240,128
Tv 100,236,24576
Tv 102,236,26624
CV 48,48,49
AR 50,2
WL 6
Mvav 16,244,132
Tv 104,237,24576
Tv 106,237,26624
AR 51,3
Mvav 20,248,132
Ta 240,238,24576
Ta 242,238,26624
CV 49,50,51
WL 6
Mvav 24,252,132
Ta 244,239,24576
Ta 246,239,26624
AR 52,4
Mvvv 28,96,132
Ta 248,236,28672
Ta 250,236,30720
AR 53,5
CV 50,52,53
WL 6
Mvvv 16,100,136
Ta 252,237,28672
Ta 254,237,30720
AR 54,6
Mvvv 20,104,136
Tv 96,238,28672
Tv 98,238,30720
AR 55,7
WL 6
Mvav 24,240,136
Tv 100,239,28672
Tv 102,239,30720
CV 51,54,55
Mvav 28,244,136
v_add_u32 v236, 0x18000, v236
v_add_u32 v237, 0x18000, v237
v_add_u32 v238, 0x18000, v238
v_add_u32 v239, 0x18000, v239
Tv 104,236,16384
Tv 106,236,18432
WL 6
Mvav 16,248,140
Ta 240,237,16384
Ta 242,237,18432
s_mul_i32 s61, s44, 112
s_add_u32 s61, s61, s39
buffer_store_dwordx4 v[48:51], v244, s[28:31], s61 offen offset:0 sc1
Mvav 20,252,140
Ta 244,238,16384
Ta 246,238,18432
AR 56,8
WL 6
Mvvv 24,96,140
Ta 248,239,16384
Ta 250,239,18432
AR 57,9
Mvvv 28,100,140
Ta 252,236,20480
Ta 254,236,22528
CV 56,56,57
WL 6
Mvvv 16,104,144
Tv 96,237,20480
Tv 98,237,22528
AR 58,10
Mvav 20,240,144
Tv 100,238,20480
Tv 102,238,22528
s_waitcnt vmcnt(1)
v_cmp_ne_u32 vcc, 0, v225
s_nop 1
s_andn2_b32 s18, vcc_lo, s15
s_sub_u32 s17, s22, 1
s_cselect_b32 s21, 7, 0
s_add_u32 s17, s17, s21
s_mul_i32 s24, s17, 100352
s_add_u32 s24, s24, s19
s_bitcmp1_b32 s18, s17
s_cselect_b32 s24, s24, 0x7f000000
s_cselect_b32 s17, 1, 0
s_or_b32 s23, s23, s17
WL 6
Mvav 24,244,144
Tv 104,239,20480
Tv 106,239,22528
AR 59,11
CV 57,58,59
Mvav 28,248,144
Ta 240,236,24576
Ta 242,236,26624
AR 60,12
WL 6
Mvav 16,252,148
Ta 244,237,24576
Ta 246,237,26624
AR 61,13
Mvvv 20,96,148
Ta 248,238,24576
Ta 250,238,26624
CV 58,60,61
WL 6
Mvvv 24,100,148
Ta 252,239,24576
Ta 254,239,26624
AR 62,14
AR 63,15
Mvvv 28,104,148
Tv 96,236,28672
Tv 98,236,30720
CV 59,62,63
WL 6
Mvav 16,240,152
Tv 100,237,28672
Tv 102,237,30720
buffer_store_dwordx4 v[56:59], v244, s[28:31], s61 offen offset:1024 sc1
Mvav 20,244,152
Tv 104,238,28672
Tv 106,238,30720
buffer_load_dwordx4 a[128:131], v244, s[28:31], s24 offen offset:0 sc1
WL 6
Mvav 24,248,152
Ta 240,239,28672
Ta 242,239,30720
buffer_load_dwordx4 a[132:135], v244, s[28:31], s24 offen offset:1024 sc1
Mvav 28,252,152
AR 1,208
v_lshlrev_b32 v0, 16, v1
v_and_b32 v1, 0xffff0000, v1
WL 4
Mvvv 16,96,156
AR 3,209
v_lshlrev_b32 v2, 16, v3
v_and_b32 v3, 0xffff0000, v3
Mvvv 20,100,156
s_waitcnt vmcnt(6) lgkmcnt(0)
s_barrier
s_add_u32 s5, s62, s40
buffer_store_dword v85, v84, s[28:31], s5 offen sc1
Ta 244,236,49152
Ta 246,236,51200
Ta 248,237,49152
Ta 250,237,51200
Ta 252,238,49152
Ta 254,238,51200
Mvvv 24,104,156
Tv 96,239,49152
Tv 98,239,51200
Mvav 28,240,156
Tv 100,236,53248
Tv 102,236,55296
AR 5,210
WL 6
Maav 48,244,128
Tv 104,237,53248
Tv 106,237,55296
buffer_load_dword v225, v224, s[28:31], s16 offen sc1
Maav 52,248,128
Ta 240,238,53248
Ta 242,238,55296
CV 16,16,17
WL 6
Maav 56,252,128
Ta 244,239,53248
Ta 246,239,55296
v_lshlrev_b32 v4, 16, v5
Mavv 60,96,128
Ta 248,236,57344
Ta 250,236,59392
CV 17,18,19
WL 6
Mavv 48,100,132
Ta 252,237,57344
Ta 254,237,59392
v_and_b32 v5, 0xffff0000, v5
Mavv 52,104,132
Tv 96,238,57344
Tv 98,238,59392
CV 18,20,21
WL 6
Maav 56,240,132
Tv 100,239,57344
Tv 102,239,59392
AR 7,211
Maav 60,244,132
Tv 104,236,61440
Tv 106,236,63488
CV 19,22,23
WL 6
Maav 48,248,136
Ta 240,237,61440
Ta 242,237,63488
Maav 52,252,136
Ta 244,238,61440
Ta 246,238,63488
v_lshlrev_b32 v6, 16, v7
WL 6
Mavv 56,96,136
Ta 248,239,61440
Ta 250,239,63488
v_and_b32 v7, 0xffff0000, v7
Mavv 60,100,136
v_add_u32 v236, 0xfffe8000, v236
v_add_u32 v237, 0xfffe8000, v237
v_add_u32 v238, 0xfffe8000, v238
v_add_u32 v239, 0xfffe8000, v239
Ta 252,236,0
Ta 254,236,2048
s_mul_i32 s61, s41, 112
s_add_u32 s61, s61, s39
buffer_store_dwordx4 v[16:19], v244, s[28:31], s61 offen offset:0 sc1
WL 6
Mavv 48,104,140
Tv 96,237,0
Tv 98,237,2048
AR 9,212
Maav 52,240,140
Tv 100,238,0
Tv 102,238,2048
v_lshlrev_b32 v8, 16, v9
WL 6
Maav 56,244,140
Tv 104,239,0
Tv 106,239,2048
Maav 60,248,140
Ta 240,236,4096
Ta 242,236,6144
CV 24,24,25
WL 6
Maav 48,252,144
Ta 244,237,4096
Ta 246,237,6144
v_and_b32 v9, 0xffff0000, v9
Mavv 52,96,144
Ta 248,238,4096
Ta 250,238,6144
s_waitcnt vmcnt(1)
v_cmp_ne_u32 vcc, 0, v225
s_nop 1
s_andn2_b32 s18, vcc_lo, s15
s_sub_u32 s17, s22, 2
s_cselect_b32 s21, 7, 0
s_add_u32 s17, s17, s21
s_mul_i32 s25, s17, 100352
s_add_u32 s25, s25, s19
s_bitcmp1_b32 s18, s17
s_cselect_b32 s25, s25, 0x7f000000
s_cselect_b32 s17, 2, 0
s_or_b32 s23, s23, s17
WL 6
Mavv 56,100,144
Ta 252,239,4096
Ta 254,239,6144
CV 25,26,27
Mavv 60,104,144
Tv 96,236,8192
Tv 98,236,10240
AR 11,213
WL 6
Maav 48,240,148
Tv 100,237,8192
Tv 102,237,10240
CV 26,28,29
Maav 52,244,148
Tv 104,238,8192
Tv 106,238,10240
buffer_load_dwordx4 a[144:147], v244, s[28:31], s25 offen offset:0 sc1
WL 6
Maav 56,248,148
Ta 240,239,8192
Ta 242,239,10240
CV 27,30,31
Maav 60,252,148
Ta 244,236,12288
Ta 246,236,14336
v_lshlrev_b32 v10, 16, v11
WL 6
Mavv 48,96,152
Ta 248,237,12288
Ta 250,237,14336
buffer_store_dwordx4 v[24:27], v244, s[28:31], s61 offen offset:1024 sc1
Mavv 52,100,152
Ta 252,238,12288
Ta 254,238,14336
buffer_load_dwordx4 a[148:151], v244, s[28:31], s25 offen offset:1024 sc1
WL 6
Mavv 56,104,152
Tv 96,239,12288
Tv 98,239,14336
v_and_b32 v11, 0xffff0000, v11
Maav 60,240,152
AR 13,214
v_lshlrev_b32 v12, 16, v13
WL 4
Maav 48,244,156
v_and_b32 v13, 0xffff0000, v13
AR 15,215
v_lshlrev_b32 v14, 16, v15
Maav 52,248,156
s_waitcnt vmcnt(8) lgkmcnt(0)
s_barrier
s_add_u32 s5, s62, s44
buffer_store_dword v85, v84, s[28:31], s5 offen sc1
v_add_u32 v236, 0x18000, v236
v_add_u32 v237, 0x18000, v237
v_add_u32 v238, 0x18000, v238
v_add_u32 v239, 0x18000, v239
Tv 100,236,32768
Tv 102,236,34816
Tv 104,237,32768
Tv 106,237,34816
Ta 240,238,32768
Ta 242,238,34816
Maav 56,252,156
Ta 244,239,32768
Ta 246,239,34816
v_and_b32 v15, 0xffff0000, v15
Mavv 60,96,156
Ta 248,236,36864
Ta 250,236,38912
WL 6
Mvvv 0,100,128
Ta 252,237,36864
Ta 254,237,38912
buffer_load_dword v225, v224, s[28:31], s16 offen sc1
Mvvv 4,104,128
Tv 96,238,36864
Tv 98,238,38912
AR 32,48
AR 33,49
WL 6
Mvav 8,240,128
Tv 100,239,36864
Tv 102,239,38912
CV 32,32,33
AR 34,50
AR 35,51
Mvav 12,244,128
Tv 104,236,40960
Tv 106,236,43008
CV 33,34,35
AR 36,52
WL 6
Mvav 0,248,132
Ta 240,237,40960
Ta 242,237,43008
AR 37,53
CV 34,36,37
Mvav 4,252,132
Ta 244,238,40960
Ta 246,238,43008
AR 38,54
AR 39,55
CV 35,38,39
WL 6
Mvvv 8,96,132
Ta 248,239,40960
Ta 250,239,43008
s_mul_i32 s61, s43, 112
s_add_u32 s61, s61, s39
buffer_store_dwordx4 v[32:35], v244, s[28:31], s61 offen offset:0 sc1
Mvvv 12,100,132
Ta 252,236,45056
Ta 254,236,47104
AR 40,56
WL 6
Mvvv 0,104,136
Tv 96,237,45056
Tv 98,237,47104
AR 41,57
CV 40,40,41
AR 42,58
Mvav 4,240,136
Tv 100,238,45056
Tv 102,238,47104
AR 43,59
CV 41,42,43
WL 6
Mvav 8,244,136
Tv 104,239,45056
Tv 106,239,47104
AR 44,60
AR 45,61
Mvav 12,248,136
v_add_u32 v236, 0xffff8000, v236
v_add_u32 v237, 0xffff8000, v237
v_add_u32 v238, 0xffff8000, v238
v_add_u32 v239, 0xffff8000, v239
Ta 240,236,16384
Ta 242,236,18432
CV 42,44,45
AR 46,62
AR 47,63
WL 6
Mvav 0,252,140
Ta 244,237,16384
Ta 246,237,18432
CV 43,46,47
buffer_store_dwordx4 v[40:43], v244, s[28:31], s61 offen offset:1024 sc1
Mvvv 4,96,140
Ta 248,238,16384
Ta 250,238,18432
WL 6
Mvvv 8,100,140
Ta 252,239,16384
Ta 254,239,18432
Mvvv 12,104,140
Tv 96,236,20480
Tv 98,236,22528
WL 6
Mvav 0,240,144
Tv 100,237,20480
Tv 102,237,22528
Mvav 4,244,144
Tv 104,238,20480
Tv 106,238,22528
s_waitcnt vmcnt(2)
v_cmp_ne_u32 vcc, 0, v225
s_nop 1
s_andn2_b32 s18, vcc_lo, s15
s_sub_u32 s17, s22, 3
s_cselect_b32 s21, 7, 0
s_add_u32 s17, s17, s21
s_mul_i32 s26, s17, 100352
s_add_u32 s26, s26, s19
s_bitcmp1_b32 s18, s17
s_cselect_b32 s26, s26, 0x7f000000
s_cselect_b32 s17, 4, 0
s_or_b32 s23, s23, s17
s_sub_u32 s17, s22, 4
s_cselect_b32 s21, 7, 0
s_add_u32 s17, s17, s21
s_mul_i32 s27, s17, 100352
s_add_u32 s27, s27, s19
s_bitcmp1_b32 s18, s17
s_cselect_b32 s27, s27, 0x7f000000
s_cselect_b32 s17, 8, 0
s_or_b32 s23, s23, s17
WL 6
Mvav 8,248,144
Ta 240,239,20480
Ta 242,239,22528
Mvav 12,252,144
Ta 244,236,24576
Ta 246,236,26624
buffer_load_dwordx4 a[160:163], v244, s[28:31], s26 offen offset:0 sc1
WL 6
Mvvv 0,96,148
Ta 248,237,24576
Ta 250,237,26624
Mvvv 4,100,148
Ta 252,238,24576
Ta 254,238,26624
buffer_load_dwordx4 a[164:167], v244, s[28:31], s26 offen offset:1024 sc1
WL 6
Mvvv 8,104,148
Tv 96,239,24576
Tv 98,239,26624
Mvav 12,240,148
Tv 100,236,28672
Tv 102,236,30720
buffer_load_dwordx4 a[176:179], v244, s[28:31], s27 offen offset:0 sc1
WL 6
Mvav 0,244,152
Tv 104,237,28672
Tv 106,237,30720
Mvav 4,248,152
Ta 240,238,28672
Ta 242,238,30720
buffer_load_dwordx4 a[180:183], v244, s[28:31], s27 offen offset:1024 sc1
WL 6
Mvav 8,252,152
Ta 244,239,28672
Ta 246,239,30720
Mvvv 12,96,152
WL 4
Mvvv 0,100,156
buffer_load_dword v225, v224, s[28:31], s16 offen sc1
Mvvv 4,104,156
WL 2
Mvav 8,240,156
WL 0
Mvav 12,244,156
s_cmp_lg_u32 s15, 0
s_cbranch_scc1 LB_wg7
s_waitcnt vmcnt(10)
s_barrier
s_add_u32 s5, s62, s41
buffer_store_dword v85, v84, s[28:31], s5 offen sc1
s_waitcnt vmcnt(6)
s_barrier
s_add_u32 s5, s62, s43
buffer_store_dword v85, v84, s[28:31], s5 offen sc1
s_waitcnt vmcnt(2)
v_cmp_ne_u32 vcc, 0, v225
s_nop 1
s_mov_b32 s18, vcc_lo
s_bitcmp1_b32 s23, 0
s_cbranch_scc1 LB_m0
s_sub_u32 s17, s22, 1
s_cselect_b32 s21, 7, 0
s_add_u32 s17, s17, s21
LB_w0:
s_bitcmp0_b32 s18, s17
s_cbranch_scc1 LB_sp0
s_mul_i32 s24, s17, 100352
s_add_u32 s24, s24, s19
buffer_load_dwordx4 a[128:131], v244, s[28:31], s24 offen offset:0 sc1
buffer_load_dwordx4 a[132:135], v244, s[28:31], s24 offen offset:1024 sc1
LB_m0:
s_bitcmp1_b32 s23, 1
s_cbranch_scc1 LB_m1
s_sub_u32 s17, s22, 2
s_cselect_b32 s21, 7, 0
s_add_u32 s17, s17, s21
LB_w1:
s_bitcmp0_b32 s18, s17
s_cbranch_scc1 LB_sp1
s_mul_i32 s25, s17, 100352
s_add_u32 s25, s25, s19
buffer_load_dwordx4 a[144:147], v244, s[28:31], s25 offen offset:0 sc1
buffer_load_dwordx4 a[148:151], v244, s[28:31], s25 offen offset:1024 sc1
LB_m1:
s_bitcmp1_b32 s23, 2
s_cbranch_scc1 LB_m2
s_sub_u32 s17, s22, 3
s_cselect_b32 s21, 7, 0
s_add_u32 s17, s17, s21
LB_w2:
s_bitcmp0_b32 s18, s17
s_cbranch_scc1 LB_sp2
s_mul_i32 s26, s17, 100352
s_add_u32 s26, s26, s19
buffer_load_dwordx4 a[160:163], v244, s[28:31], s26 offen offset:0 sc1
buffer_load_dwordx4 a[164:167], v244, s[28:31], s26 offen offset:1024 sc1
LB_m2:
s_bitcmp1_b32 s23, 3
s_cbranch_scc1 LB_m3
s_sub_u32 s17, s22, 4
s_cselect_b32 s21, 7, 0
s_add_u32 s17, s17, s21
LB_w3:
s_bitcmp0_b32 s18, s17
s_cbranch_scc1 LB_sp3
s_mul_i32 s27, s17, 100352
s_add_u32 s27, s27, s19
buffer_load_dwordx4 a[176:179], v244, s[28:31], s27 offen offset:0 sc1
buffer_load_dwordx4 a[180:183], v244, s[28:31], s27 offen offset:1024 sc1
LB_m3:
s_sub_u32 s17, s22, 5
s_cselect_b32 s21, 7, 0
s_add_u32 s17, s17, s21
LB_w4:
s_bitcmp0_b32 s18, s17
s_cbranch_scc1 LB_sp4
s_mul_i32 s24, s17, 100352
s_add_u32 s24, s24, s19
buffer_load_dwordx4 v[108:111], v244, s[28:31], s24 offen offset:0 sc1
buffer_load_dwordx4 v[112:115], v244, s[28:31], s24 offen offset:1024 sc1
s_sub_u32 s17, s22, 6
s_cselect_b32 s21, 7, 0
s_add_u32 s17, s17, s21
s_lshl_b32 s21, 1, s17
s_or_b32 s21, s21, 0x80
s_and_b32 s20, s18, s21
s_cmp_eq_u32 s20, s21
s_cbranch_scc0 LB_slowp
s_mul_i32 s25, s17, 100352
s_add_u32 s25, s25, s19
buffer_load_dwordx4 v[116:119], v244, s[28:31], s25 offen offset:0 sc1
buffer_load_dwordx4 v[120:123], v244, s[28:31], s25 offen offset:1024 sc1
s_mov_b32 s17, 7
s_mul_i32 s26, s17, 100352
s_add_u32 s26, s26, s19
buffer_load_dwordx4 v[88:91], v244, s[28:31], s26 offen offset:0 sc1
buffer_load_dwordx4 v[92:95], v244, s[28:31], s26 offen offset:1024 sc1
s_waitcnt vmcnt(6)
Mvva 0,230,128
Mvva 4,228,128
Mvva 8,230,132
Mvva 12,228,132
Mvva 0,230,144
Mvva 4,228,144
Mvva 8,230,148
Mvva 12,228,148
Mvva 0,230,160
Mvva 4,228,160
Mvva 8,230,164
Mvva 12,228,164
Mvva 0,230,176
Mvva 4,228,176
Mvva 8,230,180
Mvva 12,228,180
s_branch LB_join
LB_slowp:
s_waitcnt vmcnt(2)
Mvva 0,230,128
Mvva 4,228,128
Mvva 8,230,132
Mvva 12,228,132
Mvva 0,230,144
Mvva 4,228,144
Mvva 8,230,148
Mvva 12,228,148
Mvva 0,230,160
Mvva 4,228,160
Mvva 8,230,164
Mvva 12,228,164
Mvva 0,230,176
Mvva 4,228,176
Mvva 8,230,180
Mvva 12,228,180
s_sub_u32 s17, s22, 6
s_cselect_b32 s21, 7, 0
s_add_u32 s17, s17, s21
LB_w5:
s_bitcmp0_b32 s18, s17
s_cbranch_scc1 LB_sp5
s_mul_i32 s25, s17, 100352
s_add_u32 s25, s25, s19
buffer_load_dwordx4 v[116:119], v244, s[28:31], s25 offen offset:0 sc1
buffer_load_dwordx4 v[120:123], v244, s[28:31], s25 offen offset:1024 sc1
s_mov_b32 s17, 7
LB_w6:
s_bitcmp0_b32 s18, s17
s_cbranch_scc1 LB_sp6
s_mul_i32 s26, s17, 100352
s_add_u32 s26, s26, s19
buffer_load_dwordx4 v[88:91], v244, s[28:31], s26 offen offset:0 sc1
buffer_load_dwordx4 v[92:95], v244, s[28:31], s26 offen offset:1024 sc1
LB_join:
s_waitcnt vmcnt(4)
Mvvv 0,230,108
Mvvv 4,228,108
Mvvv 8,230,112
Mvvv 12,228,112
s_waitcnt vmcnt(2)
Mvvv 0,230,116
Mvvv 4,228,116
Mvvv 8,230,120
Mvvv 12,228,120
s_waitcnt vmcnt(0)
Mvvv 0,230,88
Mvvv 4,228,88
Mvvv 8,230,92
Mvvv 12,228,92
LB_out:
s_nop 7
CV 32,0,1
CV 33,2,3
CV 34,4,5
CV 35,6,7
s_nop 0
v_permlane32_swap_b32 v32, v34
v_permlane32_swap_b32 v33, v35
s_nop 0
v_permlane16_swap_b32 v32, v34
v_permlane16_swap_b32 v33, v35
buffer_store_dwordx4 v[32:35], v226, s[8:11], s12 offen offset:0 sc1
CV 36,8,9
CV 37,10,11
CV 38,12,13
CV 39,14,15
s_nop 0
v_permlane32_swap_b32 v36, v38
v_permlane32_swap_b32 v37, v39
s_nop 0
v_permlane16_swap_b32 v36, v38
v_permlane16_swap_b32 v37, v39
buffer_store_dwordx4 v[36:39], v226, s[8:11], s12 offen offset:64 sc1
s_branch LB_fin
LB_sp0:
buffer_load_dword v225, v224, s[28:31], s16 offen sc1
s_waitcnt vmcnt(0)
v_cmp_ne_u32 vcc, 0, v225
s_sub_u32 s14, s14, 1
s_cselect_b32 s18, -1, vcc_lo
s_branch LB_w0
LB_sp1:
buffer_load_dword v225, v224, s[28:31], s16 offen sc1
s_waitcnt vmcnt(0)
v_cmp_ne_u32 vcc, 0, v225
s_sub_u32 s14, s14, 1
s_cselect_b32 s18, -1, vcc_lo
s_branch LB_w1
LB_sp2:
buffer_load_dword v225, v224, s[28:31], s16 offen sc1
s_waitcnt vmcnt(0)
v_cmp_ne_u32 vcc, 0, v225
s_sub_u32 s14, s14, 1
s_cselect_b32 s18, -1, vcc_lo
s_branch LB_w2
LB_sp3:
buffer_load_dword v225, v224, s[28:31], s16 offen sc1
s_waitcnt vmcnt(0)
v_cmp_ne_u32 vcc, 0, v225
s_sub_u32 s14, s14, 1
s_cselect_b32 s18, -1, vcc_lo
s_branch LB_w3
LB_sp4:
buffer_load_dword v225, v224, s[28:31], s16 offen sc1
s_waitcnt vmcnt(0)
v_cmp_ne_u32 vcc, 0, v225
s_sub_u32 s14, s14, 1
s_cselect_b32 s18, -1, vcc_lo
s_branch LB_w4
LB_sp5:
buffer_load_dword v225, v224, s[28:31], s16 offen sc1
s_waitcnt vmcnt(0)
v_cmp_ne_u32 vcc, 0, v225
s_sub_u32 s14, s14, 1
s_cselect_b32 s18, -1, vcc_lo
s_branch LB_w5
LB_sp6:
buffer_load_dword v225, v224, s[28:31], s16 offen sc1
s_waitcnt vmcnt(0)
v_cmp_ne_u32 vcc, 0, v225
s_sub_u32 s14, s14, 1
s_cselect_b32 s18, -1, vcc_lo
s_branch LB_w6
LB_wg7:
s_nop 7
CV 0,0,1
CV 1,2,3
CV 2,4,5
CV 3,6,7
s_mul_i32 s61, s42, 112
s_add_u32 s61, s61, s39
buffer_store_dwordx4 v[0:3], v244, s[28:31], s61 offen offset:0 sc1
CV 8,8,9
CV 9,10,11
CV 10,12,13
CV 11,14,15
buffer_store_dwordx4 v[8:11], v244, s[28:31], s61 offen offset:1024 sc1
s_waitcnt vmcnt(2)
s_barrier
s_add_u32 s5, s62, s41
buffer_store_dword v85, v84, s[28:31], s5 offen sc1
s_add_u32 s5, s62, s43
buffer_store_dword v85, v84, s[28:31], s5 offen sc1
s_waitcnt vmcnt(2)
s_barrier
s_add_u32 s5, s62, s42
buffer_store_dword v85, v84, s[28:31], s5 offen sc1
LB_fin:
LB_end:
s_endpgm
LB_ra1:
s_call_b64 s[56:57], LB_newmax1
s_branch LB_rb1
LB_ra2:
s_call_b64 s[56:57], LB_rescale
s_branch LB_rb2
LB_ra3:
s_call_b64 s[56:57], LB_newmax0
s_branch LB_rb3
LB_ra4:
s_call_b64 s[56:57], LB_rescale
s_branch LB_rb4
LB_ra5:
s_call_b64 s[56:57], LB_newmax1
s_branch LB_rb5
LB_ra6:
s_call_b64 s[56:57], LB_rescale
s_branch LB_rb6
LB_ra7:
s_call_b64 s[56:57], LB_newmax0
s_branch LB_rb7
LB_ra8:
s_call_b64 s[56:57], LB_rescale
s_branch LB_rb8
LB_ra9:
s_call_b64 s[56:57], LB_newmax1
s_branch LB_rb9
LB_ra10:
s_call_b64 s[56:57], LB_rescale
s_branch LB_rb10
LB_ra11:
s_call_b64 s[56:57], LB_newmax0
s_branch LB_rb11
LB_ra12:
s_call_b64 s[56:57], LB_rescale
s_branch LB_rb12
LB_ra13:
s_call_b64 s[56:57], LB_newmax1
s_branch LB_rb13
LB_ra14:
s_call_b64 s[56:57], LB_rescale
s_branch LB_rb14
LB_ra15:
s_call_b64 s[56:57], LB_newmax0
s_branch LB_rb15
LB_ra16:
s_call_b64 s[56:57], LB_rescale
s_branch LB_rb16
LB_ra17:
s_call_b64 s[56:57], LB_newmax1
s_branch LB_rb17
LB_ra18:
s_call_b64 s[56:57], LB_rescale
s_branch LB_rb18
LB_ra19:
s_call_b64 s[56:57], LB_newmax0
s_branch LB_rb19
LB_ra20:
s_call_b64 s[56:57], LB_rescale
s_branch LB_rb20
LB_ra21:
s_call_b64 s[56:57], LB_newmax1
s_branch LB_rb21
LB_ra22:
s_call_b64 s[56:57], LB_rescale
s_branch LB_rb22
LB_ra23:
s_call_b64 s[56:57], LB_newmax0
s_branch LB_rb23
LB_ra24:
s_call_b64 s[56:57], LB_rescale
s_branch LB_rb24
LB_ra25:
s_call_b64 s[56:57], LB_newmax1
s_branch LB_rb25
LB_ra26:
s_call_b64 s[56:57], LB_rescale
s_branch LB_rb26
LB_ra27:
s_call_b64 s[56:57], LB_newmax0
s_branch LB_rb27
LB_ra28:
s_call_b64 s[56:57], LB_rescale
s_branch LB_rb28
LB_ra29:
s_call_b64 s[56:57], LB_newmax1
s_branch LB_rb29
LB_ra30:
s_call_b64 s[56:57], LB_rescale
s_branch LB_rb30
LB_ra31:
s_call_b64 s[56:57], LB_newmax1
s_branch LB_rb31
LB_ra32:
s_call_b64 s[56:57], LB_rescale
s_branch LB_rb32
LB_ra33:
s_call_b64 s[56:57], LB_newmax0
s_branch LB_rb33
LB_ra34:
s_call_b64 s[56:57], LB_rescale
s_branch LB_rb34
LB_ra35:
s_call_b64 s[56:57], LB_newmax1
s_branch LB_rb35
LB_ra36:
s_call_b64 s[56:57], LB_rescale
s_branch LB_rb36
LB_ra37:
s_call_b64 s[56:57], LB_newmax0
s_branch LB_rb37
LB_ra38:
s_call_b64 s[56:57], LB_rescale
s_branch LB_rb38
LB_ra39:
s_call_b64 s[56:57], LB_newmax1
s_branch LB_rb39
LB_ra40:
s_call_b64 s[56:57], LB_rescale
s_branch LB_rb40
LB_ra41:
s_call_b64 s[56:57], LB_newmax0
s_branch LB_rb41
LB_ra42:
s_call_b64 s[56:57], LB_rescale
s_branch LB_rb42
LB_ra43:
s_call_b64 s[56:57], LB_newmax1
s_branch LB_rb43
LB_ra44:
s_call_b64 s[56:57], LB_rescale
s_branch LB_rb44
LB_ra45:
s_call_b64 s[56:57], LB_newmax0
s_branch LB_rb45
LB_ra46:
s_call_b64 s[56:57], LB_rescale
s_branch LB_rb46
LB_ra47:
s_call_b64 s[56:57], LB_newmax1
s_branch LB_rb47
LB_ra48:
s_call_b64 s[56:57], LB_rescale
s_branch LB_rb48
LB_ra49:
s_call_b64 s[56:57], LB_newmax0
s_branch LB_rb49
LB_ra50:
s_call_b64 s[56:57], LB_rescale
s_branch LB_rb50
LB_ra51:
s_call_b64 s[56:57], LB_newmax1
s_branch LB_rb51
LB_ra52:
s_call_b64 s[56:57], LB_rescale
s_branch LB_rb52
LB_ra53:
s_call_b64 s[56:57], LB_newmax0
s_branch LB_rb53
LB_ra54:
s_call_b64 s[56:57], LB_rescale
s_branch LB_rb54
LB_ra55:
s_call_b64 s[56:57], LB_newmax1
s_branch LB_rb55
LB_ra56:
s_call_b64 s[56:57], LB_rescale
s_branch LB_rb56
LB_ra57:
s_call_b64 s[56:57], LB_newmax0
s_branch LB_rb57
LB_ra58:
s_call_b64 s[56:57], LB_rescale
s_branch LB_rb58
LB_ra59:
s_call_b64 s[56:57], LB_newmax1
s_branch LB_rb59
LB_ra60:
s_call_b64 s[56:57], LB_rescale
s_branch LB_rb60
LB_newmax0:
v_max3_f32 v251, v192, v193, v194
v_max3_f32 v251, v251, v195, v196
v_max3_f32 v251, v251, v197, v198
v_max3_f32 v251, v251, v199, 0
v_mov_b32 v252, v251
s_nop 1
v_permlane32_swap_b32 v251, v252
v_max_f32 v251, v251, v252
v_mov_b32 v252, v251
s_nop 1
v_permlane16_swap_b32 v251, v252
v_max_f32 v251, v251, v252
v_add_f32 v245, v245, v251
v_sub_f32 v192, v192, v251
v_sub_f32 v193, v193, v251
v_sub_f32 v194, v194, v251
v_sub_f32 v195, v195, v251
v_sub_f32 v196, v196, v251
v_sub_f32 v197, v197, v251
v_sub_f32 v198, v198, v251
v_sub_f32 v199, v199, v251
v_sub_f32 v251, 0, v251
v_exp_f32 v249, v251
s_nop 0
v_mul_f32 v247, v247, v249
s_mov_b32 s49, 1
s_setpc_b64 s[56:57]
LB_newmax1:
v_max3_f32 v251, v208, v209, v210
v_max3_f32 v251, v251, v211, v212
v_max3_f32 v251, v251, v213, v214
v_max3_f32 v251, v251, v215, 0
v_mov_b32 v252, v251
s_nop 1
v_permlane32_swap_b32 v251, v252
v_max_f32 v251, v251, v252
v_mov_b32 v252, v251
s_nop 1
v_permlane16_swap_b32 v251, v252
v_max_f32 v251, v251, v252
v_add_f32 v245, v245, v251
v_sub_f32 v208, v208, v251
v_sub_f32 v209, v209, v251
v_sub_f32 v210, v210, v251
v_sub_f32 v211, v211, v251
v_sub_f32 v212, v212, v251
v_sub_f32 v213, v213, v251
v_sub_f32 v214, v214, v251
v_sub_f32 v215, v215, v251
v_sub_f32 v251, 0, v251
v_exp_f32 v249, v251
s_nop 0
v_mul_f32 v247, v247, v249
s_mov_b32 s49, 1
s_setpc_b64 s[56:57]
LB_rescale:
s_nop 7
v_mul_f32 v0, v0, v249
v_mul_f32 v1, v1, v249
v_mul_f32 v2, v2, v249
v_mul_f32 v3, v3, v249
v_mul_f32 v4, v4, v249
v_mul_f32 v5, v5, v249
v_mul_f32 v6, v6, v249
v_mul_f32 v7, v7, v249
v_mul_f32 v8, v8, v249
v_mul_f32 v9, v9, v249
v_mul_f32 v10, v10, v249
v_mul_f32 v11, v11, v249
v_mul_f32 v12, v12, v249
v_mul_f32 v13, v13, v249
v_mul_f32 v14, v14, v249
v_mul_f32 v15, v15, v249
v_mul_f32 v16, v16, v249
v_mul_f32 v17, v17, v249
v_mul_f32 v18, v18, v249
v_mul_f32 v19, v19, v249
v_mul_f32 v20, v20, v249
v_mul_f32 v21, v21, v249
v_mul_f32 v22, v22, v249
v_mul_f32 v23, v23, v249
v_mul_f32 v24, v24, v249
v_mul_f32 v25, v25, v249
v_mul_f32 v26, v26, v249
v_mul_f32 v27, v27, v249
v_mul_f32 v28, v28, v249
v_mul_f32 v29, v29, v249
v_mul_f32 v30, v30, v249
v_mul_f32 v31, v31, v249
v_mul_f32 v32, v32, v249
v_mul_f32 v33, v33, v249
v_mul_f32 v34, v34, v249
v_mul_f32 v35, v35, v249
v_mul_f32 v36, v36, v249
v_mul_f32 v37, v37, v249
v_mul_f32 v38, v38, v249
v_mul_f32 v39, v39, v249
v_mul_f32 v40, v40, v249
v_mul_f32 v41, v41, v249
v_mul_f32 v42, v42, v249
v_mul_f32 v43, v43, v249
v_mul_f32 v44, v44, v249
v_mul_f32 v45, v45, v249
v_mul_f32 v46, v46, v249
v_mul_f32 v47, v47, v249
v_mul_f32 v48, v48, v249
v_mul_f32 v49, v49, v249
v_mul_f32 v50, v50, v249
v_mul_f32 v51, v51, v249
v_mul_f32 v52, v52, v249
v_mul_f32 v53, v53, v249
v_mul_f32 v54, v54, v249
v_mul_f32 v55, v55, v249
v_mul_f32 v56, v56, v249
v_mul_f32 v57, v57, v249
v_mul_f32 v58, v58, v249
v_mul_f32 v59, v59, v249
v_mul_f32 v60, v60, v249
v_mul_f32 v61, v61, v249
v_mul_f32 v62, v62, v249
v_mul_f32 v63, v63, v249
s_mov_b32 s49, 0
s_nop 1
s_setpc_b64 s[56:57]
.globl concat_heads__mha_block_cached__gqa_block_cached__near_ridge_kernel
.p2align 8
.type concat_heads__mha_block_cached__gqa_block_cached__near_ridge_kernel,@function
concat_heads__mha_block_cached__gqa_block_cached__near_ridge_kernel:
s_cmp_lt_u32 s2, 256
s_cbranch_scc1 L_go
s_endpgm
L_go:
s_mov_b32 s59, s2
s_and_b32 s3, s2, 3
s_lshl_b32 s3, s3, 1
s_bfe_u32 s4, s2, 0x10003
s_or_b32 s3, s3, s4
s_lshr_b32 s6, s2, 4
s_bfe_u32 s4, s2, 0x10002
s_mul_i32 s7, s4, 40
s_add_u32 s60, s0, s7
s_addc_u32 s61, s1, 0
s_load_dwordx4 s[84:87], s[60:61], 0
s_load_dwordx4 s[88:91], s[60:61], 16
s_load_dwordx2 s[92:93], s[60:61], 32
s_load_dwordx2 s[94:95], s[0:1], 96
s_load_dwordx4 s[80:83], s[0:1], 80
s_lshl_b32 s4, s4, 7
s_lshl_b32 s2, s6, 3
s_or_b32 s2, s2, s3
s_or_b32 s2, s2, s4
v_lshrrev_b32 v1, 6, v0
s_nop 0
v_readfirstlane_b32 s58, v1
v_and_b32 v2, 63, v0
s_mul_i32 s7, s6, 37
s_lshr_b32 s7, s7, 8
s_mul_i32 s7, s7, 7
s_sub_u32 s47, s6, s7
s_cmp_eq_u32 s58, 3
s_cbranch_scc1 LB_start
s_getpc_b64 s[96:97]
L_pc:
s_sub_u32 s96, s96, L_pc-LB_start
s_subb_u32 s97, s97, 0
s_lshr_b32 s7, s59, 3
s_mul_i32 s7, s7, 6144
v_min_u32 v10, 47, v0
v_lshl_add_u32 v10, v10, 7, s7
v_min_u32 v10, LA_end-LB_start, v10
global_load_dword v255, v10, s[96:97]
v_lshrrev_b32 v3, 5, v2
v_and_b32 v4, 31, v2
s_lshl_b32 s32, s6, 22
s_lshl_b32 s7, s3, 19
s_add_u32 s32, s32, s7
s_lshl_b32 s34, s3, 10
s_mul_i32 s33, s6, 100352
s_mul_i32 s35, s3, 458752
s_and_b32 s7, s3, 1
s_mul_i32 s7, s7, 3
s_add_u32 s7, s7, s47
s_sub_u32 s5, s7, 7
s_cselect_b32 s7, s7, s5
s_lshl_b32 s40, s7, 7
s_add_u32 s7, s40, 128
s_cmp_eq_u32 s7, 896
s_cselect_b32 s41, 0, s7
s_add_u32 s7, s41, 128
s_cmp_eq_u32 s7, 896
s_cselect_b32 s42, 0, s7
s_add_u32 s7, s42, 128
s_cmp_eq_u32 s7, 896
s_cselect_b32 s43, 0, s7
s_add_u32 s7, s43, 128
s_cmp_eq_u32 s7, 896
s_cselect_b32 s44, 0, s7
s_add_u32 s7, s44, 128
s_cmp_eq_u32 s7, 896
s_cselect_b32 s45, 0, s7
s_add_u32 s7, s45, 128
s_cmp_eq_u32 s7, 896
s_cselect_b32 s46, 0, s7
v_lshrrev_b32 v5, 3, v2
v_mul_u32_u24 v5, 896, v5
v_lshrrev_b32 v6, 4, v2
v_and_b32 v7, 7, v2
v_xor_b32 v6, v6, v7
v_lshlrev_b32 v6, 4, v6
v_add_u32 v132, v5, v6
v_xor_b32 v6, 64, v6
v_add_u32 v133, v5, v6
v_add_u32 v133, 6144, v133
v_add_u32 v134, 12288, v132
v_add_u32 v135, 12288, v133
v_lshlrev_b32 v5, 1, v3
v_xor_b32 v5, v4, v5
v_lshlrev_b32 v5, 4, v5
v_lshl_add_u32 v128, v3, 13, v5
v_xor_b32 v129, 64, v128
v_add_u32 v129, 15360, v129
v_xor_b32 v130, 128, v128
v_add_u32 v130, 63488, v130
v_xor_b32 v131, 192, v128
v_add_u32 v131, 78848, v131
s_lshl_b32 s98, s58, 12
s_mul_i32 s63, s58, 28672
s_add_u32 s63, s63, s33
s_and_b32 s7, s58, 1
s_lshl_b32 s7, s7, 17
s_add_u32 s99, s34, s7
s_lshr_b32 s7, s58, 1
s_lshl_b32 s7, s7, 15
s_add_u32 s99, s99, s7
WL 0
s_mov_b32 s24, s84
s_mov_b32 s25, s85
s_mov_b32 s26, 1605632
s_mov_b32 s27, 0x20000
s_mov_b32 s16, s90
s_mov_b32 s17, s91
s_mov_b32 s18, 3670016
s_mov_b32 s19, 0x20000
s_add_u32 m0, s98, 81920
s_add_u32 s36, s63, s40
DD 132,24,36,0
DD 133,24,36,1024
DD 134,24,36,2048
DD 135,24,36,3072
s_add_u32 m0, s98, 114688
s_lshl_b32 s36, s40, 12
s_add_u32 s36, s36, s99
DD 128,16,36,0
DD 129,16,36,1024
DD 130,16,36,2048
DD 131,16,36,3072
s_add_u32 m0, s98, 131072
s_lshl_b32 s36, s40, 12
s_add_u32 s36, s36, s99
s_add_u32 s36, s36, 262144
DD 128,16,36,0
DD 129,16,36,1024
DD 130,16,36,2048
DD 131,16,36,3072
s_add_u32 m0, s98, 65536
s_add_u32 s36, s63, s41
DD 132,24,36,0
DD 133,24,36,1024
DD 134,24,36,2048
DD 135,24,36,3072
WL 0
s_mov_b32 s52, s82
s_mov_b32 s53, s83
s_mov_b32 s54, 256
s_mov_b32 s55, 0x20000
s_mov_b32 s28, s94
s_mov_b32 s29, s95
s_mov_b32 s30, 26738688
s_mov_b32 s31, 0x20000
s_mul_i32 s39, s2, 100352
s_mov_b32 s37, 0x3db8aa3b
s_mov_b32 s38, 0x41000000
s_mov_b32 s49, 0
s_add_u32 s51, s3, s47
s_sub_u32 s5, s51, 7
s_cselect_b32 s51, s51, s5
s_cmp_eq_u32 s3, 7
s_cselect_b32 s50, 7, s51
s_and_b32 s5, s2, 0xf8
s_lshl_b32 s5, s5, 7
s_add_u32 s62, s5, 25690112
v_and_b32 v8, 15, v2
v_lshrrev_b32 v9, 4, v2
s_lshl_b32 s7, s58, 12
v_lshl_add_u32 v244, v2, 4, s7
v_lshrrev_b32 v5, 1, v8
v_xor_b32 v5, v5, v9
v_lshlrev_b32 v5, 4, v5
v_lshl_add_u32 v208, v8, 7, v5
v_add_u32 v208, s7, v208
v_add_u32 v208, 0x8000, v208
v_xor_b32 v209, 64, v208
v_xor_b32 v5, v8, v9
v_lshlrev_b32 v5, 4, v5
v_lshl_add_u32 v224, v8, 9, v5
v_xor_b32 v225, 64, v224
v_xor_b32 v226, 128, v224
v_xor_b32 v227, 192, v224
v_lshrrev_b32 v5, 2, v2
v_lshlrev_b32 v6, 9, v5
v_and_b32 v5, 7, v5
v_lshl_add_u32 v6, v5, 5, v6
v_and_b32 v5, 3, v2
v_lshl_add_u32 v6, v5, 3, v6
v_add_u32 v236, 0x18000, v6
v_add_u32 v228, 0x10000, v6
v_xor_b32 v237, 32, v236
v_xor_b32 v238, 64, v236
v_xor_b32 v239, 96, v236
v_xor_b32 v240, 128, v236
v_xor_b32 v241, 160, v236
v_xor_b32 v242, 192, v236
v_xor_b32 v243, 224, v236
v_xor_b32 v229, 32, v228
v_xor_b32 v230, 64, v228
v_xor_b32 v231, 96, v228
v_xor_b32 v232, 128, v228
v_xor_b32 v233, 160, v228
v_xor_b32 v234, 192, v228
v_xor_b32 v235, 224, v228
s_waitcnt vmcnt(8) lgkmcnt(0)
s_barrier
Ba 128,208,49152
Ba 132,208,51200
Ba 136,209,49152
Ba 140,209,51200
Ta 240,236,16384
Ta 242,236,24576
Ta 244,237,16384
WL 1
v_mfma_f32_16x16x32_bf16 v[0:3], a[240:243], a[128:131], 0
Ta 246,237,24576
Ta 248,238,16384
Ta 250,238,24576
Ta 252,239,16384
Ta 254,239,24576
Tv 212,240,16384
Tv 214,240,24576
v_mfma_f32_16x16x32_bf16 v[8:11], a[240:243], a[132:135], 0
Tv 216,241,16384
WL 5
v_mfma_f32_16x16x32_bf16 v[4:7], a[244:247], a[128:131], 0
Tv 218,241,24576
s_add_u32 m0, s98, 147456
s_lshl_b32 s36, s41, 12
s_add_u32 s36, s36, s99
DD 128,16,36,0
v_mfma_f32_16x16x32_bf16 v[12:15], a[244:247], a[132:135], 0
Tv 220,242,16384
v_mfma_f32_16x16x32_bf16 v[16:19], a[248:251], a[128:131], 0
Tv 222,242,24576
DD 129,16,36,1024
v_mfma_f32_16x16x32_bf16 v[24:27], a[248:251], a[132:135], 0
Ta 240,243,16384
WL 5
v_mfma_f32_16x16x32_bf16 v[20:23], a[252:255], a[128:131], 0
Ta 242,243,24576
DD 130,16,36,2048
v_mfma_f32_16x16x32_bf16 v[28:31], a[252:255], a[132:135], 0
Ta 244,236,16640
v_mfma_f32_16x16x32_bf16 v[32:35], v[212:215], a[128:131], 0
Ta 246,236,24832
DD 131,16,36,3072
v_mfma_f32_16x16x32_bf16 v[40:43], v[212:215], a[132:135], 0
Ta 248,237,16640
WL 5
v_mfma_f32_16x16x32_bf16 v[36:39], v[216:219], a[128:131], 0
Ta 250,237,24832
s_add_u32 m0, s98, 49152
s_add_u32 s36, s63, s42
DD 132,24,36,0
v_mfma_f32_16x16x32_bf16 v[44:47], v[216:219], a[132:135], 0
Ta 252,238,16640
v_mfma_f32_16x16x32_bf16 v[48:51], v[220:223], a[128:131], 0
Ta 254,238,24832
DD 133,24,36,1024
v_mfma_f32_16x16x32_bf16 v[56:59], v[220:223], a[132:135], 0
Tv 212,239,16640
WL 5
v_mfma_f32_16x16x32_bf16 v[52:55], a[240:243], a[128:131], 0
Tv 214,239,24832
DD 134,24,36,2048
v_mfma_f32_16x16x32_bf16 v[60:63], a[240:243], a[132:135], 0
Tv 216,240,16640
v_mfma_f32_16x16x32_bf16 v[64:67], a[244:247], a[128:131], 0
Tv 218,240,24832
DD 135,24,36,3072
v_mfma_f32_16x16x32_bf16 v[72:75], a[244:247], a[132:135], 0
Tv 220,241,16640
WL 5
v_mfma_f32_16x16x32_bf16 v[68:71], a[248:251], a[128:131], 0
Tv 222,241,24832
s_add_u32 m0, s98, 98304
s_lshl_b32 s36, s41, 12
s_add_u32 s36, s36, s99
s_add_u32 s36, s36, 262144
DD 128,16,36,0
v_mfma_f32_16x16x32_bf16 v[76:79], a[248:251], a[132:135], 0
Ta 240,242,16640
v_mfma_f32_16x16x32_bf16 v[80:83], a[252:255], a[128:131], 0
Ta 242,242,24832
DD 129,16,36,1024
v_mfma_f32_16x16x32_bf16 v[88:91], a[252:255], a[132:135], 0
Ta 244,243,16640
WL 5
v_mfma_f32_16x16x32_bf16 v[84:87], v[212:215], a[128:131], 0
Ta 246,243,24832
DD 130,16,36,2048
v_mfma_f32_16x16x32_bf16 v[92:95], v[212:215], a[132:135], 0
v_mfma_f32_16x16x32_bf16 v[96:99], v[216:219], a[128:131], 0
DD 131,16,36,3072
v_mfma_f32_16x16x32_bf16 v[104:107], v[216:219], a[132:135], 0
WL 2
v_mfma_f32_16x16x32_bf16 v[100:103], v[220:223], a[128:131], 0
v_mfma_f32_16x16x32_bf16 v[108:111], v[220:223], a[132:135], 0
s_waitcnt vmcnt(16) lgkmcnt(0)
s_barrier
Ta 248,236,32768
v_mfma_f32_16x16x32_bf16 v[112:115], a[240:243], a[128:131], 0
Ta 250,236,40960
Ta 252,237,32768
Ta 254,237,40960
Tv 212,238,32768
Tv 214,238,40960
v_mfma_f32_16x16x32_bf16 v[120:123], a[240:243], a[132:135], 0
Tv 216,239,32768
v_mfma_f32_16x16x32_bf16 v[116:119], a[244:247], a[128:131], 0
Tv 218,239,40960
s_add_u32 m0, s98, 81920
s_add_u32 s36, s63, s43
DD 132,24,36,0
v_mfma_f32_16x16x32_bf16 v[124:127], a[244:247], a[132:135], 0
Tv 220,240,32768
WL 5
Mvaa 0,248,136
Tv 222,240,40960
DD 133,24,36,1024
Mvaa 8,248,140
Ta 240,241,32768
Mvaa 4,252,136
Ta 242,241,40960
Mvaa 12,252,140
Ta 244,242,32768
WL 5
Mvva 16,212,136
Ta 246,242,40960
DD 134,24,36,2048
Mvva 24,212,140
Ta 248,243,32768
Mvva 20,216,136
Ta 250,243,40960
Mvva 28,216,140
Ta 252,236,33024
WL 5
Mvva 32,220,136
Ta 254,236,41216
DD 135,24,36,3072
Mvva 40,220,140
Tv 212,237,33024
Mvaa 36,240,136
Tv 214,237,41216
Mvaa 44,240,140
Tv 216,238,33024
WL 5
Mvaa 48,244,136
Tv 218,238,41216
s_add_u32 m0, s98, 114688
s_lshl_b32 s36, s42, 12
s_add_u32 s36, s36, s99
DD 128,16,36,0
Mvaa 56,244,140
Tv 220,239,33024
Mvaa 52,248,136
Tv 222,239,41216
Mvaa 60,248,140
Ta 240,240,33024
WL 5
Mvaa 64,252,136
Ta 242,240,41216
DD 129,16,36,1024
Mvaa 72,252,140
Ta 244,241,33024
Mvva 68,212,136
Ta 246,241,41216
Mvva 76,212,140
Ta 248,242,33024
WL 5
Mvva 80,216,136
Ta 250,242,41216
DD 130,16,36,2048
Mvva 88,216,140
Ta 252,243,33024
Mvva 84,220,136
Ta 254,243,41216
Mvva 92,220,140
WL 4
Mvaa 96,240,136
DD 131,16,36,3072
Mvaa 104,240,140
Mvaa 100,244,136
Mvaa 108,244,140
s_waitcnt vmcnt(16) lgkmcnt(0)
s_barrier
Ba 144,208,32768
Ba 148,208,34816
Ba 152,209,32768
Ba 156,209,34816
Tv 212,236,49152
Mvaa 112,248,136
Tv 214,236,57344
Tv 216,237,49152
Tv 218,237,57344
Tv 220,238,49152
Tv 222,238,57344
Mvaa 120,248,140
Ta 240,239,49152
Mvaa 116,252,136
Ta 242,239,57344
s_add_u32 m0, s98, 131072
s_lshl_b32 s36, s42, 12
s_add_u32 s36, s36, s99
s_add_u32 s36, s36, 262144
DD 128,16,36,0
Mvaa 124,252,140
Ta 244,240,49152
WL 5
Mvva 0,212,144
Ta 246,240,57344
Mvva 8,212,148
Ta 248,241,49152
Mvva 4,216,144
Ta 250,241,57344
Mvva 12,216,148
Ta 252,242,49152
WL 5
Mvva 16,220,144
Ta 254,242,57344
DD 129,16,36,1024
Mvva 24,220,148
Tv 212,243,49152
Mvaa 20,240,144
Tv 214,243,57344
Mvaa 28,240,148
Tv 216,236,49408
WL 5
Mvaa 32,244,144
Tv 218,236,57600
Mvaa 40,244,148
Tv 220,237,49408
Mvaa 36,248,144
Tv 222,237,57600
Mvaa 44,248,148
Ta 240,238,49408
WL 5
Mvaa 48,252,144
Ta 242,238,57600
DD 130,16,36,2048
Mvaa 56,252,148
Ta 244,239,49408
Mvva 52,212,144
Ta 246,239,57600
Mvva 60,212,148
Ta 248,240,49408
WL 5
Mvva 64,216,144
Ta 250,240,57600
Mvva 72,216,148
Ta 252,241,49408
Mvva 68,220,144
Ta 254,241,57600
Mvva 76,220,148
Tv 212,242,49408
WL 5
Mvaa 80,240,144
Tv 214,242,57600
DD 131,16,36,3072
Mvaa 88,240,148
Tv 216,243,49408
Mvaa 84,244,144
Tv 218,243,57600
Mvaa 92,244,148
WL 4
Mvaa 96,248,144
Mvaa 104,248,148
Mvaa 100,252,144
Mvaa 108,252,148
s_waitcnt vmcnt(12) lgkmcnt(0)
s_barrier
Ba 160,208,16384
Ba 164,208,18432
Ba 168,209,16384
Ba 172,209,18432
Tv 220,236,0
Mvva 112,212,144
Tv 222,236,8192
Ta 240,237,0
Ta 242,237,8192
Ta 244,238,0
Ta 246,238,8192
Mvva 120,212,148
Ta 248,239,0
Mvva 116,216,144
Ta 250,239,8192
s_add_u32 m0, s98, 65536
s_add_u32 s36, s63, s44
DD 132,24,36,0
Mvva 124,216,148
Ta 252,240,0
WL 5
Mvva 0,220,152
Ta 254,240,8192
DD 133,24,36,1024
Mvva 8,220,156
Tv 212,241,0
Mvaa 4,240,152
Tv 214,241,8192
Mvaa 12,240,156
Tv 216,242,0
WL 5
Mvaa 16,244,152
Tv 218,242,8192
DD 134,24,36,2048
Mvaa 24,244,156
Tv 220,243,0
Mvaa 20,248,152
Tv 222,243,8192
Mvaa 28,248,156
Ta 240,236,256
WL 5
Mvaa 32,252,152
Ta 242,236,8448
DD 135,24,36,3072
Mvaa 40,252,156
Ta 244,237,256
Mvva 36,212,152
Ta 246,237,8448
Mvva 44,212,156
Ta 248,238,256
WL 5
Mvva 48,216,152
Ta 250,238,8448
s_add_u32 m0, s98, 147456
s_lshl_b32 s36, s43, 12
s_add_u32 s36, s36, s99
DD 128,16,36,0
Mvva 56,216,156
Ta 252,239,256
Mvva 52,220,152
Ta 254,239,8448
Mvva 60,220,156
Tv 212,240,256
WL 5
Mvaa 64,240,152
Tv 214,240,8448
DD 129,16,36,1024
Mvaa 72,240,156
Tv 216,241,256
Mvaa 68,244,152
Tv 218,241,8448
Mvaa 76,244,156
Tv 220,242,256
WL 5
Mvaa 80,248,152
Tv 222,242,8448
DD 130,16,36,2048
Mvaa 88,248,156
Ta 240,243,256
Mvaa 84,252,152
Ta 242,243,8448
Mvaa 92,252,156
WL 4
Mvva 96,212,152
DD 131,16,36,3072
Mvva 104,212,156
Mvva 100,216,152
Mvva 108,216,156
s_waitcnt vmcnt(12) lgkmcnt(0)
s_barrier
Ba 176,208,49152
Ba 180,208,51200
Ba 184,209,49152
Ba 188,209,51200
Ta 244,236,16384
Mvva 112,220,152
Ta 246,236,24576
Ta 248,237,16384
Ta 250,237,24576
Ta 252,238,16384
Ta 254,238,24576
Mvva 120,220,156
Tv 212,239,16384
Mvaa 116,240,152
Tv 214,239,24576
s_add_u32 m0, s98, 49152
s_add_u32 s36, s63, s45
DD 132,24,36,0
Mvaa 124,240,156
Tv 216,240,16384
WL 5
Mvaa 0,244,160
Tv 218,240,24576
DD 133,24,36,1024
Mvaa 8,244,164
Tv 220,241,16384
Mvaa 4,248,160
Tv 222,241,24576
Mvaa 12,248,164
Ta 240,242,16384
WL 5
Mvaa 16,252,160
Ta 242,242,24576
DD 134,24,36,2048
Mvaa 24,252,164
Ta 244,243,16384
Mvva 20,212,160
Ta 246,243,24576
Mvva 28,212,164
Ta 248,236,16640
WL 5
Mvva 32,216,160
Ta 250,236,24832
DD 135,24,36,3072
Mvva 40,216,164
Ta 252,237,16640
Mvva 36,220,160
Ta 254,237,24832
Mvva 44,220,164
Tv 212,238,16640
WL 5
Mvaa 48,240,160
Tv 214,238,24832
s_add_u32 m0, s98, 98304
s_lshl_b32 s36, s43, 12
s_add_u32 s36, s36, s99
s_add_u32 s36, s36, 262144
DD 128,16,36,0
Mvaa 56,240,164
Tv 216,239,16640
Mvaa 52,244,160
Tv 218,239,24832
Mvaa 60,244,164
Tv 220,240,16640
WL 5
Mvaa 64,248,160
Tv 222,240,24832
DD 129,16,36,1024
Mvaa 72,248,164
Ta 240,241,16640
Mvaa 68,252,160
Ta 242,241,24832
Mvaa 76,252,164
Ta 244,242,16640
WL 5
Mvva 80,212,160
Ta 246,242,24832
DD 130,16,36,2048
Mvva 88,212,164
Ta 248,243,16640
Mvva 84,216,160
Ta 250,243,24832
Mvva 92,216,164
WL 4
Mvva 96,220,160
DD 131,16,36,3072
Mvva 104,220,164
Mvaa 100,240,160
Mvaa 108,240,164
s_waitcnt vmcnt(12) lgkmcnt(0)
s_barrier
Ba 192,208,32768
Ba 196,208,34816
Ba 200,209,32768
Ba 204,209,34816
Ta 252,236,32768
Mvaa 112,244,160
Ta 254,236,40960
Tv 212,237,32768
Tv 214,237,40960
Tv 216,238,32768
Tv 218,238,40960
Mvaa 120,244,164
Tv 220,239,32768
Mvaa 116,248,160
Tv 222,239,40960
s_add_u32 m0, s98, 81920
s_add_u32 s36, s63, s46
DD 132,24,36,0
Mvaa 124,248,164
Ta 240,240,32768
WL 5
Mvaa 0,252,168
Ta 242,240,40960
DD 133,24,36,1024
Mvaa 8,252,172
Ta 244,241,32768
Mvva 4,212,168
Ta 246,241,40960
Mvva 12,212,172
Ta 248,242,32768
WL 5
Mvva 16,216,168
Ta 250,242,40960
DD 134,24,36,2048
Mvva 24,216,172
Ta 252,243,32768
Mvva 20,220,168
Ta 254,243,40960
Mvva 28,220,172
Tv 212,236,33024
WL 5
Mvaa 32,240,168
Tv 214,236,41216
DD 135,24,36,3072
Mvaa 40,240,172
Tv 216,237,33024
Mvaa 36,244,168
Tv 218,237,41216
Mvaa 44,244,172
Tv 220,238,33024
WL 5
Mvaa 48,248,168
Tv 222,238,41216
s_add_u32 m0, s98, 114688
s_lshl_b32 s36, s44, 12
s_add_u32 s36, s36, s99
DD 128,16,36,0
Mvaa 56,248,172
Ta 240,239,33024
Mvaa 52,252,168
Ta 242,239,41216
Mvaa 60,252,172
Ta 244,240,33024
WL 5
Mvva 64,212,168
Ta 246,240,41216
DD 129,16,36,1024
Mvva 72,212,172
Ta 248,241,33024
Mvva 68,216,168
Ta 250,241,41216
Mvva 76,216,172
Ta 252,242,33024
WL 5
Mvva 80,220,168
Ta 254,242,41216
DD 130,16,36,2048
Mvva 88,220,172
Tv 212,243,33024
Mvaa 84,240,168
Tv 214,243,41216
Mvaa 92,240,172
WL 4
Mvaa 96,244,168
DD 131,16,36,3072
Mvaa 104,244,172
Mvaa 100,248,168
Mvaa 108,248,172
s_waitcnt vmcnt(12) lgkmcnt(0)
s_barrier
Ba 208,208,16384
Ba 212,208,18432
Ba 216,209,16384
Ba 220,209,18432
Tv 216,236,49152
Mvaa 112,252,168
Tv 218,236,57344
Tv 220,237,49152
Tv 222,237,57344
Ta 240,238,49152
Ta 242,238,57344
Mvaa 120,252,172
Ta 244,239,49152
Mvva 116,212,168
Ta 246,239,57344
s_add_u32 m0, s98, 131072
s_lshl_b32 s36, s44, 12
s_add_u32 s36, s36, s99
s_add_u32 s36, s36, 262144
DD 128,16,36,0
Mvva 124,212,172
Ta 248,240,49152
WL 5
Mvva 0,216,176
Ta 250,240,57344
Mvva 8,216,180
Ta 252,241,49152
Mvva 4,220,176
Ta 254,241,57344
Mvva 12,220,180
Tv 212,242,49152
WL 5
Mvaa 16,240,176
Tv 214,242,57344
DD 129,16,36,1024
Mvaa 24,240,180
Tv 216,243,49152
Mvaa 20,244,176
Tv 218,243,57344
Mvaa 28,244,180
Tv 220,236,49408
WL 5
Mvaa 32,248,176
Tv 222,236,57600
Mvaa 40,248,180
Ta 240,237,49408
Mvaa 36,252,176
Ta 242,237,57600
Mvaa 44,252,180
Ta 244,238,49408
WL 5
Mvva 48,212,176
Ta 246,238,57600
DD 130,16,36,2048
Mvva 56,212,180
Ta 248,239,49408
Mvva 52,216,176
Ta 250,239,57600
Mvva 60,216,180
Ta 252,240,49408
WL 5
Mvva 64,220,176
Ta 254,240,57600
Mvva 72,220,180
Tv 212,241,49408
Mvaa 68,240,176
Tv 214,241,57600
Mvaa 76,240,180
Tv 216,242,49408
WL 5
Mvaa 80,244,176
Tv 218,242,57600
DD 131,16,36,3072
Mvaa 88,244,180
Tv 220,243,49408
Mvaa 84,248,176
Tv 222,243,57600
Mvaa 92,248,180
WL 4
Mvaa 96,252,176
Mvaa 104,252,180
Mvva 100,212,176
Mvva 108,212,180
s_waitcnt vmcnt(8) lgkmcnt(0)
s_barrier
Ba 224,208,49152
Ba 228,208,51200
Ba 232,209,49152
Ba 236,209,51200
Ta 240,236,0
Mvva 112,216,176
Ta 242,236,8192
Ta 244,237,0
Ta 246,237,8192
Ta 248,238,0
Ta 250,238,8192
Mvva 120,216,180
Ta 252,239,0
Mvva 116,220,176
Ta 254,239,8192
s_add_u32 m0, s98, 147456
s_lshl_b32 s36, s45, 12
s_add_u32 s36, s36, s99
DD 128,16,36,0
Mvva 124,220,180
Tv 212,240,0
WL 5
Mvaa 0,240,184
Tv 214,240,8192
Mvaa 8,240,188
Tv 216,241,0
Mvaa 4,244,184
Tv 218,241,8192
Mvaa 12,244,188
Tv 220,242,0
WL 5
Mvaa 16,248,184
Tv 222,242,8192
DD 129,16,36,1024
Mvaa 24,248,188
Ta 240,243,0
Mvaa 20,252,184
Ta 242,243,8192
Mvaa 28,252,188
Ta 244,236,256
WL 5
Mvva 32,212,184
Ta 246,236,8448
Mvva 40,212,188
Ta 248,237,256
Mvva 36,216,184
Ta 250,237,8448
Mvva 44,216,188
Ta 252,238,256
WL 5
Mvva 48,220,184
Ta 254,238,8448
DD 130,16,36,2048
Mvva 56,220,188
Tv 212,239,256
Mvaa 52,240,184
Tv 214,239,8448
Mvaa 60,240,188
Tv 216,240,256
WL 5
Mvaa 64,244,184
Tv 218,240,8448
Mvaa 72,244,188
Tv 220,241,256
Mvaa 68,248,184
Tv 222,241,8448
Mvaa 76,248,188
Ta 240,242,256
WL 5
Mvaa 80,252,184
Ta 242,242,8448
DD 131,16,36,3072
Mvaa 88,252,188
Ta 244,243,256
Mvva 84,212,184
Ta 246,243,8448
Mvva 92,212,188
WL 4
Mvva 96,216,184
Mvva 104,216,188
Mvva 100,220,184
Mvva 108,220,188
s_waitcnt vmcnt(8) lgkmcnt(0)
s_barrier
Ta 248,236,16384
Mvaa 112,240,184
Ta 250,236,24576
Ta 252,237,16384
Ta 254,237,24576
Tv 212,238,16384
Tv 214,238,24576
Mvaa 120,240,188
Tv 216,239,16384
Mvaa 116,244,184
Tv 218,239,24576
s_add_u32 m0, s98, 98304
s_lshl_b32 s36, s45, 12
s_add_u32 s36, s36, s99
s_add_u32 s36, s36, 262144
DD 128,16,36,0
Mvaa 124,244,188
Tv 220,240,16384
WL 5
Mvaa 0,248,192
Tv 222,240,24576
Mvaa 8,248,196
Ta 240,241,16384
Mvaa 4,252,192
Ta 242,241,24576
Mvaa 12,252,196
Ta 244,242,16384
WL 5
Mvva 16,212,192
Ta 246,242,24576
DD 129,16,36,1024
Mvva 24,212,196
Ta 248,243,16384
Mvva 20,216,192
Ta 250,243,24576
Mvva 28,216,196
Ta 252,236,16640
WL 5
Mvva 32,220,192
Ta 254,236,24832
Mvva 40,220,196
Tv 212,237,16640
Mvaa 36,240,192
Tv 214,237,24832
Mvaa 44,240,196
Tv 216,238,16640
WL 5
Mvaa 48,244,192
Tv 218,238,24832
DD 130,16,36,2048
Mvaa 56,244,196
Tv 220,239,16640
Mvaa 52,248,192
Tv 222,239,24832
Mvaa 60,248,196
Ta 240,240,16640
WL 5
Mvaa 64,252,192
Ta 242,240,24832
Mvaa 72,252,196
Ta 244,241,16640
Mvva 68,212,192
Ta 246,241,24832
Mvva 76,212,196
Ta 248,242,16640
WL 5
Mvva 80,216,192
Ta 250,242,24832
DD 131,16,36,3072
Mvva 88,216,196
Ta 252,243,16640
Mvva 84,220,192
Ta 254,243,24832
Mvva 92,220,196
WL 4
Mvaa 96,240,192
Mvaa 104,240,196
Mvaa 100,244,192
Mvaa 108,244,196
s_waitcnt vmcnt(8) lgkmcnt(0)
s_barrier
Tv 212,236,32768
Mvaa 112,248,192
Tv 214,236,40960
Tv 216,237,32768
Tv 218,237,40960
Tv 220,238,32768
Tv 222,238,40960
Mvaa 120,248,196
Ta 240,239,32768
Mvaa 116,252,192
Ta 242,239,40960
s_add_u32 m0, s98, 114688
s_lshl_b32 s36, s46, 12
s_add_u32 s36, s36, s99
DD 128,16,36,0
Mvaa 124,252,196
Ta 244,240,32768
WL 5
Mvva 0,212,200
Ta 246,240,40960
Mvva 8,212,204
Ta 248,241,32768
Mvva 4,216,200
Ta 250,241,40960
Mvva 12,216,204
Ta 252,242,32768
WL 5
Mvva 16,220,200
Ta 254,242,40960
DD 129,16,36,1024
Mvva 24,220,204
Tv 212,243,32768
Mvaa 20,240,200
Tv 214,243,40960
Mvaa 28,240,204
Tv 216,236,33024
WL 5
Mvaa 32,244,200
Tv 218,236,41216
Mvaa 40,244,204
Tv 220,237,33024
Mvaa 36,248,200
Tv 222,237,41216
Mvaa 44,248,204
Ta 240,238,33024
WL 5
Mvaa 48,252,200
Ta 242,238,41216
DD 130,16,36,2048
Mvaa 56,252,204
Ta 244,239,33024
Mvva 52,212,200
Ta 246,239,41216
Mvva 60,212,204
Ta 248,240,33024
WL 5
Mvva 64,216,200
Ta 250,240,41216
Mvva 72,216,204
Ta 252,241,33024
Mvva 68,220,200
Ta 254,241,41216
Mvva 76,220,204
Tv 212,242,33024
WL 5
Mvaa 80,240,200
Tv 214,242,41216
DD 131,16,36,3072
Mvaa 88,240,204
Tv 216,243,33024
Mvaa 84,244,200
Tv 218,243,41216
Mvaa 92,244,204
WL 4
Mvaa 96,248,200
Mvaa 104,248,204
Mvaa 100,252,200
Mvaa 108,252,204
s_waitcnt vmcnt(8) lgkmcnt(0)
s_barrier
Tv 220,236,49152
Mvva 112,212,200
Tv 222,236,57344
Ta 240,237,49152
Ta 242,237,57344
Ta 244,238,49152
Ta 246,238,57344
Mvva 120,212,204
Ta 248,239,49152
Mvva 116,216,200
Ta 250,239,57344
s_add_u32 m0, s98, 131072
s_lshl_b32 s36, s46, 12
s_add_u32 s36, s36, s99
s_add_u32 s36, s36, 262144
DD 128,16,36,0
Mvva 124,216,204
Ta 252,240,49152
WL 5
Mvva 0,220,208
Ta 254,240,57344
Mvva 8,220,212
Tv 212,241,49152
Mvaa 4,240,208
Tv 214,241,57344
Mvaa 12,240,212
Tv 216,242,49152
WL 5
Mvaa 16,244,208
Tv 218,242,57344
DD 129,16,36,1024
Mvaa 24,244,212
Tv 220,243,49152
Mvaa 20,248,208
Tv 222,243,57344
Mvaa 28,248,212
Ta 240,236,49408
WL 5
Mvaa 32,252,208
Ta 242,236,57600
Mvaa 40,252,212
Ta 244,237,49408
Mvva 36,212,208
Ta 246,237,57600
Mvva 44,212,212
Ta 248,238,49408
WL 5
Mvva 48,216,208
Ta 250,238,57600
DD 130,16,36,2048
Mvva 56,216,212
Ta 252,239,49408
Mvva 52,220,208
Ta 254,239,57600
Mvva 60,220,212
Tv 212,240,49408
WL 5
Mvaa 64,240,208
Tv 214,240,57600
Mvaa 72,240,212
Tv 216,241,49408
Mvaa 68,244,208
Tv 218,241,57600
Mvaa 76,244,212
Tv 220,242,49408
WL 5
Mvaa 80,248,208
Tv 222,242,57600
DD 131,16,36,3072
Mvaa 88,248,212
Ta 240,243,49408
Mvaa 84,252,208
Ta 242,243,57600
Mvaa 92,252,212
WL 4
Mvva 96,212,208
Mvva 104,212,212
Mvva 100,216,208
Mvva 108,216,212
s_waitcnt vmcnt(8) lgkmcnt(0)
s_barrier
Ta 244,236,0
Mvva 112,220,208
Ta 246,236,8192
Ta 248,237,0
Ta 250,237,8192
Ta 252,238,0
Ta 254,238,8192
Mvva 120,220,212
Tv 212,239,0
Mvaa 116,240,208
Tv 214,239,8192
Mvaa 124,240,212
Tv 216,240,0
WL 5
Mvaa 0,244,216
Tv 218,240,8192
Mvaa 8,244,220
Tv 220,241,0
Mvaa 4,248,216
Tv 222,241,8192
Mvaa 12,248,220
Ta 240,242,0
WL 5
Mvaa 16,252,216
Ta 242,242,8192
Mvaa 24,252,220
Ta 244,243,0
v_mbcnt_lo_u32_b32 v253, -1, 0
v_mbcnt_hi_u32_b32 v253, -1, v253
v_and_b32 v253, 31, v253
s_lshl_b32 s7, s58, 30
v_lshl_add_u32 v253, v253, 2, s7
v_mov_b32 v254, 0
s_lshl_b32 s5, s50, 7
s_add_u32 s5, s5, s62
buffer_store_dword v254, v253, s[28:31], s5 offen sc1
Mvva 20,212,216
Ta 246,243,8192
Mvva 28,212,220
Ta 248,236,256
WL 5
Mvva 32,216,216
Ta 250,236,8448
Mvva 40,216,220
Ta 252,237,256
Mvva 36,220,216
Ta 254,237,8448
Mvva 44,220,220
Tv 212,238,256
WL 5
Mvaa 48,240,216
Tv 214,238,8448
Mvaa 56,240,220
Tv 216,239,256
Mvaa 52,244,216
Tv 218,239,8448
Mvaa 60,244,220
Tv 220,240,256
WL 5
Mvaa 64,248,216
Tv 222,240,8448
Mvaa 72,248,220
Ta 240,241,256
Mvaa 68,252,216
Ta 242,241,8448
Mvaa 76,252,220
Ta 244,242,256
WL 5
Mvva 80,212,216
Ta 246,242,8448
Mvva 88,212,220
Ta 248,243,256
Mvva 84,216,216
Ta 250,243,8448
Mvva 92,216,220
WL 4
Mvva 96,220,216
Mvva 104,220,220
Mvaa 100,240,216
Mvaa 108,240,220
s_waitcnt vmcnt(5) lgkmcnt(0)
s_barrier
Ta 252,236,16384
Mvaa 112,244,216
Ta 254,236,24576
Tv 212,237,16384
Tv 214,237,24576
Tv 216,238,16384
Tv 218,238,24576
Mvaa 120,244,220
Tv 220,239,16384
Mvaa 116,248,216
Tv 222,239,24576
Mvaa 124,248,220
Ta 240,240,16384
WL 5
Mvaa 0,252,224
Ta 242,240,24576
Mvaa 8,252,228
Ta 244,241,16384
Mvva 4,212,224
Ta 246,241,24576
Mvva 12,212,228
Ta 248,242,16384
WL 5
Mvva 16,216,224
Ta 250,242,24576
Mvva 24,216,228
Ta 252,243,16384
Mvva 20,220,224
Ta 254,243,24576
Mvva 28,220,228
Tv 212,236,16640
WL 5
Mvaa 32,240,224
Tv 214,236,24832
Mvaa 40,240,228
Tv 216,237,16640
Mvaa 36,244,224
Tv 218,237,24832
Mvaa 44,244,228
Tv 220,238,16640
WL 5
Mvaa 48,248,224
Tv 222,238,24832
Mvaa 56,248,228
Ta 240,239,16640
Mvaa 52,252,224
Ta 242,239,24832
Mvaa 60,252,228
Ta 244,240,16640
WL 5
Mvva 64,212,224
Ta 246,240,24832
Mvva 72,212,228
Ta 248,241,16640
Mvva 68,216,224
Ta 250,241,24832
Mvva 76,216,228
Ta 252,242,16640
WL 5
Mvva 80,220,224
Ta 254,242,24832
Mvva 88,220,228
Tv 212,243,16640
Mvaa 84,240,224
Tv 214,243,24832
Mvaa 92,240,228
WL 4
Mvaa 96,244,224
Mvaa 104,244,228
Mvaa 100,248,224
Mvaa 108,248,228
s_waitcnt vmcnt(1) lgkmcnt(0)
s_barrier
Tv 216,236,32768
Mvaa 112,252,224
Tv 218,236,40960
Tv 220,237,32768
Tv 222,237,40960
Ta 240,238,32768
Ta 242,238,40960
Mvaa 120,252,228
Ta 244,239,32768
Mvva 116,212,224
Ta 246,239,40960
Mvva 124,212,228
Ta 248,240,32768
WL 5
Mvva 0,216,232
Ta 250,240,40960
Mvva 8,216,236
Ta 252,241,32768
Mvva 4,220,232
Ta 254,241,40960
Mvva 12,220,236
Tv 212,242,32768
WL 5
Mvaa 16,240,232
Tv 214,242,40960
Mvaa 24,240,236
Tv 216,243,32768
Mvaa 20,244,232
Tv 218,243,40960
Mvaa 28,244,236
WL 4
Mvaa 32,248,232
Mvaa 40,248,236
Ta 240,236,33024
Mvaa 36,252,232
Ta 242,236,41216
Mvaa 44,252,236
Ta 244,237,33024
CV 128,0,1
CV 129,2,3
WL 3
Mvva 48,212,232
Ta 246,237,41216
CV 130,4,5
CV 131,6,7
CV 132,8,9
Mvva 56,212,236
Ta 248,238,33024
CV 133,10,11
CV 134,12,13
Mvva 52,216,232
Ta 250,238,41216
CV 135,14,15
v_permlane32_swap_b32 v128, v130
Mvva 60,216,236
Ta 252,239,33024
v_permlane32_swap_b32 v129, v131
v_permlane16_swap_b32 v128, v130
WL 3
Mvaa 64,240,232
Ta 254,239,41216
v_permlane16_swap_b32 v129, v131
v_permlane32_swap_b32 v132, v134
v_permlane32_swap_b32 v133, v135
Mvaa 72,240,236
Ta 240,240,33024
v_permlane16_swap_b32 v132, v134
v_permlane16_swap_b32 v133, v135
Mvaa 68,244,232
Ta 242,240,41216
CV 136,16,17
CV 137,18,19
CV 138,20,21
Mvaa 76,244,236
Ta 244,241,33024
CV 139,22,23
CV 140,24,25
CV 141,26,27
WL 3
Mvaa 80,248,232
Ta 246,241,41216
CV 142,28,29
CV 143,30,31
Mvaa 88,248,236
Ta 248,242,33024
v_permlane32_swap_b32 v136, v138
v_permlane32_swap_b32 v137, v139
s_nop 0
v_permlane16_swap_b32 v136, v138
Mvaa 84,252,232
Ta 250,242,41216
v_permlane16_swap_b32 v137, v139
v_permlane32_swap_b32 v140, v142
v_permlane32_swap_b32 v141, v143
Mvaa 92,252,236
Ta 252,243,33024
v_permlane16_swap_b32 v140, v142
v_permlane16_swap_b32 v141, v143
WL 3
Mvaa 96,240,232
Ta 254,243,41216
CV 144,32,33
CV 145,34,35
CV 146,36,37
Mvaa 104,240,236
CV 147,38,39
CV 148,40,41
CV 149,42,43
Mvaa 100,244,232
CV 150,44,45
CV 151,46,47
v_permlane32_swap_b32 v144, v146
v_permlane32_swap_b32 v145, v147
Mvaa 108,244,236
WL 0
s_barrier
Ba 240,224,0
Ba 244,224,8192
Mvaa 112,248,232
v_permlane16_swap_b32 v144, v146
v_permlane16_swap_b32 v145, v147
v_permlane32_swap_b32 v148, v150
v_permlane32_swap_b32 v149, v151
Mvaa 120,248,236
Ba 248,225,0
v_permlane16_swap_b32 v148, v150
v_permlane16_swap_b32 v149, v151
Mvaa 116,252,232
CV 152,48,49
CV 153,50,51
CV 154,52,53
Mvaa 124,252,236
Ba 252,225,8192
CV 155,54,55
CV 156,56,57
WL 2
v_mfma_f32_16x16x32_bf16 v[192:195], a[240:243], v[128:131], 0
CV 157,58,59
CV 158,60,61
CV 159,62,63
v_permlane32_swap_b32 v152, v154
v_mfma_f32_16x16x32_bf16 v[200:203], a[240:243], v[132:135], 0
Ba 240,226,0
v_permlane32_swap_b32 v153, v155
v_permlane16_swap_b32 v152, v154
v_mfma_f32_16x16x32_bf16 v[196:199], a[244:247], v[128:131], 0
v_permlane16_swap_b32 v153, v155
v_permlane32_swap_b32 v156, v158
v_permlane32_swap_b32 v157, v159
v_mfma_f32_16x16x32_bf16 v[204:207], a[244:247], v[132:135], 0
Ba 244,226,8192
v_permlane16_swap_b32 v156, v158
v_permlane16_swap_b32 v157, v159
WL 2
Mvav 192,248,136
CV 160,64,65
CV 161,66,67
CV 162,68,69
Mvav 200,248,140
Ba 248,227,0
CV 163,70,71
CV 164,72,73
Mvav 196,252,136
CV 165,74,75
CV 166,76,77
CV 167,78,79
v_permlane32_swap_b32 v160, v162
Mvav 204,252,140
Ba 252,227,8192
v_permlane32_swap_b32 v161, v163
v_permlane16_swap_b32 v160, v162
WL 2
Mvav 192,240,144
v_permlane16_swap_b32 v161, v163
v_permlane32_swap_b32 v164, v166
v_permlane32_swap_b32 v165, v167
Mvav 200,240,148
Ba 240,224,256
v_permlane16_swap_b32 v164, v166
v_permlane16_swap_b32 v165, v167
Mvav 196,244,144
CV 168,80,81
CV 169,82,83
CV 170,84,85
Mvav 204,244,148
Ba 244,224,8448
CV 171,86,87
CV 172,88,89
WL 2
Mvav 192,248,152
CV 173,90,91
CV 174,92,93
CV 175,94,95
v_permlane32_swap_b32 v168, v170
Mvav 200,248,156
Ba 248,225,256
v_permlane32_swap_b32 v169, v171
v_permlane16_swap_b32 v168, v170
Mvav 196,252,152
v_permlane16_swap_b32 v169, v171
v_permlane32_swap_b32 v172, v174
v_permlane32_swap_b32 v173, v175
Mvav 204,252,156
Ba 252,225,8448
v_permlane16_swap_b32 v172, v174
v_permlane16_swap_b32 v173, v175
WL 2
Mvav 192,240,160
CV 176,96,97
CV 177,98,99
CV 178,100,101
Mvav 200,240,164
Ba 240,226,256
CV 179,102,103
CV 180,104,105
Mvav 196,244,160
CV 181,106,107
CV 182,108,109
CV 183,110,111
v_permlane32_swap_b32 v176, v178
Mvav 204,244,164
Ba 244,226,8448
v_permlane32_swap_b32 v177, v179
v_permlane16_swap_b32 v176, v178
WL 2
Mvav 192,248,168
v_permlane16_swap_b32 v177, v179
v_permlane32_swap_b32 v180, v182
v_permlane32_swap_b32 v181, v183
Mvav 200,248,172
Ba 248,227,256
v_permlane16_swap_b32 v180, v182
v_permlane16_swap_b32 v181, v183
CV 184,112,113
Mvav 196,252,168
CV 185,114,115
CV 186,116,117
CV 187,118,119
CV 188,120,121
Mvav 204,252,172
Ba 252,227,8448
CV 189,122,123
CV 190,124,125
CV 191,126,127
WL 2
Mvav 192,240,176
v_permlane32_swap_b32 v184, v186
v_permlane32_swap_b32 v185, v187
s_nop 0
v_permlane16_swap_b32 v184, v186
v_permlane16_swap_b32 v185, v187
Mvav 200,240,180
v_permlane32_swap_b32 v188, v190
v_permlane32_swap_b32 v189, v191
s_nop 0
v_permlane16_swap_b32 v188, v190
v_permlane16_swap_b32 v189, v191
Mvav 196,244,176
Mvav 204,244,180
WL 0
s_barrier
Ba 240,224,16384
Ba 244,224,24576
Mvav 192,248,184
Mvav 200,248,188
Ba 248,225,16384
Mvav 196,252,184
Mvav 204,252,188
Ba 252,225,24576
WL 2
v_mfma_f32_16x16x32_bf16 v[208:211], a[240:243], v[128:131], 0
v_mfma_f32_16x16x32_bf16 v[216:219], a[240:243], v[132:135], 0
Ba 240,226,16384
v_mfma_f32_16x16x32_bf16 v[212:215], a[244:247], v[128:131], 0
v_mfma_f32_16x16x32_bf16 v[220:223], a[244:247], v[132:135], 0
Ba 244,226,24576
v_mul_f32 v192, s37, v192
v_mul_f32 v193, s37, v193
v_mul_f32 v194, s37, v194
WL 2
Mvav 208,248,136
v_mul_f32 v195, s37, v195
v_mul_f32 v196, s37, v196
v_mul_f32 v197, s37, v197
v_mul_f32 v198, s37, v198
Mvav 216,248,140
Ba 248,227,16384
v_mbcnt_lo_u32_b32 v253, -1, 0
v_mbcnt_hi_u32_b32 v253, -1, v253
s_lshl_b32 s7, s58, 30
v_lshl_add_u32 v253, v253, 12, s7
v_mov_b32 v254, 1
s_lshr_b32 s5, s2, 3
s_lshl_b32 s5, s5, 2
s_waitcnt vmcnt(0)
buffer_atomic_add v254, v253, s[52:55], s5 offen offset:128 sc1
Mvav 212,252,136
v_mul_f32 v199, s37, v199
v_mul_f32 v200, s37, v200
v_mul_f32 v201, s37, v201
v_mul_f32 v202, s37, v202
v_mul_f32 v203, s37, v203
Mvav 220,252,140
Ba 252,227,24576
v_mul_f32 v204, s37, v204
v_mul_f32 v205, s37, v205
v_mul_f32 v206, s37, v206
WL 2
Mvav 208,240,144
v_mul_f32 v207, s37, v207
v_max3_f32 v245, v192, v193, v194
v_max3_f32 v245, v245, v195, v196
v_max3_f32 v245, v245, v197, v198
Mvav 216,240,148
Ba 240,224,16640
v_max_f32 v245, v245, v199
v_mov_b32 v251, v245
s_nop 1
v_permlane32_swap_b32 v245, v251
Mvav 212,244,144
v_max_f32 v245, v245, v251
v_mov_b32 v251, v245
s_nop 1
v_permlane16_swap_b32 v245, v251
v_max_f32 v245, v245, v251
v_max3_f32 v246, v200, v201, v202
Mvav 220,244,148
Ba 244,224,24832
v_max3_f32 v246, v246, v203, v204
v_max3_f32 v246, v246, v205, v206
v_max_f32 v246, v246, v207
WL 2
Mvav 208,248,152
v_mov_b32 v251, v246
s_nop 1
v_permlane32_swap_b32 v246, v251
v_max_f32 v246, v246, v251
v_mov_b32 v251, v246
Mvav 216,248,156
Ba 248,225,16640
v_permlane16_swap_b32 v246, v251
v_max_f32 v246, v246, v251
v_sub_f32 v192, v192, v245
Mvav 212,252,152
v_sub_f32 v200, v200, v246
v_sub_f32 v193, v193, v245
v_sub_f32 v201, v201, v246
v_sub_f32 v194, v194, v245
v_sub_f32 v202, v202, v246
Mvav 220,252,156
Ba 252,225,24832
v_sub_f32 v195, v195, v245
v_sub_f32 v203, v203, v246
v_sub_f32 v196, v196, v245
WL 2
Mvav 208,240,160
v_sub_f32 v204, v204, v246
v_sub_f32 v197, v197, v245
v_sub_f32 v205, v205, v246
v_sub_f32 v198, v198, v245
Mvav 216,240,164
Ba 240,226,16640
v_sub_f32 v206, v206, v246
v_sub_f32 v199, v199, v245
v_sub_f32 v207, v207, v246
Mvav 212,244,160
Mvav 220,244,164
Ba 244,226,24832
v_exp_f32 v192, v192
v_exp_f32 v200, v200
v_mov_b32 v247, v192
WL 2
Mvav 208,248,168
v_exp_f32 v193, v193
v_mov_b32 v248, v200
v_exp_f32 v201, v201
v_add_f32 v247, v247, v193
Mvav 216,248,172
Ba 248,227,16640
CV 192,192,193
v_exp_f32 v194, v194
v_add_f32 v248, v248, v201
Mvav 212,252,168
CV 200,200,201
v_exp_f32 v202, v202
v_add_f32 v247, v247, v194
v_exp_f32 v195, v195
Mvav 220,252,172
Ba 252,227,24832
v_add_f32 v248, v248, v202
v_exp_f32 v203, v203
v_add_f32 v247, v247, v195
CV 193,194,195
WL 2
Mvav 208,240,176
v_exp_f32 v196, v196
v_add_f32 v248, v248, v203
CV 201,202,203
v_exp_f32 v204, v204
Mvav 216,240,180
v_add_u32 v228, 0xffff0000, v228
v_add_u32 v229, 0xffff0000, v229
v_add_u32 v230, 0xffff0000, v230
v_add_u32 v231, 0xffff0000, v231
v_add_u32 v232, 0xffff0000, v232
v_add_u32 v233, 0xffff0000, v233
v_add_u32 v234, 0xffff0000, v234
v_add_u32 v235, 0xffff0000, v235
Ta 240,228,32768
v_add_f32 v247, v247, v196
v_exp_f32 v197, v197
v_add_f32 v248, v248, v204
Mvav 212,244,176
Ta 242,228,40960
v_exp_f32 v205, v205
v_add_f32 v247, v247, v197
CV 194,196,197
v_exp_f32 v198, v198
Mvav 220,244,180
Ta 244,229,32768
v_add_f32 v248, v248, v205
CV 202,204,205
v_exp_f32 v206, v206
WL 3
Mvav 208,248,184
Ta 246,229,40960
v_add_f32 v247, v247, v198
v_exp_f32 v199, v199
v_add_f32 v248, v248, v206
v_exp_f32 v207, v207
Mvav 216,248,188
Ta 248,230,32768
v_add_f32 v247, v247, v199
CV 195,198,199
v_add_f32 v248, v248, v207
CV 203,206,207
Mvav 212,252,184
Ta 250,230,40960
Mvav 220,252,188
Ta 252,231,32768
WL 3
v_mfma_f32_16x16x32_bf16 v[0:3], a[240:243], v[192:195], 0
Ta 254,231,40960
v_mfma_f32_16x16x32_bf16 v[8:11], a[240:243], v[200:203], 0
Ta 240,232,32768
v_mfma_f32_16x16x32_bf16 v[4:7], a[244:247], v[192:195], 0
Ta 242,232,40960
v_mfma_f32_16x16x32_bf16 v[12:15], a[244:247], v[200:203], 0
Ta 244,233,32768
v_fma_f32 v208, v208, s37, -v245
WL 3
v_mfma_f32_16x16x32_bf16 v[16:19], a[248:251], v[192:195], 0
Ta 246,233,40960
v_fma_f32 v209, v209, s37, -v245
v_fma_f32 v210, v210, s37, -v245
v_mfma_f32_16x16x32_bf16 v[24:27], a[248:251], v[200:203], 0
Ta 248,234,32768
v_fma_f32 v211, v211, s37, -v245
v_mfma_f32_16x16x32_bf16 v[20:23], a[252:255], v[192:195], 0
Ta 250,234,40960
v_fma_f32 v212, v212, s37, -v245
v_mfma_f32_16x16x32_bf16 v[28:31], a[252:255], v[200:203], 0
Ta 252,235,32768
v_fma_f32 v213, v213, s37, -v245
WL 3
v_mfma_f32_16x16x32_bf16 v[32:35], a[240:243], v[192:195], 0
Ta 254,235,40960
v_max3_f32 v251, v208, v209, v210
v_fma_f32 v214, v214, s37, -v245
v_mfma_f32_16x16x32_bf16 v[40:43], a[240:243], v[200:203], 0
Ta 240,228,33024
v_fma_f32 v215, v215, s37, -v245
v_mfma_f32_16x16x32_bf16 v[36:39], a[244:247], v[192:195], 0
Ta 242,228,41216
v_max3_f32 v252, v211, v212, v213
v_mfma_f32_16x16x32_bf16 v[44:47], a[244:247], v[200:203], 0
Ta 244,229,33024
v_fma_f32 v216, v216, s37, -v246
WL 3
v_mfma_f32_16x16x32_bf16 v[48:51], a[248:251], v[192:195], 0
Ta 246,229,41216
v_fma_f32 v217, v217, s37, -v246
v_max3_f32 v251, v251, v214, v215
v_mfma_f32_16x16x32_bf16 v[56:59], a[248:251], v[200:203], 0
Ta 248,230,33024
v_fma_f32 v218, v218, s37, -v246
v_mfma_f32_16x16x32_bf16 v[52:55], a[252:255], v[192:195], 0
Ta 250,230,41216
v_fma_f32 v219, v219, s37, -v246
v_mfma_f32_16x16x32_bf16 v[60:63], a[252:255], v[200:203], 0
Ta 252,231,33024
v_max3_f32 v252, v252, v216, v217
WL 3
v_mfma_f32_16x16x32_bf16 v[64:67], a[240:243], v[192:195], 0
Ta 254,231,41216
v_fma_f32 v220, v220, s37, -v246
v_fma_f32 v221, v221, s37, -v246
v_mfma_f32_16x16x32_bf16 v[72:75], a[240:243], v[200:203], 0
Ta 240,232,33024
v_max3_f32 v251, v251, v218, v219
v_mfma_f32_16x16x32_bf16 v[68:71], a[244:247], v[192:195], 0
Ta 242,232,41216
v_fma_f32 v222, v222, s37, -v246
v_mfma_f32_16x16x32_bf16 v[76:79], a[244:247], v[200:203], 0
Ta 244,233,33024
v_fma_f32 v223, v223, s37, -v246
WL 3
v_mfma_f32_16x16x32_bf16 v[80:83], a[248:251], v[192:195], 0
Ta 246,233,41216
v_max3_f32 v252, v252, v220, v221
v_max3_f32 v251, v251, v222, v223
v_mfma_f32_16x16x32_bf16 v[88:91], a[248:251], v[200:203], 0
Ta 248,234,33024
v_max_f32 v251, v251, v252
v_mfma_f32_16x16x32_bf16 v[84:87], a[252:255], v[192:195], 0
Ta 250,234,41216
v_cmp_lt_f32 vcc, s38, v251
v_mfma_f32_16x16x32_bf16 v[92:95], a[252:255], v[200:203], 0
Ta 252,235,33024
s_cbranch_vccnz LA_ra1
LA_rb1:
WL 3
v_mfma_f32_16x16x32_bf16 v[96:99], a[240:243], v[192:195], 0
Ta 254,235,41216
v_mfma_f32_16x16x32_bf16 v[104:107], a[240:243], v[200:203], 0
v_exp_f32 v208, v208
v_mfma_f32_16x16x32_bf16 v[100:103], a[244:247], v[192:195], 0
v_exp_f32 v216, v216
v_mfma_f32_16x16x32_bf16 v[108:111], a[244:247], v[200:203], 0
WL 0
s_barrier
v_add_u32 v224, 0x10000, v224
v_add_u32 v225, 0x10000, v225
v_add_u32 v226, 0x10000, v226
v_add_u32 v227, 0x10000, v227
Ba 240,224,0
Ba 244,224,8192
v_mfma_f32_16x16x32_bf16 v[112:115], a[248:251], v[192:195], 0
v_add_f32 v247, v247, v208
v_exp_f32 v209, v209
v_mfma_f32_16x16x32_bf16 v[120:123], a[248:251], v[200:203], 0
Ba 248,225,0
v_mfma_f32_16x16x32_bf16 v[116:119], a[252:255], v[192:195], 0
v_add_f32 v248, v248, v216
v_exp_f32 v217, v217
v_mfma_f32_16x16x32_bf16 v[124:127], a[252:255], v[200:203], 0
Ba 252,225,8192
s_cmp_lg_u32 s49, 0
s_cbranch_scc1 LA_ra2
LA_rb2:
WL 2
v_mfma_f32_16x16x32_bf16 v[192:195], a[240:243], v[128:131], 0
v_add_f32 v247, v247, v209
CV 208,208,209
v_mfma_f32_16x16x32_bf16 v[200:203], a[240:243], v[132:135], 0
Ba 240,226,0
v_exp_f32 v210, v210
v_mfma_f32_16x16x32_bf16 v[196:199], a[244:247], v[128:131], 0
v_add_f32 v248, v248, v217
v_mfma_f32_16x16x32_bf16 v[204:207], a[244:247], v[132:135], 0
Ba 244,226,8192
CV 216,216,217
WL 2
Mvav 192,248,136
v_exp_f32 v218, v218
v_add_f32 v247, v247, v210
Mvav 200,248,140
Ba 248,227,0
Mvav 196,252,136
v_exp_f32 v211, v211
v_add_f32 v248, v248, v218
Mvav 204,252,140
Ba 252,227,8192
WL 2
Mvav 192,240,144
v_exp_f32 v219, v219
v_add_f32 v247, v247, v211
Mvav 200,240,148
Ba 240,224,256
CV 209,210,211
Mvav 196,244,144
v_exp_f32 v212, v212
Mvav 204,244,148
Ba 244,224,8448
v_add_f32 v248, v248, v219
WL 2
Mvav 192,248,152
CV 217,218,219
v_exp_f32 v220, v220
Mvav 200,248,156
Ba 248,225,256
Mvav 196,252,152
v_add_f32 v247, v247, v212
v_exp_f32 v213, v213
Mvav 204,252,156
Ba 252,225,8448
v_add_f32 v248, v248, v220
WL 2
Mvav 192,240,160
v_exp_f32 v221, v221
Mvav 200,240,164
Ba 240,226,256
v_add_f32 v247, v247, v213
Mvav 196,244,160
CV 210,212,213
v_exp_f32 v214, v214
Mvav 204,244,164
Ba 244,226,8448
WL 2
Mvav 192,248,168
v_add_f32 v248, v248, v221
CV 218,220,221
Mvav 200,248,172
Ba 248,227,256
v_exp_f32 v222, v222
Mvav 196,252,168
v_add_f32 v247, v247, v214
Mvav 204,252,172
Ba 252,227,8448
v_exp_f32 v215, v215
WL 2
Mvav 192,240,176
v_add_f32 v248, v248, v222
Mvav 200,240,180
Ta 240,228,49152
v_exp_f32 v223, v223
Mvav 196,244,176
Ta 242,228,57344
v_add_f32 v247, v247, v215
Mvav 204,244,180
Ta 244,229,49152
CV 211,214,215
WL 3
Mvav 192,248,184
Ta 246,229,57344
v_add_f32 v248, v248, v223
Mvav 200,248,188
Ta 248,230,49152
CV 219,222,223
Mvav 196,252,184
Ta 250,230,57344
Mvav 204,252,188
Ta 252,231,49152
WL 3
Mvav 0,240,208
Ta 254,231,57344
Mvav 8,240,216
Ta 240,232,49152
Mvav 4,244,208
Ta 242,232,57344
Mvav 12,244,216
Ta 244,233,49152
v_fma_f32 v192, v192, s37, -v245
WL 3
Mvav 16,248,208
Ta 246,233,57344
v_fma_f32 v193, v193, s37, -v245
Mvav 24,248,216
Ta 248,234,49152
v_fma_f32 v194, v194, s37, -v245
Mvav 20,252,208
Ta 250,234,57344
v_fma_f32 v195, v195, s37, -v245
Mvav 28,252,216
Ta 252,235,49152
v_fma_f32 v196, v196, s37, -v245
WL 3
Mvav 32,240,208
Ta 254,235,57344
v_fma_f32 v197, v197, s37, -v245
Mvav 40,240,216
Ta 240,228,49408
v_max3_f32 v251, v192, v193, v194
Mvav 36,244,208
Ta 242,228,57600
v_fma_f32 v198, v198, s37, -v245
Mvav 44,244,216
Ta 244,229,49408
v_fma_f32 v199, v199, s37, -v245
WL 3
Mvav 48,248,208
Ta 246,229,57600
v_max3_f32 v252, v195, v196, v197
Mvav 56,248,216
Ta 248,230,49408
Mvav 52,252,208
Ta 250,230,57600
v_fma_f32 v200, v200, s37, -v246
v_fma_f32 v201, v201, s37, -v246
Mvav 60,252,216
Ta 252,231,49408
WL 3
Mvav 64,240,208
Ta 254,231,57600
v_max3_f32 v251, v251, v198, v199
v_fma_f32 v202, v202, s37, -v246
Mvav 72,240,216
Ta 240,232,49408
Mvav 68,244,208
Ta 242,232,57600
v_fma_f32 v203, v203, s37, -v246
v_max3_f32 v252, v252, v200, v201
Mvav 76,244,216
Ta 244,233,49408
WL 3
Mvav 80,248,208
Ta 246,233,57600
v_fma_f32 v204, v204, s37, -v246
v_fma_f32 v205, v205, s37, -v246
Mvav 88,248,216
Ta 248,234,49408
Mvav 84,252,208
Ta 250,234,57600
v_max3_f32 v251, v251, v202, v203
Mvav 92,252,216
Ta 252,235,49408
v_fma_f32 v206, v206, s37, -v246
WL 3
Mvav 96,240,208
Ta 254,235,57600
v_fma_f32 v207, v207, s37, -v246
Mvav 104,240,216
Ta 240,236,32768
v_max3_f32 v252, v252, v204, v205
Mvav 100,244,208
Ta 242,236,40960
v_max3_f32 v251, v251, v206, v207
Mvav 108,244,216
Ta 244,237,32768
v_max_f32 v251, v251, v252
WL 3
Mvav 112,248,208
Ta 246,237,40960
v_cmp_lt_f32 vcc, s38, v251
Mvav 120,248,216
Ta 248,238,32768
s_cbranch_vccnz LA_ra3
LA_rb3:
Mvav 116,252,208
Ta 250,238,40960
Mvav 124,252,216
Ta 252,239,32768
s_cmp_lg_u32 s49, 0
s_cbranch_scc1 LA_ra4
LA_rb4:
WL 3
v_mfma_f32_16x16x32_bf16 a[0:3], a[240:243], a[128:131], 0
Ta 254,239,40960
v_mfma_f32_16x16x32_bf16 a[8:11], a[240:243], a[132:135], 0
Ta 240,240,32768
v_exp_f32 v192, v192
v_mfma_f32_16x16x32_bf16 a[4:7], a[244:247], a[128:131], 0
Ta 242,240,40960
v_mfma_f32_16x16x32_bf16 a[12:15], a[244:247], a[132:135], 0
Ta 244,241,32768
WL 3
v_mfma_f32_16x16x32_bf16 a[16:19], a[248:251], a[128:131], 0
Ta 246,241,40960
v_exp_f32 v200, v200
v_mfma_f32_16x16x32_bf16 a[24:27], a[248:251], a[132:135], 0
Ta 248,242,32768
v_mfma_f32_16x16x32_bf16 a[20:23], a[252:255], a[128:131], 0
Ta 250,242,40960
v_add_f32 v247, v247, v192
v_mfma_f32_16x16x32_bf16 a[28:31], a[252:255], a[132:135], 0
Ta 252,243,32768
WL 3
v_mfma_f32_16x16x32_bf16 a[32:35], a[240:243], a[128:131], 0
Ta 254,243,40960
v_mfma_f32_16x16x32_bf16 a[40:43], a[240:243], a[132:135], 0
Ta 240,236,33024
v_exp_f32 v193, v193
v_mfma_f32_16x16x32_bf16 a[36:39], a[244:247], a[128:131], 0
Ta 242,236,41216
v_mfma_f32_16x16x32_bf16 a[44:47], a[244:247], a[132:135], 0
Ta 244,237,33024
v_add_f32 v248, v248, v200
WL 3
v_mfma_f32_16x16x32_bf16 a[48:51], a[248:251], a[128:131], 0
Ta 246,237,41216
v_mfma_f32_16x16x32_bf16 a[56:59], a[248:251], a[132:135], 0
Ta 248,238,33024
v_mfma_f32_16x16x32_bf16 a[52:55], a[252:255], a[128:131], 0
Ta 250,238,41216
v_exp_f32 v201, v201
v_mfma_f32_16x16x32_bf16 a[60:63], a[252:255], a[132:135], 0
Ta 252,239,33024
WL 3
v_mfma_f32_16x16x32_bf16 a[64:67], a[240:243], a[128:131], 0
Ta 254,239,41216
v_add_f32 v247, v247, v193
v_mfma_f32_16x16x32_bf16 a[72:75], a[240:243], a[132:135], 0
Ta 240,240,33024
v_mfma_f32_16x16x32_bf16 a[68:71], a[244:247], a[128:131], 0
Ta 242,240,41216
CV 192,192,193
v_mfma_f32_16x16x32_bf16 a[76:79], a[244:247], a[132:135], 0
Ta 244,241,33024
WL 3
v_mfma_f32_16x16x32_bf16 a[80:83], a[248:251], a[128:131], 0
Ta 246,241,41216
v_exp_f32 v194, v194
v_mfma_f32_16x16x32_bf16 a[88:91], a[248:251], a[132:135], 0
Ta 248,242,33024
v_mfma_f32_16x16x32_bf16 a[84:87], a[252:255], a[128:131], 0
Ta 250,242,41216
v_add_f32 v248, v248, v201
v_mfma_f32_16x16x32_bf16 a[92:95], a[252:255], a[132:135], 0
Ta 252,243,33024
WL 3
v_mfma_f32_16x16x32_bf16 a[96:99], a[240:243], a[128:131], 0
Ta 254,243,41216
CV 200,200,201
v_mfma_f32_16x16x32_bf16 a[104:107], a[240:243], a[132:135], 0
v_exp_f32 v202, v202
v_mfma_f32_16x16x32_bf16 a[100:103], a[244:247], a[128:131], 0
v_add_f32 v247, v247, v194
v_mfma_f32_16x16x32_bf16 a[108:111], a[244:247], a[132:135], 0
WL 0
s_barrier
Ba 240,224,16384
Ba 244,224,24576
v_mfma_f32_16x16x32_bf16 a[112:115], a[248:251], a[128:131], 0
v_exp_f32 v195, v195
v_mfma_f32_16x16x32_bf16 a[120:123], a[248:251], a[132:135], 0
Ba 248,225,16384
v_add_f32 v248, v248, v202
v_mfma_f32_16x16x32_bf16 a[116:119], a[252:255], a[128:131], 0
v_exp_f32 v203, v203
v_mfma_f32_16x16x32_bf16 a[124:127], a[252:255], a[132:135], 0
Ba 252,225,24576
WL 2
v_mfma_f32_16x16x32_bf16 v[208:211], a[240:243], v[128:131], 0
v_add_f32 v247, v247, v195
CV 193,194,195
v_mfma_f32_16x16x32_bf16 v[216:219], a[240:243], v[132:135], 0
Ba 240,226,16384
v_mfma_f32_16x16x32_bf16 v[212:215], a[244:247], v[128:131], 0
v_exp_f32 v196, v196
v_mfma_f32_16x16x32_bf16 v[220:223], a[244:247], v[132:135], 0
Ba 244,226,24576
WL 2
Mvav 208,248,136
v_add_f32 v248, v248, v203
CV 201,202,203
Mvav 216,248,140
Ba 248,227,16384
Mvav 212,252,136
v_exp_f32 v204, v204
v_add_f32 v247, v247, v196
Mvav 220,252,140
Ba 252,227,24576
WL 2
Mvav 208,240,144
v_exp_f32 v197, v197
Mvav 216,240,148
Ba 240,224,16640
Mvav 212,244,144
v_add_f32 v248, v248, v204
v_exp_f32 v205, v205
Mvav 220,244,148
Ba 244,224,24832
WL 2
Mvav 208,248,152
v_add_f32 v247, v247, v197
Mvav 216,248,156
Ba 248,225,16640
CV 194,196,197
Mvav 212,252,152
v_exp_f32 v198, v198
Mvav 220,252,156
Ba 252,225,24832
WL 2
Mvav 208,240,160
v_add_f32 v248, v248, v205
CV 202,204,205
Mvav 216,240,164
Ba 240,226,16640
Mvav 212,244,160
v_exp_f32 v206, v206
Mvav 220,244,164
Ba 244,226,24832
v_add_f32 v247, v247, v198
WL 2
Mvav 208,248,168
v_exp_f32 v199, v199
Mvav 216,248,172
Ba 248,227,16640
Mvav 212,252,168
v_add_f32 v248, v248, v206
Mvav 220,252,172
Ba 252,227,24832
v_exp_f32 v207, v207
WL 2
Mvav 208,240,176
v_add_f32 v247, v247, v199
Mvav 216,240,180
v_add_u32 v228, 0x18000, v228
v_add_u32 v229, 0x18000, v229
v_add_u32 v230, 0x18000, v230
v_add_u32 v231, 0x18000, v231
v_add_u32 v232, 0x18000, v232
v_add_u32 v233, 0x18000, v233
v_add_u32 v234, 0x18000, v234
v_add_u32 v235, 0x18000, v235
Ta 240,228,49152
Mvav 212,244,176
Ta 242,228,57344
CV 195,198,199
Mvav 220,244,180
Ta 244,229,49152
v_add_f32 v248, v248, v207
WL 3
Mvav 208,248,184
Ta 246,229,57344
CV 203,206,207
Mvav 216,248,188
Ta 248,230,49152
Mvav 212,252,184
Ta 250,230,57344
Mvav 220,252,188
Ta 252,231,49152
WL 3
Mvav 0,240,192
Ta 254,231,57344
Mvav 8,240,200
Ta 240,232,49152
Mvav 4,244,192
Ta 242,232,57344
Mvav 12,244,200
Ta 244,233,49152
v_fma_f32 v208, v208, s37, -v245
WL 3
Mvav 16,248,192
Ta 246,233,57344
v_fma_f32 v209, v209, s37, -v245
Mvav 24,248,200
Ta 248,234,49152
v_fma_f32 v210, v210, s37, -v245
Mvav 20,252,192
Ta 250,234,57344
v_fma_f32 v211, v211, s37, -v245
Mvav 28,252,200
Ta 252,235,49152
v_fma_f32 v212, v212, s37, -v245
WL 3
Mvav 32,240,192
Ta 254,235,57344
v_fma_f32 v213, v213, s37, -v245
Mvav 40,240,200
Ta 240,228,49408
v_max3_f32 v251, v208, v209, v210
Mvav 36,244,192
Ta 242,228,57600
v_fma_f32 v214, v214, s37, -v245
Mvav 44,244,200
Ta 244,229,49408
v_fma_f32 v215, v215, s37, -v245
WL 3
Mvav 48,248,192
Ta 246,229,57600
v_max3_f32 v252, v211, v212, v213
Mvav 56,248,200
Ta 248,230,49408
Mvav 52,252,192
Ta 250,230,57600
v_fma_f32 v216, v216, s37, -v246
v_fma_f32 v217, v217, s37, -v246
Mvav 60,252,200
Ta 252,231,49408
WL 3
Mvav 64,240,192
Ta 254,231,57600
v_max3_f32 v251, v251, v214, v215
v_fma_f32 v218, v218, s37, -v246
Mvav 72,240,200
Ta 240,232,49408
Mvav 68,244,192
Ta 242,232,57600
v_fma_f32 v219, v219, s37, -v246
v_max3_f32 v252, v252, v216, v217
Mvav 76,244,200
Ta 244,233,49408
WL 3
Mvav 80,248,192
Ta 246,233,57600
v_fma_f32 v220, v220, s37, -v246
v_fma_f32 v221, v221, s37, -v246
Mvav 88,248,200
Ta 248,234,49408
Mvav 84,252,192
Ta 250,234,57600
v_max3_f32 v251, v251, v218, v219
Mvav 92,252,200
Ta 252,235,49408
v_fma_f32 v222, v222, s37, -v246
WL 3
Mvav 96,240,192
Ta 254,235,57600
v_fma_f32 v223, v223, s37, -v246
Mvav 104,240,200
v_add_u32 v236, 0xfffe8000, v236
v_add_u32 v237, 0xfffe8000, v237
v_add_u32 v238, 0xfffe8000, v238
v_add_u32 v239, 0xfffe8000, v239
v_add_u32 v240, 0xfffe8000, v240
v_add_u32 v241, 0xfffe8000, v241
v_add_u32 v242, 0xfffe8000, v242
v_add_u32 v243, 0xfffe8000, v243
Ta 240,236,0
v_max3_f32 v252, v252, v220, v221
Mvav 100,244,192
Ta 242,236,8192
v_max3_f32 v251, v251, v222, v223
Mvav 108,244,200
Ta 244,237,0
v_max_f32 v251, v251, v252
WL 3
Mvav 112,248,192
Ta 246,237,8192
v_cmp_lt_f32 vcc, s38, v251
Mvav 120,248,200
Ta 248,238,0
s_cbranch_vccnz LA_ra5
LA_rb5:
Mvav 116,252,192
Ta 250,238,8192
Mvav 124,252,200
Ta 252,239,0
s_cmp_lg_u32 s49, 0
s_cbranch_scc1 LA_ra6
LA_rb6:
WL 3
Maaa 0,240,136
Ta 254,239,8192
Maaa 8,240,140
Ta 240,240,0
v_exp_f32 v208, v208
Maaa 4,244,136
Ta 242,240,8192
Maaa 12,244,140
Ta 244,241,0
WL 3
Maaa 16,248,136
Ta 246,241,8192
v_exp_f32 v216, v216
Maaa 24,248,140
Ta 248,242,0
Maaa 20,252,136
Ta 250,242,8192
v_add_f32 v247, v247, v208
Maaa 28,252,140
Ta 252,243,0
WL 3
Maaa 32,240,136
Ta 254,243,8192
Maaa 40,240,140
Ta 240,236,256
v_exp_f32 v209, v209
Maaa 36,244,136
Ta 242,236,8448
Maaa 44,244,140
Ta 244,237,256
v_add_f32 v248, v248, v216
WL 3
Maaa 48,248,136
Ta 246,237,8448
Maaa 56,248,140
Ta 248,238,256
Maaa 52,252,136
Ta 250,238,8448
v_exp_f32 v217, v217
Maaa 60,252,140
Ta 252,239,256
WL 3
Maaa 64,240,136
Ta 254,239,8448
v_add_f32 v247, v247, v209
Maaa 72,240,140
Ta 240,240,256
Maaa 68,244,136
Ta 242,240,8448
CV 208,208,209
Maaa 76,244,140
Ta 244,241,256
WL 3
Maaa 80,248,136
Ta 246,241,8448
v_exp_f32 v210, v210
Maaa 88,248,140
Ta 248,242,256
Maaa 84,252,136
Ta 250,242,8448
v_add_f32 v248, v248, v217
Maaa 92,252,140
Ta 252,243,256
WL 3
Maaa 96,240,136
Ta 254,243,8448
CV 216,216,217
Maaa 104,240,140
v_exp_f32 v218, v218
Maaa 100,244,136
v_add_f32 v247, v247, v210
Maaa 108,244,140
WL 0
s_barrier
Ba 240,224,32768
Ba 244,224,40960
Maaa 112,248,136
v_exp_f32 v211, v211
Maaa 120,248,140
Ba 248,225,32768
v_add_f32 v248, v248, v218
Maaa 116,252,136
v_exp_f32 v219, v219
Maaa 124,252,140
Ba 252,225,40960
WL 2
v_mfma_f32_16x16x32_bf16 v[192:195], a[240:243], v[128:131], 0
v_add_f32 v247, v247, v211
CV 209,210,211
v_mfma_f32_16x16x32_bf16 v[200:203], a[240:243], v[132:135], 0
Ba 240,226,32768
v_mfma_f32_16x16x32_bf16 v[196:199], a[244:247], v[128:131], 0
v_exp_f32 v212, v212
v_mfma_f32_16x16x32_bf16 v[204:207], a[244:247], v[132:135], 0
Ba 244,226,40960
WL 2
Mvav 192,248,136
v_add_f32 v248, v248, v219
CV 217,218,219
Mvav 200,248,140
Ba 248,227,32768
Mvav 196,252,136
v_exp_f32 v220, v220
v_add_f32 v247, v247, v212
Mvav 204,252,140
Ba 252,227,40960
WL 2
Mvav 192,240,144
v_exp_f32 v213, v213
Mvav 200,240,148
Ba 240,224,33024
Mvav 196,244,144
v_add_f32 v248, v248, v220
v_exp_f32 v221, v221
Mvav 204,244,148
Ba 244,224,41216
WL 2
Mvav 192,248,152
v_add_f32 v247, v247, v213
Mvav 200,248,156
Ba 248,225,33024
CV 210,212,213
Mvav 196,252,152
v_exp_f32 v214, v214
Mvav 204,252,156
Ba 252,225,41216
WL 2
Mvav 192,240,160
v_add_f32 v248, v248, v221
CV 218,220,221
Mvav 200,240,164
Ba 240,226,33024
Mvav 196,244,160
v_exp_f32 v222, v222
Mvav 204,244,164
Ba 244,226,41216
v_add_f32 v247, v247, v214
WL 2
Mvav 192,248,168
v_exp_f32 v215, v215
Mvav 200,248,172
Ba 248,227,33024
Mvav 196,252,168
v_add_f32 v248, v248, v222
Mvav 204,252,172
Ba 252,227,41216
v_exp_f32 v223, v223
WL 2
Mvav 192,240,176
v_add_f32 v247, v247, v215
Mvav 200,240,180
Ta 240,228,16384
Mvav 196,244,176
Ta 242,228,24576
CV 211,214,215
Mvav 204,244,180
Ta 244,229,16384
v_add_f32 v248, v248, v223
WL 3
Mvav 192,248,184
Ta 246,229,24576
CV 219,222,223
Mvav 200,248,188
Ta 248,230,16384
Mvav 196,252,184
Ta 250,230,24576
Mvav 204,252,188
Ta 252,231,16384
WL 3
Mvav 0,240,208
Ta 254,231,24576
Mvav 8,240,216
Ta 240,232,16384
Mvav 4,244,208
Ta 242,232,24576
Mvav 12,244,216
Ta 244,233,16384
v_fma_f32 v192, v192, s37, -v245
WL 3
Mvav 16,248,208
Ta 246,233,24576
v_fma_f32 v193, v193, s37, -v245
Mvav 24,248,216
Ta 248,234,16384
v_fma_f32 v194, v194, s37, -v245
Mvav 20,252,208
Ta 250,234,24576
v_fma_f32 v195, v195, s37, -v245
Mvav 28,252,216
Ta 252,235,16384
v_fma_f32 v196, v196, s37, -v245
WL 3
Mvav 32,240,208
Ta 254,235,24576
v_fma_f32 v197, v197, s37, -v245
Mvav 40,240,216
Ta 240,228,16640
v_max3_f32 v251, v192, v193, v194
Mvav 36,244,208
Ta 242,228,24832
v_fma_f32 v198, v198, s37, -v245
Mvav 44,244,216
Ta 244,229,16640
v_fma_f32 v199, v199, s37, -v245
WL 3
Mvav 48,248,208
Ta 246,229,24832
v_max3_f32 v252, v195, v196, v197
Mvav 56,248,216
Ta 248,230,16640
Mvav 52,252,208
Ta 250,230,24832
v_fma_f32 v200, v200, s37, -v246
v_fma_f32 v201, v201, s37, -v246
Mvav 60,252,216
Ta 252,231,16640
WL 3
Mvav 64,240,208
Ta 254,231,24832
v_max3_f32 v251, v251, v198, v199
v_fma_f32 v202, v202, s37, -v246
Mvav 72,240,216
Ta 240,232,16640
Mvav 68,244,208
Ta 242,232,24832
v_fma_f32 v203, v203, s37, -v246
v_max3_f32 v252, v252, v200, v201
Mvav 76,244,216
Ta 244,233,16640
WL 3
Mvav 80,248,208
Ta 246,233,24832
v_fma_f32 v204, v204, s37, -v246
v_fma_f32 v205, v205, s37, -v246
Mvav 88,248,216
Ta 248,234,16640
Mvav 84,252,208
Ta 250,234,24832
v_max3_f32 v251, v251, v202, v203
Mvav 92,252,216
Ta 252,235,16640
v_fma_f32 v206, v206, s37, -v246
WL 3
Mvav 96,240,208
Ta 254,235,24832
v_fma_f32 v207, v207, s37, -v246
Mvav 104,240,216
Ta 240,236,32768
v_max3_f32 v252, v252, v204, v205
Mvav 100,244,208
Ta 242,236,40960
v_max3_f32 v251, v251, v206, v207
Mvav 108,244,216
Ta 244,237,32768
v_max_f32 v251, v251, v252
WL 3
Mvav 112,248,208
Ta 246,237,40960
v_cmp_lt_f32 vcc, s38, v251
Mvav 120,248,216
Ta 248,238,32768
s_cbranch_vccnz LA_ra7
LA_rb7:
Mvav 116,252,208
Ta 250,238,40960
Mvav 124,252,216
Ta 252,239,32768
s_cmp_lg_u32 s49, 0
s_cbranch_scc1 LA_ra8
LA_rb8:
WL 3
Maaa 0,240,144
Ta 254,239,40960
Maaa 8,240,148
Ta 240,240,32768
v_exp_f32 v192, v192
Maaa 4,244,144
Ta 242,240,40960
Maaa 12,244,148
Ta 244,241,32768
WL 3
Maaa 16,248,144
Ta 246,241,40960
v_exp_f32 v200, v200
Maaa 24,248,148
Ta 248,242,32768
Maaa 20,252,144
Ta 250,242,40960
v_add_f32 v247, v247, v192
Maaa 28,252,148
Ta 252,243,32768
WL 3
Maaa 32,240,144
Ta 254,243,40960
Maaa 40,240,148
Ta 240,236,33024
v_exp_f32 v193, v193
Maaa 36,244,144
Ta 242,236,41216
Maaa 44,244,148
Ta 244,237,33024
v_add_f32 v248, v248, v200
WL 3
Maaa 48,248,144
Ta 246,237,41216
Maaa 56,248,148
Ta 248,238,33024
Maaa 52,252,144
Ta 250,238,41216
v_exp_f32 v201, v201
Maaa 60,252,148
Ta 252,239,33024
WL 3
Maaa 64,240,144
Ta 254,239,41216
v_add_f32 v247, v247, v193
Maaa 72,240,148
Ta 240,240,33024
Maaa 68,244,144
Ta 242,240,41216
CV 192,192,193
Maaa 76,244,148
Ta 244,241,33024
WL 3
Maaa 80,248,144
Ta 246,241,41216
v_exp_f32 v194, v194
Maaa 88,248,148
Ta 248,242,33024
Maaa 84,252,144
Ta 250,242,41216
v_add_f32 v248, v248, v201
Maaa 92,252,148
Ta 252,243,33024
WL 3
Maaa 96,240,144
Ta 254,243,41216
CV 200,200,201
Maaa 104,240,148
v_exp_f32 v202, v202
Maaa 100,244,144
v_add_f32 v247, v247, v194
Maaa 108,244,148
WL 0
s_barrier
v_add_u32 v224, 0xffff0000, v224
v_add_u32 v225, 0xffff0000, v225
v_add_u32 v226, 0xffff0000, v226
v_add_u32 v227, 0xffff0000, v227
Ba 240,224,16384
Ba 244,224,24576
Maaa 112,248,144
v_exp_f32 v195, v195
Maaa 120,248,148
Ba 248,225,16384
v_add_f32 v248, v248, v202
Maaa 116,252,144
v_exp_f32 v203, v203
Maaa 124,252,148
Ba 252,225,24576
WL 2
v_mfma_f32_16x16x32_bf16 v[208:211], a[240:243], v[128:131], 0
v_add_f32 v247, v247, v195
CV 193,194,195
v_mfma_f32_16x16x32_bf16 v[216:219], a[240:243], v[132:135], 0
Ba 240,226,16384
v_mfma_f32_16x16x32_bf16 v[212:215], a[244:247], v[128:131], 0
v_exp_f32 v196, v196
v_mfma_f32_16x16x32_bf16 v[220:223], a[244:247], v[132:135], 0
Ba 244,226,24576
WL 2
Mvav 208,248,136
v_add_f32 v248, v248, v203
CV 201,202,203
Mvav 216,248,140
Ba 248,227,16384
Mvav 212,252,136
v_exp_f32 v204, v204
v_add_f32 v247, v247, v196
Mvav 220,252,140
Ba 252,227,24576
WL 2
Mvav 208,240,144
v_exp_f32 v197, v197
Mvav 216,240,148
Ba 240,224,16640
Mvav 212,244,144
v_add_f32 v248, v248, v204
v_exp_f32 v205, v205
Mvav 220,244,148
Ba 244,224,24832
WL 2
Mvav 208,248,152
v_add_f32 v247, v247, v197
Mvav 216,248,156
Ba 248,225,16640
CV 194,196,197
Mvav 212,252,152
v_exp_f32 v198, v198
Mvav 220,252,156
Ba 252,225,24832
WL 2
Mvav 208,240,160
v_add_f32 v248, v248, v205
CV 202,204,205
Mvav 216,240,164
Ba 240,226,16640
Mvav 212,244,160
v_exp_f32 v206, v206
Mvav 220,244,164
Ba 244,226,24832
v_add_f32 v247, v247, v198
WL 2
Mvav 208,248,168
v_exp_f32 v199, v199
Mvav 216,248,172
Ba 248,227,16640
Mvav 212,252,168
v_add_f32 v248, v248, v206
Mvav 220,252,172
Ba 252,227,24832
v_exp_f32 v207, v207
WL 2
Mvav 208,240,176
v_add_f32 v247, v247, v199
Mvav 216,240,180
v_add_u32 v228, 0xffff8000, v228
v_add_u32 v229, 0xffff8000, v229
v_add_u32 v230, 0xffff8000, v230
v_add_u32 v231, 0xffff8000, v231
v_add_u32 v232, 0xffff8000, v232
v_add_u32 v233, 0xffff8000, v233
v_add_u32 v234, 0xffff8000, v234
v_add_u32 v235, 0xffff8000, v235
Ta 240,228,0
Mvav 212,244,176
Ta 242,228,8192
CV 195,198,199
Mvav 220,244,180
Ta 244,229,0
v_add_f32 v248, v248, v207
WL 3
Mvav 208,248,184
Ta 246,229,8192
CV 203,206,207
Mvav 216,248,188
Ta 248,230,0
Mvav 212,252,184
Ta 250,230,8192
Mvav 220,252,188
Ta 252,231,0
WL 3
Mvav 0,240,192
Ta 254,231,8192
Mvav 8,240,200
Ta 240,232,0
Mvav 4,244,192
Ta 242,232,8192
Mvav 12,244,200
Ta 244,233,0
v_fma_f32 v208, v208, s37, -v245
WL 3
Mvav 16,248,192
Ta 246,233,8192
v_fma_f32 v209, v209, s37, -v245
Mvav 24,248,200
Ta 248,234,0
v_fma_f32 v210, v210, s37, -v245
Mvav 20,252,192
Ta 250,234,8192
v_fma_f32 v211, v211, s37, -v245
Mvav 28,252,200
Ta 252,235,0
v_fma_f32 v212, v212, s37, -v245
WL 3
Mvav 32,240,192
Ta 254,235,8192
v_fma_f32 v213, v213, s37, -v245
Mvav 40,240,200
Ta 240,228,256
v_max3_f32 v251, v208, v209, v210
Mvav 36,244,192
Ta 242,228,8448
v_fma_f32 v214, v214, s37, -v245
Mvav 44,244,200
Ta 244,229,256
v_fma_f32 v215, v215, s37, -v245
WL 3
Mvav 48,248,192
Ta 246,229,8448
v_max3_f32 v252, v211, v212, v213
Mvav 56,248,200
Ta 248,230,256
Mvav 52,252,192
Ta 250,230,8448
v_fma_f32 v216, v216, s37, -v246
v_fma_f32 v217, v217, s37, -v246
Mvav 60,252,200
Ta 252,231,256
WL 3
Mvav 64,240,192
Ta 254,231,8448
v_max3_f32 v251, v251, v214, v215
v_fma_f32 v218, v218, s37, -v246
Mvav 72,240,200
Ta 240,232,256
Mvav 68,244,192
Ta 242,232,8448
v_fma_f32 v219, v219, s37, -v246
v_max3_f32 v252, v252, v216, v217
Mvav 76,244,200
Ta 244,233,256
WL 3
Mvav 80,248,192
Ta 246,233,8448
v_fma_f32 v220, v220, s37, -v246
v_fma_f32 v221, v221, s37, -v246
Mvav 88,248,200
Ta 248,234,256
Mvav 84,252,192
Ta 250,234,8448
v_max3_f32 v251, v251, v218, v219
Mvav 92,252,200
Ta 252,235,256
v_fma_f32 v222, v222, s37, -v246
WL 3
Mvav 96,240,192
Ta 254,235,8448
v_fma_f32 v223, v223, s37, -v246
Mvav 104,240,200
v_add_u32 v236, 0x18000, v236
v_add_u32 v237, 0x18000, v237
v_add_u32 v238, 0x18000, v238
v_add_u32 v239, 0x18000, v239
v_add_u32 v240, 0x18000, v240
v_add_u32 v241, 0x18000, v241
v_add_u32 v242, 0x18000, v242
v_add_u32 v243, 0x18000, v243
Ta 240,236,32768
v_max3_f32 v252, v252, v220, v221
Mvav 100,244,192
Ta 242,236,40960
v_max3_f32 v251, v251, v222, v223
Mvav 108,244,200
Ta 244,237,32768
v_max_f32 v251, v251, v252
WL 3
Mvav 112,248,192
Ta 246,237,40960
v_cmp_lt_f32 vcc, s38, v251
Mvav 120,248,200
Ta 248,238,32768
s_cbranch_vccnz LA_ra9
LA_rb9:
Mvav 116,252,192
Ta 250,238,40960
Mvav 124,252,200
Ta 252,239,32768
s_cmp_lg_u32 s49, 0
s_cbranch_scc1 LA_ra10
LA_rb10:
WL 3
Maaa 0,240,152
Ta 254,239,40960
Maaa 8,240,156
Ta 240,240,32768
v_exp_f32 v208, v208
Maaa 4,244,152
Ta 242,240,40960
Maaa 12,244,156
Ta 244,241,32768
WL 3
Maaa 16,248,152
Ta 246,241,40960
v_exp_f32 v216, v216
Maaa 24,248,156
Ta 248,242,32768
Maaa 20,252,152
Ta 250,242,40960
v_add_f32 v247, v247, v208
Maaa 28,252,156
Ta 252,243,32768
WL 3
Maaa 32,240,152
Ta 254,243,40960
Maaa 40,240,156
Ta 240,236,33024
v_exp_f32 v209, v209
Maaa 36,244,152
Ta 242,236,41216
Maaa 44,244,156
Ta 244,237,33024
v_add_f32 v248, v248, v216
WL 3
Maaa 48,248,152
Ta 246,237,41216
Maaa 56,248,156
Ta 248,238,33024
Maaa 52,252,152
Ta 250,238,41216
v_exp_f32 v217, v217
Maaa 60,252,156
Ta 252,239,33024
WL 3
Maaa 64,240,152
Ta 254,239,41216
v_add_f32 v247, v247, v209
Maaa 72,240,156
Ta 240,240,33024
Maaa 68,244,152
Ta 242,240,41216
CV 208,208,209
Maaa 76,244,156
Ta 244,241,33024
WL 3
Maaa 80,248,152
Ta 246,241,41216
v_exp_f32 v210, v210
Maaa 88,248,156
Ta 248,242,33024
Maaa 84,252,152
Ta 250,242,41216
v_add_f32 v248, v248, v217
Maaa 92,252,156
Ta 252,243,33024
WL 3
Maaa 96,240,152
Ta 254,243,41216
CV 216,216,217
Maaa 104,240,156
v_exp_f32 v218, v218
Maaa 100,244,152
v_add_f32 v247, v247, v210
Maaa 108,244,156
WL 0
s_barrier
Ba 240,224,49152
Ba 244,224,57344
Maaa 112,248,152
v_exp_f32 v211, v211
Maaa 120,248,156
Ba 248,225,49152
v_add_f32 v248, v248, v218
Maaa 116,252,152
v_exp_f32 v219, v219
Maaa 124,252,156
Ba 252,225,57344
WL 2
v_mfma_f32_16x16x32_bf16 v[192:195], a[240:243], v[128:131], 0
v_add_f32 v247, v247, v211
CV 209,210,211
v_mfma_f32_16x16x32_bf16 v[200:203], a[240:243], v[132:135], 0
Ba 240,226,49152
v_mfma_f32_16x16x32_bf16 v[196:199], a[244:247], v[128:131], 0
v_exp_f32 v212, v212
v_mfma_f32_16x16x32_bf16 v[204:207], a[244:247], v[132:135], 0
Ba 244,226,57344
WL 2
Mvav 192,248,136
v_add_f32 v248, v248, v219
CV 217,218,219
Mvav 200,248,140
Ba 248,227,49152
Mvav 196,252,136
v_exp_f32 v220, v220
v_add_f32 v247, v247, v212
Mvav 204,252,140
Ba 252,227,57344
WL 2
Mvav 192,240,144
v_exp_f32 v213, v213
Mvav 200,240,148
Ba 240,224,49408
Mvav 196,244,144
v_add_f32 v248, v248, v220
v_exp_f32 v221, v221
Mvav 204,244,148
Ba 244,224,57600
WL 2
Mvav 192,248,152
v_add_f32 v247, v247, v213
Mvav 200,248,156
Ba 248,225,49408
CV 210,212,213
Mvav 196,252,152
v_exp_f32 v214, v214
Mvav 204,252,156
Ba 252,225,57600
WL 2
Mvav 192,240,160
v_add_f32 v248, v248, v221
CV 218,220,221
Mvav 200,240,164
Ba 240,226,49408
Mvav 196,244,160
v_exp_f32 v222, v222
Mvav 204,244,164
Ba 244,226,57600
v_add_f32 v247, v247, v214
WL 2
Mvav 192,248,168
v_exp_f32 v215, v215
Mvav 200,248,172
Ba 248,227,49408
Mvav 196,252,168
v_add_f32 v248, v248, v222
Mvav 204,252,172
Ba 252,227,57600
v_exp_f32 v223, v223
WL 2
Mvav 192,240,176
v_add_f32 v247, v247, v215
Mvav 200,240,180
Ta 240,228,16384
Mvav 196,244,176
Ta 242,228,24576
CV 211,214,215
Mvav 204,244,180
Ta 244,229,16384
v_add_f32 v248, v248, v223
WL 3
Mvav 192,248,184
Ta 246,229,24576
CV 219,222,223
Mvav 200,248,188
Ta 248,230,16384
Mvav 196,252,184
Ta 250,230,24576
Mvav 204,252,188
Ta 252,231,16384
WL 3
Mvav 0,240,208
Ta 254,231,24576
Mvav 8,240,216
Ta 240,232,16384
Mvav 4,244,208
Ta 242,232,24576
Mvav 12,244,216
Ta 244,233,16384
v_fma_f32 v192, v192, s37, -v245
WL 3
Mvav 16,248,208
Ta 246,233,24576
v_fma_f32 v193, v193, s37, -v245
Mvav 24,248,216
Ta 248,234,16384
v_fma_f32 v194, v194, s37, -v245
Mvav 20,252,208
Ta 250,234,24576
v_fma_f32 v195, v195, s37, -v245
Mvav 28,252,216
Ta 252,235,16384
v_fma_f32 v196, v196, s37, -v245
WL 3
Mvav 32,240,208
Ta 254,235,24576
v_fma_f32 v197, v197, s37, -v245
Mvav 40,240,216
Ta 240,228,16640
v_max3_f32 v251, v192, v193, v194
Mvav 36,244,208
Ta 242,228,24832
v_fma_f32 v198, v198, s37, -v245
Mvav 44,244,216
Ta 244,229,16640
v_fma_f32 v199, v199, s37, -v245
WL 3
Mvav 48,248,208
Ta 246,229,24832
v_max3_f32 v252, v195, v196, v197
Mvav 56,248,216
Ta 248,230,16640
Mvav 52,252,208
Ta 250,230,24832
v_fma_f32 v200, v200, s37, -v246
v_fma_f32 v201, v201, s37, -v246
Mvav 60,252,216
Ta 252,231,16640
WL 3
Mvav 64,240,208
Ta 254,231,24832
v_max3_f32 v251, v251, v198, v199
v_fma_f32 v202, v202, s37, -v246
Mvav 72,240,216
Ta 240,232,16640
Mvav 68,244,208
Ta 242,232,24832
v_fma_f32 v203, v203, s37, -v246
v_max3_f32 v252, v252, v200, v201
Mvav 76,244,216
Ta 244,233,16640
WL 3
Mvav 80,248,208
Ta 246,233,24832
v_fma_f32 v204, v204, s37, -v246
v_fma_f32 v205, v205, s37, -v246
Mvav 88,248,216
Ta 248,234,16640
Mvav 84,252,208
Ta 250,234,24832
v_max3_f32 v251, v251, v202, v203
Mvav 92,252,216
Ta 252,235,16640
v_fma_f32 v206, v206, s37, -v246
WL 3
Mvav 96,240,208
Ta 254,235,24832
v_fma_f32 v207, v207, s37, -v246
Mvav 104,240,216
Ta 240,236,49152
v_max3_f32 v252, v252, v204, v205
Mvav 100,244,208
Ta 242,236,57344
v_max3_f32 v251, v251, v206, v207
Mvav 108,244,216
Ta 244,237,49152
v_max_f32 v251, v251, v252
WL 3
Mvav 112,248,208
Ta 246,237,57344
v_cmp_lt_f32 vcc, s38, v251
Mvav 120,248,216
Ta 248,238,49152
s_cbranch_vccnz LA_ra11
LA_rb11:
Mvav 116,252,208
Ta 250,238,57344
Mvav 124,252,216
Ta 252,239,49152
s_cmp_lg_u32 s49, 0
s_cbranch_scc1 LA_ra12
LA_rb12:
WL 3
Maaa 0,240,160
Ta 254,239,57344
Maaa 8,240,164
Ta 240,240,49152
v_exp_f32 v192, v192
Maaa 4,244,160
Ta 242,240,57344
Maaa 12,244,164
Ta 244,241,49152
WL 3
Maaa 16,248,160
Ta 246,241,57344
v_exp_f32 v200, v200
Maaa 24,248,164
Ta 248,242,49152
Maaa 20,252,160
Ta 250,242,57344
v_add_f32 v247, v247, v192
Maaa 28,252,164
Ta 252,243,49152
WL 3
Maaa 32,240,160
Ta 254,243,57344
Maaa 40,240,164
Ta 240,236,49408
v_exp_f32 v193, v193
Maaa 36,244,160
Ta 242,236,57600
Maaa 44,244,164
Ta 244,237,49408
v_add_f32 v248, v248, v200
WL 3
Maaa 48,248,160
Ta 246,237,57600
Maaa 56,248,164
Ta 248,238,49408
Maaa 52,252,160
Ta 250,238,57600
v_exp_f32 v201, v201
Maaa 60,252,164
Ta 252,239,49408
WL 3
Maaa 64,240,160
Ta 254,239,57600
v_add_f32 v247, v247, v193
Maaa 72,240,164
Ta 240,240,49408
Maaa 68,244,160
Ta 242,240,57600
CV 192,192,193
Maaa 76,244,164
Ta 244,241,49408
WL 3
Maaa 80,248,160
Ta 246,241,57600
v_exp_f32 v194, v194
Maaa 88,248,164
Ta 248,242,49408
Maaa 84,252,160
Ta 250,242,57600
v_add_f32 v248, v248, v201
Maaa 92,252,164
Ta 252,243,49408
WL 3
Maaa 96,240,160
Ta 254,243,57600
CV 200,200,201
Maaa 104,240,164
v_exp_f32 v202, v202
Maaa 100,244,160
v_add_f32 v247, v247, v194
Maaa 108,244,164
WL 0
s_barrier
Ba 240,224,0
Ba 244,224,8192
Maaa 112,248,160
v_exp_f32 v195, v195
Maaa 120,248,164
Ba 248,225,0
v_add_f32 v248, v248, v202
Maaa 116,252,160
v_exp_f32 v203, v203
Maaa 124,252,164
Ba 252,225,8192
WL 2
v_mfma_f32_16x16x32_bf16 v[208:211], a[240:243], v[128:131], 0
v_add_f32 v247, v247, v195
CV 193,194,195
v_mfma_f32_16x16x32_bf16 v[216:219], a[240:243], v[132:135], 0
Ba 240,226,0
v_mfma_f32_16x16x32_bf16 v[212:215], a[244:247], v[128:131], 0
v_exp_f32 v196, v196
v_mfma_f32_16x16x32_bf16 v[220:223], a[244:247], v[132:135], 0
Ba 244,226,8192
WL 2
Mvav 208,248,136
v_add_f32 v248, v248, v203
CV 201,202,203
Mvav 216,248,140
Ba 248,227,0
Mvav 212,252,136
v_exp_f32 v204, v204
v_add_f32 v247, v247, v196
Mvav 220,252,140
Ba 252,227,8192
WL 2
Mvav 208,240,144
v_exp_f32 v197, v197
Mvav 216,240,148
Ba 240,224,256
Mvav 212,244,144
v_add_f32 v248, v248, v204
v_exp_f32 v205, v205
Mvav 220,244,148
Ba 244,224,8448
WL 2
Mvav 208,248,152
v_add_f32 v247, v247, v197
Mvav 216,248,156
Ba 248,225,256
CV 194,196,197
Mvav 212,252,152
v_exp_f32 v198, v198
Mvav 220,252,156
Ba 252,225,8448
WL 2
Mvav 208,240,160
v_add_f32 v248, v248, v205
CV 202,204,205
Mvav 216,240,164
Ba 240,226,256
Mvav 212,244,160
v_exp_f32 v206, v206
Mvav 220,244,164
Ba 244,226,8448
v_add_f32 v247, v247, v198
WL 2
Mvav 208,248,168
v_exp_f32 v199, v199
Mvav 216,248,172
Ba 248,227,256
Mvav 212,252,168
v_add_f32 v248, v248, v206
Mvav 220,252,172
Ba 252,227,8448
v_exp_f32 v207, v207
WL 2
Mvav 208,240,176
v_add_f32 v247, v247, v199
Mvav 216,240,180
Ta 240,228,32768
Mvav 212,244,176
Ta 242,228,40960
CV 195,198,199
Mvav 220,244,180
Ta 244,229,32768
v_add_f32 v248, v248, v207
WL 3
Mvav 208,248,184
Ta 246,229,40960
CV 203,206,207
Mvav 216,248,188
Ta 248,230,32768
Mvav 212,252,184
Ta 250,230,40960
Mvav 220,252,188
Ta 252,231,32768
WL 3
Mvav 0,240,192
Ta 254,231,40960
Mvav 8,240,200
Ta 240,232,32768
Mvav 4,244,192
Ta 242,232,40960
Mvav 12,244,200
Ta 244,233,32768
v_fma_f32 v208, v208, s37, -v245
WL 3
Mvav 16,248,192
Ta 246,233,40960
v_fma_f32 v209, v209, s37, -v245
Mvav 24,248,200
Ta 248,234,32768
v_fma_f32 v210, v210, s37, -v245
Mvav 20,252,192
Ta 250,234,40960
v_fma_f32 v211, v211, s37, -v245
Mvav 28,252,200
Ta 252,235,32768
v_fma_f32 v212, v212, s37, -v245
WL 3
Mvav 32,240,192
Ta 254,235,40960
v_fma_f32 v213, v213, s37, -v245
Mvav 40,240,200
Ta 240,228,33024
v_max3_f32 v251, v208, v209, v210
Mvav 36,244,192
Ta 242,228,41216
v_fma_f32 v214, v214, s37, -v245
Mvav 44,244,200
Ta 244,229,33024
v_fma_f32 v215, v215, s37, -v245
WL 3
Mvav 48,248,192
Ta 246,229,41216
v_max3_f32 v252, v211, v212, v213
Mvav 56,248,200
Ta 248,230,33024
Mvav 52,252,192
Ta 250,230,41216
v_fma_f32 v216, v216, s37, -v246
v_fma_f32 v217, v217, s37, -v246
Mvav 60,252,200
Ta 252,231,33024
WL 3
Mvav 64,240,192
Ta 254,231,41216
v_max3_f32 v251, v251, v214, v215
v_fma_f32 v218, v218, s37, -v246
Mvav 72,240,200
Ta 240,232,33024
Mvav 68,244,192
Ta 242,232,41216
v_fma_f32 v219, v219, s37, -v246
v_max3_f32 v252, v252, v216, v217
Mvav 76,244,200
Ta 244,233,33024
WL 3
Mvav 80,248,192
Ta 246,233,41216
v_fma_f32 v220, v220, s37, -v246
v_fma_f32 v221, v221, s37, -v246
Mvav 88,248,200
Ta 248,234,33024
Mvav 84,252,192
Ta 250,234,41216
v_max3_f32 v251, v251, v218, v219
Mvav 92,252,200
Ta 252,235,33024
v_fma_f32 v222, v222, s37, -v246
WL 3
Mvav 96,240,192
Ta 254,235,41216
v_fma_f32 v223, v223, s37, -v246
Mvav 104,240,200
Ta 240,236,16384
v_max3_f32 v252, v252, v220, v221
Mvav 100,244,192
Ta 242,236,24576
v_max3_f32 v251, v251, v222, v223
Mvav 108,244,200
Ta 244,237,16384
v_max_f32 v251, v251, v252
WL 3
Mvav 112,248,192
Ta 246,237,24576
v_cmp_lt_f32 vcc, s38, v251
Mvav 120,248,200
Ta 248,238,16384
s_cbranch_vccnz LA_ra13
LA_rb13:
Mvav 116,252,192
Ta 250,238,24576
Mvav 124,252,200
Ta 252,239,16384
s_cmp_lg_u32 s49, 0
s_cbranch_scc1 LA_ra14
LA_rb14:
WL 3
Maaa 0,240,168
Ta 254,239,24576
Maaa 8,240,172
Ta 240,240,16384
v_exp_f32 v208, v208
Maaa 4,244,168
Ta 242,240,24576
Maaa 12,244,172
Ta 244,241,16384
WL 3
Maaa 16,248,168
Ta 246,241,24576
v_exp_f32 v216, v216
Maaa 24,248,172
Ta 248,242,16384
Maaa 20,252,168
Ta 250,242,24576
v_add_f32 v247, v247, v208
Maaa 28,252,172
Ta 252,243,16384
WL 3
Maaa 32,240,168
Ta 254,243,24576
Maaa 40,240,172
Ta 240,236,16640
v_exp_f32 v209, v209
Maaa 36,244,168
Ta 242,236,24832
Maaa 44,244,172
Ta 244,237,16640
v_add_f32 v248, v248, v216
WL 3
Maaa 48,248,168
Ta 246,237,24832
Maaa 56,248,172
Ta 248,238,16640
Maaa 52,252,168
Ta 250,238,24832
v_exp_f32 v217, v217
Maaa 60,252,172
Ta 252,239,16640
WL 3
Maaa 64,240,168
Ta 254,239,24832
v_add_f32 v247, v247, v209
Maaa 72,240,172
Ta 240,240,16640
Maaa 68,244,168
Ta 242,240,24832
CV 208,208,209
Maaa 76,244,172
Ta 244,241,16640
WL 3
Maaa 80,248,168
Ta 246,241,24832
v_exp_f32 v210, v210
Maaa 88,248,172
Ta 248,242,16640
Maaa 84,252,168
Ta 250,242,24832
v_add_f32 v248, v248, v217
Maaa 92,252,172
Ta 252,243,16640
WL 3
Maaa 96,240,168
Ta 254,243,24832
CV 216,216,217
Maaa 104,240,172
v_exp_f32 v218, v218
Maaa 100,244,168
v_add_f32 v247, v247, v210
Maaa 108,244,172
WL 0
s_barrier
Ba 240,224,32768
Ba 244,224,40960
Maaa 112,248,168
v_exp_f32 v211, v211
Maaa 120,248,172
Ba 248,225,32768
v_add_f32 v248, v248, v218
Maaa 116,252,168
v_exp_f32 v219, v219
Maaa 124,252,172
Ba 252,225,40960
WL 2
v_mfma_f32_16x16x32_bf16 v[192:195], a[240:243], v[128:131], 0
v_add_f32 v247, v247, v211
CV 209,210,211
v_mfma_f32_16x16x32_bf16 v[200:203], a[240:243], v[132:135], 0
Ba 240,226,32768
v_mfma_f32_16x16x32_bf16 v[196:199], a[244:247], v[128:131], 0
v_exp_f32 v212, v212
v_mfma_f32_16x16x32_bf16 v[204:207], a[244:247], v[132:135], 0
Ba 244,226,40960
WL 2
Mvav 192,248,136
v_add_f32 v248, v248, v219
CV 217,218,219
Mvav 200,248,140
Ba 248,227,32768
Mvav 196,252,136
v_exp_f32 v220, v220
v_add_f32 v247, v247, v212
Mvav 204,252,140
Ba 252,227,40960
WL 2
Mvav 192,240,144
v_exp_f32 v213, v213
Mvav 200,240,148
Ba 240,224,33024
Mvav 196,244,144
v_add_f32 v248, v248, v220
v_exp_f32 v221, v221
Mvav 204,244,148
Ba 244,224,41216
WL 2
Mvav 192,248,152
v_add_f32 v247, v247, v213
Mvav 200,248,156
Ba 248,225,33024
CV 210,212,213
Mvav 196,252,152
v_exp_f32 v214, v214
Mvav 204,252,156
Ba 252,225,41216
WL 2
Mvav 192,240,160
v_add_f32 v248, v248, v221
CV 218,220,221
Mvav 200,240,164
Ba 240,226,33024
Mvav 196,244,160
v_exp_f32 v222, v222
Mvav 204,244,164
Ba 244,226,41216
v_add_f32 v247, v247, v214
WL 2
Mvav 192,248,168
v_exp_f32 v215, v215
Mvav 200,248,172
Ba 248,227,33024
Mvav 196,252,168
v_add_f32 v248, v248, v222
Mvav 204,252,172
Ba 252,227,41216
v_exp_f32 v223, v223
WL 2
Mvav 192,240,176
v_add_f32 v247, v247, v215
Mvav 200,240,180
Ta 240,228,0
Mvav 196,244,176
Ta 242,228,8192
CV 211,214,215
Mvav 204,244,180
Ta 244,229,0
v_add_f32 v248, v248, v223
WL 3
Mvav 192,248,184
Ta 246,229,8192
CV 219,222,223
Mvav 200,248,188
Ta 248,230,0
Mvav 196,252,184
Ta 250,230,8192
Mvav 204,252,188
Ta 252,231,0
WL 3
Mvav 0,240,208
Ta 254,231,8192
Mvav 8,240,216
Ta 240,232,0
Mvav 4,244,208
Ta 242,232,8192
Mvav 12,244,216
Ta 244,233,0
v_fma_f32 v192, v192, s37, -v245
WL 3
Mvav 16,248,208
Ta 246,233,8192
v_fma_f32 v193, v193, s37, -v245
Mvav 24,248,216
Ta 248,234,0
v_fma_f32 v194, v194, s37, -v245
Mvav 20,252,208
Ta 250,234,8192
v_fma_f32 v195, v195, s37, -v245
Mvav 28,252,216
Ta 252,235,0
v_fma_f32 v196, v196, s37, -v245
WL 3
Mvav 32,240,208
Ta 254,235,8192
v_fma_f32 v197, v197, s37, -v245
Mvav 40,240,216
Ta 240,228,256
v_max3_f32 v251, v192, v193, v194
Mvav 36,244,208
Ta 242,228,8448
v_fma_f32 v198, v198, s37, -v245
Mvav 44,244,216
Ta 244,229,256
v_fma_f32 v199, v199, s37, -v245
WL 3
Mvav 48,248,208
Ta 246,229,8448
v_max3_f32 v252, v195, v196, v197
Mvav 56,248,216
Ta 248,230,256
Mvav 52,252,208
Ta 250,230,8448
v_fma_f32 v200, v200, s37, -v246
v_fma_f32 v201, v201, s37, -v246
Mvav 60,252,216
Ta 252,231,256
WL 3
Mvav 64,240,208
Ta 254,231,8448
v_max3_f32 v251, v251, v198, v199
v_fma_f32 v202, v202, s37, -v246
Mvav 72,240,216
Ta 240,232,256
Mvav 68,244,208
Ta 242,232,8448
v_fma_f32 v203, v203, s37, -v246
v_max3_f32 v252, v252, v200, v201
Mvav 76,244,216
Ta 244,233,256
WL 3
Mvav 80,248,208
Ta 246,233,8448
v_fma_f32 v204, v204, s37, -v246
v_fma_f32 v205, v205, s37, -v246
Mvav 88,248,216
Ta 248,234,256
Mvav 84,252,208
Ta 250,234,8448
v_max3_f32 v251, v251, v202, v203
Mvav 92,252,216
Ta 252,235,256
v_fma_f32 v206, v206, s37, -v246
WL 3
Mvav 96,240,208
Ta 254,235,8448
v_fma_f32 v207, v207, s37, -v246
Mvav 104,240,216
Ta 240,236,32768
v_max3_f32 v252, v252, v204, v205
Mvav 100,244,208
Ta 242,236,40960
v_max3_f32 v251, v251, v206, v207
Mvav 108,244,216
Ta 244,237,32768
v_max_f32 v251, v251, v252
WL 3
Mvav 112,248,208
Ta 246,237,40960
v_cmp_lt_f32 vcc, s38, v251
Mvav 120,248,216
Ta 248,238,32768
s_cbranch_vccnz LA_ra15
LA_rb15:
Mvav 116,252,208
Ta 250,238,40960
Mvav 124,252,216
Ta 252,239,32768
s_cmp_lg_u32 s49, 0
s_cbranch_scc1 LA_ra16
LA_rb16:
WL 3
Maaa 0,240,176
Ta 254,239,40960
Maaa 8,240,180
Ta 240,240,32768
v_exp_f32 v192, v192
Maaa 4,244,176
Ta 242,240,40960
Maaa 12,244,180
Ta 244,241,32768
WL 3
Maaa 16,248,176
Ta 246,241,40960
v_exp_f32 v200, v200
Maaa 24,248,180
Ta 248,242,32768
Maaa 20,252,176
Ta 250,242,40960
v_add_f32 v247, v247, v192
Maaa 28,252,180
Ta 252,243,32768
WL 3
Maaa 32,240,176
Ta 254,243,40960
Maaa 40,240,180
Ta 240,236,33024
v_exp_f32 v193, v193
Maaa 36,244,176
Ta 242,236,41216
Maaa 44,244,180
Ta 244,237,33024
v_add_f32 v248, v248, v200
WL 3
Maaa 48,248,176
Ta 246,237,41216
Maaa 56,248,180
Ta 248,238,33024
Maaa 52,252,176
Ta 250,238,41216
v_exp_f32 v201, v201
Maaa 60,252,180
Ta 252,239,33024
WL 3
Maaa 64,240,176
Ta 254,239,41216
v_add_f32 v247, v247, v193
Maaa 72,240,180
Ta 240,240,33024
Maaa 68,244,176
Ta 242,240,41216
CV 192,192,193
Maaa 76,244,180
Ta 244,241,33024
WL 3
Maaa 80,248,176
Ta 246,241,41216
v_exp_f32 v194, v194
Maaa 88,248,180
Ta 248,242,33024
Maaa 84,252,176
Ta 250,242,41216
v_add_f32 v248, v248, v201
Maaa 92,252,180
Ta 252,243,33024
WL 3
Maaa 96,240,176
Ta 254,243,41216
CV 200,200,201
Maaa 104,240,180
v_exp_f32 v202, v202
Maaa 100,244,176
v_add_f32 v247, v247, v194
Maaa 108,244,180
WL 0
s_barrier
Ba 240,224,16384
Ba 244,224,24576
Maaa 112,248,176
v_exp_f32 v195, v195
Maaa 120,248,180
Ba 248,225,16384
v_add_f32 v248, v248, v202
Maaa 116,252,176
v_exp_f32 v203, v203
Maaa 124,252,180
Ba 252,225,24576
WL 2
v_mfma_f32_16x16x32_bf16 v[208:211], a[240:243], v[128:131], 0
v_add_f32 v247, v247, v195
CV 193,194,195
v_mfma_f32_16x16x32_bf16 v[216:219], a[240:243], v[132:135], 0
Ba 240,226,16384
v_mfma_f32_16x16x32_bf16 v[212:215], a[244:247], v[128:131], 0
v_exp_f32 v196, v196
v_mfma_f32_16x16x32_bf16 v[220:223], a[244:247], v[132:135], 0
Ba 244,226,24576
WL 2
Mvav 208,248,136
v_add_f32 v248, v248, v203
CV 201,202,203
Mvav 216,248,140
Ba 248,227,16384
Mvav 212,252,136
v_exp_f32 v204, v204
v_add_f32 v247, v247, v196
Mvav 220,252,140
Ba 252,227,24576
WL 2
Mvav 208,240,144
v_exp_f32 v197, v197
Mvav 216,240,148
Ba 240,224,16640
Mvav 212,244,144
v_add_f32 v248, v248, v204
v_exp_f32 v205, v205
Mvav 220,244,148
Ba 244,224,24832
WL 2
Mvav 208,248,152
v_add_f32 v247, v247, v197
Mvav 216,248,156
Ba 248,225,16640
CV 194,196,197
Mvav 212,252,152
v_exp_f32 v198, v198
Mvav 220,252,156
Ba 252,225,24832
WL 2
Mvav 208,240,160
v_add_f32 v248, v248, v205
CV 202,204,205
Mvav 216,240,164
Ba 240,226,16640
Mvav 212,244,160
v_exp_f32 v206, v206
Mvav 220,244,164
Ba 244,226,24832
v_add_f32 v247, v247, v198
WL 2
Mvav 208,248,168
v_exp_f32 v199, v199
Mvav 216,248,172
Ba 248,227,16640
Mvav 212,252,168
v_add_f32 v248, v248, v206
Mvav 220,252,172
Ba 252,227,24832
v_exp_f32 v207, v207
WL 2
Mvav 208,240,176
v_add_f32 v247, v247, v199
Mvav 216,240,180
Ta 240,228,16384
Mvav 212,244,176
Ta 242,228,24576
CV 195,198,199
Mvav 220,244,180
Ta 244,229,16384
v_add_f32 v248, v248, v207
WL 3
Mvav 208,248,184
Ta 246,229,24576
CV 203,206,207
Mvav 216,248,188
Ta 248,230,16384
Mvav 212,252,184
Ta 250,230,24576
Mvav 220,252,188
Ta 252,231,16384
WL 3
Mvav 0,240,192
Ta 254,231,24576
Mvav 8,240,200
Ta 240,232,16384
Mvav 4,244,192
Ta 242,232,24576
Mvav 12,244,200
Ta 244,233,16384
v_fma_f32 v208, v208, s37, -v245
WL 3
Mvav 16,248,192
Ta 246,233,24576
v_fma_f32 v209, v209, s37, -v245
Mvav 24,248,200
Ta 248,234,16384
v_fma_f32 v210, v210, s37, -v245
Mvav 20,252,192
Ta 250,234,24576
v_fma_f32 v211, v211, s37, -v245
Mvav 28,252,200
Ta 252,235,16384
v_fma_f32 v212, v212, s37, -v245
WL 3
Mvav 32,240,192
Ta 254,235,24576
v_fma_f32 v213, v213, s37, -v245
Mvav 40,240,200
Ta 240,228,16640
v_max3_f32 v251, v208, v209, v210
Mvav 36,244,192
Ta 242,228,24832
v_fma_f32 v214, v214, s37, -v245
Mvav 44,244,200
Ta 244,229,16640
v_fma_f32 v215, v215, s37, -v245
WL 3
Mvav 48,248,192
Ta 246,229,24832
v_max3_f32 v252, v211, v212, v213
Mvav 56,248,200
Ta 248,230,16640
Mvav 52,252,192
Ta 250,230,24832
v_fma_f32 v216, v216, s37, -v246
v_fma_f32 v217, v217, s37, -v246
Mvav 60,252,200
Ta 252,231,16640
WL 3
Mvav 64,240,192
Ta 254,231,24832
v_max3_f32 v251, v251, v214, v215
v_fma_f32 v218, v218, s37, -v246
Mvav 72,240,200
Ta 240,232,16640
Mvav 68,244,192
Ta 242,232,24832
v_fma_f32 v219, v219, s37, -v246
v_max3_f32 v252, v252, v216, v217
Mvav 76,244,200
Ta 244,233,16640
WL 3
Mvav 80,248,192
Ta 246,233,24832
v_fma_f32 v220, v220, s37, -v246
v_fma_f32 v221, v221, s37, -v246
Mvav 88,248,200
Ta 248,234,16640
Mvav 84,252,192
Ta 250,234,24832
v_max3_f32 v251, v251, v218, v219
Mvav 92,252,200
Ta 252,235,16640
v_fma_f32 v222, v222, s37, -v246
WL 3
Mvav 96,240,192
Ta 254,235,24832
v_fma_f32 v223, v223, s37, -v246
Mvav 104,240,200
Ta 240,236,49152
v_max3_f32 v252, v252, v220, v221
Mvav 100,244,192
Ta 242,236,57344
v_max3_f32 v251, v251, v222, v223
Mvav 108,244,200
Ta 244,237,49152
v_max_f32 v251, v251, v252
WL 3
Mvav 112,248,192
Ta 246,237,57344
v_cmp_lt_f32 vcc, s38, v251
Mvav 120,248,200
Ta 248,238,49152
s_cbranch_vccnz LA_ra17
LA_rb17:
Mvav 116,252,192
Ta 250,238,57344
Mvav 124,252,200
Ta 252,239,49152
s_cmp_lg_u32 s49, 0
s_cbranch_scc1 LA_ra18
LA_rb18:
WL 3
Maaa 0,240,184
Ta 254,239,57344
Maaa 8,240,188
Ta 240,240,49152
v_exp_f32 v208, v208
Maaa 4,244,184
Ta 242,240,57344
Maaa 12,244,188
Ta 244,241,49152
WL 3
Maaa 16,248,184
Ta 246,241,57344
v_exp_f32 v216, v216
Maaa 24,248,188
Ta 248,242,49152
Maaa 20,252,184
Ta 250,242,57344
v_add_f32 v247, v247, v208
Maaa 28,252,188
Ta 252,243,49152
WL 3
Maaa 32,240,184
Ta 254,243,57344
Maaa 40,240,188
Ta 240,236,49408
v_exp_f32 v209, v209
Maaa 36,244,184
Ta 242,236,57600
Maaa 44,244,188
Ta 244,237,49408
v_add_f32 v248, v248, v216
WL 3
Maaa 48,248,184
Ta 246,237,57600
Maaa 56,248,188
Ta 248,238,49408
Maaa 52,252,184
Ta 250,238,57600
v_exp_f32 v217, v217
Maaa 60,252,188
Ta 252,239,49408
WL 3
Maaa 64,240,184
Ta 254,239,57600
v_add_f32 v247, v247, v209
Maaa 72,240,188
Ta 240,240,49408
Maaa 68,244,184
Ta 242,240,57600
CV 208,208,209
Maaa 76,244,188
Ta 244,241,49408
WL 3
Maaa 80,248,184
Ta 246,241,57600
v_exp_f32 v210, v210
Maaa 88,248,188
Ta 248,242,49408
Maaa 84,252,184
Ta 250,242,57600
v_add_f32 v248, v248, v217
Maaa 92,252,188
Ta 252,243,49408
WL 3
Maaa 96,240,184
Ta 254,243,57600
CV 216,216,217
Maaa 104,240,188
v_exp_f32 v218, v218
Maaa 100,244,184
v_add_f32 v247, v247, v210
Maaa 108,244,188
WL 0
s_barrier
Ba 240,224,49152
Ba 244,224,57344
Maaa 112,248,184
v_exp_f32 v211, v211
Maaa 120,248,188
Ba 248,225,49152
v_add_f32 v248, v248, v218
Maaa 116,252,184
v_exp_f32 v219, v219
Maaa 124,252,188
Ba 252,225,57344
WL 2
v_mfma_f32_16x16x32_bf16 v[192:195], a[240:243], v[128:131], 0
v_add_f32 v247, v247, v211
CV 209,210,211
v_mfma_f32_16x16x32_bf16 v[200:203], a[240:243], v[132:135], 0
Ba 240,226,49152
v_mfma_f32_16x16x32_bf16 v[196:199], a[244:247], v[128:131], 0
v_exp_f32 v212, v212
v_mfma_f32_16x16x32_bf16 v[204:207], a[244:247], v[132:135], 0
Ba 244,226,57344
WL 2
Mvav 192,248,136
v_add_f32 v248, v248, v219
CV 217,218,219
Mvav 200,248,140
Ba 248,227,49152
Mvav 196,252,136
v_exp_f32 v220, v220
v_add_f32 v247, v247, v212
Mvav 204,252,140
Ba 252,227,57344
WL 2
Mvav 192,240,144
v_exp_f32 v213, v213
Mvav 200,240,148
Ba 240,224,49408
Mvav 196,244,144
v_add_f32 v248, v248, v220
v_exp_f32 v221, v221
Mvav 204,244,148
Ba 244,224,57600
WL 2
Mvav 192,248,152
v_add_f32 v247, v247, v213
Mvav 200,248,156
Ba 248,225,49408
CV 210,212,213
Mvav 196,252,152
v_exp_f32 v214, v214
Mvav 204,252,156
Ba 252,225,57600
WL 2
Mvav 192,240,160
v_add_f32 v248, v248, v221
CV 218,220,221
Mvav 200,240,164
Ba 240,226,49408
Mvav 196,244,160
v_exp_f32 v222, v222
Mvav 204,244,164
Ba 244,226,57600
v_add_f32 v247, v247, v214
WL 2
Mvav 192,248,168
v_exp_f32 v215, v215
Mvav 200,248,172
Ba 248,227,49408
Mvav 196,252,168
v_add_f32 v248, v248, v222
Mvav 204,252,172
Ba 252,227,57600
v_exp_f32 v223, v223
WL 2
Mvav 192,240,176
v_add_f32 v247, v247, v215
Mvav 200,240,180
Ta 240,228,32768
Mvav 196,244,176
Ta 242,228,40960
CV 211,214,215
Mvav 204,244,180
Ta 244,229,32768
v_add_f32 v248, v248, v223
WL 3
Mvav 192,248,184
Ta 246,229,40960
CV 219,222,223
Mvav 200,248,188
Ta 248,230,32768
Mvav 196,252,184
Ta 250,230,40960
Mvav 204,252,188
Ta 252,231,32768
WL 3
Mvav 0,240,208
Ta 254,231,40960
Mvav 8,240,216
Ta 240,232,32768
Mvav 4,244,208
Ta 242,232,40960
Mvav 12,244,216
Ta 244,233,32768
v_fma_f32 v192, v192, s37, -v245
WL 3
Mvav 16,248,208
Ta 246,233,40960
v_fma_f32 v193, v193, s37, -v245
Mvav 24,248,216
Ta 248,234,32768
v_fma_f32 v194, v194, s37, -v245
Mvav 20,252,208
Ta 250,234,40960
v_fma_f32 v195, v195, s37, -v245
Mvav 28,252,216
Ta 252,235,32768
v_fma_f32 v196, v196, s37, -v245
WL 3
Mvav 32,240,208
Ta 254,235,40960
v_fma_f32 v197, v197, s37, -v245
Mvav 40,240,216
Ta 240,228,33024
v_max3_f32 v251, v192, v193, v194
Mvav 36,244,208
Ta 242,228,41216
v_fma_f32 v198, v198, s37, -v245
Mvav 44,244,216
Ta 244,229,33024
v_fma_f32 v199, v199, s37, -v245
WL 3
Mvav 48,248,208
Ta 246,229,41216
v_max3_f32 v252, v195, v196, v197
Mvav 56,248,216
Ta 248,230,33024
Mvav 52,252,208
Ta 250,230,41216
v_fma_f32 v200, v200, s37, -v246
v_fma_f32 v201, v201, s37, -v246
Mvav 60,252,216
Ta 252,231,33024
WL 3
Mvav 64,240,208
Ta 254,231,41216
v_max3_f32 v251, v251, v198, v199
v_fma_f32 v202, v202, s37, -v246
Mvav 72,240,216
Ta 240,232,33024
Mvav 68,244,208
Ta 242,232,41216
v_fma_f32 v203, v203, s37, -v246
v_max3_f32 v252, v252, v200, v201
Mvav 76,244,216
Ta 244,233,33024
WL 3
Mvav 80,248,208
Ta 246,233,41216
v_fma_f32 v204, v204, s37, -v246
v_fma_f32 v205, v205, s37, -v246
Mvav 88,248,216
Ta 248,234,33024
Mvav 84,252,208
Ta 250,234,41216
v_max3_f32 v251, v251, v202, v203
Mvav 92,252,216
Ta 252,235,33024
v_fma_f32 v206, v206, s37, -v246
WL 3
Mvav 96,240,208
Ta 254,235,41216
v_fma_f32 v207, v207, s37, -v246
Mvav 104,240,216
Ta 240,236,16384
v_max3_f32 v252, v252, v204, v205
Mvav 100,244,208
Ta 242,236,24576
v_max3_f32 v251, v251, v206, v207
Mvav 108,244,216
Ta 244,237,16384
v_max_f32 v251, v251, v252
WL 3
Mvav 112,248,208
Ta 246,237,24576
v_cmp_lt_f32 vcc, s38, v251
Mvav 120,248,216
Ta 248,238,16384
s_cbranch_vccnz LA_ra19
LA_rb19:
Mvav 116,252,208
Ta 250,238,24576
Mvav 124,252,216
Ta 252,239,16384
s_cmp_lg_u32 s49, 0
s_cbranch_scc1 LA_ra20
LA_rb20:
WL 3
Maaa 0,240,192
Ta 254,239,24576
Maaa 8,240,196
Ta 240,240,16384
v_exp_f32 v192, v192
Maaa 4,244,192
Ta 242,240,24576
Maaa 12,244,196
Ta 244,241,16384
WL 3
Maaa 16,248,192
Ta 246,241,24576
v_exp_f32 v200, v200
Maaa 24,248,196
Ta 248,242,16384
Maaa 20,252,192
Ta 250,242,24576
v_add_f32 v247, v247, v192
Maaa 28,252,196
Ta 252,243,16384
WL 3
Maaa 32,240,192
Ta 254,243,24576
Maaa 40,240,196
Ta 240,236,16640
v_exp_f32 v193, v193
Maaa 36,244,192
Ta 242,236,24832
Maaa 44,244,196
Ta 244,237,16640
v_add_f32 v248, v248, v200
WL 3
Maaa 48,248,192
Ta 246,237,24832
Maaa 56,248,196
Ta 248,238,16640
Maaa 52,252,192
Ta 250,238,24832
v_exp_f32 v201, v201
Maaa 60,252,196
Ta 252,239,16640
WL 3
Maaa 64,240,192
Ta 254,239,24832
v_add_f32 v247, v247, v193
Maaa 72,240,196
Ta 240,240,16640
Maaa 68,244,192
Ta 242,240,24832
CV 192,192,193
Maaa 76,244,196
Ta 244,241,16640
WL 3
Maaa 80,248,192
Ta 246,241,24832
v_exp_f32 v194, v194
Maaa 88,248,196
Ta 248,242,16640
Maaa 84,252,192
Ta 250,242,24832
v_add_f32 v248, v248, v201
Maaa 92,252,196
Ta 252,243,16640
WL 3
Maaa 96,240,192
Ta 254,243,24832
CV 200,200,201
Maaa 104,240,196
v_exp_f32 v202, v202
Maaa 100,244,192
v_add_f32 v247, v247, v194
Maaa 108,244,196
WL 0
s_barrier
Ba 240,224,0
Ba 244,224,8192
Maaa 112,248,192
v_exp_f32 v195, v195
Maaa 120,248,196
Ba 248,225,0
v_add_f32 v248, v248, v202
Maaa 116,252,192
v_exp_f32 v203, v203
Maaa 124,252,196
Ba 252,225,8192
WL 2
v_mfma_f32_16x16x32_bf16 v[208:211], a[240:243], v[128:131], 0
v_add_f32 v247, v247, v195
CV 193,194,195
v_mfma_f32_16x16x32_bf16 v[216:219], a[240:243], v[132:135], 0
Ba 240,226,0
v_mfma_f32_16x16x32_bf16 v[212:215], a[244:247], v[128:131], 0
v_exp_f32 v196, v196
v_mfma_f32_16x16x32_bf16 v[220:223], a[244:247], v[132:135], 0
Ba 244,226,8192
WL 2
Mvav 208,248,136
v_add_f32 v248, v248, v203
CV 201,202,203
Mvav 216,248,140
Ba 248,227,0
Mvav 212,252,136
v_exp_f32 v204, v204
v_add_f32 v247, v247, v196
Mvav 220,252,140
Ba 252,227,8192
WL 2
Mvav 208,240,144
v_exp_f32 v197, v197
Mvav 216,240,148
Ba 240,224,256
Mvav 212,244,144
v_add_f32 v248, v248, v204
v_exp_f32 v205, v205
Mvav 220,244,148
Ba 244,224,8448
WL 2
Mvav 208,248,152
v_add_f32 v247, v247, v197
Mvav 216,248,156
Ba 248,225,256
CV 194,196,197
Mvav 212,252,152
v_exp_f32 v198, v198
Mvav 220,252,156
Ba 252,225,8448
WL 2
Mvav 208,240,160
v_add_f32 v248, v248, v205
CV 202,204,205
Mvav 216,240,164
Ba 240,226,256
Mvav 212,244,160
v_exp_f32 v206, v206
Mvav 220,244,164
Ba 244,226,8448
v_add_f32 v247, v247, v198
WL 2
Mvav 208,248,168
v_exp_f32 v199, v199
Mvav 216,248,172
Ba 248,227,256
Mvav 212,252,168
v_add_f32 v248, v248, v206
Mvav 220,252,172
Ba 252,227,8448
v_exp_f32 v207, v207
WL 2
Mvav 208,240,176
v_add_f32 v247, v247, v199
Mvav 216,240,180
Ta 240,228,0
Mvav 212,244,176
Ta 242,228,8192
CV 195,198,199
Mvav 220,244,180
Ta 244,229,0
v_add_f32 v248, v248, v207
WL 3
Mvav 208,248,184
Ta 246,229,8192
CV 203,206,207
Mvav 216,248,188
Ta 248,230,0
Mvav 212,252,184
Ta 250,230,8192
Mvav 220,252,188
Ta 252,231,0
WL 3
Mvav 0,240,192
Ta 254,231,8192
Mvav 8,240,200
Ta 240,232,0
Mvav 4,244,192
Ta 242,232,8192
Mvav 12,244,200
Ta 244,233,0
v_fma_f32 v208, v208, s37, -v245
WL 3
Mvav 16,248,192
Ta 246,233,8192
v_fma_f32 v209, v209, s37, -v245
Mvav 24,248,200
Ta 248,234,0
v_fma_f32 v210, v210, s37, -v245
Mvav 20,252,192
Ta 250,234,8192
v_fma_f32 v211, v211, s37, -v245
Mvav 28,252,200
Ta 252,235,0
v_fma_f32 v212, v212, s37, -v245
WL 3
Mvav 32,240,192
Ta 254,235,8192
v_fma_f32 v213, v213, s37, -v245
Mvav 40,240,200
Ta 240,228,256
v_max3_f32 v251, v208, v209, v210
Mvav 36,244,192
Ta 242,228,8448
v_fma_f32 v214, v214, s37, -v245
Mvav 44,244,200
Ta 244,229,256
v_fma_f32 v215, v215, s37, -v245
WL 3
Mvav 48,248,192
Ta 246,229,8448
v_max3_f32 v252, v211, v212, v213
Mvav 56,248,200
Ta 248,230,256
Mvav 52,252,192
Ta 250,230,8448
v_fma_f32 v216, v216, s37, -v246
v_fma_f32 v217, v217, s37, -v246
Mvav 60,252,200
Ta 252,231,256
WL 3
Mvav 64,240,192
Ta 254,231,8448
v_max3_f32 v251, v251, v214, v215
v_fma_f32 v218, v218, s37, -v246
Mvav 72,240,200
Ta 240,232,256
Mvav 68,244,192
Ta 242,232,8448
v_fma_f32 v219, v219, s37, -v246
v_max3_f32 v252, v252, v216, v217
Mvav 76,244,200
Ta 244,233,256
WL 3
Mvav 80,248,192
Ta 246,233,8448
v_fma_f32 v220, v220, s37, -v246
v_fma_f32 v221, v221, s37, -v246
Mvav 88,248,200
Ta 248,234,256
Mvav 84,252,192
Ta 250,234,8448
v_max3_f32 v251, v251, v218, v219
Mvav 92,252,200
Ta 252,235,256
v_fma_f32 v222, v222, s37, -v246
WL 3
Mvav 96,240,192
Ta 254,235,8448
v_fma_f32 v223, v223, s37, -v246
Mvav 104,240,200
Ta 240,236,32768
v_max3_f32 v252, v252, v220, v221
Mvav 100,244,192
Ta 242,236,40960
v_max3_f32 v251, v251, v222, v223
Mvav 108,244,200
Ta 244,237,32768
v_max_f32 v251, v251, v252
WL 3
Mvav 112,248,192
Ta 246,237,40960
v_cmp_lt_f32 vcc, s38, v251
Mvav 120,248,200
Ta 248,238,32768
s_cbranch_vccnz LA_ra21
LA_rb21:
Mvav 116,252,192
Ta 250,238,40960
Mvav 124,252,200
Ta 252,239,32768
s_cmp_lg_u32 s49, 0
s_cbranch_scc1 LA_ra22
LA_rb22:
WL 3
Maaa 0,240,200
Ta 254,239,40960
Maaa 8,240,204
Ta 240,240,32768
v_exp_f32 v208, v208
Maaa 4,244,200
Ta 242,240,40960
Maaa 12,244,204
Ta 244,241,32768
WL 3
Maaa 16,248,200
Ta 246,241,40960
v_exp_f32 v216, v216
Maaa 24,248,204
Ta 248,242,32768
Maaa 20,252,200
Ta 250,242,40960
v_add_f32 v247, v247, v208
Maaa 28,252,204
Ta 252,243,32768
WL 3
Maaa 32,240,200
Ta 254,243,40960
Maaa 40,240,204
Ta 240,236,33024
v_exp_f32 v209, v209
Maaa 36,244,200
Ta 242,236,41216
Maaa 44,244,204
Ta 244,237,33024
v_add_f32 v248, v248, v216
WL 3
Maaa 48,248,200
Ta 246,237,41216
Maaa 56,248,204
Ta 248,238,33024
Maaa 52,252,200
Ta 250,238,41216
v_exp_f32 v217, v217
Maaa 60,252,204
Ta 252,239,33024
WL 3
Maaa 64,240,200
Ta 254,239,41216
v_add_f32 v247, v247, v209
Maaa 72,240,204
Ta 240,240,33024
Maaa 68,244,200
Ta 242,240,41216
CV 208,208,209
Maaa 76,244,204
Ta 244,241,33024
WL 3
Maaa 80,248,200
Ta 246,241,41216
v_exp_f32 v210, v210
Maaa 88,248,204
Ta 248,242,33024
Maaa 84,252,200
Ta 250,242,41216
v_add_f32 v248, v248, v217
Maaa 92,252,204
Ta 252,243,33024
WL 3
Maaa 96,240,200
Ta 254,243,41216
CV 216,216,217
Maaa 104,240,204
v_exp_f32 v218, v218
Maaa 100,244,200
v_add_f32 v247, v247, v210
Maaa 108,244,204
WL 0
s_barrier
Ba 240,224,16384
Ba 244,224,24576
Maaa 112,248,200
v_exp_f32 v211, v211
Maaa 120,248,204
Ba 248,225,16384
v_add_f32 v248, v248, v218
Maaa 116,252,200
v_exp_f32 v219, v219
Maaa 124,252,204
Ba 252,225,24576
WL 2
v_mfma_f32_16x16x32_bf16 v[192:195], a[240:243], v[128:131], 0
v_add_f32 v247, v247, v211
CV 209,210,211
v_mfma_f32_16x16x32_bf16 v[200:203], a[240:243], v[132:135], 0
Ba 240,226,16384
v_mfma_f32_16x16x32_bf16 v[196:199], a[244:247], v[128:131], 0
v_exp_f32 v212, v212
v_mfma_f32_16x16x32_bf16 v[204:207], a[244:247], v[132:135], 0
Ba 244,226,24576
WL 2
Mvav 192,248,136
v_add_f32 v248, v248, v219
CV 217,218,219
Mvav 200,248,140
Ba 248,227,16384
Mvav 196,252,136
v_exp_f32 v220, v220
v_add_f32 v247, v247, v212
Mvav 204,252,140
Ba 252,227,24576
WL 2
Mvav 192,240,144
v_exp_f32 v213, v213
Mvav 200,240,148
Ba 240,224,16640
Mvav 196,244,144
v_add_f32 v248, v248, v220
v_exp_f32 v221, v221
Mvav 204,244,148
Ba 244,224,24832
WL 2
Mvav 192,248,152
v_add_f32 v247, v247, v213
Mvav 200,248,156
Ba 248,225,16640
CV 210,212,213
Mvav 196,252,152
v_exp_f32 v214, v214
Mvav 204,252,156
Ba 252,225,24832
WL 2
Mvav 192,240,160
v_add_f32 v248, v248, v221
CV 218,220,221
Mvav 200,240,164
Ba 240,226,16640
Mvav 196,244,160
v_exp_f32 v222, v222
Mvav 204,244,164
Ba 244,226,24832
v_add_f32 v247, v247, v214
WL 2
Mvav 192,248,168
v_exp_f32 v215, v215
Mvav 200,248,172
Ba 248,227,16640
Mvav 196,252,168
v_add_f32 v248, v248, v222
Mvav 204,252,172
Ba 252,227,24832
v_exp_f32 v223, v223
WL 2
Mvav 192,240,176
v_add_f32 v247, v247, v215
Mvav 200,240,180
Ta 240,228,16384
Mvav 196,244,176
Ta 242,228,24576
CV 211,214,215
Mvav 204,244,180
Ta 244,229,16384
v_add_f32 v248, v248, v223
WL 3
Mvav 192,248,184
Ta 246,229,24576
CV 219,222,223
Mvav 200,248,188
Ta 248,230,16384
Mvav 196,252,184
Ta 250,230,24576
Mvav 204,252,188
Ta 252,231,16384
WL 3
Mvav 0,240,208
Ta 254,231,24576
Mvav 8,240,216
Ta 240,232,16384
Mvav 4,244,208
Ta 242,232,24576
Mvav 12,244,216
Ta 244,233,16384
v_fma_f32 v192, v192, s37, -v245
WL 3
Mvav 16,248,208
Ta 246,233,24576
v_fma_f32 v193, v193, s37, -v245
Mvav 24,248,216
Ta 248,234,16384
v_fma_f32 v194, v194, s37, -v245
Mvav 20,252,208
Ta 250,234,24576
v_fma_f32 v195, v195, s37, -v245
Mvav 28,252,216
Ta 252,235,16384
v_fma_f32 v196, v196, s37, -v245
WL 3
Mvav 32,240,208
Ta 254,235,24576
v_fma_f32 v197, v197, s37, -v245
Mvav 40,240,216
Ta 240,228,16640
v_max3_f32 v251, v192, v193, v194
Mvav 36,244,208
Ta 242,228,24832
v_fma_f32 v198, v198, s37, -v245
Mvav 44,244,216
Ta 244,229,16640
v_fma_f32 v199, v199, s37, -v245
WL 3
Mvav 48,248,208
Ta 246,229,24832
v_max3_f32 v252, v195, v196, v197
Mvav 56,248,216
Ta 248,230,16640
Mvav 52,252,208
Ta 250,230,24832
v_fma_f32 v200, v200, s37, -v246
v_fma_f32 v201, v201, s37, -v246
Mvav 60,252,216
Ta 252,231,16640
WL 3
Mvav 64,240,208
Ta 254,231,24832
v_max3_f32 v251, v251, v198, v199
v_fma_f32 v202, v202, s37, -v246
Mvav 72,240,216
Ta 240,232,16640
Mvav 68,244,208
Ta 242,232,24832
v_fma_f32 v203, v203, s37, -v246
v_max3_f32 v252, v252, v200, v201
Mvav 76,244,216
Ta 244,233,16640
WL 3
Mvav 80,248,208
Ta 246,233,24832
v_fma_f32 v204, v204, s37, -v246
v_fma_f32 v205, v205, s37, -v246
Mvav 88,248,216
Ta 248,234,16640
Mvav 84,252,208
Ta 250,234,24832
v_max3_f32 v251, v251, v202, v203
Mvav 92,252,216
Ta 252,235,16640
v_fma_f32 v206, v206, s37, -v246
WL 3
Mvav 96,240,208
Ta 254,235,24832
v_fma_f32 v207, v207, s37, -v246
Mvav 104,240,216
Ta 240,236,49152
v_max3_f32 v252, v252, v204, v205
Mvav 100,244,208
Ta 242,236,57344
v_max3_f32 v251, v251, v206, v207
Mvav 108,244,216
Ta 244,237,49152
v_max_f32 v251, v251, v252
WL 3
Mvav 112,248,208
Ta 246,237,57344
v_cmp_lt_f32 vcc, s38, v251
Mvav 120,248,216
Ta 248,238,49152
s_cbranch_vccnz LA_ra23
LA_rb23:
Mvav 116,252,208
Ta 250,238,57344
Mvav 124,252,216
Ta 252,239,49152
s_cmp_lg_u32 s49, 0
s_cbranch_scc1 LA_ra24
LA_rb24:
WL 3
Maaa 0,240,208
Ta 254,239,57344
Maaa 8,240,212
Ta 240,240,49152
v_exp_f32 v192, v192
Maaa 4,244,208
Ta 242,240,57344
Maaa 12,244,212
Ta 244,241,49152
WL 3
Maaa 16,248,208
Ta 246,241,57344
v_exp_f32 v200, v200
Maaa 24,248,212
Ta 248,242,49152
Maaa 20,252,208
Ta 250,242,57344
v_add_f32 v247, v247, v192
Maaa 28,252,212
Ta 252,243,49152
WL 3
Maaa 32,240,208
Ta 254,243,57344
Maaa 40,240,212
Ta 240,236,49408
v_exp_f32 v193, v193
Maaa 36,244,208
Ta 242,236,57600
Maaa 44,244,212
Ta 244,237,49408
v_add_f32 v248, v248, v200
WL 3
Maaa 48,248,208
Ta 246,237,57600
Maaa 56,248,212
Ta 248,238,49408
Maaa 52,252,208
Ta 250,238,57600
v_exp_f32 v201, v201
Maaa 60,252,212
Ta 252,239,49408
WL 3
Maaa 64,240,208
Ta 254,239,57600
v_add_f32 v247, v247, v193
Maaa 72,240,212
Ta 240,240,49408
Maaa 68,244,208
Ta 242,240,57600
CV 192,192,193
Maaa 76,244,212
Ta 244,241,49408
WL 3
Maaa 80,248,208
Ta 246,241,57600
v_exp_f32 v194, v194
Maaa 88,248,212
Ta 248,242,49408
Maaa 84,252,208
Ta 250,242,57600
v_add_f32 v248, v248, v201
Maaa 92,252,212
Ta 252,243,49408
WL 3
Maaa 96,240,208
Ta 254,243,57600
CV 200,200,201
Maaa 104,240,212
v_exp_f32 v202, v202
Maaa 100,244,208
v_add_f32 v247, v247, v194
Maaa 108,244,212
WL 0
s_barrier
Ba 240,224,32768
Ba 244,224,40960
Maaa 112,248,208
v_exp_f32 v195, v195
Maaa 120,248,212
Ba 248,225,32768
v_add_f32 v248, v248, v202
Maaa 116,252,208
v_exp_f32 v203, v203
Maaa 124,252,212
Ba 252,225,40960
WL 2
v_mfma_f32_16x16x32_bf16 v[208:211], a[240:243], v[128:131], 0
v_add_f32 v247, v247, v195
CV 193,194,195
v_mfma_f32_16x16x32_bf16 v[216:219], a[240:243], v[132:135], 0
Ba 240,226,32768
v_mfma_f32_16x16x32_bf16 v[212:215], a[244:247], v[128:131], 0
v_exp_f32 v196, v196
v_mfma_f32_16x16x32_bf16 v[220:223], a[244:247], v[132:135], 0
Ba 244,226,40960
WL 2
Mvav 208,248,136
v_add_f32 v248, v248, v203
CV 201,202,203
Mvav 216,248,140
Ba 248,227,32768
Mvav 212,252,136
v_exp_f32 v204, v204
v_add_f32 v247, v247, v196
Mvav 220,252,140
Ba 252,227,40960
WL 2
Mvav 208,240,144
v_exp_f32 v197, v197
Mvav 216,240,148
Ba 240,224,33024
Mvav 212,244,144
v_add_f32 v248, v248, v204
v_exp_f32 v205, v205
Mvav 220,244,148
Ba 244,224,41216
WL 2
Mvav 208,248,152
v_add_f32 v247, v247, v197
Mvav 216,248,156
Ba 248,225,33024
CV 194,196,197
Mvav 212,252,152
v_exp_f32 v198, v198
Mvav 220,252,156
Ba 252,225,41216
WL 2
Mvav 208,240,160
v_add_f32 v248, v248, v205
CV 202,204,205
Mvav 216,240,164
Ba 240,226,33024
Mvav 212,244,160
v_exp_f32 v206, v206
Mvav 220,244,164
Ba 244,226,41216
v_add_f32 v247, v247, v198
WL 2
Mvav 208,248,168
v_exp_f32 v199, v199
Mvav 216,248,172
Ba 248,227,33024
Mvav 212,252,168
v_add_f32 v248, v248, v206
Mvav 220,252,172
Ba 252,227,41216
v_exp_f32 v207, v207
WL 2
Mvav 208,240,176
v_add_f32 v247, v247, v199
Mvav 216,240,180
Ta 240,228,32768
Mvav 212,244,176
Ta 242,228,40960
CV 195,198,199
Mvav 220,244,180
Ta 244,229,32768
v_add_f32 v248, v248, v207
WL 3
Mvav 208,248,184
Ta 246,229,40960
CV 203,206,207
Mvav 216,248,188
Ta 248,230,32768
Mvav 212,252,184
Ta 250,230,40960
Mvav 220,252,188
Ta 252,231,32768
WL 3
Mvav 0,240,192
Ta 254,231,40960
Mvav 8,240,200
Ta 240,232,32768
Mvav 4,244,192
Ta 242,232,40960
Mvav 12,244,200
Ta 244,233,32768
v_fma_f32 v208, v208, s37, -v245
WL 3
Mvav 16,248,192
Ta 246,233,40960
v_fma_f32 v209, v209, s37, -v245
Mvav 24,248,200
Ta 248,234,32768
v_fma_f32 v210, v210, s37, -v245
Mvav 20,252,192
Ta 250,234,40960
v_fma_f32 v211, v211, s37, -v245
Mvav 28,252,200
Ta 252,235,32768
v_fma_f32 v212, v212, s37, -v245
WL 3
Mvav 32,240,192
Ta 254,235,40960
v_fma_f32 v213, v213, s37, -v245
Mvav 40,240,200
Ta 240,228,33024
v_max3_f32 v251, v208, v209, v210
Mvav 36,244,192
Ta 242,228,41216
v_fma_f32 v214, v214, s37, -v245
Mvav 44,244,200
Ta 244,229,33024
v_fma_f32 v215, v215, s37, -v245
WL 3
Mvav 48,248,192
Ta 246,229,41216
v_max3_f32 v252, v211, v212, v213
Mvav 56,248,200
Ta 248,230,33024
Mvav 52,252,192
Ta 250,230,41216
v_fma_f32 v216, v216, s37, -v246
v_fma_f32 v217, v217, s37, -v246
Mvav 60,252,200
Ta 252,231,33024
WL 3
Mvav 64,240,192
Ta 254,231,41216
v_max3_f32 v251, v251, v214, v215
v_fma_f32 v218, v218, s37, -v246
Mvav 72,240,200
Ta 240,232,33024
Mvav 68,244,192
Ta 242,232,41216
v_fma_f32 v219, v219, s37, -v246
v_max3_f32 v252, v252, v216, v217
Mvav 76,244,200
Ta 244,233,33024
WL 3
Mvav 80,248,192
Ta 246,233,41216
v_fma_f32 v220, v220, s37, -v246
v_fma_f32 v221, v221, s37, -v246
Mvav 88,248,200
Ta 248,234,33024
Mvav 84,252,192
Ta 250,234,41216
v_max3_f32 v251, v251, v218, v219
Mvav 92,252,200
Ta 252,235,33024
v_fma_f32 v222, v222, s37, -v246
WL 3
Mvav 96,240,192
Ta 254,235,41216
v_fma_f32 v223, v223, s37, -v246
Mvav 104,240,200
Ta 240,236,16384
v_max3_f32 v252, v252, v220, v221
Mvav 100,244,192
Ta 242,236,24576
v_max3_f32 v251, v251, v222, v223
Mvav 108,244,200
Ta 244,237,16384
v_max_f32 v251, v251, v252
WL 3
Mvav 112,248,192
Ta 246,237,24576
v_cmp_lt_f32 vcc, s38, v251
Mvav 120,248,200
Ta 248,238,16384
s_cbranch_vccnz LA_ra25
LA_rb25:
Mvav 116,252,192
Ta 250,238,24576
Mvav 124,252,200
Ta 252,239,16384
s_cmp_lg_u32 s49, 0
s_cbranch_scc1 LA_ra26
LA_rb26:
WL 3
Maaa 0,240,216
Ta 254,239,24576
Maaa 8,240,220
Ta 240,240,16384
v_exp_f32 v208, v208
Maaa 4,244,216
Ta 242,240,24576
Maaa 12,244,220
Ta 244,241,16384
WL 3
Maaa 16,248,216
Ta 246,241,24576
v_exp_f32 v216, v216
Maaa 24,248,220
Ta 248,242,16384
Maaa 20,252,216
Ta 250,242,24576
v_add_f32 v247, v247, v208
Maaa 28,252,220
Ta 252,243,16384
WL 3
Maaa 32,240,216
Ta 254,243,24576
Maaa 40,240,220
Ta 240,236,16640
v_exp_f32 v209, v209
Maaa 36,244,216
Ta 242,236,24832
Maaa 44,244,220
Ta 244,237,16640
v_add_f32 v248, v248, v216
WL 3
Maaa 48,248,216
Ta 246,237,24832
Maaa 56,248,220
Ta 248,238,16640
Maaa 52,252,216
Ta 250,238,24832
v_exp_f32 v217, v217
Maaa 60,252,220
Ta 252,239,16640
WL 3
Maaa 64,240,216
Ta 254,239,24832
v_add_f32 v247, v247, v209
Maaa 72,240,220
Ta 240,240,16640
Maaa 68,244,216
Ta 242,240,24832
CV 208,208,209
Maaa 76,244,220
Ta 244,241,16640
WL 3
Maaa 80,248,216
Ta 246,241,24832
v_exp_f32 v210, v210
Maaa 88,248,220
Ta 248,242,16640
Maaa 84,252,216
Ta 250,242,24832
v_add_f32 v248, v248, v217
Maaa 92,252,220
Ta 252,243,16640
WL 3
Maaa 96,240,216
Ta 254,243,24832
CV 216,216,217
Maaa 104,240,220
v_exp_f32 v218, v218
Maaa 100,244,216
v_add_f32 v247, v247, v210
Maaa 108,244,220
WL 0
s_barrier
Ba 240,224,0
Ba 244,224,8192
Maaa 112,248,216
v_exp_f32 v211, v211
Maaa 120,248,220
Ba 248,225,0
v_add_f32 v248, v248, v218
Maaa 116,252,216
v_exp_f32 v219, v219
Maaa 124,252,220
Ba 252,225,8192
WL 2
v_mfma_f32_16x16x32_bf16 v[192:195], a[240:243], v[128:131], 0
v_add_f32 v247, v247, v211
CV 209,210,211
v_mfma_f32_16x16x32_bf16 v[200:203], a[240:243], v[132:135], 0
Ba 240,226,0
v_mfma_f32_16x16x32_bf16 v[196:199], a[244:247], v[128:131], 0
v_exp_f32 v212, v212
v_mfma_f32_16x16x32_bf16 v[204:207], a[244:247], v[132:135], 0
Ba 244,226,8192
WL 2
Mvav 192,248,136
v_add_f32 v248, v248, v219
CV 217,218,219
Mvav 200,248,140
Ba 248,227,0
Mvav 196,252,136
v_exp_f32 v220, v220
v_add_f32 v247, v247, v212
Mvav 204,252,140
Ba 252,227,8192
WL 2
Mvav 192,240,144
v_exp_f32 v213, v213
Mvav 200,240,148
Ba 240,224,256
Mvav 196,244,144
v_add_f32 v248, v248, v220
v_exp_f32 v221, v221
Mvav 204,244,148
Ba 244,224,8448
WL 2
Mvav 192,248,152
v_add_f32 v247, v247, v213
Mvav 200,248,156
Ba 248,225,256
CV 210,212,213
Mvav 196,252,152
v_exp_f32 v214, v214
Mvav 204,252,156
Ba 252,225,8448
WL 2
Mvav 192,240,160
v_add_f32 v248, v248, v221
CV 218,220,221
Mvav 200,240,164
Ba 240,226,256
Mvav 196,244,160
v_exp_f32 v222, v222
Mvav 204,244,164
Ba 244,226,8448
v_add_f32 v247, v247, v214
WL 2
Mvav 192,248,168
v_exp_f32 v215, v215
Mvav 200,248,172
Ba 248,227,256
Mvav 196,252,168
v_add_f32 v248, v248, v222
Mvav 204,252,172
Ba 252,227,8448
v_exp_f32 v223, v223
WL 2
Mvav 192,240,176
v_add_f32 v247, v247, v215
Mvav 200,240,180
Ta 240,228,0
Mvav 196,244,176
Ta 242,228,8192
CV 211,214,215
Mvav 204,244,180
Ta 244,229,0
v_add_f32 v248, v248, v223
WL 3
Mvav 192,248,184
Ta 246,229,8192
CV 219,222,223
Mvav 200,248,188
Ta 248,230,0
Mvav 196,252,184
Ta 250,230,8192
Mvav 204,252,188
Ta 252,231,0
WL 3
Mvav 0,240,208
Ta 254,231,8192
Mvav 8,240,216
Ta 240,232,0
Mvav 4,244,208
Ta 242,232,8192
Mvav 12,244,216
Ta 244,233,0
v_fma_f32 v192, v192, s37, -v245
WL 3
Mvav 16,248,208
Ta 246,233,8192
v_fma_f32 v193, v193, s37, -v245
Mvav 24,248,216
Ta 248,234,0
v_fma_f32 v194, v194, s37, -v245
Mvav 20,252,208
Ta 250,234,8192
v_fma_f32 v195, v195, s37, -v245
Mvav 28,252,216
Ta 252,235,0
v_fma_f32 v196, v196, s37, -v245
WL 3
Mvav 32,240,208
Ta 254,235,8192
v_fma_f32 v197, v197, s37, -v245
Mvav 40,240,216
Ta 240,228,256
v_max3_f32 v251, v192, v193, v194
Mvav 36,244,208
Ta 242,228,8448
v_fma_f32 v198, v198, s37, -v245
Mvav 44,244,216
Ta 244,229,256
v_fma_f32 v199, v199, s37, -v245
WL 3
Mvav 48,248,208
Ta 246,229,8448
v_max3_f32 v252, v195, v196, v197
Mvav 56,248,216
Ta 248,230,256
Mvav 52,252,208
Ta 250,230,8448
v_fma_f32 v200, v200, s37, -v246
v_fma_f32 v201, v201, s37, -v246
Mvav 60,252,216
Ta 252,231,256
WL 3
Mvav 64,240,208
Ta 254,231,8448
v_max3_f32 v251, v251, v198, v199
v_fma_f32 v202, v202, s37, -v246
Mvav 72,240,216
Ta 240,232,256
Mvav 68,244,208
Ta 242,232,8448
v_fma_f32 v203, v203, s37, -v246
v_max3_f32 v252, v252, v200, v201
Mvav 76,244,216
Ta 244,233,256
WL 3
Mvav 80,248,208
Ta 246,233,8448
v_fma_f32 v204, v204, s37, -v246
v_fma_f32 v205, v205, s37, -v246
Mvav 88,248,216
Ta 248,234,256
Mvav 84,252,208
Ta 250,234,8448
v_max3_f32 v251, v251, v202, v203
Mvav 92,252,216
Ta 252,235,256
v_fma_f32 v206, v206, s37, -v246
WL 3
Mvav 96,240,208
Ta 254,235,8448
v_fma_f32 v207, v207, s37, -v246
Mvav 104,240,216
Ta 240,236,32768
v_max3_f32 v252, v252, v204, v205
Mvav 100,244,208
Ta 242,236,40960
v_max3_f32 v251, v251, v206, v207
Mvav 108,244,216
Ta 244,237,32768
v_max_f32 v251, v251, v252
WL 3
Mvav 112,248,208
Ta 246,237,40960
v_cmp_lt_f32 vcc, s38, v251
Mvav 120,248,216
Ta 248,238,32768
s_cbranch_vccnz LA_ra27
LA_rb27:
Mvav 116,252,208
Ta 250,238,40960
Mvav 124,252,216
Ta 252,239,32768
s_cmp_lg_u32 s49, 0
s_cbranch_scc1 LA_ra28
LA_rb28:
WL 3
Maaa 0,240,224
Ta 254,239,40960
Maaa 8,240,228
Ta 240,240,32768
v_exp_f32 v192, v192
Maaa 4,244,224
Ta 242,240,40960
Maaa 12,244,228
Ta 244,241,32768
WL 3
Maaa 16,248,224
Ta 246,241,40960
v_exp_f32 v200, v200
Maaa 24,248,228
Ta 248,242,32768
Maaa 20,252,224
Ta 250,242,40960
v_add_f32 v247, v247, v192
Maaa 28,252,228
Ta 252,243,32768
WL 3
Maaa 32,240,224
Ta 254,243,40960
Maaa 40,240,228
Ta 240,236,33024
v_exp_f32 v193, v193
Maaa 36,244,224
Ta 242,236,41216
Maaa 44,244,228
Ta 244,237,33024
v_add_f32 v248, v248, v200
WL 3
Maaa 48,248,224
Ta 246,237,41216
Maaa 56,248,228
Ta 248,238,33024
Maaa 52,252,224
Ta 250,238,41216
v_exp_f32 v201, v201
Maaa 60,252,228
Ta 252,239,33024
WL 3
Maaa 64,240,224
Ta 254,239,41216
v_add_f32 v247, v247, v193
Maaa 72,240,228
Ta 240,240,33024
Maaa 68,244,224
Ta 242,240,41216
CV 192,192,193
Maaa 76,244,228
Ta 244,241,33024
WL 3
Maaa 80,248,224
Ta 246,241,41216
v_exp_f32 v194, v194
Maaa 88,248,228
Ta 248,242,33024
Maaa 84,252,224
Ta 250,242,41216
v_add_f32 v248, v248, v201
Maaa 92,252,228
Ta 252,243,33024
WL 3
Maaa 96,240,224
Ta 254,243,41216
CV 200,200,201
Maaa 104,240,228
v_exp_f32 v202, v202
Maaa 100,244,224
v_add_f32 v247, v247, v194
Maaa 108,244,228
WL 0
s_barrier
Ba 240,224,16384
Ba 244,224,24576
Maaa 112,248,224
v_exp_f32 v195, v195
Maaa 120,248,228
Ba 248,225,16384
v_add_f32 v248, v248, v202
Maaa 116,252,224
v_exp_f32 v203, v203
Maaa 124,252,228
Ba 252,225,24576
WL 2
v_mfma_f32_16x16x32_bf16 v[208:211], a[240:243], v[128:131], 0
v_add_f32 v247, v247, v195
CV 193,194,195
v_mfma_f32_16x16x32_bf16 v[216:219], a[240:243], v[132:135], 0
Ba 240,226,16384
v_mfma_f32_16x16x32_bf16 v[212:215], a[244:247], v[128:131], 0
v_exp_f32 v196, v196
v_mfma_f32_16x16x32_bf16 v[220:223], a[244:247], v[132:135], 0
Ba 244,226,24576
WL 2
Mvav 208,248,136
v_add_f32 v248, v248, v203
CV 201,202,203
Mvav 216,248,140
Ba 248,227,16384
Mvav 212,252,136
v_exp_f32 v204, v204
v_add_f32 v247, v247, v196
Mvav 220,252,140
Ba 252,227,24576
WL 2
Mvav 208,240,144
v_exp_f32 v197, v197
Mvav 216,240,148
Ba 240,224,16640
Mvav 212,244,144
v_add_f32 v248, v248, v204
v_exp_f32 v205, v205
Mvav 220,244,148
Ba 244,224,24832
WL 2
Mvav 208,248,152
v_add_f32 v247, v247, v197
Mvav 216,248,156
Ba 248,225,16640
CV 194,196,197
Mvav 212,252,152
v_exp_f32 v198, v198
Mvav 220,252,156
Ba 252,225,24832
WL 2
Mvav 208,240,160
v_add_f32 v248, v248, v205
CV 202,204,205
Mvav 216,240,164
Ba 240,226,16640
Mvav 212,244,160
v_exp_f32 v206, v206
Mvav 220,244,164
Ba 244,226,24832
v_add_f32 v247, v247, v198
WL 2
Mvav 208,248,168
v_exp_f32 v199, v199
Mvav 216,248,172
Ba 248,227,16640
Mvav 212,252,168
v_add_f32 v248, v248, v206
Mvav 220,252,172
Ba 252,227,24832
v_exp_f32 v207, v207
WL 2
Mvav 208,240,176
v_add_f32 v247, v247, v199
Mvav 216,240,180
Ta 240,228,16384
Mvav 212,244,176
Ta 242,228,24576
CV 195,198,199
Mvav 220,244,180
Ta 244,229,16384
v_add_f32 v248, v248, v207
WL 3
Mvav 208,248,184
Ta 246,229,24576
CV 203,206,207
Mvav 216,248,188
Ta 248,230,16384
Mvav 212,252,184
Ta 250,230,24576
Mvav 220,252,188
Ta 252,231,16384
WL 3
Mvav 0,240,192
Ta 254,231,24576
Mvav 8,240,200
Ta 240,232,16384
Mvav 4,244,192
Ta 242,232,24576
Mvav 12,244,200
Ta 244,233,16384
v_fma_f32 v208, v208, s37, -v245
WL 3
Mvav 16,248,192
Ta 246,233,24576
v_fma_f32 v209, v209, s37, -v245
Mvav 24,248,200
Ta 248,234,16384
v_fma_f32 v210, v210, s37, -v245
Mvav 20,252,192
Ta 250,234,24576
v_fma_f32 v211, v211, s37, -v245
Mvav 28,252,200
Ta 252,235,16384
v_fma_f32 v212, v212, s37, -v245
WL 3
Mvav 32,240,192
Ta 254,235,24576
v_fma_f32 v213, v213, s37, -v245
Mvav 40,240,200
Ta 240,228,16640
v_max3_f32 v251, v208, v209, v210
Mvav 36,244,192
Ta 242,228,24832
v_fma_f32 v214, v214, s37, -v245
Mvav 44,244,200
Ta 244,229,16640
v_fma_f32 v215, v215, s37, -v245
WL 3
Mvav 48,248,192
Ta 246,229,24832
v_max3_f32 v252, v211, v212, v213
Mvav 56,248,200
Ta 248,230,16640
Mvav 52,252,192
Ta 250,230,24832
v_fma_f32 v216, v216, s37, -v246
v_fma_f32 v217, v217, s37, -v246
Mvav 60,252,200
Ta 252,231,16640
WL 3
Mvav 64,240,192
Ta 254,231,24832
v_max3_f32 v251, v251, v214, v215
v_fma_f32 v218, v218, s37, -v246
Mvav 72,240,200
Ta 240,232,16640
Mvav 68,244,192
Ta 242,232,24832
v_fma_f32 v219, v219, s37, -v246
v_max3_f32 v252, v252, v216, v217
Mvav 76,244,200
Ta 244,233,16640
WL 3
Mvav 80,248,192
Ta 246,233,24832
v_fma_f32 v220, v220, s37, -v246
v_fma_f32 v221, v221, s37, -v246
Mvav 88,248,200
Ta 248,234,16640
Mvav 84,252,192
Ta 250,234,24832
v_max3_f32 v251, v251, v218, v219
Mvav 92,252,200
Ta 252,235,16640
v_fma_f32 v222, v222, s37, -v246
WL 3
Mvav 96,240,192
Ta 254,235,24832
v_fma_f32 v223, v223, s37, -v246
Mvav 104,240,200
Ta 240,236,49152
v_max3_f32 v252, v252, v220, v221
Mvav 100,244,192
Ta 242,236,57344
v_max3_f32 v251, v251, v222, v223
Mvav 108,244,200
Ta 244,237,49152
v_max_f32 v251, v251, v252
WL 3
Mvav 112,248,192
Ta 246,237,57344
v_cmp_lt_f32 vcc, s38, v251
Mvav 120,248,200
Ta 248,238,49152
s_cbranch_vccnz LA_ra29
LA_rb29:
Mvav 116,252,192
Ta 250,238,57344
Mvav 124,252,200
Ta 252,239,49152
s_cmp_lg_u32 s49, 0
s_cbranch_scc1 LA_ra30
LA_rb30:
WL 3
Maaa 0,240,232
Ta 254,239,57344
v_exp_f32 v208, v208
v_exp_f32 v216, v216
Maaa 8,240,236
Ta 240,240,49152
v_add_f32 v247, v247, v208
Maaa 4,244,232
Ta 242,240,57344
v_exp_f32 v209, v209
v_add_f32 v248, v248, v216
Maaa 12,244,236
Ta 244,241,49152
v_exp_f32 v217, v217
v_add_f32 v247, v247, v209
WL 3
Maaa 16,248,232
Ta 246,241,57344
CV 208,208,209
v_exp_f32 v210, v210
Maaa 24,248,236
Ta 248,242,49152
v_add_f32 v248, v248, v217
CV 216,216,217
Maaa 20,252,232
Ta 250,242,57344
v_exp_f32 v218, v218
v_add_f32 v247, v247, v210
Maaa 28,252,236
Ta 252,243,49152
v_exp_f32 v211, v211
v_add_f32 v248, v248, v218
WL 3
Maaa 32,240,232
Ta 254,243,57344
v_exp_f32 v219, v219
v_add_f32 v247, v247, v211
Maaa 40,240,236
Ta 240,236,49408
CV 209,210,211
v_exp_f32 v212, v212
Maaa 36,244,232
Ta 242,236,57600
v_add_f32 v248, v248, v219
CV 217,218,219
Maaa 44,244,236
Ta 244,237,49408
AR 128,0
AR 253,1
CV 128,128,253
AR 129,2
AR 254,3
CV 129,129,254
WL 3
Maaa 48,248,232
Ta 246,237,57600
AR 130,4
AR 253,5
CV 130,130,253
AR 131,6
AR 254,7
CV 131,131,254
AR 132,8
Maaa 56,248,236
Ta 248,238,49408
AR 253,9
CV 132,132,253
AR 133,10
AR 254,11
CV 133,133,254
AR 134,12
Maaa 52,252,232
Ta 250,238,57600
AR 253,13
CV 134,134,253
AR 135,14
AR 254,15
CV 135,135,254
v_permlane32_swap_b32 v128, v130
v_permlane32_swap_b32 v129, v131
Maaa 60,252,236
Ta 252,239,49408
v_permlane16_swap_b32 v128, v130
v_permlane16_swap_b32 v129, v131
v_permlane32_swap_b32 v132, v134
v_permlane32_swap_b32 v133, v135
s_nop 0
v_permlane16_swap_b32 v132, v134
v_permlane16_swap_b32 v133, v135
WL 3
Maaa 64,240,232
Ta 254,239,57600
v_exp_f32 v220, v220
v_add_f32 v247, v247, v212
Maaa 72,240,236
Ta 240,240,49408
AR 136,16
AR 253,17
CV 136,136,253
AR 137,18
AR 254,19
CV 137,137,254
Maaa 68,244,232
Ta 242,240,57600
AR 138,20
AR 253,21
CV 138,138,253
AR 139,22
AR 254,23
CV 139,139,254
AR 140,24
Maaa 76,244,236
Ta 244,241,49408
AR 253,25
CV 140,140,253
AR 141,26
AR 254,27
CV 141,141,254
AR 142,28
WL 3
Maaa 80,248,232
Ta 246,241,57600
AR 253,29
CV 142,142,253
AR 143,30
AR 254,31
CV 143,143,254
v_permlane32_swap_b32 v136, v138
v_permlane32_swap_b32 v137, v139
Maaa 88,248,236
Ta 248,242,49408
v_permlane16_swap_b32 v136, v138
v_permlane16_swap_b32 v137, v139
v_permlane32_swap_b32 v140, v142
v_permlane32_swap_b32 v141, v143
s_nop 0
v_permlane16_swap_b32 v140, v142
v_permlane16_swap_b32 v141, v143
Maaa 84,252,232
Ta 250,242,57600
v_exp_f32 v213, v213
v_add_f32 v248, v248, v220
Maaa 92,252,236
Ta 252,243,49408
AR 144,32
AR 253,33
CV 144,144,253
AR 145,34
AR 254,35
CV 145,145,254
WL 3
Maaa 96,240,232
Ta 254,243,57600
AR 146,36
AR 253,37
CV 146,146,253
AR 147,38
AR 254,39
CV 147,147,254
AR 148,40
Maaa 104,240,236
AR 253,41
CV 148,148,253
AR 149,42
AR 254,43
CV 149,149,254
AR 150,44
AR 253,45
CV 150,150,253
Maaa 100,244,232
AR 151,46
AR 254,47
CV 151,151,254
v_permlane32_swap_b32 v144, v146
v_permlane32_swap_b32 v145, v147
s_nop 0
v_permlane16_swap_b32 v144, v146
v_permlane16_swap_b32 v145, v147
v_permlane32_swap_b32 v148, v150
Maaa 108,244,236
WL 0
s_barrier
Ba 240,224,32768
Ba 244,224,40960
v_permlane32_swap_b32 v149, v151
v_permlane16_swap_b32 v148, v150
s_nop 0
v_permlane16_swap_b32 v149, v151
Maaa 112,248,232
v_exp_f32 v221, v221
v_add_f32 v247, v247, v213
CV 210,212,213
Maaa 120,248,236
Ba 248,225,32768
AR 152,48
AR 253,49
CV 152,152,253
AR 153,50
AR 254,51
CV 153,153,254
Maaa 116,252,232
AR 154,52
AR 253,53
CV 154,154,253
AR 155,54
AR 254,55
CV 155,155,254
AR 156,56
Maaa 124,252,236
Ba 252,225,40960
AR 253,57
CV 156,156,253
AR 157,58
AR 254,59
CV 157,157,254
AR 158,60
WL 2
v_mfma_f32_16x16x32_bf16 v[192:195], a[240:243], v[128:131], 0
AR 253,61
CV 158,158,253
AR 159,62
AR 254,63
CV 159,159,254
v_permlane32_swap_b32 v152, v154
v_permlane32_swap_b32 v153, v155
v_mfma_f32_16x16x32_bf16 v[200:203], a[240:243], v[132:135], 0
Ba 240,226,32768
v_permlane16_swap_b32 v152, v154
v_permlane16_swap_b32 v153, v155
v_permlane32_swap_b32 v156, v158
v_permlane32_swap_b32 v157, v159
s_nop 0
v_permlane16_swap_b32 v156, v158
v_permlane16_swap_b32 v157, v159
v_mfma_f32_16x16x32_bf16 v[196:199], a[244:247], v[128:131], 0
v_exp_f32 v214, v214
v_add_f32 v248, v248, v221
CV 218,220,221
v_mfma_f32_16x16x32_bf16 v[204:207], a[244:247], v[132:135], 0
Ba 244,226,40960
AR 160,64
AR 253,65
CV 160,160,253
AR 161,66
AR 254,67
CV 161,161,254
WL 2
Mvav 192,248,136
AR 162,68
AR 253,69
CV 162,162,253
AR 163,70
AR 254,71
CV 163,163,254
AR 164,72
Mvav 200,248,140
Ba 248,227,32768
AR 253,73
CV 164,164,253
AR 165,74
AR 254,75
CV 165,165,254
AR 166,76
Mvav 196,252,136
AR 253,77
CV 166,166,253
AR 167,78
AR 254,79
CV 167,167,254
v_permlane32_swap_b32 v160, v162
v_permlane32_swap_b32 v161, v163
Mvav 204,252,140
Ba 252,227,40960
v_permlane16_swap_b32 v160, v162
v_permlane16_swap_b32 v161, v163
v_permlane32_swap_b32 v164, v166
v_permlane32_swap_b32 v165, v167
s_nop 0
v_permlane16_swap_b32 v164, v166
v_permlane16_swap_b32 v165, v167
WL 2
Mvav 192,240,144
v_exp_f32 v222, v222
v_add_f32 v247, v247, v214
v_exp_f32 v215, v215
Mvav 200,240,148
Ba 240,224,33024
AR 168,80
AR 253,81
CV 168,168,253
AR 169,82
AR 254,83
CV 169,169,254
Mvav 196,244,144
AR 170,84
AR 253,85
CV 170,170,253
AR 171,86
AR 254,87
CV 171,171,254
AR 172,88
Mvav 204,244,148
Ba 244,224,41216
AR 253,89
CV 172,172,253
AR 173,90
AR 254,91
CV 173,173,254
AR 174,92
WL 2
Mvav 192,248,152
AR 253,93
CV 174,174,253
AR 175,94
AR 254,95
CV 175,175,254
v_permlane32_swap_b32 v168, v170
v_permlane32_swap_b32 v169, v171
Mvav 200,248,156
Ba 248,225,33024
v_permlane16_swap_b32 v168, v170
v_permlane16_swap_b32 v169, v171
v_permlane32_swap_b32 v172, v174
v_permlane32_swap_b32 v173, v175
s_nop 0
v_permlane16_swap_b32 v172, v174
v_permlane16_swap_b32 v173, v175
Mvav 196,252,152
v_add_f32 v248, v248, v222
v_exp_f32 v223, v223
Mvav 204,252,156
Ba 252,225,41216
AR 176,96
AR 253,97
CV 176,176,253
AR 177,98
AR 254,99
CV 177,177,254
WL 2
Mvav 192,240,160
AR 178,100
AR 253,101
CV 178,178,253
AR 179,102
AR 254,103
CV 179,179,254
AR 180,104
Mvav 200,240,164
Ba 240,226,33024
AR 253,105
CV 180,180,253
AR 181,106
AR 254,107
CV 181,181,254
AR 182,108
Mvav 196,244,160
AR 253,109
CV 182,182,253
AR 183,110
AR 254,111
CV 183,183,254
v_permlane32_swap_b32 v176, v178
v_permlane32_swap_b32 v177, v179
Mvav 204,244,164
Ba 244,226,41216
v_permlane16_swap_b32 v176, v178
v_permlane16_swap_b32 v177, v179
v_permlane32_swap_b32 v180, v182
v_permlane32_swap_b32 v181, v183
s_nop 0
v_permlane16_swap_b32 v180, v182
v_permlane16_swap_b32 v181, v183
WL 2
Mvav 192,248,168
v_add_f32 v247, v247, v215
CV 211,214,215
v_add_f32 v248, v248, v223
CV 219,222,223
Mvav 200,248,172
Ba 248,227,33024
AR 184,112
AR 253,113
CV 184,184,253
AR 185,114
AR 254,115
CV 185,185,254
Mvav 196,252,168
AR 186,116
AR 253,117
CV 186,186,253
AR 187,118
AR 254,119
CV 187,187,254
AR 188,120
Mvav 204,252,172
Ba 252,227,41216
AR 253,121
CV 188,188,253
AR 189,122
AR 254,123
CV 189,189,254
AR 190,124
WL 2
Mvav 192,240,176
AR 253,125
CV 190,190,253
AR 191,126
AR 254,127
CV 191,191,254
v_permlane32_swap_b32 v184, v186
v_permlane32_swap_b32 v185, v187
Mvav 200,240,180
Ta 240,228,0
v_permlane16_swap_b32 v184, v186
v_permlane16_swap_b32 v185, v187
v_permlane32_swap_b32 v188, v190
v_permlane32_swap_b32 v189, v191
s_nop 0
v_permlane16_swap_b32 v188, v190
v_permlane16_swap_b32 v189, v191
Mvav 196,244,176
Ta 242,228,8192
v_mov_b32 v251, v247
s_nop 1
v_permlane32_swap_b32 v247, v251
v_add_f32 v247, v247, v251
v_mov_b32 v251, v247
Mvav 204,244,180
Ta 244,229,0
v_permlane16_swap_b32 v247, v251
v_add_f32 v247, v247, v251
v_rcp_f32 v249, v247
WL 3
Mvav 192,248,184
Ta 246,229,8192
v_mov_b32 v251, v248
s_nop 1
v_permlane32_swap_b32 v248, v251
v_add_f32 v248, v248, v251
v_mov_b32 v251, v248
Mvav 200,248,188
Ta 248,230,0
v_permlane16_swap_b32 v248, v251
v_add_f32 v248, v248, v251
v_rcp_f32 v250, v248
Mvav 196,252,184
Ta 250,230,8192
Mvav 204,252,188
Ta 252,231,0
WL 3
Mvav 0,240,208
Ta 254,231,8192
Mvav 8,240,216
Ta 240,232,0
Mvav 4,244,208
Ta 242,232,8192
Mvav 12,244,216
Ta 244,233,0
v_mul_f32 v192, s37, v192
v_mul_f32 v193, s37, v193
v_mul_f32 v194, s37, v194
v_mul_f32 v195, s37, v195
v_mul_f32 v196, s37, v196
WL 3
Mvav 16,248,208
Ta 246,233,8192
v_mul_f32 v197, s37, v197
v_mul_f32 v198, s37, v198
v_mul_f32 v199, s37, v199
v_mul_f32 v200, s37, v200
v_mul_f32 v201, s37, v201
Mvav 24,248,216
Ta 248,234,0
v_mul_f32 v202, s37, v202
v_mul_f32 v203, s37, v203
v_mul_f32 v204, s37, v204
v_mul_f32 v205, s37, v205
v_mul_f32 v206, s37, v206
Mvav 20,252,208
Ta 250,234,8192
v_mul_f32 v207, s37, v207
v_max3_f32 v245, v192, v193, v194
v_max3_f32 v245, v245, v195, v196
v_max3_f32 v245, v245, v197, v198
v_max_f32 v245, v245, v199
v_mov_b32 v251, v245
Mvav 28,252,216
Ta 252,235,0
v_permlane32_swap_b32 v245, v251
v_max_f32 v245, v245, v251
v_mov_b32 v251, v245
s_nop 1
v_permlane16_swap_b32 v245, v251
v_max_f32 v245, v245, v251
WL 3
Mvav 32,240,208
Ta 254,235,8192
v_max3_f32 v246, v200, v201, v202
v_max3_f32 v246, v246, v203, v204
v_max3_f32 v246, v246, v205, v206
v_max_f32 v246, v246, v207
v_mov_b32 v251, v246
Mvav 40,240,216
v_mbcnt_lo_u32_b32 v253, -1, 0
v_mbcnt_hi_u32_b32 v253, -1, v253
v_lshrrev_b32 v236, 2, v253
v_lshlrev_b32 v236, 7, v236
v_and_b32 v254, 24, v253
v_lshl_add_u32 v236, v254, 2, v236
v_and_b32 v254, 3, v253
v_lshl_add_u32 v236, v254, 3, v236
v_xor_b32 v237, 32, v236
v_xor_b32 v238, 64, v236
v_xor_b32 v239, 96, v236
Ta 240,228,256
Mvav 36,244,208
Ta 242,228,8448
v_mul_f32 v0, v0, v249
v_mul_f32 v1, v1, v249
v_mul_f32 v2, v2, v249
v_mul_f32 v3, v3, v249
v_mul_f32 v4, v4, v249
v_mul_f32 v5, v5, v249
v_mul_f32 v6, v6, v249
v_mul_f32 v7, v7, v249
Mvav 44,244,216
Ta 244,229,256
CV 0,0,1
CV 2,2,3
CV 4,4,5
CV 6,6,7
AW 128,0
AW 129,2
AW 130,4
AW 131,6
WL 3
Mvav 48,248,208
Ta 246,229,8448
v_mul_f32 v8, v8, v250
v_mul_f32 v9, v9, v250
v_mul_f32 v10, v10, v250
v_mul_f32 v11, v11, v250
v_mul_f32 v12, v12, v250
v_mul_f32 v13, v13, v250
v_mul_f32 v14, v14, v250
v_mul_f32 v15, v15, v250
Mvav 56,248,216
Ta 248,230,256
CV 8,8,9
CV 10,10,11
CV 12,12,13
CV 14,14,15
AW 132,8
AW 133,10
AW 134,12
AW 135,14
Mvav 52,252,208
Ta 250,230,8448
v_permlane32_swap_b32 v246, v251
v_max_f32 v246, v246, v251
v_mov_b32 v251, v246
s_nop 1
v_permlane16_swap_b32 v246, v251
v_max_f32 v246, v246, v251
v_sub_f32 v192, v192, v245
Mvav 60,252,216
Ta 252,231,256
v_mul_f32 v16, v16, v249
v_mul_f32 v17, v17, v249
v_mul_f32 v18, v18, v249
v_mul_f32 v19, v19, v249
v_mul_f32 v20, v20, v249
v_mul_f32 v21, v21, v249
WL 3
Mvav 64,240,208
Ta 254,231,8448
v_mul_f32 v22, v22, v249
v_mul_f32 v23, v23, v249
CV 16,16,17
CV 18,18,19
CV 20,20,21
CV 22,22,23
AW 136,16
Mvav 72,240,216
Ta 240,232,256
AW 137,18
AW 138,20
AW 139,22
v_mul_f32 v24, v24, v250
v_mul_f32 v25, v25, v250
v_mul_f32 v26, v26, v250
Mvav 68,244,208
Ta 242,232,8448
v_mul_f32 v27, v27, v250
v_mul_f32 v28, v28, v250
v_mul_f32 v29, v29, v250
v_mul_f32 v30, v30, v250
v_mul_f32 v31, v31, v250
CV 24,24,25
CV 26,26,27
Mvav 76,244,216
Ta 244,233,256
CV 28,28,29
CV 30,30,31
AW 140,24
AW 141,26
AW 142,28
AW 143,30
WL 3
Mvav 80,248,208
Ta 246,233,8448
v_sub_f32 v200, v200, v246
v_sub_f32 v193, v193, v245
v_sub_f32 v201, v201, v246
v_sub_f32 v194, v194, v245
v_sub_f32 v202, v202, v246
Mvav 88,248,216
Ta 248,234,256
v_mul_f32 v32, v32, v249
v_mul_f32 v33, v33, v249
v_mul_f32 v34, v34, v249
v_mul_f32 v35, v35, v249
v_mul_f32 v36, v36, v249
Mvav 84,252,208
Ta 250,234,8448
v_mul_f32 v37, v37, v249
v_mul_f32 v38, v38, v249
v_mul_f32 v39, v39, v249
CV 32,32,33
CV 34,34,35
v_sub_f32 v195, v195, v245
Mvav 92,252,216
Ta 252,235,256
CV 36,36,37
CV 38,38,39
AW 144,32
AW 145,34
v_sub_f32 v203, v203, v246
WL 3
Mvav 96,240,208
Ta 254,235,8448
AW 146,36
AW 147,38
v_mul_f32 v40, v40, v250
v_mul_f32 v41, v41, v250
v_mul_f32 v42, v42, v250
Mvav 104,240,216
v_mul_f32 v43, v43, v250
v_mul_f32 v44, v44, v250
v_mul_f32 v45, v45, v250
v_mul_f32 v46, v46, v250
v_mul_f32 v47, v47, v250
CV 40,40,41
Mvav 100,244,208
CV 42,42,43
CV 44,44,45
CV 46,46,47
AW 148,40
AW 149,42
AW 150,44
v_sub_f32 v196, v196, v245
Mvav 108,244,216
WL 0
s_barrier
Ba 240,224,0
Ba 244,224,8192
AW 151,46
v_sub_f32 v204, v204, v246
Mvav 112,248,208
v_sub_f32 v197, v197, v245
v_sub_f32 v205, v205, v246
v_sub_f32 v198, v198, v245
v_sub_f32 v206, v206, v246
v_sub_f32 v199, v199, v245
v_sub_f32 v207, v207, v246
Mvav 120,248,216
Ba 248,225,0
v_mul_f32 v48, v48, v249
v_mul_f32 v49, v49, v249
v_mul_f32 v50, v50, v249
v_mul_f32 v51, v51, v249
v_mul_f32 v52, v52, v249
v_mul_f32 v53, v53, v249
Mvav 116,252,208
v_mul_f32 v54, v54, v249
v_mul_f32 v55, v55, v249
CV 48,48,49
CV 50,50,51
CV 52,52,53
CV 54,54,55
AW 152,48
Mvav 124,252,216
Ba 252,225,8192
AW 153,50
AW 154,52
AW 155,54
v_mul_f32 v56, v56, v250
v_mul_f32 v57, v57, v250
v_mul_f32 v58, v58, v250
WL 2
v_mfma_f32_16x16x32_bf16 v[208:211], a[240:243], v[128:131], 0
v_mul_f32 v59, v59, v250
v_mul_f32 v60, v60, v250
v_mul_f32 v61, v61, v250
v_mul_f32 v62, v62, v250
v_mul_f32 v63, v63, v250
CV 56,56,57
CV 58,58,59
v_mfma_f32_16x16x32_bf16 v[216:219], a[240:243], v[132:135], 0
Ba 240,226,0
CV 60,60,61
CV 62,62,63
AW 156,56
AW 157,58
AW 158,60
AW 159,62
v_mfma_f32_16x16x32_bf16 v[212:215], a[244:247], v[128:131], 0
v_exp_f32 v192, v192
v_exp_f32 v200, v200
v_mov_b32 v247, v192
v_exp_f32 v193, v193
v_mov_b32 v248, v200
v_mfma_f32_16x16x32_bf16 v[220:223], a[244:247], v[132:135], 0
Ba 244,226,8192
v_mul_f32 v64, v64, v249
v_mul_f32 v65, v65, v249
v_mul_f32 v66, v66, v249
v_mul_f32 v67, v67, v249
v_mul_f32 v68, v68, v249
v_mul_f32 v69, v69, v249
WL 2
Mvav 208,248,136
v_mul_f32 v70, v70, v249
v_mul_f32 v71, v71, v249
CV 64,64,65
CV 66,66,67
CV 68,68,69
CV 70,70,71
AW 160,64
Mvav 216,248,140
Ba 248,227,0
AW 161,66
AW 162,68
AW 163,70
v_mul_f32 v72, v72, v250
v_mul_f32 v73, v73, v250
v_mul_f32 v74, v74, v250
Mvav 212,252,136
v_mul_f32 v75, v75, v250
v_mul_f32 v76, v76, v250
v_mul_f32 v77, v77, v250
v_mul_f32 v78, v78, v250
v_mul_f32 v79, v79, v250
CV 72,72,73
CV 74,74,75
Mvav 220,252,140
Ba 252,227,8192
CV 76,76,77
CV 78,78,79
AW 164,72
AW 165,74
AW 166,76
AW 167,78
WL 2
Mvav 208,240,144
v_exp_f32 v201, v201
v_add_f32 v247, v247, v193
CV 192,192,193
v_exp_f32 v194, v194
v_add_f32 v248, v248, v201
CV 200,200,201
Mvav 216,240,148
Ba 240,224,256
v_mul_f32 v80, v80, v249
v_mul_f32 v81, v81, v249
v_mul_f32 v82, v82, v249
v_mul_f32 v83, v83, v249
v_exp_f32 v202, v202
Mvav 212,244,144
v_mul_f32 v84, v84, v249
v_mul_f32 v85, v85, v249
v_mul_f32 v86, v86, v249
v_mul_f32 v87, v87, v249
CV 80,80,81
v_add_f32 v247, v247, v194
Mvav 220,244,148
Ba 244,224,8448
CV 82,82,83
CV 84,84,85
CV 86,86,87
AW 168,80
v_exp_f32 v195, v195
v_add_f32 v248, v248, v202
WL 2
Mvav 208,248,152
AW 169,82
AW 170,84
AW 171,86
v_mul_f32 v88, v88, v250
v_mul_f32 v89, v89, v250
v_mul_f32 v90, v90, v250
v_exp_f32 v203, v203
Mvav 216,248,156
Ba 248,225,256
v_mul_f32 v91, v91, v250
v_mul_f32 v92, v92, v250
v_mul_f32 v93, v93, v250
v_mul_f32 v94, v94, v250
v_add_f32 v247, v247, v195
Mvav 212,252,152
v_mul_f32 v95, v95, v250
CV 88,88,89
CV 90,90,91
CV 92,92,93
CV 94,94,95
CV 193,194,195
v_exp_f32 v196, v196
Mvav 220,252,156
Ba 252,225,8448
AW 172,88
AW 173,90
AW 174,92
AW 175,94
v_add_f32 v248, v248, v203
WL 2
Mvav 208,240,160
CV 201,202,203
v_exp_f32 v204, v204
v_add_f32 v247, v247, v196
v_exp_f32 v197, v197
v_add_f32 v248, v248, v204
Mvav 216,240,164
Ba 240,226,256
v_mul_f32 v96, v96, v249
v_mul_f32 v97, v97, v249
v_mul_f32 v98, v98, v249
v_mul_f32 v99, v99, v249
v_mul_f32 v100, v100, v249
v_mul_f32 v101, v101, v249
Mvav 212,244,160
v_mul_f32 v102, v102, v249
v_mul_f32 v103, v103, v249
CV 96,96,97
CV 98,98,99
CV 100,100,101
CV 102,102,103
AW 176,96
Mvav 220,244,164
Ba 244,226,8448
AW 177,98
AW 178,100
AW 179,102
v_mul_f32 v104, v104, v250
v_mul_f32 v105, v105, v250
v_mul_f32 v106, v106, v250
WL 2
Mvav 208,248,168
v_mul_f32 v107, v107, v250
v_mul_f32 v108, v108, v250
v_mul_f32 v109, v109, v250
v_mul_f32 v110, v110, v250
v_mul_f32 v111, v111, v250
CV 104,104,105
CV 106,106,107
v_exp_f32 v205, v205
Mvav 216,248,172
Ba 248,227,256
CV 108,108,109
CV 110,110,111
AW 180,104
AW 181,106
AW 182,108
AW 183,110
Mvav 212,252,168
v_add_f32 v247, v247, v197
CV 194,196,197
v_exp_f32 v198, v198
v_add_f32 v248, v248, v205
CV 202,204,205
Mvav 220,252,172
Ba 252,227,8448
v_mul_f32 v112, v112, v249
v_mul_f32 v113, v113, v249
v_mul_f32 v114, v114, v249
v_mul_f32 v115, v115, v249
v_exp_f32 v206, v206
WL 2
Mvav 208,240,176
v_mul_f32 v116, v116, v249
v_mul_f32 v117, v117, v249
v_mul_f32 v118, v118, v249
v_mul_f32 v119, v119, v249
CV 112,112,113
CV 114,114,115
v_add_f32 v247, v247, v198
Mvav 216,240,180
Ta 240,228,32768
CV 116,116,117
CV 118,118,119
AW 184,112
AW 185,114
v_exp_f32 v199, v199
v_add_f32 v248, v248, v206
Mvav 212,244,176
Ta 242,228,40960
AW 186,116
AW 187,118
v_mul_f32 v120, v120, v250
v_mul_f32 v121, v121, v250
v_mul_f32 v122, v122, v250
Mvav 220,244,180
Ta 244,229,32768
v_mul_f32 v123, v123, v250
v_mul_f32 v124, v124, v250
v_mul_f32 v125, v125, v250
v_mul_f32 v126, v126, v250
v_exp_f32 v207, v207
v_add_f32 v247, v247, v199
WL 3
Mvav 208,248,184
Ta 246,229,40960
v_mul_f32 v127, v127, v250
CV 120,120,121
CV 122,122,123
CV 124,124,125
CV 126,126,127
CV 195,198,199
Mvav 216,248,188
Ta 248,230,32768
AW 188,120
AW 189,122
AW 190,124
AW 191,126
v_add_f32 v248, v248, v207
CV 203,206,207
Mvav 212,252,184
Ta 250,230,40960
Mvav 220,252,188
Ta 252,231,32768
WL 3
v_mfma_f32_16x16x32_bf16 v[0:3], a[240:243], v[192:195], 0
Ta 254,231,40960
v_mfma_f32_16x16x32_bf16 v[8:11], a[240:243], v[200:203], 0
Ta 240,232,32768
v_mfma_f32_16x16x32_bf16 v[4:7], a[244:247], v[192:195], 0
Ta 242,232,40960
v_mfma_f32_16x16x32_bf16 v[12:15], a[244:247], v[200:203], 0
Ta 244,233,32768
v_fma_f32 v208, v208, s37, -v245
WL 3
v_mfma_f32_16x16x32_bf16 v[16:19], a[248:251], v[192:195], 0
Ta 246,233,40960
v_fma_f32 v209, v209, s37, -v245
v_mfma_f32_16x16x32_bf16 v[24:27], a[248:251], v[200:203], 0
Ta 248,234,32768
v_fma_f32 v210, v210, s37, -v245
v_mfma_f32_16x16x32_bf16 v[20:23], a[252:255], v[192:195], 0
Ta 250,234,40960
v_fma_f32 v211, v211, s37, -v245
v_mfma_f32_16x16x32_bf16 v[28:31], a[252:255], v[200:203], 0
Ta 252,235,32768
v_fma_f32 v212, v212, s37, -v245
WL 3
v_mfma_f32_16x16x32_bf16 v[32:35], a[240:243], v[192:195], 0
Ta 254,235,40960
v_fma_f32 v213, v213, s37, -v245
v_mfma_f32_16x16x32_bf16 v[40:43], a[240:243], v[200:203], 0
Ta 240,228,33024
v_max3_f32 v251, v208, v209, v210
v_mfma_f32_16x16x32_bf16 v[36:39], a[244:247], v[192:195], 0
Ta 242,228,41216
v_fma_f32 v214, v214, s37, -v245
v_mfma_f32_16x16x32_bf16 v[44:47], a[244:247], v[200:203], 0
Ta 244,229,33024
v_fma_f32 v215, v215, s37, -v245
WL 3
v_mfma_f32_16x16x32_bf16 v[48:51], a[248:251], v[192:195], 0
Ta 246,229,41216
v_max3_f32 v252, v211, v212, v213
v_mfma_f32_16x16x32_bf16 v[56:59], a[248:251], v[200:203], 0
Ta 248,230,33024
v_mfma_f32_16x16x32_bf16 v[52:55], a[252:255], v[192:195], 0
Ta 250,230,41216
v_fma_f32 v216, v216, s37, -v246
v_fma_f32 v217, v217, s37, -v246
v_mfma_f32_16x16x32_bf16 v[60:63], a[252:255], v[200:203], 0
Ta 252,231,33024
WL 3
v_mfma_f32_16x16x32_bf16 v[64:67], a[240:243], v[192:195], 0
Ta 254,231,41216
v_max3_f32 v251, v251, v214, v215
v_fma_f32 v218, v218, s37, -v246
v_mfma_f32_16x16x32_bf16 v[72:75], a[240:243], v[200:203], 0
Ta 240,232,33024
v_mfma_f32_16x16x32_bf16 v[68:71], a[244:247], v[192:195], 0
Ta 242,232,41216
v_fma_f32 v219, v219, s37, -v246
v_max3_f32 v252, v252, v216, v217
v_mfma_f32_16x16x32_bf16 v[76:79], a[244:247], v[200:203], 0
Ta 244,233,33024
WL 3
v_mfma_f32_16x16x32_bf16 v[80:83], a[248:251], v[192:195], 0
Ta 246,233,41216
v_fma_f32 v220, v220, s37, -v246
v_fma_f32 v221, v221, s37, -v246
v_mfma_f32_16x16x32_bf16 v[88:91], a[248:251], v[200:203], 0
Ta 248,234,33024
v_mfma_f32_16x16x32_bf16 v[84:87], a[252:255], v[192:195], 0
Ta 250,234,41216
v_max3_f32 v251, v251, v218, v219
v_mfma_f32_16x16x32_bf16 v[92:95], a[252:255], v[200:203], 0
Ta 252,235,33024
v_fma_f32 v222, v222, s37, -v246
WL 3
v_mfma_f32_16x16x32_bf16 v[96:99], a[240:243], v[192:195], 0
Ta 254,235,41216
v_fma_f32 v223, v223, s37, -v246
v_mfma_f32_16x16x32_bf16 v[104:107], a[240:243], v[200:203], 0
v_add_u32 v236, 0x18000, v236
v_add_u32 v237, 0x18000, v237
v_add_u32 v238, 0x18000, v238
v_add_u32 v239, 0x18000, v239
Ta 240,236,16384
v_max3_f32 v252, v252, v220, v221
v_mfma_f32_16x16x32_bf16 v[100:103], a[244:247], v[192:195], 0
Ta 242,236,18432
v_max3_f32 v251, v251, v222, v223
v_mfma_f32_16x16x32_bf16 v[108:111], a[244:247], v[200:203], 0
Ta 244,237,16384
v_max_f32 v251, v251, v252
WL 3
v_mfma_f32_16x16x32_bf16 v[112:115], a[248:251], v[192:195], 0
Ta 246,237,18432
v_cmp_lt_f32 vcc, s38, v251
v_mfma_f32_16x16x32_bf16 v[120:123], a[248:251], v[200:203], 0
Ta 248,238,16384
s_cbranch_vccnz LA_ra31
LA_rb31:
v_mfma_f32_16x16x32_bf16 v[116:119], a[252:255], v[192:195], 0
Ta 250,238,18432
v_mfma_f32_16x16x32_bf16 v[124:127], a[252:255], v[200:203], 0
Ta 252,239,16384
s_cmp_lg_u32 s49, 0
s_cbranch_scc1 LA_ra32
LA_rb32:
WL 3
v_mfma_f32_16x16x32_bf16 a[0:3], a[240:243], a[128:131], 0
Ta 254,239,18432
v_mfma_f32_16x16x32_bf16 a[8:11], a[240:243], a[132:135], 0
Ta 240,236,20480
v_exp_f32 v208, v208
v_mfma_f32_16x16x32_bf16 a[4:7], a[244:247], a[128:131], 0
Ta 242,236,22528
v_mfma_f32_16x16x32_bf16 a[12:15], a[244:247], a[132:135], 0
Ta 244,237,20480
WL 3
v_mfma_f32_16x16x32_bf16 a[16:19], a[248:251], a[128:131], 0
Ta 246,237,22528
v_exp_f32 v216, v216
v_mfma_f32_16x16x32_bf16 a[24:27], a[248:251], a[132:135], 0
Ta 248,238,20480
v_mfma_f32_16x16x32_bf16 a[20:23], a[252:255], a[128:131], 0
Ta 250,238,22528
v_add_f32 v247, v247, v208
v_mfma_f32_16x16x32_bf16 a[28:31], a[252:255], a[132:135], 0
Ta 252,239,20480
WL 3
Maaa 0,240,136
Ta 254,239,22528
Maaa 8,240,140
Ta 240,236,24576
v_exp_f32 v209, v209
Maaa 4,244,136
Ta 242,236,26624
Maaa 12,244,140
Ta 244,237,24576
v_add_f32 v248, v248, v216
WL 3
Maaa 16,248,136
Ta 246,237,26624
Maaa 24,248,140
Ta 248,238,24576
Maaa 20,252,136
Ta 250,238,26624
v_exp_f32 v217, v217
Maaa 28,252,140
Ta 252,239,24576
WL 3
Maaa 0,240,144
Ta 254,239,26624
v_add_f32 v247, v247, v209
Maaa 8,240,148
Ta 240,236,28672
Maaa 4,244,144
Ta 242,236,30720
CV 208,208,209
Maaa 12,244,148
Ta 244,237,28672
WL 3
Maaa 16,248,144
Ta 246,237,30720
v_exp_f32 v210, v210
Maaa 24,248,148
Ta 248,238,28672
Maaa 20,252,144
Ta 250,238,30720
v_add_f32 v248, v248, v217
Maaa 28,252,148
Ta 252,239,28672
WL 3
Maaa 0,240,152
Ta 254,239,30720
CV 216,216,217
Maaa 8,240,156
v_exp_f32 v218, v218
Maaa 4,244,152
v_add_f32 v247, v247, v210
Maaa 12,244,156
WL 0
s_barrier
Ba 240,224,16384
Ba 244,224,24576
Maaa 16,248,152
v_exp_f32 v211, v211
Maaa 24,248,156
Ba 248,225,16384
v_add_f32 v248, v248, v218
Maaa 20,252,152
v_exp_f32 v219, v219
Maaa 28,252,156
Ba 252,225,24576
WL 2
v_mfma_f32_16x16x32_bf16 v[192:195], a[240:243], v[128:131], 0
v_add_f32 v247, v247, v211
CV 209,210,211
v_mfma_f32_16x16x32_bf16 v[200:203], a[240:243], v[132:135], 0
Ba 240,226,16384
v_mfma_f32_16x16x32_bf16 v[196:199], a[244:247], v[128:131], 0
v_exp_f32 v212, v212
v_mfma_f32_16x16x32_bf16 v[204:207], a[244:247], v[132:135], 0
Ba 244,226,24576
WL 2
Mvav 192,248,136
v_add_f32 v248, v248, v219
CV 217,218,219
Mvav 200,248,140
Ba 248,227,16384
Mvav 196,252,136
v_exp_f32 v220, v220
v_add_f32 v247, v247, v212
Mvav 204,252,140
Ba 252,227,24576
WL 2
Mvav 192,240,144
v_exp_f32 v213, v213
Mvav 200,240,148
Ba 240,224,16640
Mvav 196,244,144
v_add_f32 v248, v248, v220
v_exp_f32 v221, v221
Mvav 204,244,148
Ba 244,224,24832
WL 2
Mvav 192,248,152
v_add_f32 v247, v247, v213
Mvav 200,248,156
Ba 248,225,16640
CV 210,212,213
Mvav 196,252,152
v_exp_f32 v214, v214
Mvav 204,252,156
Ba 252,225,24832
WL 2
Mvav 192,240,160
v_add_f32 v248, v248, v221
CV 218,220,221
Mvav 200,240,164
Ba 240,226,16640
Mvav 196,244,160
v_exp_f32 v222, v222
Mvav 204,244,164
Ba 244,226,24832
v_add_f32 v247, v247, v214
WL 2
Mvav 192,248,168
v_exp_f32 v215, v215
Mvav 200,248,172
Ba 248,227,16640
Mvav 196,252,168
v_add_f32 v248, v248, v222
Mvav 204,252,172
Ba 252,227,24832
v_exp_f32 v223, v223
WL 2
Mvav 192,240,176
v_add_f32 v247, v247, v215
Mvav 200,240,180
Ta 240,228,16384
Mvav 196,244,176
Ta 242,228,24576
CV 211,214,215
Mvav 204,244,180
Ta 244,229,16384
v_add_f32 v248, v248, v223
WL 3
Mvav 192,248,184
Ta 246,229,24576
CV 219,222,223
Mvav 200,248,188
Ta 248,230,16384
Mvav 196,252,184
Ta 250,230,24576
Mvav 204,252,188
Ta 252,231,16384
WL 3
Mvav 0,240,208
Ta 254,231,24576
Mvav 8,240,216
Ta 240,232,16384
Mvav 4,244,208
Ta 242,232,24576
Mvav 12,244,216
Ta 244,233,16384
v_fma_f32 v192, v192, s37, -v245
WL 3
Mvav 16,248,208
Ta 246,233,24576
v_fma_f32 v193, v193, s37, -v245
Mvav 24,248,216
Ta 248,234,16384
v_fma_f32 v194, v194, s37, -v245
Mvav 20,252,208
Ta 250,234,24576
v_fma_f32 v195, v195, s37, -v245
Mvav 28,252,216
Ta 252,235,16384
v_fma_f32 v196, v196, s37, -v245
WL 3
Mvav 32,240,208
Ta 254,235,24576
v_fma_f32 v197, v197, s37, -v245
Mvav 40,240,216
Ta 240,228,16640
v_max3_f32 v251, v192, v193, v194
Mvav 36,244,208
Ta 242,228,24832
v_fma_f32 v198, v198, s37, -v245
Mvav 44,244,216
Ta 244,229,16640
v_fma_f32 v199, v199, s37, -v245
WL 3
Mvav 48,248,208
Ta 246,229,24832
v_max3_f32 v252, v195, v196, v197
Mvav 56,248,216
Ta 248,230,16640
Mvav 52,252,208
Ta 250,230,24832
v_fma_f32 v200, v200, s37, -v246
v_fma_f32 v201, v201, s37, -v246
Mvav 60,252,216
Ta 252,231,16640
WL 3
Mvav 64,240,208
Ta 254,231,24832
v_max3_f32 v251, v251, v198, v199
v_fma_f32 v202, v202, s37, -v246
Mvav 72,240,216
Ta 240,232,16640
Mvav 68,244,208
Ta 242,232,24832
v_fma_f32 v203, v203, s37, -v246
v_max3_f32 v252, v252, v200, v201
Mvav 76,244,216
Ta 244,233,16640
WL 3
Mvav 80,248,208
Ta 246,233,24832
v_fma_f32 v204, v204, s37, -v246
v_fma_f32 v205, v205, s37, -v246
Mvav 88,248,216
Ta 248,234,16640
Mvav 84,252,208
Ta 250,234,24832
v_max3_f32 v251, v251, v202, v203
Mvav 92,252,216
Ta 252,235,16640
v_fma_f32 v206, v206, s37, -v246
WL 3
Mvav 96,240,208
Ta 254,235,24832
v_fma_f32 v207, v207, s37, -v246
Mvav 104,240,216
Ta 240,236,32768
v_max3_f32 v252, v252, v204, v205
Mvav 100,244,208
Ta 242,236,34816
v_max3_f32 v251, v251, v206, v207
Mvav 108,244,216
Ta 244,237,32768
v_max_f32 v251, v251, v252
WL 3
Mvav 112,248,208
Ta 246,237,34816
v_cmp_lt_f32 vcc, s38, v251
Mvav 120,248,216
Ta 248,238,32768
s_cbranch_vccnz LA_ra33
LA_rb33:
Mvav 116,252,208
Ta 250,238,34816
Mvav 124,252,216
Ta 252,239,32768
s_cmp_lg_u32 s49, 0
s_cbranch_scc1 LA_ra34
LA_rb34:
WL 3
Maaa 0,240,160
Ta 254,239,34816
Maaa 8,240,164
Ta 240,236,36864
v_exp_f32 v192, v192
Maaa 4,244,160
Ta 242,236,38912
Maaa 12,244,164
Ta 244,237,36864
WL 3
Maaa 16,248,160
Ta 246,237,38912
v_exp_f32 v200, v200
Maaa 24,248,164
Ta 248,238,36864
Maaa 20,252,160
Ta 250,238,38912
v_add_f32 v247, v247, v192
Maaa 28,252,164
Ta 252,239,36864
WL 3
Maaa 0,240,168
Ta 254,239,38912
Maaa 8,240,172
Ta 240,236,40960
v_exp_f32 v193, v193
Maaa 4,244,168
Ta 242,236,43008
Maaa 12,244,172
Ta 244,237,40960
v_add_f32 v248, v248, v200
WL 3
Maaa 16,248,168
Ta 246,237,43008
Maaa 24,248,172
Ta 248,238,40960
Maaa 20,252,168
Ta 250,238,43008
v_exp_f32 v201, v201
Maaa 28,252,172
Ta 252,239,40960
WL 3
Maaa 0,240,176
Ta 254,239,43008
v_add_f32 v247, v247, v193
Maaa 8,240,180
Ta 240,236,45056
Maaa 4,244,176
Ta 242,236,47104
CV 192,192,193
Maaa 12,244,180
Ta 244,237,45056
WL 3
Maaa 16,248,176
Ta 246,237,47104
v_exp_f32 v194, v194
Maaa 24,248,180
Ta 248,238,45056
Maaa 20,252,176
Ta 250,238,47104
v_add_f32 v248, v248, v201
Maaa 28,252,180
Ta 252,239,45056
WL 3
Maaa 0,240,184
Ta 254,239,47104
CV 200,200,201
Maaa 8,240,188
v_exp_f32 v202, v202
Maaa 4,244,184
v_add_f32 v247, v247, v194
Maaa 12,244,188
WL 0
s_barrier
Ba 240,224,32768
Ba 244,224,40960
Maaa 16,248,184
v_exp_f32 v195, v195
Maaa 24,248,188
Ba 248,225,32768
v_add_f32 v248, v248, v202
Maaa 20,252,184
v_exp_f32 v203, v203
Maaa 28,252,188
Ba 252,225,40960
WL 2
v_mfma_f32_16x16x32_bf16 v[208:211], a[240:243], v[128:131], 0
v_add_f32 v247, v247, v195
CV 193,194,195
v_mfma_f32_16x16x32_bf16 v[216:219], a[240:243], v[132:135], 0
Ba 240,226,32768
v_mfma_f32_16x16x32_bf16 v[212:215], a[244:247], v[128:131], 0
v_exp_f32 v196, v196
v_mfma_f32_16x16x32_bf16 v[220:223], a[244:247], v[132:135], 0
Ba 244,226,40960
WL 2
Mvav 208,248,136
v_add_f32 v248, v248, v203
CV 201,202,203
Mvav 216,248,140
Ba 248,227,32768
AR 253,0
AR 254,1
Mvav 212,252,136
v_exp_f32 v204, v204
v_add_f32 v247, v247, v196
Mvav 220,252,140
Ba 252,227,40960
WL 2
Mvav 208,240,144
v_exp_f32 v197, v197
Mvav 216,240,148
Ba 240,224,33024
Mvav 212,244,144
v_add_f32 v248, v248, v204
v_exp_f32 v205, v205
Mvav 220,244,148
Ba 244,224,41216
CV 253,253,254
AW 192,253
WL 2
Mvav 208,248,152
v_add_f32 v247, v247, v197
Mvav 216,248,156
Ba 248,225,33024
CV 194,196,197
Mvav 212,252,152
v_exp_f32 v198, v198
Mvav 220,252,156
Ba 252,225,41216
WL 2
Mvav 208,240,160
v_add_f32 v248, v248, v205
CV 202,204,205
AR 253,2
AR 254,3
Mvav 216,240,164
Ba 240,226,33024
Mvav 212,244,160
v_exp_f32 v206, v206
Mvav 220,244,164
Ba 244,226,41216
v_add_f32 v247, v247, v198
WL 2
Mvav 208,248,168
v_exp_f32 v199, v199
Mvav 216,248,172
Ba 248,227,33024
Mvav 212,252,168
v_add_f32 v248, v248, v206
CV 253,253,254
AW 193,253
Mvav 220,252,172
Ba 252,227,41216
v_exp_f32 v207, v207
WL 2
Mvav 208,240,176
v_add_f32 v247, v247, v199
Mvav 216,240,180
Ta 240,228,0
AR 253,4
AR 254,5
Mvav 212,244,176
Ta 242,228,8192
CV 195,198,199
Mvav 220,244,180
Ta 244,229,0
v_add_f32 v248, v248, v207
WL 3
Mvav 208,248,184
Ta 246,229,8192
CV 203,206,207
Mvav 216,248,188
Ta 248,230,0
Mvav 212,252,184
Ta 250,230,8192
CV 253,253,254
AW 194,253
Mvav 220,252,188
Ta 252,231,0
WL 3
Mvav 0,240,192
Ta 254,231,8192
Mvav 8,240,200
Ta 240,232,0
AR 253,6
AR 254,7
Mvav 4,244,192
Ta 242,232,8192
Mvav 12,244,200
Ta 244,233,0
v_fma_f32 v208, v208, s37, -v245
WL 3
Mvav 16,248,192
Ta 246,233,8192
v_fma_f32 v209, v209, s37, -v245
Mvav 24,248,200
Ta 248,234,0
v_fma_f32 v210, v210, s37, -v245
Mvav 20,252,192
Ta 250,234,8192
v_fma_f32 v211, v211, s37, -v245
Mvav 28,252,200
Ta 252,235,0
v_fma_f32 v212, v212, s37, -v245
WL 3
Mvav 32,240,192
Ta 254,235,8192
v_fma_f32 v213, v213, s37, -v245
Mvav 40,240,200
Ta 240,228,256
v_max3_f32 v251, v208, v209, v210
Mvav 36,244,192
Ta 242,228,8448
v_fma_f32 v214, v214, s37, -v245
Mvav 44,244,200
Ta 244,229,256
v_fma_f32 v215, v215, s37, -v245
WL 3
Mvav 48,248,192
Ta 246,229,8448
v_max3_f32 v252, v211, v212, v213
Mvav 56,248,200
Ta 248,230,256
CV 253,253,254
AW 195,253
Mvav 52,252,192
Ta 250,230,8448
v_fma_f32 v216, v216, s37, -v246
v_fma_f32 v217, v217, s37, -v246
Mvav 60,252,200
Ta 252,231,256
WL 3
Mvav 64,240,192
Ta 254,231,8448
v_max3_f32 v251, v251, v214, v215
v_fma_f32 v218, v218, s37, -v246
Mvav 72,240,200
Ta 240,232,256
Mvav 68,244,192
Ta 242,232,8448
v_fma_f32 v219, v219, s37, -v246
v_max3_f32 v252, v252, v216, v217
Mvav 76,244,200
Ta 244,233,256
AR 253,8
AR 254,9
WL 3
Mvav 80,248,192
Ta 246,233,8448
v_fma_f32 v220, v220, s37, -v246
v_fma_f32 v221, v221, s37, -v246
Mvav 88,248,200
Ta 248,234,256
Mvav 84,252,192
Ta 250,234,8448
v_max3_f32 v251, v251, v218, v219
Mvav 92,252,200
Ta 252,235,256
v_fma_f32 v222, v222, s37, -v246
WL 3
Mvav 96,240,192
Ta 254,235,8448
v_fma_f32 v223, v223, s37, -v246
Mvav 104,240,200
Ta 240,236,49152
v_max3_f32 v252, v252, v220, v221
Mvav 100,244,192
Ta 242,236,51200
v_max3_f32 v251, v251, v222, v223
Mvav 108,244,200
Ta 244,237,49152
v_max_f32 v251, v251, v252
WL 3
Mvav 112,248,192
Ta 246,237,51200
v_cmp_lt_f32 vcc, s38, v251
Mvav 120,248,200
Ta 248,238,49152
s_cbranch_vccnz LA_ra35
LA_rb35:
Mvav 116,252,192
Ta 250,238,51200
CV 253,253,254
AW 196,253
Mvav 124,252,200
Ta 252,239,49152
s_cmp_lg_u32 s49, 0
s_cbranch_scc1 LA_ra36
LA_rb36:
WL 3
v_mfma_f32_16x16x32_bf16 a[32:35], a[240:243], a[128:131], 0
Ta 254,239,51200
v_mfma_f32_16x16x32_bf16 a[40:43], a[240:243], a[132:135], 0
Ta 240,236,53248
v_exp_f32 v208, v208
v_mfma_f32_16x16x32_bf16 a[36:39], a[244:247], a[128:131], 0
Ta 242,236,55296
AR 253,10
AR 254,11
v_mfma_f32_16x16x32_bf16 a[44:47], a[244:247], a[132:135], 0
Ta 244,237,53248
WL 3
v_mfma_f32_16x16x32_bf16 a[48:51], a[248:251], a[128:131], 0
Ta 246,237,55296
v_exp_f32 v216, v216
v_mfma_f32_16x16x32_bf16 a[56:59], a[248:251], a[132:135], 0
Ta 248,238,53248
v_mfma_f32_16x16x32_bf16 a[52:55], a[252:255], a[128:131], 0
Ta 250,238,55296
v_add_f32 v247, v247, v208
v_mfma_f32_16x16x32_bf16 a[60:63], a[252:255], a[132:135], 0
Ta 252,239,53248
CV 253,253,254
AW 197,253
WL 3
Maaa 32,240,136
Ta 254,239,55296
v_exp_f32 v209, v209
Maaa 40,240,140
Ta 240,236,57344
Maaa 36,244,136
Ta 242,236,59392
AR 253,12
AR 254,13
Maaa 44,244,140
Ta 244,237,57344
v_add_f32 v248, v248, v216
WL 3
Maaa 48,248,136
Ta 246,237,59392
Maaa 56,248,140
Ta 248,238,57344
Maaa 52,252,136
Ta 250,238,59392
v_exp_f32 v217, v217
Maaa 60,252,140
Ta 252,239,57344
CV 253,253,254
AW 198,253
WL 3
Maaa 32,240,144
Ta 254,239,59392
v_add_f32 v247, v247, v209
Maaa 40,240,148
Ta 240,236,61440
CV 208,208,209
Maaa 36,244,144
Ta 242,236,63488
Maaa 44,244,148
Ta 244,237,61440
AR 253,14
AR 254,15
WL 3
Maaa 48,248,144
Ta 246,237,63488
v_exp_f32 v210, v210
Maaa 56,248,148
Ta 248,238,61440
Maaa 52,252,144
Ta 250,238,63488
v_add_f32 v248, v248, v217
Maaa 60,252,148
Ta 252,239,61440
WL 3
Maaa 32,240,152
Ta 254,239,63488
CV 216,216,217
Maaa 40,240,156
v_exp_f32 v218, v218
Maaa 36,244,152
v_add_f32 v247, v247, v210
CV 253,253,254
AW 199,253
Maaa 44,244,156
WL 0
s_barrier
Ba 240,224,49152
Ba 244,224,57344
Maaa 48,248,152
v_exp_f32 v211, v211
Maaa 56,248,156
Ba 248,225,49152
v_add_f32 v248, v248, v218
Maaa 52,252,152
v_exp_f32 v219, v219
Maaa 60,252,156
Ba 252,225,57344
WL 2
v_mfma_f32_16x16x32_bf16 v[192:195], a[240:243], v[128:131], 0
v_add_f32 v247, v247, v211
CV 209,210,211
v_mfma_f32_16x16x32_bf16 v[200:203], a[240:243], v[132:135], 0
Ba 240,226,49152
AR 253,16
AR 254,17
v_mfma_f32_16x16x32_bf16 v[196:199], a[244:247], v[128:131], 0
v_exp_f32 v212, v212
v_mfma_f32_16x16x32_bf16 v[204:207], a[244:247], v[132:135], 0
Ba 244,226,57344
s_mov_b32 s7, s51
s_add_u32 s7, s7, 1
s_sub_u32 s5, s7, 7
s_cselect_b32 s7, s7, s5
s_lshl_b32 s46, s7, 7
s_add_u32 s7, s7, 1
s_sub_u32 s5, s7, 7
s_cselect_b32 s7, s7, s5
s_lshl_b32 s45, s7, 7
s_add_u32 s7, s7, 1
s_sub_u32 s5, s7, 7
s_cselect_b32 s7, s7, s5
s_lshl_b32 s40, s7, 7
s_add_u32 s7, s7, 1
s_sub_u32 s5, s7, 7
s_cselect_b32 s7, s7, s5
s_lshl_b32 s44, s7, 7
s_add_u32 s7, s7, 1
s_sub_u32 s5, s7, 7
s_cselect_b32 s7, s7, s5
s_lshl_b32 s41, s7, 7
s_add_u32 s7, s7, 1
s_sub_u32 s5, s7, 7
s_cselect_b32 s7, s7, s5
s_lshl_b32 s43, s7, 7
s_add_u32 s7, s7, 1
s_sub_u32 s5, s7, 7
s_cselect_b32 s7, s7, s5
s_lshl_b32 s42, s7, 7
WL 2
Mvav 192,248,136
v_add_f32 v248, v248, v219
CV 217,218,219
Mvav 200,248,140
Ba 248,227,49152
Mvav 196,252,136
v_exp_f32 v220, v220
Mvav 204,252,140
Ba 252,227,57344
v_add_f32 v247, v247, v212
WL 2
Mvav 192,240,144
v_exp_f32 v213, v213
Mvav 200,240,148
Ba 240,224,49408
Mvav 196,244,144
v_add_f32 v248, v248, v220
v_exp_f32 v221, v221
Mvav 204,244,148
Ba 244,224,57600
CV 253,253,254
AW 200,253
WL 2
Mvav 192,248,152
v_add_f32 v247, v247, v213
Mvav 200,248,156
Ba 248,225,49408
CV 210,212,213
Mvav 196,252,152
v_exp_f32 v214, v214
Mvav 204,252,156
Ba 252,225,57600
AR 253,18
AR 254,19
WL 2
Mvav 192,240,160
v_add_f32 v248, v248, v221
CV 218,220,221
Mvav 200,240,164
Ba 240,226,49408
Mvav 196,244,160
v_exp_f32 v222, v222
Mvav 204,244,164
Ba 244,226,57600
v_add_f32 v247, v247, v214
WL 2
Mvav 192,248,168
v_exp_f32 v215, v215
Mvav 200,248,172
Ba 248,227,49408
Mvav 196,252,168
v_add_f32 v248, v248, v222
CV 253,253,254
AW 201,253
Mvav 204,252,172
Ba 252,227,57600
v_exp_f32 v223, v223
WL 2
Mvav 192,240,176
v_add_f32 v247, v247, v215
Mvav 200,240,180
Ta 240,228,32768
AR 253,20
AR 254,21
Mvav 196,244,176
Ta 242,228,40960
CV 211,214,215
Mvav 204,244,180
Ta 244,229,32768
v_add_f32 v248, v248, v223
WL 3
Mvav 192,248,184
Ta 246,229,40960
CV 219,222,223
Mvav 200,248,188
Ta 248,230,32768
Mvav 196,252,184
Ta 250,230,40960
CV 253,253,254
AW 202,253
Mvav 204,252,188
Ta 252,231,32768
WL 3
Mvav 0,240,208
Ta 254,231,40960
Mvav 8,240,216
Ta 240,232,32768
AR 253,22
AR 254,23
Mvav 4,244,208
Ta 242,232,40960
Mvav 12,244,216
Ta 244,233,32768
v_fma_f32 v192, v192, s37, -v245
WL 3
Mvav 16,248,208
Ta 246,233,40960
v_fma_f32 v193, v193, s37, -v245
Mvav 24,248,216
Ta 248,234,32768
v_fma_f32 v194, v194, s37, -v245
Mvav 20,252,208
Ta 250,234,40960
v_fma_f32 v195, v195, s37, -v245
Mvav 28,252,216
Ta 252,235,32768
v_fma_f32 v196, v196, s37, -v245
WL 3
Mvav 32,240,208
Ta 254,235,40960
v_fma_f32 v197, v197, s37, -v245
Mvav 40,240,216
Ta 240,228,33024
v_max3_f32 v251, v192, v193, v194
Mvav 36,244,208
Ta 242,228,41216
v_fma_f32 v198, v198, s37, -v245
Mvav 44,244,216
Ta 244,229,33024
v_fma_f32 v199, v199, s37, -v245
WL 3
Mvav 48,248,208
Ta 246,229,41216
v_max3_f32 v252, v195, v196, v197
CV 253,253,254
AW 203,253
Mvav 56,248,216
Ta 248,230,33024
Mvav 52,252,208
Ta 250,230,41216
v_fma_f32 v200, v200, s37, -v246
v_fma_f32 v201, v201, s37, -v246
Mvav 60,252,216
Ta 252,231,33024
WL 3
Mvav 64,240,208
Ta 254,231,41216
v_max3_f32 v251, v251, v198, v199
v_fma_f32 v202, v202, s37, -v246
Mvav 72,240,216
Ta 240,232,33024
Mvav 68,244,208
Ta 242,232,41216
v_fma_f32 v203, v203, s37, -v246
v_max3_f32 v252, v252, v200, v201
Mvav 76,244,216
Ta 244,233,33024
AR 253,24
AR 254,25
WL 3
Mvav 80,248,208
Ta 246,233,41216
v_fma_f32 v204, v204, s37, -v246
v_fma_f32 v205, v205, s37, -v246
Mvav 88,248,216
Ta 248,234,33024
Mvav 84,252,208
Ta 250,234,41216
v_max3_f32 v251, v251, v202, v203
Mvav 92,252,216
Ta 252,235,33024
v_fma_f32 v206, v206, s37, -v246
WL 3
Mvav 96,240,208
Ta 254,235,41216
v_fma_f32 v207, v207, s37, -v246
Mvav 104,240,216
Ta 240,236,16384
v_max3_f32 v252, v252, v204, v205
Mvav 100,244,208
Ta 242,236,18432
v_max3_f32 v251, v251, v206, v207
Mvav 108,244,216
Ta 244,237,16384
v_max_f32 v251, v251, v252
WL 3
Mvav 112,248,208
Ta 246,237,18432
v_cmp_lt_f32 vcc, s38, v251
Mvav 120,248,216
Ta 248,238,16384
s_cbranch_vccnz LA_ra37
LA_rb37:
Mvav 116,252,208
Ta 250,238,18432
CV 253,253,254
AW 204,253
Mvav 124,252,216
Ta 252,239,16384
s_cmp_lg_u32 s49, 0
s_cbranch_scc1 LA_ra38
LA_rb38:
WL 3
Maaa 32,240,160
Ta 254,239,18432
Maaa 40,240,164
Ta 240,236,20480
v_exp_f32 v192, v192
Maaa 36,244,160
Ta 242,236,22528
AR 253,26
AR 254,27
Maaa 44,244,164
Ta 244,237,20480
WL 3
Maaa 48,248,160
Ta 246,237,22528
v_exp_f32 v200, v200
Maaa 56,248,164
Ta 248,238,20480
Maaa 52,252,160
Ta 250,238,22528
v_add_f32 v247, v247, v192
Maaa 60,252,164
Ta 252,239,20480
CV 253,253,254
AW 205,253
WL 3
Maaa 32,240,168
Ta 254,239,22528
Maaa 40,240,172
Ta 240,236,24576
v_exp_f32 v193, v193
Maaa 36,244,168
Ta 242,236,26624
AR 253,28
AR 254,29
Maaa 44,244,172
Ta 244,237,24576
v_add_f32 v248, v248, v200
WL 3
Maaa 48,248,168
Ta 246,237,26624
Maaa 56,248,172
Ta 248,238,24576
CV 253,253,254
AW 206,253
Maaa 52,252,168
Ta 250,238,26624
v_exp_f32 v201, v201
Maaa 60,252,172
Ta 252,239,24576
WL 3
Maaa 32,240,176
Ta 254,239,26624
v_add_f32 v247, v247, v193
Maaa 40,240,180
Ta 240,236,28672
Maaa 36,244,176
Ta 242,236,30720
CV 192,192,193
Maaa 44,244,180
Ta 244,237,28672
AR 253,30
AR 254,31
WL 3
Maaa 48,248,176
Ta 246,237,30720
v_exp_f32 v194, v194
Maaa 56,248,180
Ta 248,238,28672
Maaa 52,252,176
Ta 250,238,30720
v_add_f32 v248, v248, v201
Maaa 60,252,180
Ta 252,239,28672
WL 3
Maaa 32,240,184
Ta 254,239,30720
CV 200,200,201
Maaa 40,240,188
v_exp_f32 v202, v202
Maaa 36,244,184
v_add_f32 v247, v247, v194
CV 253,253,254
AW 207,253
Maaa 44,244,188
WL 0
s_barrier
Ba 240,224,0
Ba 244,224,8192
Maaa 48,248,184
v_exp_f32 v195, v195
Maaa 56,248,188
Ba 248,225,0
v_add_f32 v248, v248, v202
Maaa 52,252,184
v_exp_f32 v203, v203
Maaa 60,252,188
Ba 252,225,8192
WL 2
v_mfma_f32_16x16x32_bf16 v[208:211], a[240:243], v[128:131], 0
v_add_f32 v247, v247, v195
CV 193,194,195
v_mfma_f32_16x16x32_bf16 v[216:219], a[240:243], v[132:135], 0
Ba 240,226,0
v_mfma_f32_16x16x32_bf16 v[212:215], a[244:247], v[128:131], 0
v_exp_f32 v196, v196
v_mfma_f32_16x16x32_bf16 v[220:223], a[244:247], v[132:135], 0
Ba 244,226,8192
WL 2
Mvav 208,248,136
v_add_f32 v248, v248, v203
CV 201,202,203
Mvav 216,248,140
Ba 248,227,0
AR 253,32
AR 254,33
Mvav 212,252,136
v_exp_f32 v204, v204
v_add_f32 v247, v247, v196
Mvav 220,252,140
Ba 252,227,8192
WL 2
Mvav 208,240,144
v_exp_f32 v197, v197
Mvav 216,240,148
Ba 240,224,256
Mvav 212,244,144
v_add_f32 v248, v248, v204
v_exp_f32 v205, v205
Mvav 220,244,148
Ba 244,224,8448
CV 253,253,254
AW 208,253
WL 2
Mvav 208,248,152
v_add_f32 v247, v247, v197
Mvav 216,248,156
Ba 248,225,256
CV 194,196,197
Mvav 212,252,152
v_exp_f32 v198, v198
Mvav 220,252,156
Ba 252,225,8448
WL 2
Mvav 208,240,160
v_add_f32 v248, v248, v205
CV 202,204,205
Mvav 216,240,164
Ba 240,226,256
AR 253,34
AR 254,35
Mvav 212,244,160
v_exp_f32 v206, v206
Mvav 220,244,164
Ba 244,226,8448
v_add_f32 v247, v247, v198
WL 2
Mvav 208,248,168
v_exp_f32 v199, v199
Mvav 216,248,172
Ba 248,227,256
Mvav 212,252,168
v_add_f32 v248, v248, v206
CV 253,253,254
AW 209,253
Mvav 220,252,172
Ba 252,227,8448
v_exp_f32 v207, v207
WL 2
Mvav 208,240,176
v_add_f32 v247, v247, v199
Mvav 216,240,180
Ta 240,228,16384
AR 253,36
AR 254,37
Mvav 212,244,176
Ta 242,228,24576
CV 195,198,199
Mvav 220,244,180
Ta 244,229,16384
v_add_f32 v248, v248, v207
WL 3
Mvav 208,248,184
Ta 246,229,24576
CV 203,206,207
Mvav 216,248,188
Ta 248,230,16384
Mvav 212,252,184
Ta 250,230,24576
Mvav 220,252,188
Ta 252,231,16384
CV 253,253,254
AW 210,253
WL 3
Mvav 0,240,192
Ta 254,231,24576
Mvav 8,240,200
Ta 240,232,16384
AR 253,38
AR 254,39
Mvav 4,244,192
Ta 242,232,24576
Mvav 12,244,200
Ta 244,233,16384
v_fma_f32 v208, v208, s37, -v245
WL 3
Mvav 16,248,192
Ta 246,233,24576
v_fma_f32 v209, v209, s37, -v245
Mvav 24,248,200
Ta 248,234,16384
v_fma_f32 v210, v210, s37, -v245
Mvav 20,252,192
Ta 250,234,24576
v_fma_f32 v211, v211, s37, -v245
Mvav 28,252,200
Ta 252,235,16384
v_fma_f32 v212, v212, s37, -v245
WL 3
Mvav 32,240,192
Ta 254,235,24576
v_fma_f32 v213, v213, s37, -v245
Mvav 40,240,200
Ta 240,228,16640
v_max3_f32 v251, v208, v209, v210
Mvav 36,244,192
Ta 242,228,24832
v_fma_f32 v214, v214, s37, -v245
Mvav 44,244,200
Ta 244,229,16640
v_fma_f32 v215, v215, s37, -v245
WL 3
Mvav 48,248,192
Ta 246,229,24832
v_max3_f32 v252, v211, v212, v213
Mvav 56,248,200
Ta 248,230,16640
CV 253,253,254
AW 211,253
Mvav 52,252,192
Ta 250,230,24832
v_fma_f32 v216, v216, s37, -v246
v_fma_f32 v217, v217, s37, -v246
Mvav 60,252,200
Ta 252,231,16640
WL 3
Mvav 64,240,192
Ta 254,231,24832
v_max3_f32 v251, v251, v214, v215
v_fma_f32 v218, v218, s37, -v246
Mvav 72,240,200
Ta 240,232,16640
Mvav 68,244,192
Ta 242,232,24832
v_fma_f32 v219, v219, s37, -v246
v_max3_f32 v252, v252, v216, v217
Mvav 76,244,200
Ta 244,233,16640
WL 3
Mvav 80,248,192
Ta 246,233,24832
v_fma_f32 v220, v220, s37, -v246
v_fma_f32 v221, v221, s37, -v246
Mvav 88,248,200
Ta 248,234,16640
AR 253,40
AR 254,41
Mvav 84,252,192
Ta 250,234,24832
v_max3_f32 v251, v251, v218, v219
Mvav 92,252,200
Ta 252,235,16640
v_fma_f32 v222, v222, s37, -v246
WL 3
Mvav 96,240,192
Ta 254,235,24832
v_fma_f32 v223, v223, s37, -v246
Mvav 104,240,200
Ta 240,236,32768
v_max3_f32 v252, v252, v220, v221
Mvav 100,244,192
Ta 242,236,34816
v_max3_f32 v251, v251, v222, v223
Mvav 108,244,200
Ta 244,237,32768
v_max_f32 v251, v251, v252
WL 3
Mvav 112,248,192
Ta 246,237,34816
v_cmp_lt_f32 vcc, s38, v251
Mvav 120,248,200
Ta 248,238,32768
s_cbranch_vccnz LA_ra39
LA_rb39:
Mvav 116,252,192
Ta 250,238,34816
Mvav 124,252,200
Ta 252,239,32768
s_cmp_lg_u32 s49, 0
s_cbranch_scc1 LA_ra40
LA_rb40:
WL 3
v_mfma_f32_16x16x32_bf16 a[64:67], a[240:243], a[128:131], 0
Ta 254,239,34816
CV 253,253,254
AW 212,253
v_mfma_f32_16x16x32_bf16 a[72:75], a[240:243], a[132:135], 0
Ta 240,236,36864
v_exp_f32 v208, v208
v_mfma_f32_16x16x32_bf16 a[68:71], a[244:247], a[128:131], 0
Ta 242,236,38912
AR 253,42
AR 254,43
v_mfma_f32_16x16x32_bf16 a[76:79], a[244:247], a[132:135], 0
Ta 244,237,36864
WL 3
v_mfma_f32_16x16x32_bf16 a[80:83], a[248:251], a[128:131], 0
Ta 246,237,38912
v_exp_f32 v216, v216
v_mfma_f32_16x16x32_bf16 a[88:91], a[248:251], a[132:135], 0
Ta 248,238,36864
v_mfma_f32_16x16x32_bf16 a[84:87], a[252:255], a[128:131], 0
Ta 250,238,38912
v_add_f32 v247, v247, v208
v_mfma_f32_16x16x32_bf16 a[92:95], a[252:255], a[132:135], 0
Ta 252,239,36864
CV 253,253,254
AW 213,253
WL 3
Maaa 64,240,136
Ta 254,239,38912
Maaa 72,240,140
Ta 240,236,40960
v_exp_f32 v209, v209
Maaa 68,244,136
Ta 242,236,43008
AR 253,44
AR 254,45
Maaa 76,244,140
Ta 244,237,40960
v_add_f32 v248, v248, v216
WL 3
Maaa 80,248,136
Ta 246,237,43008
Maaa 88,248,140
Ta 248,238,40960
Maaa 84,252,136
Ta 250,238,43008
v_exp_f32 v217, v217
Maaa 92,252,140
Ta 252,239,40960
CV 253,253,254
AW 214,253
WL 3
Maaa 64,240,144
Ta 254,239,43008
v_add_f32 v247, v247, v209
Maaa 72,240,148
Ta 240,236,45056
Maaa 68,244,144
Ta 242,236,47104
CV 208,208,209
Maaa 76,244,148
Ta 244,237,45056
WL 3
Maaa 80,248,144
Ta 246,237,47104
v_exp_f32 v210, v210
Maaa 88,248,148
Ta 248,238,45056
AR 253,46
AR 254,47
Maaa 84,252,144
Ta 250,238,47104
v_add_f32 v248, v248, v217
Maaa 92,252,148
Ta 252,239,45056
WL 3
Maaa 64,240,152
Ta 254,239,47104
CV 216,216,217
Maaa 72,240,156
v_exp_f32 v218, v218
Maaa 68,244,152
v_add_f32 v247, v247, v210
CV 253,253,254
AW 215,253
Maaa 76,244,156
WL 0
s_barrier
Ba 240,224,16384
Ba 244,224,24576
Maaa 80,248,152
v_exp_f32 v211, v211
Maaa 88,248,156
Ba 248,225,16384
v_add_f32 v248, v248, v218
Maaa 84,252,152
v_exp_f32 v219, v219
Maaa 92,252,156
Ba 252,225,24576
WL 2
v_mfma_f32_16x16x32_bf16 v[192:195], a[240:243], v[128:131], 0
v_add_f32 v247, v247, v211
CV 209,210,211
v_mfma_f32_16x16x32_bf16 v[200:203], a[240:243], v[132:135], 0
Ba 240,226,16384
v_mfma_f32_16x16x32_bf16 v[196:199], a[244:247], v[128:131], 0
v_exp_f32 v212, v212
v_mfma_f32_16x16x32_bf16 v[204:207], a[244:247], v[132:135], 0
Ba 244,226,24576
AR 253,48
AR 254,49
WL 2
Mvav 192,248,136
v_add_f32 v248, v248, v219
CV 217,218,219
Mvav 200,248,140
Ba 248,227,16384
Mvav 196,252,136
v_exp_f32 v220, v220
v_add_f32 v247, v247, v212
Mvav 204,252,140
Ba 252,227,24576
WL 2
Mvav 192,240,144
v_exp_f32 v213, v213
Mvav 200,240,148
Ba 240,224,16640
CV 253,253,254
AW 216,253
Mvav 196,244,144
v_add_f32 v248, v248, v220
v_exp_f32 v221, v221
Mvav 204,244,148
Ba 244,224,24832
WL 2
Mvav 192,248,152
v_add_f32 v247, v247, v213
Mvav 200,248,156
Ba 248,225,16640
CV 210,212,213
Mvav 196,252,152
v_exp_f32 v214, v214
Mvav 204,252,156
Ba 252,225,24832
AR 253,50
AR 254,51
WL 2
Mvav 192,240,160
v_add_f32 v248, v248, v221
CV 218,220,221
Mvav 200,240,164
Ba 240,226,16640
Mvav 196,244,160
v_exp_f32 v222, v222
Mvav 204,244,164
Ba 244,226,24832
v_add_f32 v247, v247, v214
WL 2
Mvav 192,248,168
v_exp_f32 v215, v215
Mvav 200,248,172
Ba 248,227,16640
Mvav 196,252,168
v_add_f32 v248, v248, v222
CV 253,253,254
AW 217,253
Mvav 204,252,172
Ba 252,227,24832
v_exp_f32 v223, v223
WL 2
Mvav 192,240,176
v_add_f32 v247, v247, v215
AR 253,52
AR 254,53
Mvav 200,240,180
Ta 240,228,0
Mvav 196,244,176
Ta 242,228,8192
CV 211,214,215
Mvav 204,244,180
Ta 244,229,0
v_add_f32 v248, v248, v223
WL 3
Mvav 192,248,184
Ta 246,229,8192
CV 219,222,223
Mvav 200,248,188
Ta 248,230,0
Mvav 196,252,184
Ta 250,230,8192
CV 253,253,254
AW 218,253
Mvav 204,252,188
Ta 252,231,0
WL 3
Mvav 0,240,208
Ta 254,231,8192
AR 253,54
AR 254,55
Mvav 8,240,216
Ta 240,232,0
Mvav 4,244,208
Ta 242,232,8192
Mvav 12,244,216
Ta 244,233,0
v_fma_f32 v192, v192, s37, -v245
WL 3
Mvav 16,248,208
Ta 246,233,8192
v_fma_f32 v193, v193, s37, -v245
CV 253,253,254
AW 219,253
Mvav 24,248,216
Ta 248,234,0
v_fma_f32 v194, v194, s37, -v245
Mvav 20,252,208
Ta 250,234,8192
v_fma_f32 v195, v195, s37, -v245
Mvav 28,252,216
Ta 252,235,0
v_fma_f32 v196, v196, s37, -v245
WL 3
Mvav 32,240,208
Ta 254,235,8192
v_fma_f32 v197, v197, s37, -v245
Mvav 40,240,216
Ta 240,228,256
v_max3_f32 v251, v192, v193, v194
Mvav 36,244,208
Ta 242,228,8448
v_fma_f32 v198, v198, s37, -v245
Mvav 44,244,216
Ta 244,229,256
v_fma_f32 v199, v199, s37, -v245
WL 3
Mvav 48,248,208
Ta 246,229,8448
v_max3_f32 v252, v195, v196, v197
Mvav 56,248,216
Ta 248,230,256
Mvav 52,252,208
Ta 250,230,8448
v_fma_f32 v200, v200, s37, -v246
v_fma_f32 v201, v201, s37, -v246
Mvav 60,252,216
Ta 252,231,256
WL 3
Mvav 64,240,208
Ta 254,231,8448
v_max3_f32 v251, v251, v198, v199
v_fma_f32 v202, v202, s37, -v246
Mvav 72,240,216
Ta 240,232,256
AR 253,56
AR 254,57
Mvav 68,244,208
Ta 242,232,8448
v_fma_f32 v203, v203, s37, -v246
v_max3_f32 v252, v252, v200, v201
Mvav 76,244,216
Ta 244,233,256
WL 3
Mvav 80,248,208
Ta 246,233,8448
v_fma_f32 v204, v204, s37, -v246
v_fma_f32 v205, v205, s37, -v246
Mvav 88,248,216
Ta 248,234,256
Mvav 84,252,208
Ta 250,234,8448
v_max3_f32 v251, v251, v202, v203
Mvav 92,252,216
Ta 252,235,256
v_fma_f32 v206, v206, s37, -v246
WL 3
Mvav 96,240,208
Ta 254,235,8448
v_fma_f32 v207, v207, s37, -v246
Mvav 104,240,216
Ta 240,236,49152
v_max3_f32 v252, v252, v204, v205
Mvav 100,244,208
Ta 242,236,51200
v_max3_f32 v251, v251, v206, v207
Mvav 108,244,216
Ta 244,237,49152
v_max_f32 v251, v251, v252
WL 3
Mvav 112,248,208
Ta 246,237,51200
v_cmp_lt_f32 vcc, s38, v251
Mvav 120,248,216
Ta 248,238,49152
s_cbranch_vccnz LA_ra41
LA_rb41:
Mvav 116,252,208
Ta 250,238,51200
CV 253,253,254
AW 220,253
Mvav 124,252,216
Ta 252,239,49152
s_cmp_lg_u32 s49, 0
s_cbranch_scc1 LA_ra42
LA_rb42:
WL 3
Maaa 64,240,160
Ta 254,239,51200
Maaa 72,240,164
Ta 240,236,53248
v_exp_f32 v192, v192
Maaa 68,244,160
Ta 242,236,55296
AR 253,58
AR 254,59
Maaa 76,244,164
Ta 244,237,53248
WL 3
Maaa 80,248,160
Ta 246,237,55296
v_exp_f32 v200, v200
Maaa 88,248,164
Ta 248,238,53248
CV 253,253,254
AW 221,253
Maaa 84,252,160
Ta 250,238,55296
v_add_f32 v247, v247, v192
Maaa 92,252,164
Ta 252,239,53248
WL 3
Maaa 64,240,168
Ta 254,239,55296
Maaa 72,240,172
Ta 240,236,57344
v_exp_f32 v193, v193
Maaa 68,244,168
Ta 242,236,59392
AR 253,60
AR 254,61
Maaa 76,244,172
Ta 244,237,57344
v_add_f32 v248, v248, v200
WL 3
Maaa 80,248,168
Ta 246,237,59392
Maaa 88,248,172
Ta 248,238,57344
CV 253,253,254
AW 222,253
Maaa 84,252,168
Ta 250,238,59392
v_exp_f32 v201, v201
Maaa 92,252,172
Ta 252,239,57344
WL 3
Maaa 64,240,176
Ta 254,239,59392
v_add_f32 v247, v247, v193
Maaa 72,240,180
Ta 240,236,61440
Maaa 68,244,176
Ta 242,236,63488
CV 192,192,193
Maaa 76,244,180
Ta 244,237,61440
AR 253,62
AR 254,63
WL 3
Maaa 80,248,176
Ta 246,237,63488
v_exp_f32 v194, v194
Maaa 88,248,180
Ta 248,238,61440
Maaa 84,252,176
Ta 250,238,63488
v_add_f32 v248, v248, v201
Maaa 92,252,180
Ta 252,239,61440
WL 3
Maaa 64,240,184
Ta 254,239,63488
CV 200,200,201
Maaa 72,240,188
v_exp_f32 v202, v202
Maaa 68,244,184
v_add_f32 v247, v247, v194
CV 253,253,254
AW 223,253
Maaa 76,244,188
WL 0
s_barrier
Ba 240,224,32768
Ba 244,224,40960
Maaa 80,248,184
v_exp_f32 v195, v195
Maaa 88,248,188
Ba 248,225,32768
v_add_f32 v248, v248, v202
Maaa 84,252,184
v_exp_f32 v203, v203
Maaa 92,252,188
Ba 252,225,40960
WL 2
v_mfma_f32_16x16x32_bf16 v[208:211], a[240:243], v[128:131], 0
v_add_f32 v247, v247, v195
CV 193,194,195
v_mfma_f32_16x16x32_bf16 v[216:219], a[240:243], v[132:135], 0
Ba 240,226,32768
v_mfma_f32_16x16x32_bf16 v[212:215], a[244:247], v[128:131], 0
v_exp_f32 v196, v196
v_mfma_f32_16x16x32_bf16 v[220:223], a[244:247], v[132:135], 0
Ba 244,226,40960
WL 2
Mvav 208,248,136
v_add_f32 v248, v248, v203
CV 201,202,203
Mvav 216,248,140
Ba 248,227,32768
AR 253,64
AR 254,65
Mvav 212,252,136
v_exp_f32 v204, v204
v_add_f32 v247, v247, v196
Mvav 220,252,140
Ba 252,227,40960
WL 2
Mvav 208,240,144
v_exp_f32 v197, v197
Mvav 216,240,148
Ba 240,224,33024
Mvav 212,244,144
v_add_f32 v248, v248, v204
v_exp_f32 v205, v205
Mvav 220,244,148
Ba 244,224,41216
CV 253,253,254
AW 224,253
WL 2
Mvav 208,248,152
v_add_f32 v247, v247, v197
Mvav 216,248,156
Ba 248,225,33024
CV 194,196,197
Mvav 212,252,152
v_exp_f32 v198, v198
Mvav 220,252,156
Ba 252,225,41216
WL 2
Mvav 208,240,160
v_add_f32 v248, v248, v205
CV 202,204,205
Mvav 216,240,164
Ba 240,226,33024
AR 253,66
AR 254,67
Mvav 212,244,160
v_exp_f32 v206, v206
Mvav 220,244,164
Ba 244,226,41216
v_add_f32 v247, v247, v198
WL 2
Mvav 208,248,168
v_exp_f32 v199, v199
Mvav 216,248,172
Ba 248,227,33024
Mvav 212,252,168
v_add_f32 v248, v248, v206
CV 253,253,254
AW 225,253
Mvav 220,252,172
Ba 252,227,41216
v_exp_f32 v207, v207
WL 2
Mvav 208,240,176
v_add_f32 v247, v247, v199
Mvav 216,240,180
Ta 240,228,32768
AR 253,68
AR 254,69
Mvav 212,244,176
Ta 242,228,40960
CV 195,198,199
Mvav 220,244,180
Ta 244,229,32768
v_add_f32 v248, v248, v207
WL 3
Mvav 208,248,184
Ta 246,229,40960
CV 203,206,207
Mvav 216,248,188
Ta 248,230,32768
Mvav 212,252,184
Ta 250,230,40960
Mvav 220,252,188
Ta 252,231,32768
CV 253,253,254
AW 226,253
WL 3
Mvav 0,240,192
Ta 254,231,40960
Mvav 8,240,200
Ta 240,232,32768
AR 253,70
AR 254,71
Mvav 4,244,192
Ta 242,232,40960
Mvav 12,244,200
Ta 244,233,32768
v_fma_f32 v208, v208, s37, -v245
WL 3
Mvav 16,248,192
Ta 246,233,40960
v_fma_f32 v209, v209, s37, -v245
Mvav 24,248,200
Ta 248,234,32768
v_fma_f32 v210, v210, s37, -v245
Mvav 20,252,192
Ta 250,234,40960
v_fma_f32 v211, v211, s37, -v245
Mvav 28,252,200
Ta 252,235,32768
v_fma_f32 v212, v212, s37, -v245
WL 3
Mvav 32,240,192
Ta 254,235,40960
v_fma_f32 v213, v213, s37, -v245
Mvav 40,240,200
Ta 240,228,33024
v_max3_f32 v251, v208, v209, v210
Mvav 36,244,192
Ta 242,228,41216
v_fma_f32 v214, v214, s37, -v245
Mvav 44,244,200
Ta 244,229,33024
v_fma_f32 v215, v215, s37, -v245
WL 3
Mvav 48,248,192
Ta 246,229,41216
v_max3_f32 v252, v211, v212, v213
Mvav 56,248,200
Ta 248,230,33024
CV 253,253,254
AW 227,253
Mvav 52,252,192
Ta 250,230,41216
v_fma_f32 v216, v216, s37, -v246
v_fma_f32 v217, v217, s37, -v246
Mvav 60,252,200
Ta 252,231,33024
WL 3
Mvav 64,240,192
Ta 254,231,41216
v_max3_f32 v251, v251, v214, v215
v_fma_f32 v218, v218, s37, -v246
Mvav 72,240,200
Ta 240,232,33024
Mvav 68,244,192
Ta 242,232,41216
v_fma_f32 v219, v219, s37, -v246
v_max3_f32 v252, v252, v216, v217
Mvav 76,244,200
Ta 244,233,33024
WL 3
Mvav 80,248,192
Ta 246,233,41216
v_fma_f32 v220, v220, s37, -v246
v_fma_f32 v221, v221, s37, -v246
Mvav 88,248,200
Ta 248,234,33024
AR 253,72
AR 254,73
Mvav 84,252,192
Ta 250,234,41216
v_max3_f32 v251, v251, v218, v219
Mvav 92,252,200
Ta 252,235,33024
v_fma_f32 v222, v222, s37, -v246
WL 3
Mvav 96,240,192
Ta 254,235,41216
v_fma_f32 v223, v223, s37, -v246
Mvav 104,240,200
Ta 240,236,16384
v_max3_f32 v252, v252, v220, v221
Mvav 100,244,192
Ta 242,236,18432
v_max3_f32 v251, v251, v222, v223
Mvav 108,244,200
Ta 244,237,16384
v_max_f32 v251, v251, v252
WL 3
Mvav 112,248,192
Ta 246,237,18432
v_cmp_lt_f32 vcc, s38, v251
Mvav 120,248,200
Ta 248,238,16384
s_cbranch_vccnz LA_ra43
LA_rb43:
Mvav 116,252,192
Ta 250,238,18432
Mvav 124,252,200
Ta 252,239,16384
s_cmp_lg_u32 s49, 0
s_cbranch_scc1 LA_ra44
LA_rb44:
WL 3
v_mfma_f32_16x16x32_bf16 a[96:99], a[240:243], a[128:131], 0
Ta 254,239,18432
CV 253,253,254
AW 228,253
v_mfma_f32_16x16x32_bf16 a[104:107], a[240:243], a[132:135], 0
Ta 240,236,20480
v_exp_f32 v208, v208
v_mfma_f32_16x16x32_bf16 a[100:103], a[244:247], a[128:131], 0
Ta 242,236,22528
AR 253,74
AR 254,75
v_mfma_f32_16x16x32_bf16 a[108:111], a[244:247], a[132:135], 0
Ta 244,237,20480
WL 3
v_mfma_f32_16x16x32_bf16 a[112:115], a[248:251], a[128:131], 0
Ta 246,237,22528
v_exp_f32 v216, v216
v_mfma_f32_16x16x32_bf16 a[120:123], a[248:251], a[132:135], 0
Ta 248,238,20480
v_mfma_f32_16x16x32_bf16 a[116:119], a[252:255], a[128:131], 0
Ta 250,238,22528
v_add_f32 v247, v247, v208
v_mfma_f32_16x16x32_bf16 a[124:127], a[252:255], a[132:135], 0
Ta 252,239,20480
CV 253,253,254
AW 229,253
WL 3
Maaa 96,240,136
Ta 254,239,22528
Maaa 104,240,140
Ta 240,236,24576
v_exp_f32 v209, v209
Maaa 100,244,136
Ta 242,236,26624
AR 253,76
AR 254,77
Maaa 108,244,140
Ta 244,237,24576
v_add_f32 v248, v248, v216
WL 3
Maaa 112,248,136
Ta 246,237,26624
Maaa 120,248,140
Ta 248,238,24576
Maaa 116,252,136
Ta 250,238,26624
v_exp_f32 v217, v217
Maaa 124,252,140
Ta 252,239,24576
CV 253,253,254
AW 230,253
WL 3
Maaa 96,240,144
Ta 254,239,26624
v_add_f32 v247, v247, v209
Maaa 104,240,148
Ta 240,236,28672
Maaa 100,244,144
Ta 242,236,30720
CV 208,208,209
Maaa 108,244,148
Ta 244,237,28672
WL 3
Maaa 112,248,144
Ta 246,237,30720
v_exp_f32 v210, v210
Maaa 120,248,148
Ta 248,238,28672
AR 253,78
AR 254,79
Maaa 116,252,144
Ta 250,238,30720
v_add_f32 v248, v248, v217
Maaa 124,252,148
Ta 252,239,28672
WL 3
Maaa 96,240,152
Ta 254,239,30720
CV 216,216,217
Maaa 104,240,156
v_exp_f32 v218, v218
Maaa 100,244,152
v_add_f32 v247, v247, v210
CV 253,253,254
AW 231,253
Maaa 108,244,156
WL 0
s_barrier
Ba 240,224,49152
Ba 244,224,57344
Maaa 112,248,152
v_exp_f32 v211, v211
Maaa 120,248,156
Ba 248,225,49152
v_add_f32 v248, v248, v218
Maaa 116,252,152
v_exp_f32 v219, v219
Maaa 124,252,156
Ba 252,225,57344
WL 2
v_mfma_f32_16x16x32_bf16 v[192:195], a[240:243], v[128:131], 0
v_add_f32 v247, v247, v211
CV 209,210,211
v_mfma_f32_16x16x32_bf16 v[200:203], a[240:243], v[132:135], 0
Ba 240,226,49152
v_mfma_f32_16x16x32_bf16 v[196:199], a[244:247], v[128:131], 0
v_exp_f32 v212, v212
v_mfma_f32_16x16x32_bf16 v[204:207], a[244:247], v[132:135], 0
Ba 244,226,57344
AR 253,80
AR 254,81
WL 2
Mvav 192,248,136
v_add_f32 v248, v248, v219
CV 217,218,219
Mvav 200,248,140
Ba 248,227,49152
Mvav 196,252,136
v_exp_f32 v220, v220
v_add_f32 v247, v247, v212
Mvav 204,252,140
Ba 252,227,57344
WL 2
Mvav 192,240,144
v_exp_f32 v213, v213
Mvav 200,240,148
Ba 240,224,49408
CV 253,253,254
AW 232,253
Mvav 196,244,144
v_add_f32 v248, v248, v220
v_exp_f32 v221, v221
Mvav 204,244,148
Ba 244,224,57600
WL 2
Mvav 192,248,152
v_add_f32 v247, v247, v213
Mvav 200,248,156
Ba 248,225,49408
CV 210,212,213
Mvav 196,252,152
v_exp_f32 v214, v214
Mvav 204,252,156
Ba 252,225,57600
AR 253,82
AR 254,83
WL 2
Mvav 192,240,160
v_add_f32 v248, v248, v221
CV 218,220,221
Mvav 200,240,164
Ba 240,226,49408
Mvav 196,244,160
v_exp_f32 v222, v222
Mvav 204,244,164
Ba 244,226,57600
v_add_f32 v247, v247, v214
WL 2
Mvav 192,248,168
v_exp_f32 v215, v215
Mvav 200,248,172
Ba 248,227,49408
Mvav 196,252,168
v_add_f32 v248, v248, v222
CV 253,253,254
AW 233,253
Mvav 204,252,172
Ba 252,227,57600
v_exp_f32 v223, v223
WL 2
Mvav 192,240,176
v_add_f32 v247, v247, v215
AR 253,84
AR 254,85
Mvav 200,240,180
Ta 240,228,16384
Mvav 196,244,176
Ta 242,228,24576
CV 211,214,215
Mvav 204,244,180
Ta 244,229,16384
v_add_f32 v248, v248, v223
WL 3
Mvav 192,248,184
Ta 246,229,24576
CV 219,222,223
Mvav 200,248,188
Ta 248,230,16384
Mvav 196,252,184
Ta 250,230,24576
CV 253,253,254
AW 234,253
Mvav 204,252,188
Ta 252,231,16384
WL 3
Mvav 0,240,208
Ta 254,231,24576
AR 253,86
AR 254,87
Mvav 8,240,216
Ta 240,232,16384
Mvav 4,244,208
Ta 242,232,24576
Mvav 12,244,216
Ta 244,233,16384
v_fma_f32 v192, v192, s37, -v245
WL 3
Mvav 16,248,208
Ta 246,233,24576
v_fma_f32 v193, v193, s37, -v245
CV 253,253,254
AW 235,253
Mvav 24,248,216
Ta 248,234,16384
v_fma_f32 v194, v194, s37, -v245
Mvav 20,252,208
Ta 250,234,24576
v_fma_f32 v195, v195, s37, -v245
Mvav 28,252,216
Ta 252,235,16384
v_fma_f32 v196, v196, s37, -v245
WL 3
Mvav 32,240,208
Ta 254,235,24576
v_fma_f32 v197, v197, s37, -v245
Mvav 40,240,216
Ta 240,228,16640
v_max3_f32 v251, v192, v193, v194
Mvav 36,244,208
Ta 242,228,24832
v_fma_f32 v198, v198, s37, -v245
Mvav 44,244,216
Ta 244,229,16640
v_fma_f32 v199, v199, s37, -v245
WL 3
Mvav 48,248,208
Ta 246,229,24832
v_max3_f32 v252, v195, v196, v197
Mvav 56,248,216
Ta 248,230,16640
Mvav 52,252,208
Ta 250,230,24832
v_fma_f32 v200, v200, s37, -v246
v_fma_f32 v201, v201, s37, -v246
Mvav 60,252,216
Ta 252,231,16640
WL 3
Mvav 64,240,208
Ta 254,231,24832
v_max3_f32 v251, v251, v198, v199
v_fma_f32 v202, v202, s37, -v246
Mvav 72,240,216
Ta 240,232,16640
AR 253,88
AR 254,89
Mvav 68,244,208
Ta 242,232,24832
v_fma_f32 v203, v203, s37, -v246
v_max3_f32 v252, v252, v200, v201
Mvav 76,244,216
Ta 244,233,16640
WL 3
Mvav 80,248,208
Ta 246,233,24832
v_fma_f32 v204, v204, s37, -v246
v_fma_f32 v205, v205, s37, -v246
Mvav 88,248,216
Ta 248,234,16640
Mvav 84,252,208
Ta 250,234,24832
v_max3_f32 v251, v251, v202, v203
Mvav 92,252,216
Ta 252,235,16640
v_fma_f32 v206, v206, s37, -v246
WL 3
Mvav 96,240,208
Ta 254,235,24832
v_fma_f32 v207, v207, s37, -v246
Mvav 104,240,216
Ta 240,236,32768
v_max3_f32 v252, v252, v204, v205
Mvav 100,244,208
Ta 242,236,34816
v_max3_f32 v251, v251, v206, v207
Mvav 108,244,216
Ta 244,237,32768
v_max_f32 v251, v251, v252
WL 3
Mvav 112,248,208
Ta 246,237,34816
v_cmp_lt_f32 vcc, s38, v251
Mvav 120,248,216
Ta 248,238,32768
s_cbranch_vccnz LA_ra45
LA_rb45:
Mvav 116,252,208
Ta 250,238,34816
CV 253,253,254
AW 236,253
Mvav 124,252,216
Ta 252,239,32768
s_cmp_lg_u32 s49, 0
s_cbranch_scc1 LA_ra46
LA_rb46:
WL 3
Maaa 96,240,160
Ta 254,239,34816
Maaa 104,240,164
Ta 240,236,36864
v_exp_f32 v192, v192
Maaa 100,244,160
Ta 242,236,38912
AR 253,90
AR 254,91
Maaa 108,244,164
Ta 244,237,36864
WL 3
Maaa 112,248,160
Ta 246,237,38912
v_exp_f32 v200, v200
Maaa 120,248,164
Ta 248,238,36864
CV 253,253,254
AW 237,253
Maaa 116,252,160
Ta 250,238,38912
v_add_f32 v247, v247, v192
Maaa 124,252,164
Ta 252,239,36864
WL 3
Maaa 96,240,168
Ta 254,239,38912
Maaa 104,240,172
Ta 240,236,40960
v_exp_f32 v193, v193
Maaa 100,244,168
Ta 242,236,43008
AR 253,92
AR 254,93
Maaa 108,244,172
Ta 244,237,40960
v_add_f32 v248, v248, v200
WL 3
Maaa 112,248,168
Ta 246,237,43008
Maaa 120,248,172
Ta 248,238,40960
CV 253,253,254
AW 238,253
Maaa 116,252,168
Ta 250,238,43008
v_exp_f32 v201, v201
Maaa 124,252,172
Ta 252,239,40960
WL 3
Maaa 96,240,176
Ta 254,239,43008
v_add_f32 v247, v247, v193
Maaa 104,240,180
Ta 240,236,45056
Maaa 100,244,176
Ta 242,236,47104
CV 192,192,193
Maaa 108,244,180
Ta 244,237,45056
AR 253,94
AR 254,95
WL 3
Maaa 112,248,176
Ta 246,237,47104
v_exp_f32 v194, v194
Maaa 120,248,180
Ta 248,238,45056
Maaa 116,252,176
Ta 250,238,47104
v_add_f32 v248, v248, v201
Maaa 124,252,180
Ta 252,239,45056
WL 3
Maaa 96,240,184
Ta 254,239,47104
CV 200,200,201
Maaa 104,240,188
v_exp_f32 v202, v202
Maaa 100,244,184
v_add_f32 v247, v247, v194
CV 253,253,254
AW 239,253
Maaa 108,244,188
WL 0
s_barrier
Ba 240,224,0
Ba 244,224,8192
Maaa 112,248,184
v_exp_f32 v195, v195
Maaa 120,248,188
Ba 248,225,0
v_add_f32 v248, v248, v202
Maaa 116,252,184
v_exp_f32 v203, v203
Maaa 124,252,188
Ba 252,225,8192
WL 2
v_mfma_f32_16x16x32_bf16 v[208:211], a[240:243], v[128:131], 0
v_add_f32 v247, v247, v195
CV 193,194,195
v_mfma_f32_16x16x32_bf16 v[216:219], a[240:243], v[132:135], 0
Ba 240,226,0
v_mfma_f32_16x16x32_bf16 v[212:215], a[244:247], v[128:131], 0
v_exp_f32 v196, v196
v_mfma_f32_16x16x32_bf16 v[220:223], a[244:247], v[132:135], 0
Ba 244,226,8192
WL 2
Mvav 208,248,136
v_add_f32 v248, v248, v203
CV 201,202,203
Mvav 216,248,140
Ba 248,227,0
Mvav 212,252,136
v_exp_f32 v204, v204
v_add_f32 v247, v247, v196
Mvav 220,252,140
Ba 252,227,8192
WL 2
Mvav 208,240,144
v_exp_f32 v197, v197
Mvav 216,240,148
Ba 240,224,256
Mvav 212,244,144
v_add_f32 v248, v248, v204
v_exp_f32 v205, v205
Mvav 220,244,148
Ba 244,224,8448
WL 2
Mvav 208,248,152
v_add_f32 v247, v247, v197
Mvav 216,248,156
Ba 248,225,256
CV 194,196,197
Mvav 212,252,152
v_exp_f32 v198, v198
Mvav 220,252,156
Ba 252,225,8448
WL 2
Mvav 208,240,160
v_add_f32 v248, v248, v205
CV 202,204,205
Mvav 216,240,164
Ba 240,226,256
Mvav 212,244,160
v_exp_f32 v206, v206
Mvav 220,244,164
Ba 244,226,8448
v_add_f32 v247, v247, v198
WL 2
Mvav 208,248,168
v_exp_f32 v199, v199
Mvav 216,248,172
Ba 248,227,256
Mvav 212,252,168
v_add_f32 v248, v248, v206
Mvav 220,252,172
Ba 252,227,8448
v_exp_f32 v207, v207
WL 2
Mvav 208,240,176
v_add_f32 v247, v247, v199
Mvav 216,240,180
Ta 240,228,0
Mvav 212,244,176
Ta 242,228,8192
CV 195,198,199
Mvav 220,244,180
Ta 244,229,0
v_add_f32 v248, v248, v207
WL 3
Mvav 208,248,184
Ta 246,229,8192
CV 203,206,207
Mvav 216,248,188
Ta 248,230,0
Mvav 212,252,184
Ta 250,230,8192
Mvav 220,252,188
Ta 252,231,0
WL 3
Mvav 0,240,192
Ta 254,231,8192
Mvav 8,240,200
Ta 240,232,0
Mvav 4,244,192
Ta 242,232,8192
Mvav 12,244,200
Ta 244,233,0
v_fma_f32 v208, v208, s37, -v245
WL 3
Mvav 16,248,192
Ta 246,233,8192
v_fma_f32 v209, v209, s37, -v245
Mvav 24,248,200
Ta 248,234,0
v_fma_f32 v210, v210, s37, -v245
Mvav 20,252,192
Ta 250,234,8192
v_fma_f32 v211, v211, s37, -v245
Mvav 28,252,200
Ta 252,235,0
v_fma_f32 v212, v212, s37, -v245
WL 3
Mvav 32,240,192
Ta 254,235,8192
v_fma_f32 v213, v213, s37, -v245
Mvav 40,240,200
Ta 240,228,256
v_max3_f32 v251, v208, v209, v210
Mvav 36,244,192
Ta 242,228,8448
v_fma_f32 v214, v214, s37, -v245
Mvav 44,244,200
Ta 244,229,256
v_fma_f32 v215, v215, s37, -v245
WL 3
Mvav 48,248,192
Ta 246,229,8448
v_max3_f32 v252, v211, v212, v213
Mvav 56,248,200
Ta 248,230,256
Mvav 52,252,192
Ta 250,230,8448
v_fma_f32 v216, v216, s37, -v246
v_fma_f32 v217, v217, s37, -v246
Mvav 60,252,200
Ta 252,231,256
WL 3
Mvav 64,240,192
Ta 254,231,8448
v_max3_f32 v251, v251, v214, v215
v_fma_f32 v218, v218, s37, -v246
Mvav 72,240,200
Ta 240,232,256
Mvav 68,244,192
Ta 242,232,8448
v_fma_f32 v219, v219, s37, -v246
v_max3_f32 v252, v252, v216, v217
Mvav 76,244,200
Ta 244,233,256
WL 3
Mvav 80,248,192
Ta 246,233,8448
v_fma_f32 v220, v220, s37, -v246
v_fma_f32 v221, v221, s37, -v246
Mvav 88,248,200
Ta 248,234,256
Mvav 84,252,192
Ta 250,234,8448
v_max3_f32 v251, v251, v218, v219
Mvav 92,252,200
Ta 252,235,256
v_fma_f32 v222, v222, s37, -v246
WL 3
Mvav 96,240,192
Ta 254,235,8448
v_fma_f32 v223, v223, s37, -v246
Mvav 104,240,200
Ta 240,236,49152
v_max3_f32 v252, v252, v220, v221
Mvav 100,244,192
Ta 242,236,51200
v_max3_f32 v251, v251, v222, v223
Mvav 108,244,200
Ta 244,237,49152
v_max_f32 v251, v251, v252
WL 3
Mvav 112,248,192
Ta 246,237,51200
v_cmp_lt_f32 vcc, s38, v251
Mvav 120,248,200
Ta 248,238,49152
s_cbranch_vccnz LA_ra47
LA_rb47:
Mvav 116,252,192
Ta 250,238,51200
Mvav 124,252,200
Ta 252,239,49152
s_cmp_lg_u32 s49, 0
s_cbranch_scc1 LA_ra48
LA_rb48:
WL 3
v_mfma_f32_16x16x32_bf16 a[0:3], a[240:243], a[128:131], 0
Ta 254,239,51200
v_mfma_f32_16x16x32_bf16 a[8:11], a[240:243], a[132:135], 0
Ta 240,236,53248
v_exp_f32 v208, v208
v_mfma_f32_16x16x32_bf16 a[4:7], a[244:247], a[128:131], 0
Ta 242,236,55296
v_mfma_f32_16x16x32_bf16 a[12:15], a[244:247], a[132:135], 0
Ta 244,237,53248
WL 3
v_mfma_f32_16x16x32_bf16 a[16:19], a[248:251], a[128:131], 0
Ta 246,237,55296
v_exp_f32 v216, v216
v_mfma_f32_16x16x32_bf16 a[24:27], a[248:251], a[132:135], 0
Ta 248,238,53248
v_mfma_f32_16x16x32_bf16 a[20:23], a[252:255], a[128:131], 0
Ta 250,238,55296
v_add_f32 v247, v247, v208
v_mfma_f32_16x16x32_bf16 a[28:31], a[252:255], a[132:135], 0
Ta 252,239,53248
WL 3
Maaa 0,240,136
Ta 254,239,55296
Maaa 8,240,140
Ta 240,236,57344
v_exp_f32 v209, v209
Maaa 4,244,136
Ta 242,236,59392
Maaa 12,244,140
Ta 244,237,57344
v_add_f32 v248, v248, v216
WL 3
Maaa 16,248,136
Ta 246,237,59392
Maaa 24,248,140
Ta 248,238,57344
Maaa 20,252,136
Ta 250,238,59392
v_exp_f32 v217, v217
Maaa 28,252,140
Ta 252,239,57344
WL 3
Maaa 0,240,144
Ta 254,239,59392
v_add_f32 v247, v247, v209
Maaa 8,240,148
Ta 240,236,61440
Maaa 4,244,144
Ta 242,236,63488
CV 208,208,209
Maaa 12,244,148
Ta 244,237,61440
WL 3
Maaa 16,248,144
Ta 246,237,63488
v_exp_f32 v210, v210
Maaa 24,248,148
Ta 248,238,61440
Maaa 20,252,144
Ta 250,238,63488
v_add_f32 v248, v248, v217
Maaa 28,252,148
Ta 252,239,61440
WL 3
Maaa 0,240,152
Ta 254,239,63488
CV 216,216,217
Maaa 8,240,156
v_exp_f32 v218, v218
Maaa 4,244,152
v_add_f32 v247, v247, v210
Maaa 12,244,156
WL 0
s_barrier
Ba 240,224,16384
Ba 244,224,24576
Maaa 16,248,152
v_exp_f32 v211, v211
Maaa 24,248,156
Ba 248,225,16384
v_add_f32 v248, v248, v218
Maaa 20,252,152
v_exp_f32 v219, v219
Maaa 28,252,156
Ba 252,225,24576
WL 2
v_mfma_f32_16x16x32_bf16 v[192:195], a[240:243], v[128:131], 0
v_add_f32 v247, v247, v211
CV 209,210,211
v_mfma_f32_16x16x32_bf16 v[200:203], a[240:243], v[132:135], 0
Ba 240,226,16384
v_mfma_f32_16x16x32_bf16 v[196:199], a[244:247], v[128:131], 0
v_exp_f32 v212, v212
v_mfma_f32_16x16x32_bf16 v[204:207], a[244:247], v[132:135], 0
Ba 244,226,24576
WL 2
Mvav 192,248,136
v_add_f32 v248, v248, v219
CV 217,218,219
Mvav 200,248,140
Ba 248,227,16384
Mvav 196,252,136
v_exp_f32 v220, v220
v_add_f32 v247, v247, v212
Mvav 204,252,140
Ba 252,227,24576
WL 2
Mvav 192,240,144
v_exp_f32 v213, v213
Mvav 200,240,148
Ba 240,224,16640
Mvav 196,244,144
v_add_f32 v248, v248, v220
v_exp_f32 v221, v221
Mvav 204,244,148
Ba 244,224,24832
WL 2
Mvav 192,248,152
v_add_f32 v247, v247, v213
Mvav 200,248,156
Ba 248,225,16640
CV 210,212,213
Mvav 196,252,152
v_exp_f32 v214, v214
Mvav 204,252,156
Ba 252,225,24832
WL 2
Mvav 192,240,160
v_add_f32 v248, v248, v221
CV 218,220,221
Mvav 200,240,164
Ba 240,226,16640
Mvav 196,244,160
v_exp_f32 v222, v222
Mvav 204,244,164
Ba 244,226,24832
v_add_f32 v247, v247, v214
WL 2
Mvav 192,248,168
v_exp_f32 v215, v215
Mvav 200,248,172
Ba 248,227,16640
Mvav 196,252,168
v_add_f32 v248, v248, v222
Mvav 204,252,172
Ba 252,227,24832
v_exp_f32 v223, v223
WL 2
Mvav 192,240,176
v_add_f32 v247, v247, v215
Mvav 200,240,180
Ta 240,228,32768
Mvav 196,244,176
Ta 242,228,40960
CV 211,214,215
Mvav 204,244,180
Ta 244,229,32768
v_add_f32 v248, v248, v223
WL 3
Mvav 192,248,184
Ta 246,229,40960
CV 219,222,223
Mvav 200,248,188
Ta 248,230,32768
Mvav 196,252,184
Ta 250,230,40960
Mvav 204,252,188
Ta 252,231,32768
WL 3
Mvav 0,240,208
Ta 254,231,40960
Mvav 8,240,216
Ta 240,232,32768
Mvav 4,244,208
Ta 242,232,40960
Mvav 12,244,216
Ta 244,233,32768
v_fma_f32 v192, v192, s37, -v245
WL 3
Mvav 16,248,208
Ta 246,233,40960
v_fma_f32 v193, v193, s37, -v245
Mvav 24,248,216
Ta 248,234,32768
v_fma_f32 v194, v194, s37, -v245
Mvav 20,252,208
Ta 250,234,40960
v_fma_f32 v195, v195, s37, -v245
Mvav 28,252,216
Ta 252,235,32768
v_fma_f32 v196, v196, s37, -v245
WL 3
Mvav 32,240,208
Ta 254,235,40960
v_fma_f32 v197, v197, s37, -v245
Mvav 40,240,216
Ta 240,228,33024
v_max3_f32 v251, v192, v193, v194
Mvav 36,244,208
Ta 242,228,41216
v_fma_f32 v198, v198, s37, -v245
Mvav 44,244,216
Ta 244,229,33024
v_fma_f32 v199, v199, s37, -v245
WL 3
Mvav 48,248,208
Ta 246,229,41216
v_max3_f32 v252, v195, v196, v197
Mvav 56,248,216
Ta 248,230,33024
Mvav 52,252,208
Ta 250,230,41216
v_fma_f32 v200, v200, s37, -v246
v_fma_f32 v201, v201, s37, -v246
Mvav 60,252,216
Ta 252,231,33024
WL 3
Mvav 64,240,208
Ta 254,231,41216
v_max3_f32 v251, v251, v198, v199
v_fma_f32 v202, v202, s37, -v246
Mvav 72,240,216
Ta 240,232,33024
Mvav 68,244,208
Ta 242,232,41216
v_fma_f32 v203, v203, s37, -v246
v_max3_f32 v252, v252, v200, v201
Mvav 76,244,216
Ta 244,233,33024
WL 3
Mvav 80,248,208
Ta 246,233,41216
v_fma_f32 v204, v204, s37, -v246
v_fma_f32 v205, v205, s37, -v246
Mvav 88,248,216
Ta 248,234,33024
Mvav 84,252,208
Ta 250,234,41216
v_max3_f32 v251, v251, v202, v203
Mvav 92,252,216
Ta 252,235,33024
v_fma_f32 v206, v206, s37, -v246
WL 3
Mvav 96,240,208
Ta 254,235,41216
v_fma_f32 v207, v207, s37, -v246
Mvav 104,240,216
Ta 240,236,16384
v_max3_f32 v252, v252, v204, v205
Mvav 100,244,208
Ta 242,236,18432
v_max3_f32 v251, v251, v206, v207
Mvav 108,244,216
Ta 244,237,16384
v_max_f32 v251, v251, v252
WL 3
Mvav 112,248,208
Ta 246,237,18432
v_cmp_lt_f32 vcc, s38, v251
Mvav 120,248,216
Ta 248,238,16384
s_cbranch_vccnz LA_ra49
LA_rb49:
Mvav 116,252,208
Ta 250,238,18432
Mvav 124,252,216
Ta 252,239,16384
s_cmp_lg_u32 s49, 0
s_cbranch_scc1 LA_ra50
LA_rb50:
WL 3
Maaa 0,240,160
Ta 254,239,18432
Maaa 8,240,164
Ta 240,236,20480
v_exp_f32 v192, v192
Maaa 4,244,160
Ta 242,236,22528
Maaa 12,244,164
Ta 244,237,20480
WL 3
Maaa 16,248,160
Ta 246,237,22528
v_exp_f32 v200, v200
Maaa 24,248,164
Ta 248,238,20480
Maaa 20,252,160
Ta 250,238,22528
v_add_f32 v247, v247, v192
Maaa 28,252,164
Ta 252,239,20480
WL 3
Maaa 0,240,168
Ta 254,239,22528
Maaa 8,240,172
Ta 240,236,24576
v_exp_f32 v193, v193
Maaa 4,244,168
Ta 242,236,26624
Maaa 12,244,172
Ta 244,237,24576
v_add_f32 v248, v248, v200
WL 3
Maaa 16,248,168
Ta 246,237,26624
Maaa 24,248,172
Ta 248,238,24576
Maaa 20,252,168
Ta 250,238,26624
v_exp_f32 v201, v201
Maaa 28,252,172
Ta 252,239,24576
WL 3
Maaa 0,240,176
Ta 254,239,26624
v_add_f32 v247, v247, v193
Maaa 8,240,180
Ta 240,236,28672
Maaa 4,244,176
Ta 242,236,30720
CV 192,192,193
Maaa 12,244,180
Ta 244,237,28672
WL 3
Maaa 16,248,176
Ta 246,237,30720
v_exp_f32 v194, v194
Maaa 24,248,180
Ta 248,238,28672
Maaa 20,252,176
Ta 250,238,30720
v_add_f32 v248, v248, v201
Maaa 28,252,180
Ta 252,239,28672
WL 3
Maaa 0,240,184
Ta 254,239,30720
CV 200,200,201
Maaa 8,240,188
v_exp_f32 v202, v202
Maaa 4,244,184
v_add_f32 v247, v247, v194
Maaa 12,244,188
WL 0
s_barrier
Ba 240,224,32768
Ba 244,224,40960
Maaa 16,248,184
v_exp_f32 v195, v195
Maaa 24,248,188
Ba 248,225,32768
v_add_f32 v248, v248, v202
Maaa 20,252,184
v_exp_f32 v203, v203
Maaa 28,252,188
Ba 252,225,40960
WL 2
v_mfma_f32_16x16x32_bf16 v[208:211], a[240:243], v[128:131], 0
v_add_f32 v247, v247, v195
CV 193,194,195
v_mfma_f32_16x16x32_bf16 v[216:219], a[240:243], v[132:135], 0
Ba 240,226,32768
v_mfma_f32_16x16x32_bf16 v[212:215], a[244:247], v[128:131], 0
v_exp_f32 v196, v196
v_mfma_f32_16x16x32_bf16 v[220:223], a[244:247], v[132:135], 0
Ba 244,226,40960
WL 2
Mvav 208,248,136
v_add_f32 v248, v248, v203
CV 201,202,203
Mvav 216,248,140
Ba 248,227,32768
Mvav 212,252,136
v_exp_f32 v204, v204
v_add_f32 v247, v247, v196
Mvav 220,252,140
Ba 252,227,40960
WL 2
Mvav 208,240,144
v_exp_f32 v197, v197
Mvav 216,240,148
Ba 240,224,33024
Mvav 212,244,144
v_add_f32 v248, v248, v204
v_exp_f32 v205, v205
Mvav 220,244,148
Ba 244,224,41216
WL 2
Mvav 208,248,152
v_add_f32 v247, v247, v197
Mvav 216,248,156
Ba 248,225,33024
CV 194,196,197
Mvav 212,252,152
v_exp_f32 v198, v198
Mvav 220,252,156
Ba 252,225,41216
WL 2
Mvav 208,240,160
v_add_f32 v248, v248, v205
CV 202,204,205
Mvav 216,240,164
Ba 240,226,33024
Mvav 212,244,160
v_exp_f32 v206, v206
Mvav 220,244,164
Ba 244,226,41216
v_add_f32 v247, v247, v198
WL 2
Mvav 208,248,168
v_exp_f32 v199, v199
Mvav 216,248,172
Ba 248,227,33024
Mvav 212,252,168
v_add_f32 v248, v248, v206
Mvav 220,252,172
Ba 252,227,41216
v_exp_f32 v207, v207
WL 2
Mvav 208,240,176
v_add_f32 v247, v247, v199
Mvav 216,240,180
Ta 240,228,16384
Mvav 212,244,176
Ta 242,228,24576
CV 195,198,199
Mvav 220,244,180
Ta 244,229,16384
v_add_f32 v248, v248, v207
WL 3
Mvav 208,248,184
Ta 246,229,24576
CV 203,206,207
Mvav 216,248,188
Ta 248,230,16384
Mvav 212,252,184
Ta 250,230,24576
Mvav 220,252,188
Ta 252,231,16384
WL 3
Mvav 0,240,192
Ta 254,231,24576
Mvav 8,240,200
Ta 240,232,16384
Mvav 4,244,192
Ta 242,232,24576
Mvav 12,244,200
Ta 244,233,16384
v_fma_f32 v208, v208, s37, -v245
WL 3
Mvav 16,248,192
Ta 246,233,24576
v_fma_f32 v209, v209, s37, -v245
Mvav 24,248,200
Ta 248,234,16384
v_fma_f32 v210, v210, s37, -v245
Mvav 20,252,192
Ta 250,234,24576
v_fma_f32 v211, v211, s37, -v245
Mvav 28,252,200
Ta 252,235,16384
v_fma_f32 v212, v212, s37, -v245
WL 3
Mvav 32,240,192
Ta 254,235,24576
v_fma_f32 v213, v213, s37, -v245
Mvav 40,240,200
Ta 240,228,16640
v_max3_f32 v251, v208, v209, v210
Mvav 36,244,192
Ta 242,228,24832
v_fma_f32 v214, v214, s37, -v245
Mvav 44,244,200
Ta 244,229,16640
v_fma_f32 v215, v215, s37, -v245
WL 3
Mvav 48,248,192
Ta 246,229,24832
v_max3_f32 v252, v211, v212, v213
Mvav 56,248,200
Ta 248,230,16640
Mvav 52,252,192
Ta 250,230,24832
v_fma_f32 v216, v216, s37, -v246
v_fma_f32 v217, v217, s37, -v246
Mvav 60,252,200
Ta 252,231,16640
WL 3
Mvav 64,240,192
Ta 254,231,24832
v_max3_f32 v251, v251, v214, v215
v_fma_f32 v218, v218, s37, -v246
Mvav 72,240,200
Ta 240,232,16640
Mvav 68,244,192
Ta 242,232,24832
v_fma_f32 v219, v219, s37, -v246
v_max3_f32 v252, v252, v216, v217
Mvav 76,244,200
Ta 244,233,16640
WL 3
Mvav 80,248,192
Ta 246,233,24832
v_fma_f32 v220, v220, s37, -v246
v_fma_f32 v221, v221, s37, -v246
Mvav 88,248,200
Ta 248,234,16640
Mvav 84,252,192
Ta 250,234,24832
v_max3_f32 v251, v251, v218, v219
Mvav 92,252,200
Ta 252,235,16640
v_fma_f32 v222, v222, s37, -v246
WL 3
Mvav 96,240,192
Ta 254,235,24832
v_fma_f32 v223, v223, s37, -v246
Mvav 104,240,200
Ta 240,236,32768
v_max3_f32 v252, v252, v220, v221
Mvav 100,244,192
Ta 242,236,34816
v_max3_f32 v251, v251, v222, v223
Mvav 108,244,200
Ta 244,237,32768
v_max_f32 v251, v251, v252
WL 3
Mvav 112,248,192
Ta 246,237,34816
v_cmp_lt_f32 vcc, s38, v251
Mvav 120,248,200
Ta 248,238,32768
s_cbranch_vccnz LA_ra51
LA_rb51:
Mvav 116,252,192
Ta 250,238,34816
Mvav 124,252,200
Ta 252,239,32768
s_cmp_lg_u32 s49, 0
s_cbranch_scc1 LA_ra52
LA_rb52:
WL 3
v_mfma_f32_16x16x32_bf16 a[32:35], a[240:243], a[128:131], 0
Ta 254,239,34816
v_mfma_f32_16x16x32_bf16 a[40:43], a[240:243], a[132:135], 0
Ta 240,236,36864
v_exp_f32 v208, v208
v_mfma_f32_16x16x32_bf16 a[36:39], a[244:247], a[128:131], 0
Ta 242,236,38912
v_mfma_f32_16x16x32_bf16 a[44:47], a[244:247], a[132:135], 0
Ta 244,237,36864
WL 3
v_mfma_f32_16x16x32_bf16 a[48:51], a[248:251], a[128:131], 0
Ta 246,237,38912
v_exp_f32 v216, v216
v_mfma_f32_16x16x32_bf16 a[56:59], a[248:251], a[132:135], 0
Ta 248,238,36864
v_mfma_f32_16x16x32_bf16 a[52:55], a[252:255], a[128:131], 0
Ta 250,238,38912
v_add_f32 v247, v247, v208
v_mfma_f32_16x16x32_bf16 a[60:63], a[252:255], a[132:135], 0
Ta 252,239,36864
WL 3
Maaa 32,240,136
Ta 254,239,38912
Maaa 40,240,140
Ta 240,236,40960
v_exp_f32 v209, v209
Maaa 36,244,136
Ta 242,236,43008
Maaa 44,244,140
Ta 244,237,40960
v_add_f32 v248, v248, v216
WL 3
Maaa 48,248,136
Ta 246,237,43008
Maaa 56,248,140
Ta 248,238,40960
Maaa 52,252,136
Ta 250,238,43008
v_exp_f32 v217, v217
Maaa 60,252,140
Ta 252,239,40960
WL 3
Maaa 32,240,144
Ta 254,239,43008
v_add_f32 v247, v247, v209
Maaa 40,240,148
Ta 240,236,45056
Maaa 36,244,144
Ta 242,236,47104
CV 208,208,209
Maaa 44,244,148
Ta 244,237,45056
WL 3
Maaa 48,248,144
Ta 246,237,47104
v_exp_f32 v210, v210
Maaa 56,248,148
Ta 248,238,45056
Maaa 52,252,144
Ta 250,238,47104
v_add_f32 v248, v248, v217
Maaa 60,252,148
Ta 252,239,45056
WL 3
Maaa 32,240,152
Ta 254,239,47104
CV 216,216,217
Maaa 40,240,156
v_exp_f32 v218, v218
Maaa 36,244,152
v_add_f32 v247, v247, v210
Maaa 44,244,156
WL 0
s_barrier
Ba 240,224,0
Ba 244,224,8192
Maaa 48,248,152
v_exp_f32 v211, v211
Maaa 56,248,156
Ba 248,225,0
v_add_f32 v248, v248, v218
Maaa 52,252,152
v_exp_f32 v219, v219
Maaa 60,252,156
Ba 252,225,8192
WL 2
v_mfma_f32_16x16x32_bf16 v[192:195], a[240:243], v[128:131], 0
v_add_f32 v247, v247, v211
CV 209,210,211
v_mfma_f32_16x16x32_bf16 v[200:203], a[240:243], v[132:135], 0
Ba 240,226,0
v_mfma_f32_16x16x32_bf16 v[196:199], a[244:247], v[128:131], 0
v_exp_f32 v212, v212
v_mfma_f32_16x16x32_bf16 v[204:207], a[244:247], v[132:135], 0
Ba 244,226,8192
WL 2
Mvav 192,248,136
v_add_f32 v248, v248, v219
CV 217,218,219
Mvav 200,248,140
Ba 248,227,0
Mvav 196,252,136
v_exp_f32 v220, v220
v_add_f32 v247, v247, v212
Mvav 204,252,140
Ba 252,227,8192
WL 2
Mvav 192,240,144
v_exp_f32 v213, v213
Mvav 200,240,148
Ba 240,224,256
Mvav 196,244,144
v_add_f32 v248, v248, v220
v_exp_f32 v221, v221
Mvav 204,244,148
Ba 244,224,8448
WL 2
Mvav 192,248,152
v_add_f32 v247, v247, v213
Mvav 200,248,156
Ba 248,225,256
CV 210,212,213
Mvav 196,252,152
v_exp_f32 v214, v214
Mvav 204,252,156
Ba 252,225,8448
WL 2
Mvav 192,240,160
v_add_f32 v248, v248, v221
CV 218,220,221
Mvav 200,240,164
Ba 240,226,256
Mvav 196,244,160
v_exp_f32 v222, v222
Mvav 204,244,164
Ba 244,226,8448
v_add_f32 v247, v247, v214
WL 2
Mvav 192,248,168
v_exp_f32 v215, v215
Mvav 200,248,172
Ba 248,227,256
Mvav 196,252,168
v_add_f32 v248, v248, v222
Mvav 204,252,172
Ba 252,227,8448
v_exp_f32 v223, v223
WL 2
Mvav 192,240,176
v_add_f32 v247, v247, v215
Mvav 200,240,180
Ta 240,228,0
Mvav 196,244,176
Ta 242,228,8192
CV 211,214,215
Mvav 204,244,180
Ta 244,229,0
v_add_f32 v248, v248, v223
WL 3
Mvav 192,248,184
Ta 246,229,8192
CV 219,222,223
Mvav 200,248,188
Ta 248,230,0
Mvav 196,252,184
Ta 250,230,8192
Mvav 204,252,188
Ta 252,231,0
WL 3
Mvav 0,240,208
Ta 254,231,8192
Mvav 8,240,216
Ta 240,232,0
Mvav 4,244,208
Ta 242,232,8192
Mvav 12,244,216
Ta 244,233,0
v_fma_f32 v192, v192, s37, -v245
WL 3
Mvav 16,248,208
Ta 246,233,8192
v_fma_f32 v193, v193, s37, -v245
Mvav 24,248,216
Ta 248,234,0
v_fma_f32 v194, v194, s37, -v245
Mvav 20,252,208
Ta 250,234,8192
v_fma_f32 v195, v195, s37, -v245
Mvav 28,252,216
Ta 252,235,0
v_fma_f32 v196, v196, s37, -v245
WL 3
Mvav 32,240,208
Ta 254,235,8192
v_fma_f32 v197, v197, s37, -v245
Mvav 40,240,216
Ta 240,228,256
v_max3_f32 v251, v192, v193, v194
Mvav 36,244,208
Ta 242,228,8448
v_fma_f32 v198, v198, s37, -v245
Mvav 44,244,216
Ta 244,229,256
v_fma_f32 v199, v199, s37, -v245
WL 3
Mvav 48,248,208
Ta 246,229,8448
v_max3_f32 v252, v195, v196, v197
Mvav 56,248,216
Ta 248,230,256
Mvav 52,252,208
Ta 250,230,8448
v_fma_f32 v200, v200, s37, -v246
v_fma_f32 v201, v201, s37, -v246
Mvav 60,252,216
Ta 252,231,256
WL 3
Mvav 64,240,208
Ta 254,231,8448
v_max3_f32 v251, v251, v198, v199
v_fma_f32 v202, v202, s37, -v246
Mvav 72,240,216
Ta 240,232,256
Mvav 68,244,208
Ta 242,232,8448
v_fma_f32 v203, v203, s37, -v246
v_max3_f32 v252, v252, v200, v201
Mvav 76,244,216
Ta 244,233,256
WL 3
Mvav 80,248,208
Ta 246,233,8448
v_fma_f32 v204, v204, s37, -v246
v_fma_f32 v205, v205, s37, -v246
Mvav 88,248,216
Ta 248,234,256
Mvav 84,252,208
Ta 250,234,8448
v_max3_f32 v251, v251, v202, v203
Mvav 92,252,216
Ta 252,235,256
v_fma_f32 v206, v206, s37, -v246
WL 3
Mvav 96,240,208
Ta 254,235,8448
v_fma_f32 v207, v207, s37, -v246
Mvav 104,240,216
Ta 240,236,49152
v_max3_f32 v252, v252, v204, v205
Mvav 100,244,208
Ta 242,236,51200
v_max3_f32 v251, v251, v206, v207
Mvav 108,244,216
Ta 244,237,49152
v_max_f32 v251, v251, v252
WL 3
Mvav 112,248,208
Ta 246,237,51200
v_cmp_lt_f32 vcc, s38, v251
Mvav 120,248,216
Ta 248,238,49152
s_cbranch_vccnz LA_ra53
LA_rb53:
Mvav 116,252,208
Ta 250,238,51200
Mvav 124,252,216
Ta 252,239,49152
s_cmp_lg_u32 s49, 0
s_cbranch_scc1 LA_ra54
LA_rb54:
WL 3
Maaa 32,240,160
Ta 254,239,51200
Maaa 40,240,164
Ta 240,236,53248
v_exp_f32 v192, v192
Maaa 36,244,160
Ta 242,236,55296
Maaa 44,244,164
Ta 244,237,53248
WL 3
Maaa 48,248,160
Ta 246,237,55296
v_exp_f32 v200, v200
Maaa 56,248,164
Ta 248,238,53248
Maaa 52,252,160
Ta 250,238,55296
v_add_f32 v247, v247, v192
Maaa 60,252,164
Ta 252,239,53248
WL 3
Maaa 32,240,168
Ta 254,239,55296
Maaa 40,240,172
Ta 240,236,57344
v_exp_f32 v193, v193
Maaa 36,244,168
Ta 242,236,59392
Maaa 44,244,172
Ta 244,237,57344
v_add_f32 v248, v248, v200
WL 3
Maaa 48,248,168
Ta 246,237,59392
Maaa 56,248,172
Ta 248,238,57344
Maaa 52,252,168
Ta 250,238,59392
v_exp_f32 v201, v201
Maaa 60,252,172
Ta 252,239,57344
WL 3
Maaa 32,240,176
Ta 254,239,59392
v_add_f32 v247, v247, v193
Maaa 40,240,180
Ta 240,236,61440
Maaa 36,244,176
Ta 242,236,63488
CV 192,192,193
Maaa 44,244,180
Ta 244,237,61440
WL 3
Maaa 48,248,176
Ta 246,237,63488
v_exp_f32 v194, v194
Maaa 56,248,180
Ta 248,238,61440
Maaa 52,252,176
Ta 250,238,63488
v_add_f32 v248, v248, v201
Maaa 60,252,180
Ta 252,239,61440
WL 3
Maaa 32,240,184
Ta 254,239,63488
CV 200,200,201
Maaa 40,240,188
v_exp_f32 v202, v202
Maaa 36,244,184
v_add_f32 v247, v247, v194
Maaa 44,244,188
WL 0
s_barrier
Ba 240,224,16384
Ba 244,224,24576
Maaa 48,248,184
v_exp_f32 v195, v195
Maaa 56,248,188
Ba 248,225,16384
v_add_f32 v248, v248, v202
Maaa 52,252,184
v_exp_f32 v203, v203
Maaa 60,252,188
Ba 252,225,24576
WL 2
v_mfma_f32_16x16x32_bf16 v[208:211], a[240:243], v[128:131], 0
v_add_f32 v247, v247, v195
CV 193,194,195
v_mfma_f32_16x16x32_bf16 v[216:219], a[240:243], v[132:135], 0
Ba 240,226,16384
v_mfma_f32_16x16x32_bf16 v[212:215], a[244:247], v[128:131], 0
v_exp_f32 v196, v196
v_mfma_f32_16x16x32_bf16 v[220:223], a[244:247], v[132:135], 0
Ba 244,226,24576
WL 2
Mvav 208,248,136
v_add_f32 v248, v248, v203
CV 201,202,203
Mvav 216,248,140
Ba 248,227,16384
Mvav 212,252,136
v_exp_f32 v204, v204
v_add_f32 v247, v247, v196
Mvav 220,252,140
Ba 252,227,24576
WL 2
Mvav 208,240,144
v_exp_f32 v197, v197
Mvav 216,240,148
Ba 240,224,16640
Mvav 212,244,144
v_add_f32 v248, v248, v204
v_exp_f32 v205, v205
Mvav 220,244,148
Ba 244,224,24832
WL 2
Mvav 208,248,152
v_add_f32 v247, v247, v197
Mvav 216,248,156
Ba 248,225,16640
CV 194,196,197
Mvav 212,252,152
v_exp_f32 v198, v198
Mvav 220,252,156
Ba 252,225,24832
WL 2
Mvav 208,240,160
v_add_f32 v248, v248, v205
CV 202,204,205
Mvav 216,240,164
Ba 240,226,16640
Mvav 212,244,160
v_exp_f32 v206, v206
Mvav 220,244,164
Ba 244,226,24832
v_add_f32 v247, v247, v198
WL 2
Mvav 208,248,168
v_exp_f32 v199, v199
Mvav 216,248,172
Ba 248,227,16640
Mvav 212,252,168
v_add_f32 v248, v248, v206
Mvav 220,252,172
Ba 252,227,24832
v_exp_f32 v207, v207
WL 2
Mvav 208,240,176
v_add_f32 v247, v247, v199
Mvav 216,240,180
Ta 240,228,32768
Mvav 212,244,176
Ta 242,228,40960
CV 195,198,199
Mvav 220,244,180
Ta 244,229,32768
v_add_f32 v248, v248, v207
WL 3
Mvav 208,248,184
Ta 246,229,40960
CV 203,206,207
Mvav 216,248,188
Ta 248,230,32768
Mvav 212,252,184
Ta 250,230,40960
Mvav 220,252,188
Ta 252,231,32768
WL 3
Mvav 0,240,192
Ta 254,231,40960
Mvav 8,240,200
Ta 240,232,32768
Mvav 4,244,192
Ta 242,232,40960
Mvav 12,244,200
Ta 244,233,32768
v_fma_f32 v208, v208, s37, -v245
WL 3
Mvav 16,248,192
Ta 246,233,40960
v_fma_f32 v209, v209, s37, -v245
Mvav 24,248,200
Ta 248,234,32768
v_fma_f32 v210, v210, s37, -v245
Mvav 20,252,192
Ta 250,234,40960
v_fma_f32 v211, v211, s37, -v245
Mvav 28,252,200
Ta 252,235,32768
v_fma_f32 v212, v212, s37, -v245
WL 3
Mvav 32,240,192
Ta 254,235,40960
v_fma_f32 v213, v213, s37, -v245
Mvav 40,240,200
Ta 240,228,33024
v_max3_f32 v251, v208, v209, v210
Mvav 36,244,192
Ta 242,228,41216
v_fma_f32 v214, v214, s37, -v245
Mvav 44,244,200
Ta 244,229,33024
v_fma_f32 v215, v215, s37, -v245
WL 3
Mvav 48,248,192
Ta 246,229,41216
v_max3_f32 v252, v211, v212, v213
Mvav 56,248,200
Ta 248,230,33024
Mvav 52,252,192
Ta 250,230,41216
v_fma_f32 v216, v216, s37, -v246
v_fma_f32 v217, v217, s37, -v246
Mvav 60,252,200
Ta 252,231,33024
WL 3
Mvav 64,240,192
Ta 254,231,41216
v_max3_f32 v251, v251, v214, v215
v_fma_f32 v218, v218, s37, -v246
Mvav 72,240,200
Ta 240,232,33024
Mvav 68,244,192
Ta 242,232,41216
v_fma_f32 v219, v219, s37, -v246
v_max3_f32 v252, v252, v216, v217
Mvav 76,244,200
Ta 244,233,33024
WL 3
Mvav 80,248,192
Ta 246,233,41216
v_fma_f32 v220, v220, s37, -v246
v_fma_f32 v221, v221, s37, -v246
Mvav 88,248,200
Ta 248,234,33024
Mvav 84,252,192
Ta 250,234,41216
v_max3_f32 v251, v251, v218, v219
Mvav 92,252,200
Ta 252,235,33024
v_fma_f32 v222, v222, s37, -v246
WL 3
Mvav 96,240,192
Ta 254,235,41216
v_fma_f32 v223, v223, s37, -v246
Mvav 104,240,200
Ta 240,236,16384
v_max3_f32 v252, v252, v220, v221
Mvav 100,244,192
Ta 242,236,18432
v_max3_f32 v251, v251, v222, v223
Mvav 108,244,200
Ta 244,237,16384
v_max_f32 v251, v251, v252
WL 3
Mvav 112,248,192
Ta 246,237,18432
v_cmp_lt_f32 vcc, s38, v251
Mvav 120,248,200
Ta 248,238,16384
s_cbranch_vccnz LA_ra55
LA_rb55:
Mvav 116,252,192
Ta 250,238,18432
Mvav 124,252,200
Ta 252,239,16384
s_cmp_lg_u32 s49, 0
s_cbranch_scc1 LA_ra56
LA_rb56:
WL 3
v_mfma_f32_16x16x32_bf16 a[64:67], a[240:243], a[128:131], 0
Ta 254,239,18432
v_mfma_f32_16x16x32_bf16 a[72:75], a[240:243], a[132:135], 0
Ta 240,236,20480
v_exp_f32 v208, v208
v_mfma_f32_16x16x32_bf16 a[68:71], a[244:247], a[128:131], 0
Ta 242,236,22528
v_mfma_f32_16x16x32_bf16 a[76:79], a[244:247], a[132:135], 0
Ta 244,237,20480
WL 3
v_mfma_f32_16x16x32_bf16 a[80:83], a[248:251], a[128:131], 0
Ta 246,237,22528
v_exp_f32 v216, v216
v_mfma_f32_16x16x32_bf16 a[88:91], a[248:251], a[132:135], 0
Ta 248,238,20480
v_mfma_f32_16x16x32_bf16 a[84:87], a[252:255], a[128:131], 0
Ta 250,238,22528
v_add_f32 v247, v247, v208
v_mfma_f32_16x16x32_bf16 a[92:95], a[252:255], a[132:135], 0
Ta 252,239,20480
WL 3
Maaa 64,240,136
Ta 254,239,22528
Maaa 72,240,140
Ta 240,236,24576
v_exp_f32 v209, v209
Maaa 68,244,136
Ta 242,236,26624
Maaa 76,244,140
Ta 244,237,24576
v_add_f32 v248, v248, v216
WL 3
Maaa 80,248,136
Ta 246,237,26624
Maaa 88,248,140
Ta 248,238,24576
Maaa 84,252,136
Ta 250,238,26624
v_exp_f32 v217, v217
Maaa 92,252,140
Ta 252,239,24576
WL 3
Maaa 64,240,144
Ta 254,239,26624
v_add_f32 v247, v247, v209
Maaa 72,240,148
Ta 240,236,28672
Maaa 68,244,144
Ta 242,236,30720
CV 208,208,209
Maaa 76,244,148
Ta 244,237,28672
WL 3
Maaa 80,248,144
Ta 246,237,30720
v_exp_f32 v210, v210
Maaa 88,248,148
Ta 248,238,28672
Maaa 84,252,144
Ta 250,238,30720
v_add_f32 v248, v248, v217
Maaa 92,252,148
Ta 252,239,28672
WL 3
Maaa 64,240,152
Ta 254,239,30720
CV 216,216,217
Maaa 72,240,156
v_exp_f32 v218, v218
Maaa 68,244,152
v_add_f32 v247, v247, v210
Maaa 76,244,156
WL 0
s_barrier
Ba 240,224,32768
Ba 244,224,40960
Maaa 80,248,152
v_exp_f32 v211, v211
Maaa 88,248,156
Ba 248,225,32768
v_add_f32 v248, v248, v218
Maaa 84,252,152
v_exp_f32 v219, v219
Maaa 92,252,156
Ba 252,225,40960
WL 2
v_mfma_f32_16x16x32_bf16 v[192:195], a[240:243], v[128:131], 0
v_add_f32 v247, v247, v211
CV 209,210,211
v_mfma_f32_16x16x32_bf16 v[200:203], a[240:243], v[132:135], 0
Ba 240,226,32768
v_mfma_f32_16x16x32_bf16 v[196:199], a[244:247], v[128:131], 0
v_exp_f32 v212, v212
v_mfma_f32_16x16x32_bf16 v[204:207], a[244:247], v[132:135], 0
Ba 244,226,40960
WL 2
Mvav 192,248,136
v_add_f32 v248, v248, v219
CV 217,218,219
Mvav 200,248,140
Ba 248,227,32768
Mvav 196,252,136
v_exp_f32 v220, v220
v_add_f32 v247, v247, v212
Mvav 204,252,140
Ba 252,227,40960
WL 2
Mvav 192,240,144
v_exp_f32 v213, v213
Mvav 200,240,148
Ba 240,224,33024
Mvav 196,244,144
v_add_f32 v248, v248, v220
v_exp_f32 v221, v221
Mvav 204,244,148
Ba 244,224,41216
WL 2
Mvav 192,248,152
v_add_f32 v247, v247, v213
Mvav 200,248,156
Ba 248,225,33024
CV 210,212,213
Mvav 196,252,152
v_exp_f32 v214, v214
Mvav 204,252,156
Ba 252,225,41216
WL 2
Mvav 192,240,160
v_add_f32 v248, v248, v221
CV 218,220,221
Mvav 200,240,164
Ba 240,226,33024
Mvav 196,244,160
v_exp_f32 v222, v222
Mvav 204,244,164
Ba 244,226,41216
v_add_f32 v247, v247, v214
WL 2
Mvav 192,248,168
v_exp_f32 v215, v215
Mvav 200,248,172
Ba 248,227,33024
Mvav 196,252,168
v_add_f32 v248, v248, v222
Mvav 204,252,172
Ba 252,227,41216
v_exp_f32 v223, v223
WL 2
Mvav 192,240,176
v_add_f32 v247, v247, v215
Mvav 200,240,180
Ta 240,228,16384
Mvav 196,244,176
Ta 242,228,24576
CV 211,214,215
Mvav 204,244,180
Ta 244,229,16384
v_add_f32 v248, v248, v223
WL 3
Mvav 192,248,184
Ta 246,229,24576
CV 219,222,223
Mvav 200,248,188
Ta 248,230,16384
Mvav 196,252,184
Ta 250,230,24576
Mvav 204,252,188
Ta 252,231,16384
WL 3
Mvav 0,240,208
Ta 254,231,24576
Mvav 8,240,216
Ta 240,232,16384
Mvav 4,244,208
Ta 242,232,24576
Mvav 12,244,216
Ta 244,233,16384
v_fma_f32 v192, v192, s37, -v245
WL 3
Mvav 16,248,208
Ta 246,233,24576
v_fma_f32 v193, v193, s37, -v245
Mvav 24,248,216
Ta 248,234,16384
v_fma_f32 v194, v194, s37, -v245
Mvav 20,252,208
Ta 250,234,24576
v_fma_f32 v195, v195, s37, -v245
Mvav 28,252,216
Ta 252,235,16384
v_fma_f32 v196, v196, s37, -v245
WL 3
Mvav 32,240,208
Ta 254,235,24576
v_fma_f32 v197, v197, s37, -v245
Mvav 40,240,216
Ta 240,228,16640
v_max3_f32 v251, v192, v193, v194
Mvav 36,244,208
Ta 242,228,24832
v_fma_f32 v198, v198, s37, -v245
Mvav 44,244,216
Ta 244,229,16640
v_fma_f32 v199, v199, s37, -v245
WL 3
Mvav 48,248,208
Ta 246,229,24832
v_max3_f32 v252, v195, v196, v197
Mvav 56,248,216
Ta 248,230,16640
Mvav 52,252,208
Ta 250,230,24832
v_fma_f32 v200, v200, s37, -v246
v_fma_f32 v201, v201, s37, -v246
Mvav 60,252,216
Ta 252,231,16640
WL 3
Mvav 64,240,208
Ta 254,231,24832
v_max3_f32 v251, v251, v198, v199
v_fma_f32 v202, v202, s37, -v246
Mvav 72,240,216
Ta 240,232,16640
Mvav 68,244,208
Ta 242,232,24832
v_fma_f32 v203, v203, s37, -v246
v_max3_f32 v252, v252, v200, v201
Mvav 76,244,216
Ta 244,233,16640
WL 3
Mvav 80,248,208
Ta 246,233,24832
v_fma_f32 v204, v204, s37, -v246
v_fma_f32 v205, v205, s37, -v246
Mvav 88,248,216
Ta 248,234,16640
Mvav 84,252,208
Ta 250,234,24832
v_max3_f32 v251, v251, v202, v203
Mvav 92,252,216
Ta 252,235,16640
v_fma_f32 v206, v206, s37, -v246
WL 3
Mvav 96,240,208
Ta 254,235,24832
v_fma_f32 v207, v207, s37, -v246
Mvav 104,240,216
Ta 240,236,32768
v_max3_f32 v252, v252, v204, v205
Mvav 100,244,208
Ta 242,236,34816
v_max3_f32 v251, v251, v206, v207
Mvav 108,244,216
Ta 244,237,32768
v_max_f32 v251, v251, v252
WL 3
Mvav 112,248,208
Ta 246,237,34816
v_cmp_lt_f32 vcc, s38, v251
Mvav 120,248,216
Ta 248,238,32768
s_cbranch_vccnz LA_ra57
LA_rb57:
Mvav 116,252,208
Ta 250,238,34816
Mvav 124,252,216
Ta 252,239,32768
s_cmp_lg_u32 s49, 0
s_cbranch_scc1 LA_ra58
LA_rb58:
WL 3
Maaa 64,240,160
Ta 254,239,34816
Maaa 72,240,164
Ta 240,236,36864
v_exp_f32 v192, v192
Maaa 68,244,160
Ta 242,236,38912
Maaa 76,244,164
Ta 244,237,36864
WL 3
Maaa 80,248,160
Ta 246,237,38912
v_exp_f32 v200, v200
Maaa 88,248,164
Ta 248,238,36864
Maaa 84,252,160
Ta 250,238,38912
v_add_f32 v247, v247, v192
Maaa 92,252,164
Ta 252,239,36864
WL 3
Maaa 64,240,168
Ta 254,239,38912
v_exp_f32 v193, v193
Maaa 72,240,172
Ta 240,236,40960
Maaa 68,244,168
Ta 242,236,43008
Maaa 76,244,172
Ta 244,237,40960
v_add_f32 v248, v248, v200
WL 3
Maaa 80,248,168
Ta 246,237,43008
Maaa 88,248,172
Ta 248,238,40960
Maaa 84,252,168
Ta 250,238,43008
v_exp_f32 v201, v201
Maaa 92,252,172
Ta 252,239,40960
WL 3
Maaa 64,240,176
Ta 254,239,43008
v_add_f32 v247, v247, v193
Maaa 72,240,180
Ta 240,236,45056
CV 192,192,193
Maaa 68,244,176
Ta 242,236,47104
Maaa 76,244,180
Ta 244,237,45056
WL 3
Maaa 80,248,176
Ta 246,237,47104
v_exp_f32 v194, v194
Maaa 88,248,180
Ta 248,238,45056
Maaa 84,252,176
Ta 250,238,47104
v_add_f32 v248, v248, v201
Maaa 92,252,180
Ta 252,239,45056
WL 3
Maaa 64,240,184
Ta 254,239,47104
CV 200,200,201
Maaa 72,240,188
v_exp_f32 v202, v202
Maaa 68,244,184
v_add_f32 v247, v247, v194
Maaa 76,244,188
WL 0
s_barrier
Ba 240,224,0
Ba 244,224,8192
Maaa 80,248,184
v_exp_f32 v195, v195
Maaa 88,248,188
Ba 248,225,0
v_add_f32 v248, v248, v202
Maaa 84,252,184
v_exp_f32 v203, v203
Maaa 92,252,188
Ba 252,225,8192
WL 2
v_mfma_f32_16x16x32_bf16 v[208:211], a[240:243], v[128:131], 0
v_add_f32 v247, v247, v195
CV 193,194,195
v_mfma_f32_16x16x32_bf16 v[216:219], a[240:243], v[132:135], 0
Ba 240,226,0
v_mfma_f32_16x16x32_bf16 v[212:215], a[244:247], v[128:131], 0
v_exp_f32 v196, v196
v_mfma_f32_16x16x32_bf16 v[220:223], a[244:247], v[132:135], 0
Ba 244,226,8192
v_add_f32 v248, v248, v203
WL 2
Mvav 208,248,136
CV 201,202,203
Mvav 216,248,140
Ba 248,227,0
s_lshl_b32 s7, s58, 30
v_mov_b32 v253, s7
s_lshr_b32 s5, s2, 3
s_lshl_b32 s5, s5, 2
buffer_load_dword v254, v253, s[52:55], s5 offen offset:128 sc1
Mvav 212,252,136
v_exp_f32 v204, v204
Mvav 220,252,140
Ba 252,227,8192
v_add_f32 v247, v247, v196
WL 2
Mvav 208,240,144
v_exp_f32 v197, v197
Mvav 216,240,148
Ba 240,224,256
Mvav 212,244,144
v_add_f32 v248, v248, v204
v_exp_f32 v205, v205
Mvav 220,244,148
Ba 244,224,8448
WL 2
Mvav 208,248,152
v_add_f32 v247, v247, v197
Mvav 216,248,156
Ba 248,225,256
CV 194,196,197
Mvav 212,252,152
v_exp_f32 v198, v198
Mvav 220,252,156
Ba 252,225,8448
WL 2
Mvav 208,240,160
v_add_f32 v248, v248, v205
CV 202,204,205
Mvav 216,240,164
Ba 240,226,256
Mvav 212,244,160
v_exp_f32 v206, v206
Mvav 220,244,164
Ba 244,226,8448
v_add_f32 v247, v247, v198
WL 2
Mvav 208,248,168
v_exp_f32 v199, v199
Mvav 216,248,172
Ba 248,227,256
Mvav 212,252,168
v_add_f32 v248, v248, v206
Mvav 220,252,172
Ba 252,227,8448
v_exp_f32 v207, v207
WL 2
Mvav 208,240,176
v_add_f32 v247, v247, v199
Mvav 216,240,180
Ta 240,228,0
Mvav 212,244,176
Ta 242,228,8192
CV 195,198,199
Mvav 220,244,180
Ta 244,229,0
v_add_f32 v248, v248, v207
WL 3
Mvav 208,248,184
Ta 246,229,8192
CV 203,206,207
Mvav 216,248,188
Ta 248,230,0
Mvav 212,252,184
Ta 250,230,8192
Mvav 220,252,188
Ta 252,231,0
WL 3
Mvav 0,240,192
Ta 254,231,8192
Mvav 8,240,200
Ta 240,232,0
Mvav 4,244,192
Ta 242,232,8192
Mvav 12,244,200
Ta 244,233,0
v_fma_f32 v208, v208, s37, -v245
v_fma_f32 v209, v209, s37, -v245
WL 3
Mvav 16,248,192
Ta 246,233,8192
v_fma_f32 v210, v210, s37, -v245
v_fma_f32 v211, v211, s37, -v245
v_fma_f32 v212, v212, s37, -v245
Mvav 24,248,200
Ta 248,234,0
v_fma_f32 v213, v213, s37, -v245
v_max3_f32 v251, v208, v209, v210
Mvav 20,252,192
Ta 250,234,8192
v_fma_f32 v214, v214, s37, -v245
v_fma_f32 v215, v215, s37, -v245
v_max3_f32 v252, v211, v212, v213
Mvav 28,252,200
Ta 252,235,0
v_fma_f32 v216, v216, s37, -v246
v_fma_f32 v217, v217, s37, -v246
WL 3
Mvav 32,240,192
Ta 254,235,8192
v_max3_f32 v251, v251, v214, v215
v_fma_f32 v218, v218, s37, -v246
Mvav 40,240,200
Ta 240,228,256
v_fma_f32 v219, v219, s37, -v246
v_max3_f32 v252, v252, v216, v217
Mvav 36,244,192
Ta 242,228,8448
v_fma_f32 v220, v220, s37, -v246
v_fma_f32 v221, v221, s37, -v246
v_max3_f32 v251, v251, v218, v219
Mvav 44,244,200
Ta 244,229,256
v_fma_f32 v222, v222, s37, -v246
v_fma_f32 v223, v223, s37, -v246
WL 3
Mvav 48,248,192
Ta 246,229,8448
v_max3_f32 v252, v252, v220, v221
v_max3_f32 v251, v251, v222, v223
v_max_f32 v251, v251, v252
Mvav 56,248,200
Ta 248,230,256
v_cmp_lt_f32 vcc, s38, v251
s_cbranch_vccnz LA_ra59
LA_rb59:
Mvav 52,252,192
Ta 250,230,8448
Mvav 60,252,200
Ta 252,231,256
v_exp_f32 v208, v208
WL 3
Mvav 64,240,192
Ta 254,231,8448
v_exp_f32 v216, v216
v_add_f32 v247, v247, v208
Mvav 72,240,200
Ta 240,232,256
v_exp_f32 v209, v209
v_add_f32 v248, v248, v216
Mvav 68,244,192
Ta 242,232,8448
v_exp_f32 v217, v217
v_add_f32 v247, v247, v209
Mvav 76,244,200
Ta 244,233,256
v_exp_f32 v210, v210
v_add_f32 v248, v248, v217
WL 3
Mvav 80,248,192
Ta 246,233,8448
v_exp_f32 v218, v218
v_add_f32 v247, v247, v210
Mvav 88,248,200
Ta 248,234,256
v_exp_f32 v211, v211
v_add_f32 v248, v248, v218
Mvav 84,252,192
Ta 250,234,8448
v_exp_f32 v219, v219
v_add_f32 v247, v247, v211
Mvav 92,252,200
Ta 252,235,256
v_exp_f32 v212, v212
v_add_f32 v248, v248, v219
WL 3
Mvav 96,240,192
Ta 254,235,8448
v_exp_f32 v220, v220
v_add_f32 v247, v247, v212
Mvav 104,240,200
v_exp_f32 v213, v213
v_add_f32 v248, v248, v220
Mvav 100,244,192
v_exp_f32 v221, v221
v_add_f32 v247, v247, v213
v_exp_f32 v214, v214
Mvav 108,244,200
v_add_f32 v248, v248, v221
v_exp_f32 v222, v222
WL 2
Mvav 112,248,192
v_add_f32 v247, v247, v214
v_exp_f32 v215, v215
v_add_f32 v248, v248, v222
Mvav 120,248,200
v_exp_f32 v223, v223
v_add_f32 v247, v247, v215
v_add_f32 v248, v248, v223
WL 0
Mvav 116,252,192
Mvav 124,252,200
s_cmp_lg_u32 s49, 0
s_cbranch_scc1 LA_ra60
LA_rb60:
v_mov_b32 v251, v247
s_nop 1
v_permlane32_swap_b32 v247, v251
v_add_f32 v247, v247, v251
v_mov_b32 v251, v247
s_nop 1
v_permlane16_swap_b32 v247, v251
v_add_f32 v247, v247, v251
v_rcp_f32 v249, v247
v_mov_b32 v251, v248
s_nop 1
v_permlane32_swap_b32 v248, v251
v_add_f32 v248, v248, v251
v_mov_b32 v251, v248
s_nop 1
v_permlane16_swap_b32 v248, v251
v_add_f32 v248, v248, v251
v_rcp_f32 v250, v248
v_mul_f32 v208, v208, v249
v_mul_f32 v209, v209, v249
v_mul_f32 v210, v210, v249
v_mul_f32 v211, v211, v249
v_mul_f32 v212, v212, v249
v_mul_f32 v213, v213, v249
v_mul_f32 v214, v214, v249
v_mul_f32 v215, v215, v249
v_mul_f32 v216, v216, v250
v_mul_f32 v217, v217, v250
v_mul_f32 v218, v218, v250
v_mul_f32 v219, v219, v250
v_mul_f32 v220, v220, v250
v_mul_f32 v221, v221, v250
v_mul_f32 v222, v222, v250
v_mul_f32 v223, v223, v250
CV 208,208,209
CV 216,216,217
CV 209,210,211
CV 217,218,219
CV 210,212,213
CV 218,220,221
CV 211,214,215
CV 219,222,223
v_pk_mul_f32 v[0:1], v[0:1], v[248:249] op_sel:[0,1] op_sel_hi:[1,1]
v_pk_mul_f32 v[2:3], v[2:3], v[248:249] op_sel:[0,1] op_sel_hi:[1,1]
v_pk_mul_f32 v[4:5], v[4:5], v[248:249] op_sel:[0,1] op_sel_hi:[1,1]
v_pk_mul_f32 v[6:7], v[6:7], v[248:249] op_sel:[0,1] op_sel_hi:[1,1]
v_pk_mul_f32 v[8:9], v[8:9], v[250:251] op_sel_hi:[1,0]
v_pk_mul_f32 v[10:11], v[10:11], v[250:251] op_sel_hi:[1,0]
v_pk_mul_f32 v[12:13], v[12:13], v[250:251] op_sel_hi:[1,0]
v_pk_mul_f32 v[14:15], v[14:15], v[250:251] op_sel_hi:[1,0]
v_pk_mul_f32 v[16:17], v[16:17], v[248:249] op_sel:[0,1] op_sel_hi:[1,1]
v_pk_mul_f32 v[18:19], v[18:19], v[248:249] op_sel:[0,1] op_sel_hi:[1,1]
v_pk_mul_f32 v[20:21], v[20:21], v[248:249] op_sel:[0,1] op_sel_hi:[1,1]
v_pk_mul_f32 v[22:23], v[22:23], v[248:249] op_sel:[0,1] op_sel_hi:[1,1]
v_pk_mul_f32 v[24:25], v[24:25], v[250:251] op_sel_hi:[1,0]
v_pk_mul_f32 v[26:27], v[26:27], v[250:251] op_sel_hi:[1,0]
v_pk_mul_f32 v[28:29], v[28:29], v[250:251] op_sel_hi:[1,0]
v_pk_mul_f32 v[30:31], v[30:31], v[250:251] op_sel_hi:[1,0]
v_pk_mul_f32 v[32:33], v[32:33], v[248:249] op_sel:[0,1] op_sel_hi:[1,1]
v_pk_mul_f32 v[34:35], v[34:35], v[248:249] op_sel:[0,1] op_sel_hi:[1,1]
v_pk_mul_f32 v[36:37], v[36:37], v[248:249] op_sel:[0,1] op_sel_hi:[1,1]
v_pk_mul_f32 v[38:39], v[38:39], v[248:249] op_sel:[0,1] op_sel_hi:[1,1]
v_pk_mul_f32 v[40:41], v[40:41], v[250:251] op_sel_hi:[1,0]
v_pk_mul_f32 v[42:43], v[42:43], v[250:251] op_sel_hi:[1,0]
v_pk_mul_f32 v[44:45], v[44:45], v[250:251] op_sel_hi:[1,0]
v_pk_mul_f32 v[46:47], v[46:47], v[250:251] op_sel_hi:[1,0]
v_pk_mul_f32 v[48:49], v[48:49], v[248:249] op_sel:[0,1] op_sel_hi:[1,1]
v_pk_mul_f32 v[50:51], v[50:51], v[248:249] op_sel:[0,1] op_sel_hi:[1,1]
v_pk_mul_f32 v[52:53], v[52:53], v[248:249] op_sel:[0,1] op_sel_hi:[1,1]
v_pk_mul_f32 v[54:55], v[54:55], v[248:249] op_sel:[0,1] op_sel_hi:[1,1]
v_pk_mul_f32 v[56:57], v[56:57], v[250:251] op_sel_hi:[1,0]
v_pk_mul_f32 v[58:59], v[58:59], v[250:251] op_sel_hi:[1,0]
v_pk_mul_f32 v[60:61], v[60:61], v[250:251] op_sel_hi:[1,0]
v_pk_mul_f32 v[62:63], v[62:63], v[250:251] op_sel_hi:[1,0]
v_pk_mul_f32 v[64:65], v[64:65], v[248:249] op_sel:[0,1] op_sel_hi:[1,1]
v_pk_mul_f32 v[66:67], v[66:67], v[248:249] op_sel:[0,1] op_sel_hi:[1,1]
v_pk_mul_f32 v[68:69], v[68:69], v[248:249] op_sel:[0,1] op_sel_hi:[1,1]
v_pk_mul_f32 v[70:71], v[70:71], v[248:249] op_sel:[0,1] op_sel_hi:[1,1]
v_pk_mul_f32 v[72:73], v[72:73], v[250:251] op_sel_hi:[1,0]
v_pk_mul_f32 v[74:75], v[74:75], v[250:251] op_sel_hi:[1,0]
v_pk_mul_f32 v[76:77], v[76:77], v[250:251] op_sel_hi:[1,0]
v_pk_mul_f32 v[78:79], v[78:79], v[250:251] op_sel_hi:[1,0]
v_pk_mul_f32 v[80:81], v[80:81], v[248:249] op_sel:[0,1] op_sel_hi:[1,1]
v_pk_mul_f32 v[82:83], v[82:83], v[248:249] op_sel:[0,1] op_sel_hi:[1,1]
v_pk_mul_f32 v[84:85], v[84:85], v[248:249] op_sel:[0,1] op_sel_hi:[1,1]
v_pk_mul_f32 v[86:87], v[86:87], v[248:249] op_sel:[0,1] op_sel_hi:[1,1]
v_pk_mul_f32 v[88:89], v[88:89], v[250:251] op_sel_hi:[1,0]
v_pk_mul_f32 v[90:91], v[90:91], v[250:251] op_sel_hi:[1,0]
v_pk_mul_f32 v[92:93], v[92:93], v[250:251] op_sel_hi:[1,0]
v_pk_mul_f32 v[94:95], v[94:95], v[250:251] op_sel_hi:[1,0]
v_pk_mul_f32 v[96:97], v[96:97], v[248:249] op_sel:[0,1] op_sel_hi:[1,1]
v_pk_mul_f32 v[98:99], v[98:99], v[248:249] op_sel:[0,1] op_sel_hi:[1,1]
v_pk_mul_f32 v[100:101], v[100:101], v[248:249] op_sel:[0,1] op_sel_hi:[1,1]
v_pk_mul_f32 v[102:103], v[102:103], v[248:249] op_sel:[0,1] op_sel_hi:[1,1]
v_pk_mul_f32 v[104:105], v[104:105], v[250:251] op_sel_hi:[1,0]
v_pk_mul_f32 v[106:107], v[106:107], v[250:251] op_sel_hi:[1,0]
v_pk_mul_f32 v[108:109], v[108:109], v[250:251] op_sel_hi:[1,0]
v_pk_mul_f32 v[110:111], v[110:111], v[250:251] op_sel_hi:[1,0]
v_pk_mul_f32 v[112:113], v[112:113], v[248:249] op_sel:[0,1] op_sel_hi:[1,1]
v_pk_mul_f32 v[114:115], v[114:115], v[248:249] op_sel:[0,1] op_sel_hi:[1,1]
v_pk_mul_f32 v[116:117], v[116:117], v[248:249] op_sel:[0,1] op_sel_hi:[1,1]
v_pk_mul_f32 v[118:119], v[118:119], v[248:249] op_sel:[0,1] op_sel_hi:[1,1]
v_pk_mul_f32 v[120:121], v[120:121], v[250:251] op_sel_hi:[1,0]
v_pk_mul_f32 v[122:123], v[122:123], v[250:251] op_sel_hi:[1,0]
v_pk_mul_f32 v[124:125], v[124:125], v[250:251] op_sel_hi:[1,0]
v_pk_mul_f32 v[126:127], v[126:127], v[250:251] op_sel_hi:[1,0]
WL 0
s_barrier
Ta 240,228,32768
Ta 242,228,40960
Ta 244,229,32768
WL 1
Mvav 0,240,208
Ta 246,229,40960
Ta 248,230,32768
Ta 250,230,40960
Ta 252,231,32768
Ta 254,231,40960
Mvav 8,240,216
Ta 240,232,32768
WL 3
Mvav 4,244,208
Ta 242,232,40960
Mvav 12,244,216
Ta 244,233,32768
Mvav 16,248,208
Ta 246,233,40960
Mvav 24,248,216
Ta 248,234,32768
WL 3
Mvav 20,252,208
Ta 250,234,40960
Mvav 28,252,216
Ta 252,235,32768
Mvav 32,240,208
Ta 254,235,40960
Mvav 40,240,216
Ta 240,228,33024
CV 128,0,1
WL 3
Mvav 36,244,208
Ta 242,228,41216
CV 129,2,3
CV 130,4,5
Mvav 44,244,216
Ta 244,229,33024
CV 131,6,7
CV 132,8,9
Mvav 48,248,208
Ta 246,229,41216
CV 133,10,11
CV 134,12,13
Mvav 56,248,216
Ta 248,230,33024
CV 135,14,15
WL 3
Mvav 52,252,208
Ta 250,230,41216
Mvav 60,252,216
Ta 252,231,33024
CV 136,16,17
Mvav 64,240,208
Ta 254,231,41216
CV 137,18,19
CV 138,20,21
Mvav 72,240,216
Ta 240,232,33024
CV 139,22,23
CV 140,24,25
WL 3
Mvav 68,244,208
Ta 242,232,41216
CV 141,26,27
CV 142,28,29
Mvav 76,244,216
Ta 244,233,33024
CV 143,30,31
Mvav 80,248,208
Ta 246,233,41216
Mvav 88,248,216
Ta 248,234,33024
CV 144,32,33
WL 3
Mvav 84,252,208
Ta 250,234,41216
CV 145,34,35
CV 146,36,37
Mvav 92,252,216
Ta 252,235,33024
CV 147,38,39
Mvav 96,240,208
Ta 254,235,41216
CV 148,40,41
CV 149,42,43
Mvav 104,240,216
CV 150,44,45
CV 151,46,47
WL 2
Mvav 100,244,208
Mvav 108,244,216
WL 0
s_barrier
Ta 240,236,49152
Mvav 112,248,208
Ta 242,236,51200
Ta 244,237,49152
Ta 246,237,51200
CV 152,48,49
Mvav 120,248,216
Ta 248,238,49152
CV 153,50,51
CV 154,52,53
Mvav 116,252,208
Ta 250,238,51200
CV 155,54,55
CV 156,56,57
CV 157,58,59
Mvav 124,252,216
Ta 252,239,49152
CV 158,60,61
CV 159,62,63
WL 3
Maav 64,240,128
Ta 254,239,51200
Maav 72,240,132
Ta 240,236,53248
CV 160,64,65
Maav 68,244,128
Ta 242,236,55296
CV 161,66,67
CV 162,68,69
Maav 76,244,132
Ta 244,237,53248
CV 163,70,71
CV 164,72,73
WL 3
Maav 80,248,128
Ta 246,237,55296
CV 165,74,75
CV 166,76,77
Maav 88,248,132
Ta 248,238,53248
CV 167,78,79
Maav 84,252,128
Ta 250,238,55296
Maav 92,252,132
Ta 252,239,53248
CV 168,80,81
CV 169,82,83
WL 3
Maav 64,240,136
Ta 254,239,55296
Tv 220,236,57344
Tv 222,236,59392
Maav 72,240,140
Tv 212,237,57344
CV 170,84,85
CV 171,86,87
Maav 68,244,136
Tv 214,237,59392
CV 172,88,89
CV 173,90,91
Maav 76,244,140
Tv 216,238,57344
CV 174,92,93
CV 175,94,95
WL 5
Maav 80,248,136
Tv 218,238,59392
Maav 88,248,140
Ta 240,239,57344
CV 176,96,97
Maav 84,252,136
Ta 242,239,59392
CV 177,98,99
CV 178,100,101
Maav 92,252,140
Ta 244,236,61440
CV 179,102,103
CV 180,104,105
WL 5
Mavv 64,220,144
Ta 246,236,63488
CV 181,106,107
CV 182,108,109
Mavv 72,220,148
Ta 248,237,61440
CV 183,110,111
Mavv 68,212,144
Ta 250,237,63488
Mavv 76,212,148
Ta 252,238,61440
s_waitcnt vmcnt(0)
v_readfirstlane_b32 s7, v254
s_nop 0
s_lshl_b32 s5, s58, 3
s_or_b32 s7, s7, s5
s_cmp_lt_u32 s7, 8
s_cbranch_scc1 LA_hs
LA_hsb:
WL 5
Mavv 80,216,144
Ta 254,238,63488
CV 184,112,113
CV 185,114,115
Mavv 88,216,148
Tv 220,239,61440
CV 186,116,117
CV 187,118,119
Maav 84,240,144
Tv 222,239,63488
CV 188,120,121
CV 189,122,123
Maav 92,240,148
Tv 212,236,16384
CV 190,124,125
CV 191,126,127
WL 5
Maav 64,244,152
Tv 214,236,18432
Maav 72,244,156
Tv 216,237,16384
v_mbcnt_lo_u32_b32 v253, -1, 0
Maav 68,248,152
Tv 218,237,18432
v_mbcnt_hi_u32_b32 v253, -1, v253
v_lshrrev_b32 v254, 3, v253
Maav 76,248,156
Ta 240,238,16384
v_min_u32 v254, 1, v254
WL 5
Maav 80,252,152
Ta 242,238,18432
v_lshlrev_b32 v254, 31, v254
Maav 88,252,156
Ta 244,239,16384
v_lshl_add_u32 v224, v253, 2, v254
v_and_b32 v254, 15, v253
Mavv 84,220,152
Ta 246,239,18432
s_lshl_b32 s4, s58, 5
Mavv 92,220,156
Ta 248,236,20480
v_add_u32 v254, s4, v254
WL 5
Mavv 64,212,160
Ta 250,236,22528
v_mul_u32_u24 v254, 1792, v254
v_and_b32 v226, 48, v253
Mavv 72,212,164
Ta 252,237,20480
v_add_u32 v226, v226, v254
Mavv 68,216,160
Ta 254,237,22528
v_and_b32 v254, 1, v253
v_lshlrev_b32 v254, 4, v254
Mavv 76,216,164
Tv 220,238,20480
v_mov_b32 v228, 0x3f80
WL 5
Maav 80,240,160
Tv 222,238,22528
v_lshlrev_b32 v228, v254, v228
AR 1,192
Maav 88,240,164
Tv 212,239,20480
v_lshrrev_b32 v254, 3, v253
Maav 84,244,160
Tv 214,239,22528
v_and_b32 v254, 6, v254
v_bfe_u32 v253, v253, 1, 3
Maav 92,244,164
Tv 216,236,24576
v_lshlrev_b32 v0, 16, v1
WL 5
Maav 64,248,168
Tv 218,236,26624
v_cmp_eq_u32 vcc, v253, v254
v_or_b32 v254, 1, v254
v_mov_b32 v229, 0
v_cndmask_b32 v230, 0, v228, vcc
Maav 72,248,172
Ta 240,237,24576
v_and_b32 v1, 0xffff0000, v1
Maav 68,252,168
Ta 242,237,26624
AR 3,193
v_lshlrev_b32 v2, 16, v3
Maav 76,252,172
Ta 244,238,24576
v_cmp_eq_u32 vcc, v253, v254
v_mov_b32 v232, 0
v_mov_b32 v233, 0
v_cndmask_b32 v231, 0, v228, vcc
WL 5
Mavv 80,220,168
Ta 246,238,26624
v_and_b32 v3, 0xffff0000, v3
Mavv 88,220,172
Ta 248,239,24576
v_mov_b32 v228, 0
Mavv 84,212,168
Ta 250,239,26624
s_lshl_b32 s16, s50, 7
s_add_u32 s16, s16, s62
Mavv 92,212,172
Ta 252,236,28672
s_mov_b32 s8, s80
AR 5,194
WL 5
Mavv 64,216,176
Ta 254,236,30720
s_mov_b32 s9, s81
Mavv 72,216,180
Tv 220,237,28672
s_mov_b32 s10, 3211264
s_mov_b32 s11, 0x20000
Maav 68,240,176
Tv 222,237,30720
s_bfe_u32 s6, s2, 0x40003
v_lshlrev_b32 v4, 16, v5
Maav 76,240,180
Tv 212,238,28672
s_mul_i32 s12, s6, 200704
WL 5
Maav 80,244,176
Tv 214,238,30720
s_lshr_b32 s4, s2, 7
s_mul_i32 s4, s4, 896
Maav 88,244,180
Tv 216,239,28672
s_add_u32 s12, s12, s4
Maav 84,248,176
Tv 218,239,30720
s_lshl_b32 s4, s50, 7
s_add_u32 s12, s12, s4
Maav 92,248,180
s_add_u32 s13, s12, 28672
s_and_b32 s19, s2, 0xf8
WL 4
Maav 64,252,184
s_mul_i32 s19, s19, 100352
s_mul_i32 s4, s50, 14336
v_and_b32 v5, 0xffff0000, v5
Maav 72,252,188
s_add_u32 s19, s19, s4
s_mov_b32 s14, 0x40000
Mavv 68,220,184
s_and_b32 s17, s2, 7
s_cmp_eq_u32 s17, 7
s_cselect_b32 s15, -1, 0
s_cselect_b32 s19, 0x7f000000, s19
Mavv 76,220,188
WL 0
s_barrier
Ta 240,236,32768
Mavv 80,212,184
Ta 242,236,34816
Ta 244,237,32768
Ta 246,237,34816
Ta 248,238,32768
Ta 250,238,34816
Mavv 88,212,188
Ta 252,239,32768
AR 7,195
Mavv 84,216,184
Ta 254,239,34816
v_lshlrev_b32 v6, 16, v7
Mavv 92,216,188
Tv 220,236,36864
v_and_b32 v7, 0xffff0000, v7
AR 9,196
WL 5
Maav 32,240,128
Tv 222,236,38912
v_lshlrev_b32 v8, 16, v9
Maav 40,240,132
Tv 212,237,36864
v_and_b32 v9, 0xffff0000, v9
Maav 36,244,128
Tv 214,237,38912
AR 11,197
v_lshlrev_b32 v10, 16, v11
Maav 44,244,132
Tv 216,238,36864
AR 96,64
WL 5
Maav 48,248,128
Tv 218,238,38912
AR 97,65
v_and_b32 v11, 0xffff0000, v11
Maav 56,248,132
Ta 240,239,36864
CV 96,96,97
Maav 52,252,128
Ta 242,239,38912
AR 98,66
AR 99,67
Maav 60,252,132
Ta 244,236,40960
CV 97,98,99
WL 5
Mavv 32,220,136
Ta 246,236,43008
AR 100,68
Mavv 40,220,140
Ta 248,237,40960
AR 101,69
Mavv 36,212,136
Ta 250,237,43008
CV 98,100,101
AR 13,198
Mavv 44,212,140
Ta 252,238,40960
AR 102,70
WL 5
Mavv 48,216,136
Ta 254,238,43008
AR 103,71
CV 99,102,103
Mavv 56,216,140
Tv 220,239,40960
v_lshlrev_b32 v12, 16, v13
Maav 52,240,136
Tv 222,239,43008
s_mul_i32 s61, s46, 112
s_add_u32 s61, s61, s39
buffer_store_dwordx4 v[96:99], v244, s[28:31], s61 offen offset:0 sc1
Maav 60,240,140
Tv 212,236,45056
v_and_b32 v13, 0xffff0000, v13
WL 5
Maav 32,244,144
Tv 214,236,47104
AR 104,72
AR 15,199
Maav 40,244,148
Tv 216,237,45056
AR 105,73
Maav 36,248,144
Tv 218,237,47104
CV 104,104,105
v_lshlrev_b32 v14, 16, v15
Maav 44,248,148
Ta 240,238,45056
AR 106,74
WL 5
Maav 48,252,144
Ta 242,238,47104
AR 107,75
CV 105,106,107
Maav 56,252,148
Ta 244,239,45056
AR 108,76
Mavv 52,220,144
Ta 246,239,47104
AR 109,77
Mavv 60,220,148
v_add_u32 v236, 0xffff8000, v236
v_add_u32 v237, 0xffff8000, v237
v_add_u32 v238, 0xffff8000, v238
v_add_u32 v239, 0xffff8000, v239
Ta 248,236,16384
CV 106,108,109
WL 5
Mavv 32,212,152
Ta 250,236,18432
AR 110,78
v_and_b32 v15, 0xffff0000, v15
Mavv 40,212,156
Ta 252,237,16384
AR 111,79
Mavv 36,216,152
Ta 254,237,18432
CV 107,110,111
buffer_store_dwordx4 v[104:107], v244, s[28:31], s61 offen offset:2048 sc1
Mavv 44,216,156
Tv 220,238,16384
AR 112,80
WL 5
Maav 48,240,152
Tv 222,238,18432
AR 113,81
AR 17,200
Maav 56,240,156
Tv 212,239,16384
CV 112,112,113
Maav 52,244,152
Tv 214,239,18432
AR 114,82
v_lshlrev_b32 v16, 16, v17
Maav 60,244,156
Tv 216,236,20480
AR 115,83
WL 5
Maav 32,248,160
Tv 218,236,22528
CV 113,114,115
AR 116,84
Maav 40,248,164
Ta 240,237,20480
AR 117,85
Maav 36,252,160
Ta 242,237,22528
CV 114,116,117
Maav 44,252,164
Ta 244,238,20480
AR 118,86
WL 5
Mavv 48,220,160
Ta 246,238,22528
AR 119,87
v_and_b32 v17, 0xffff0000, v17
Mavv 56,220,164
Ta 248,239,20480
CV 115,118,119
Mavv 52,212,160
Ta 250,239,22528
buffer_store_dwordx4 v[112:115], v244, s[28:31], s61 offen offset:1024 sc1
AR 120,88
Mavv 60,212,164
Ta 252,236,24576
AR 19,201
WL 5
Mavv 32,216,168
Ta 254,236,26624
AR 121,89
CV 120,120,121
Mavv 40,216,172
Tv 220,237,24576
AR 122,90
Maav 36,240,168
Tv 222,237,26624
AR 123,91
v_lshlrev_b32 v18, 16, v19
Maav 44,240,172
Tv 212,238,24576
CV 121,122,123
WL 5
Maav 48,244,168
Tv 214,238,26624
AR 124,92
v_and_b32 v19, 0xffff0000, v19
Maav 56,244,172
Tv 216,239,24576
AR 125,93
Maav 52,248,168
Tv 218,239,26624
CV 122,124,125
AR 126,94
Maav 60,248,172
Ta 240,236,28672
AR 127,95
WL 5
Maav 32,252,176
Ta 242,236,30720
CV 123,126,127
Maav 40,252,180
Ta 244,237,28672
buffer_store_dwordx4 v[120:123], v244, s[28:31], s61 offen offset:3072 sc1
AR 21,202
Mavv 36,220,176
Ta 246,237,30720
v_lshlrev_b32 v20, 16, v21
Mavv 44,220,180
Ta 248,238,28672
v_and_b32 v21, 0xffff0000, v21
WL 5
Mavv 48,212,176
Ta 250,238,30720
AR 23,203
v_lshlrev_b32 v22, 16, v23
Mavv 56,212,180
Ta 252,239,28672
v_and_b32 v23, 0xffff0000, v23
Mavv 52,216,176
Ta 254,239,30720
AR 25,204
v_lshlrev_b32 v24, 16, v25
Mavv 60,216,180
v_and_b32 v25, 0xffff0000, v25
AR 27,205
WL 4
Maav 32,240,184
v_lshlrev_b32 v26, 16, v27
v_and_b32 v27, 0xffff0000, v27
Maav 40,240,188
AR 29,206
v_lshlrev_b32 v28, 16, v29
Maav 36,244,184
v_and_b32 v29, 0xffff0000, v29
AR 31,207
v_lshlrev_b32 v30, 16, v31
Maav 44,244,188
WL 0
s_barrier
Tv 220,236,0
Maav 48,248,184
Tv 222,236,2048
Tv 212,237,0
Tv 214,237,2048
Tv 216,238,0
Tv 218,238,2048
Maav 56,248,188
Ta 240,239,0
v_and_b32 v31, 0xffff0000, v31
Maav 52,252,184
Ta 242,239,2048
Maav 60,252,188
Ta 244,236,4096
WL 5
Mvvv 0,220,128
Ta 246,236,6144
Mvvv 8,220,132
Ta 248,237,4096
Mvvv 4,212,128
Ta 250,237,6144
Mvvv 12,212,132
Ta 252,238,4096
AR 64,32
WL 5
Mvvv 16,216,128
Ta 254,238,6144
AR 65,33
Mvvv 24,216,132
Tv 220,239,4096
CV 64,64,65
Mvav 20,240,128
Tv 222,239,6144
AR 66,34
AR 67,35
Mvav 28,240,132
Tv 212,236,8192
CV 65,66,67
WL 5
Mvav 0,244,136
Tv 214,236,10240
AR 68,36
Mvav 8,244,140
Tv 216,237,8192
AR 69,37
Mvav 4,248,136
Tv 218,237,10240
CV 66,68,69
Mvav 12,248,140
Ta 240,238,8192
AR 70,38
WL 5
Mvav 16,252,136
Ta 242,238,10240
AR 71,39
CV 67,70,71
Mvav 24,252,140
Ta 244,239,8192
Mvvv 20,220,136
Ta 246,239,10240
s_mul_i32 s61, s45, 112
s_add_u32 s61, s61, s39
buffer_store_dwordx4 v[64:67], v244, s[28:31], s61 offen offset:0 sc1
Mvvv 28,220,140
Ta 248,236,12288
WL 5
Mvvv 0,212,144
Ta 250,236,14336
AR 72,40
Mvvv 8,212,148
Ta 252,237,12288
AR 73,41
Mvvv 4,216,144
Ta 254,237,14336
CV 72,72,73
Mvvv 12,216,148
Tv 220,238,12288
AR 74,42
WL 5
Mvav 16,240,144
Tv 222,238,14336
AR 75,43
CV 73,74,75
Mvav 24,240,148
Tv 212,239,12288
AR 76,44
Mvav 20,244,144
Tv 214,239,14336
AR 77,45
Mvav 28,244,148
v_add_u32 v236, 0xffff0000, v236
v_add_u32 v237, 0xffff0000, v237
v_add_u32 v238, 0xffff0000, v238
v_add_u32 v239, 0xffff0000, v239
Tv 216,236,49152
CV 74,76,77
WL 5
Mvav 0,248,152
Tv 218,236,51200
AR 78,46
Mvav 8,248,156
Ta 240,237,49152
AR 79,47
Mvav 4,252,152
Ta 242,237,51200
CV 75,78,79
buffer_store_dwordx4 v[72:75], v244, s[28:31], s61 offen offset:2048 sc1
Mvav 12,252,156
Ta 244,238,49152
AR 80,48
WL 5
Mvvv 16,220,152
Ta 246,238,51200
AR 81,49
Mvvv 24,220,156
Ta 248,239,49152
CV 80,80,81
Mvvv 20,212,152
Ta 250,239,51200
AR 82,50
Mvvv 28,212,156
Ta 252,236,53248
AR 83,51
WL 5
Mvvv 0,216,160
Ta 254,236,55296
CV 81,82,83
AR 84,52
Mvvv 8,216,164
Tv 220,237,53248
AR 85,53
Mvav 4,240,160
Tv 222,237,55296
CV 82,84,85
Mvav 12,240,164
Tv 212,238,53248
AR 86,54
WL 5
Mvav 16,244,160
Tv 214,238,55296
AR 87,55
Mvav 24,244,164
Tv 216,239,53248
CV 83,86,87
Mvav 20,248,160
Tv 218,239,55296
buffer_store_dwordx4 v[80:83], v244, s[28:31], s61 offen offset:1024 sc1
AR 88,56
Mvav 28,248,164
Ta 240,236,57344
AR 33,208
WL 5
Mvav 0,252,168
Ta 242,236,59392
AR 89,57
CV 88,88,89
Mvav 8,252,172
Ta 244,237,57344
AR 90,58
Mvvv 4,220,168
Ta 246,237,59392
AR 91,59
Mvvv 12,220,172
Ta 248,238,57344
CV 89,90,91
WL 5
Mvvv 16,212,168
Ta 250,238,59392
AR 92,60
Mvvv 24,212,172
Ta 252,239,57344
AR 93,61
Mvvv 20,216,168
Ta 254,239,59392
CV 90,92,93
AR 94,62
Mvvv 28,216,172
Tv 220,236,61440
AR 95,63
WL 5
Mvav 0,240,176
Tv 222,236,63488
CV 91,94,95
Mvav 8,240,180
Tv 212,237,61440
buffer_store_dwordx4 v[88:91], v244, s[28:31], s61 offen offset:3072 sc1
Mvav 4,244,176
Tv 214,237,63488
v_lshlrev_b32 v32, 16, v33
Mvav 12,244,180
Tv 216,238,61440
v_and_b32 v33, 0xffff0000, v33
WL 5
Mvav 16,248,176
Tv 218,238,63488
AR 35,209
Mvav 24,248,180
Ta 240,239,61440
Mvav 20,252,176
Ta 242,239,63488
v_lshlrev_b32 v34, 16, v35
Mvav 28,252,180
v_and_b32 v35, 0xffff0000, v35
AR 37,210
WL 4
Mvvv 0,220,184
v_lshlrev_b32 v36, 16, v37
v_and_b32 v37, 0xffff0000, v37
Mvvv 8,220,188
AR 39,211
Mvvv 4,212,184
v_lshlrev_b32 v38, 16, v39
v_and_b32 v39, 0xffff0000, v39
AR 41,212
Mvvv 12,212,188
s_waitcnt vmcnt(4) lgkmcnt(0)
s_barrier
v_add_u32 v236, 0x18000, v236
v_add_u32 v237, 0x18000, v237
v_add_u32 v238, 0x18000, v238
v_add_u32 v239, 0x18000, v239
Ta 244,236,0
Mvvv 16,216,184
Ta 246,236,2048
Ta 248,237,0
Ta 250,237,2048
Ta 252,238,0
Ta 254,238,2048
Mvvv 24,216,188
Tv 220,239,0
Mvav 20,240,184
Tv 222,239,2048
v_lshlrev_b32 v40, 16, v41
Mvav 28,240,188
Tv 212,236,4096
v_and_b32 v41, 0xffff0000, v41
WL 5
Maav 0,244,128
Tv 214,236,6144
AR 43,213
Maav 8,244,132
Tv 216,237,4096
Maav 4,248,128
Tv 218,237,6144
v_lshlrev_b32 v42, 16, v43
Maav 12,248,132
Ta 240,238,4096
v_and_b32 v43, 0xffff0000, v43
WL 5
Maav 16,252,128
Ta 242,238,6144
CV 0,0,1
Maav 24,252,132
Ta 244,239,4096
AR 45,214
Mavv 20,220,128
Ta 246,239,6144
CV 1,2,3
Mavv 28,220,132
Ta 248,236,8192
WL 5
Mavv 0,212,136
Ta 250,236,10240
CV 2,4,5
Mavv 8,212,140
Ta 252,237,8192
v_lshlrev_b32 v44, 16, v45
Mavv 4,216,136
Ta 254,237,10240
CV 3,6,7
Mavv 12,216,140
Tv 220,238,8192
v_and_b32 v45, 0xffff0000, v45
WL 5
Maav 16,240,136
Tv 222,238,10240
AR 47,215
Maav 24,240,140
Tv 212,239,8192
Maav 20,244,136
Tv 214,239,10240
s_mul_i32 s61, s40, 112
s_add_u32 s61, s61, s39
buffer_store_dwordx4 v[0:3], v244, s[28:31], s61 offen offset:0 sc1
Maav 28,244,140
Tv 216,236,12288
v_lshlrev_b32 v46, 16, v47
WL 5
Maav 0,248,144
Tv 218,236,14336
v_and_b32 v47, 0xffff0000, v47
Maav 8,248,148
Ta 240,237,12288
Maav 4,252,144
Ta 242,237,14336
CV 8,8,9
AR 49,216
Maav 12,252,148
Ta 244,238,12288
WL 5
Mavv 16,220,144
Ta 246,238,14336
CV 9,10,11
Mavv 24,220,148
Ta 248,239,12288
v_lshlrev_b32 v48, 16, v49
Mavv 20,212,144
Ta 250,239,14336
v_and_b32 v49, 0xffff0000, v49
Mavv 28,212,148
v_add_u32 v236, 0xfffe8000, v236
v_add_u32 v237, 0xfffe8000, v237
v_add_u32 v238, 0xfffe8000, v238
v_add_u32 v239, 0xfffe8000, v239
Ta 252,236,32768
CV 10,12,13
WL 5
Mavv 0,216,152
Ta 254,236,34816
AR 51,217
Mavv 8,216,156
Tv 220,237,32768
CV 11,14,15
Maav 4,240,152
Tv 222,237,34816
v_lshlrev_b32 v50, 16, v51
Maav 12,240,156
Tv 212,238,32768
buffer_store_dwordx4 v[8:11], v244, s[28:31], s61 offen offset:2048 sc1
WL 5
Maav 16,244,152
Tv 214,238,34816
v_and_b32 v51, 0xffff0000, v51
Maav 24,244,156
Tv 216,239,32768
CV 16,16,17
Maav 20,248,152
Tv 218,239,34816
AR 53,218
Maav 28,248,156
Ta 240,236,36864
v_lshlrev_b32 v52, 16, v53
WL 5
Maav 0,252,160
Ta 242,236,38912
CV 17,18,19
Maav 8,252,164
Ta 244,237,36864
Mavv 4,220,160
Ta 246,237,38912
CV 18,20,21
Mavv 12,220,164
Ta 248,238,36864
v_and_b32 v53, 0xffff0000, v53
WL 5
Mavv 16,212,160
Ta 250,238,38912
CV 19,22,23
Mavv 24,212,164
Ta 252,239,36864
AR 55,219
Mavv 20,216,160
Ta 254,239,38912
buffer_store_dwordx4 v[16:19], v244, s[28:31], s61 offen offset:1024 sc1
Mavv 28,216,164
Tv 220,236,40960
WL 5
Maav 0,240,168
Tv 222,236,43008
CV 24,24,25
Maav 8,240,172
Tv 212,237,40960
v_lshlrev_b32 v54, 16, v55
Maav 4,244,168
Tv 214,237,43008
CV 25,26,27
Maav 12,244,172
Tv 216,238,40960
WL 5
Maav 16,248,168
Tv 218,238,43008
CV 26,28,29
v_and_b32 v55, 0xffff0000, v55
Maav 24,248,172
Ta 240,239,40960
Maav 20,252,168
Ta 242,239,43008
CV 27,30,31
Maav 28,252,172
Ta 244,236,45056
AR 57,220
WL 5
Mavv 0,220,176
Ta 246,236,47104
buffer_store_dwordx4 v[24:27], v244, s[28:31], s61 offen offset:3072 sc1
Mavv 8,220,180
Ta 248,237,45056
Mavv 4,212,176
Ta 250,237,47104
v_lshlrev_b32 v56, 16, v57
Mavv 12,212,180
Ta 252,238,45056
v_and_b32 v57, 0xffff0000, v57
WL 5
Mavv 16,216,176
Ta 254,238,47104
AR 59,221
Mavv 24,216,180
Tv 220,239,45056
v_lshlrev_b32 v58, 16, v59
Maav 20,240,176
Tv 222,239,47104
v_and_b32 v59, 0xffff0000, v59
Maav 28,240,180
s_mov_b32 s23, 0
s_and_b32 s22, s2, 7
WL 4
Maav 0,244,184
AR 61,222
v_lshlrev_b32 v60, 16, v61
Maav 8,244,188
v_and_b32 v61, 0xffff0000, v61
Maav 4,248,184
AR 63,223
v_lshlrev_b32 v62, 16, v63
Maav 12,248,188
s_waitcnt vmcnt(4) lgkmcnt(0)
s_barrier
Tv 212,236,16384
Maav 16,252,184
Tv 214,236,18432
Tv 216,237,16384
Tv 218,237,18432
Ta 240,238,16384
Ta 242,238,18432
Maav 24,252,188
Ta 244,239,16384
v_and_b32 v63, 0xffff0000, v63
Mavv 20,220,184
Ta 246,239,18432
Mavv 28,220,188
Ta 248,236,20480
WL 5
Mvvv 32,212,128
Ta 250,236,22528
Mvvv 40,212,132
Ta 252,237,20480
buffer_load_dword v225, v224, s[28:31], s16 offen sc1
Mvvv 36,216,128
Ta 254,237,22528
Mvvv 44,216,132
Tv 220,238,20480
AR 96,0
WL 5
Mvav 48,240,128
Tv 222,238,22528
AR 97,1
Mvav 56,240,132
Tv 212,239,20480
CV 96,96,97
Mvav 52,244,128
Tv 214,239,22528
AR 98,2
AR 99,3
Mvav 60,244,132
Tv 216,236,24576
CV 97,98,99
WL 5
Mvav 32,248,136
Tv 218,236,26624
AR 100,4
Mvav 40,248,140
Ta 240,237,24576
AR 101,5
Mvav 36,252,136
Ta 242,237,26624
CV 98,100,101
Mvav 44,252,140
Ta 244,238,24576
AR 102,6
WL 5
Mvvv 48,220,136
Ta 246,238,26624
AR 103,7
CV 99,102,103
Mvvv 56,220,140
Ta 248,239,24576
Mvvv 52,212,136
Ta 250,239,26624
s_mul_i32 s61, s44, 112
s_add_u32 s61, s61, s39
buffer_store_dwordx4 v[96:99], v244, s[28:31], s61 offen offset:0 sc1
Mvvv 60,212,140
Ta 252,236,28672
WL 5
Mvvv 32,216,144
Ta 254,236,30720
AR 104,8
Mvvv 40,216,148
Tv 220,237,28672
AR 105,9
Mvav 36,240,144
Tv 222,237,30720
CV 104,104,105
AR 106,10
Mvav 44,240,148
Tv 212,238,28672
AR 107,11
WL 5
Mvav 48,244,144
Tv 214,238,30720
CV 105,106,107
Mvav 56,244,148
Tv 216,239,28672
AR 108,12
Mvav 52,248,144
Tv 218,239,30720
AR 109,13
Mvav 60,248,148
v_add_u32 v236, 0x18000, v236
v_add_u32 v237, 0x18000, v237
v_add_u32 v238, 0x18000, v238
v_add_u32 v239, 0x18000, v239
Ta 240,236,16384
CV 106,108,109
WL 5
Mvav 32,252,152
Ta 242,236,18432
AR 110,14
AR 111,15
Mvav 40,252,156
Ta 244,237,16384
CV 107,110,111
Mvvv 36,220,152
Ta 246,237,18432
buffer_store_dwordx4 v[104:107], v244, s[28:31], s61 offen offset:2048 sc1
Mvvv 44,220,156
Ta 248,238,16384
AR 112,16
WL 5
Mvvv 48,212,152
Ta 250,238,18432
AR 113,17
CV 112,112,113
Mvvv 56,212,156
Ta 252,239,16384
Mvvv 52,216,152
Ta 254,239,18432
AR 114,18
AR 115,19
Mvvv 60,216,156
Tv 220,236,20480
CV 113,114,115
WL 5
Mvav 32,240,160
Tv 222,236,22528
AR 116,20
Mvav 40,240,164
Tv 212,237,20480
AR 117,21
Mvav 36,244,160
Tv 214,237,22528
CV 114,116,117
AR 118,22
Mvav 44,244,164
Tv 216,238,20480
s_waitcnt vmcnt(2)
v_cmp_ne_u32 vcc, 0, v225
s_nop 1
s_andn2_b32 s18, vcc_lo, s15
s_sub_u32 s17, s22, 1
s_cselect_b32 s21, 7, 0
s_add_u32 s17, s17, s21
s_mul_i32 s24, s17, 100352
s_add_u32 s24, s24, s19
s_bitcmp1_b32 s18, s17
s_cselect_b32 s24, s24, 0x7f000000
s_cselect_b32 s17, 1, 0
s_or_b32 s23, s23, s17
WL 5
Mvav 48,248,160
Tv 218,238,22528
AR 119,23
Mvav 56,248,164
Ta 240,239,20480
CV 115,118,119
Mvav 52,252,160
Ta 242,239,22528
buffer_store_dwordx4 v[112:115], v244, s[28:31], s61 offen offset:1024 sc1
Mvav 60,252,164
Ta 244,236,24576
AR 120,24
WL 5
Mvvv 32,220,168
Ta 246,236,26624
AR 121,25
CV 120,120,121
Mvvv 40,220,172
Ta 248,237,24576
AR 122,26
Mvvv 36,212,168
Ta 250,237,26624
AR 123,27
AR 1,224
Mvvv 44,212,172
Ta 252,238,24576
CV 121,122,123
WL 5
Mvvv 48,216,168
Ta 254,238,26624
AR 124,28
Mvvv 56,216,172
Tv 220,239,24576
AR 125,29
Mvav 52,240,168
Tv 222,239,26624
CV 122,124,125
AR 126,30
Mvav 60,240,172
Tv 212,236,28672
AR 127,31
WL 5
Mvav 32,244,176
Tv 214,236,30720
CV 123,126,127
buffer_load_dwordx4 a[128:131], v244, s[28:31], s24 offen offset:0 sc1
Mvav 40,244,180
Tv 216,237,28672
buffer_store_dwordx4 v[120:123], v244, s[28:31], s61 offen offset:3072 sc1
Mvav 36,248,176
Tv 218,237,30720
buffer_load_dwordx4 a[132:135], v244, s[28:31], s24 offen offset:2048 sc1
Mvav 44,248,180
Ta 240,238,28672
v_lshlrev_b32 v0, 16, v1
WL 5
Mvav 48,252,176
Ta 242,238,30720
buffer_load_dwordx4 a[136:139], v244, s[28:31], s24 offen offset:1024 sc1
Mvav 56,252,180
Ta 244,239,28672
buffer_load_dwordx4 a[140:143], v244, s[28:31], s24 offen offset:3072 sc1
Mvvv 52,220,176
Ta 246,239,30720
v_and_b32 v1, 0xffff0000, v1
Mvvv 60,220,180
AR 3,225
v_lshlrev_b32 v2, 16, v3
WL 4
Mvvv 32,212,184
v_and_b32 v3, 0xffff0000, v3
AR 5,226
Mvvv 40,212,188
v_lshlrev_b32 v4, 16, v5
Mvvv 36,216,184
v_and_b32 v5, 0xffff0000, v5
AR 7,227
v_lshlrev_b32 v6, 16, v7
Mvvv 44,216,188
s_waitcnt vmcnt(9) lgkmcnt(0)
s_barrier
Ta 248,236,49152
Mvav 48,240,184
Ta 250,236,51200
Ta 252,237,49152
Ta 254,237,51200
Tv 220,238,49152
Tv 222,238,51200
Mvav 56,240,188
Tv 212,239,49152
Mvav 52,244,184
Tv 214,239,51200
v_and_b32 v7, 0xffff0000, v7
Mvav 60,244,188
Tv 216,236,53248
AR 9,228
WL 5
Maav 96,248,128
Tv 218,236,55296
v_lshlrev_b32 v8, 16, v9
Maav 104,248,132
Ta 240,237,53248
buffer_load_dword v225, v224, s[28:31], s16 offen sc1
Maav 100,252,128
Ta 242,237,55296
v_and_b32 v9, 0xffff0000, v9
Maav 108,252,132
Ta 244,238,53248
AR 11,229
WL 5
Mavv 112,220,128
Ta 246,238,55296
CV 32,32,33
Mavv 120,220,132
Ta 248,239,53248
v_lshlrev_b32 v10, 16, v11
Mavv 116,212,128
Ta 250,239,55296
CV 33,34,35
Mavv 124,212,132
Ta 252,236,57344
v_and_b32 v11, 0xffff0000, v11
WL 5
Mavv 96,216,136
Ta 254,236,59392
CV 34,36,37
Mavv 104,216,140
Tv 220,237,57344
Maav 100,240,136
Tv 222,237,59392
CV 35,38,39
AR 13,230
Maav 108,240,140
Tv 212,238,57344
WL 5
Maav 112,244,136
Tv 214,238,59392
v_lshlrev_b32 v12, 16, v13
Maav 120,244,140
Tv 216,239,57344
v_and_b32 v13, 0xffff0000, v13
Maav 116,248,136
Tv 218,239,59392
s_mul_i32 s61, s41, 112
s_add_u32 s61, s61, s39
buffer_store_dwordx4 v[32:35], v244, s[28:31], s61 offen offset:0 sc1
Maav 124,248,140
Ta 240,236,61440
AR 15,231
WL 5
Maav 96,252,144
Ta 242,236,63488
v_lshlrev_b32 v14, 16, v15
Maav 104,252,148
Ta 244,237,61440
v_and_b32 v15, 0xffff0000, v15
Mavv 100,220,144
Ta 246,237,63488
CV 40,40,41
Mavv 108,220,148
Ta 248,238,61440
WL 5
Mavv 112,212,144
Ta 250,238,63488
CV 41,42,43
Mavv 120,212,148
Ta 252,239,61440
AR 17,232
Mavv 116,216,144
Ta 254,239,63488
CV 42,44,45
Mavv 124,216,148
v_add_u32 v236, 0xfffe8000, v236
v_add_u32 v237, 0xfffe8000, v237
v_add_u32 v238, 0xfffe8000, v238
v_add_u32 v239, 0xfffe8000, v239
Tv 220,236,0
v_lshlrev_b32 v16, 16, v17
WL 5
Maav 96,240,152
Tv 222,236,2048
CV 43,46,47
Maav 104,240,156
Tv 212,237,0
v_and_b32 v17, 0xffff0000, v17
Maav 100,244,152
Tv 214,237,2048
AR 19,233
Maav 108,244,156
Tv 216,238,0
buffer_store_dwordx4 v[40:43], v244, s[28:31], s61 offen offset:2048 sc1
WL 5
Maav 112,248,152
Tv 218,238,2048
v_lshlrev_b32 v18, 16, v19
Maav 120,248,156
Ta 240,239,0
CV 48,48,49
Maav 116,252,152
Ta 242,239,2048
v_and_b32 v19, 0xffff0000, v19
Maav 124,252,156
Ta 244,236,4096
CV 49,50,51
WL 5
Mavv 96,220,160
Ta 246,236,6144
AR 21,234
Mavv 104,220,164
Ta 248,237,4096
CV 50,52,53
Mavv 100,212,160
Ta 250,237,6144
v_lshlrev_b32 v20, 16, v21
v_and_b32 v21, 0xffff0000, v21
Mavv 108,212,164
Ta 252,238,4096
s_waitcnt vmcnt(2)
v_cmp_ne_u32 vcc, 0, v225
s_nop 1
s_andn2_b32 s18, vcc_lo, s15
s_sub_u32 s17, s22, 2
s_cselect_b32 s21, 7, 0
s_add_u32 s17, s17, s21
s_mul_i32 s25, s17, 100352
s_add_u32 s25, s25, s19
s_bitcmp1_b32 s18, s17
s_cselect_b32 s25, s25, 0x7f000000
s_cselect_b32 s17, 2, 0
s_or_b32 s23, s23, s17
WL 5
Mavv 112,216,160
Ta 254,238,6144
CV 51,54,55
Mavv 120,216,164
Tv 220,239,4096
Maav 116,240,160
Tv 222,239,6144
buffer_store_dwordx4 v[48:51], v244, s[28:31], s61 offen offset:1024 sc1
AR 23,235
Maav 124,240,164
Tv 212,236,8192
buffer_load_dwordx4 a[144:147], v244, s[28:31], s25 offen offset:0 sc1
WL 5
Maav 96,244,168
Tv 214,236,10240
CV 56,56,57
Maav 104,244,172
Tv 216,237,8192
Maav 100,248,168
Tv 218,237,10240
CV 57,58,59
Maav 108,248,172
Ta 240,238,8192
v_lshlrev_b32 v22, 16, v23
WL 5
Maav 112,252,168
Ta 242,238,10240
CV 58,60,61
Maav 120,252,172
Ta 244,239,8192
v_and_b32 v23, 0xffff0000, v23
Mavv 116,220,168
Ta 246,239,10240
CV 59,62,63
Mavv 124,220,172
Ta 248,236,12288
buffer_load_dwordx4 a[148:151], v244, s[28:31], s25 offen offset:2048 sc1
WL 5
Mavv 96,212,176
Ta 250,236,14336
buffer_store_dwordx4 v[56:59], v244, s[28:31], s61 offen offset:3072 sc1
Mavv 104,212,180
Ta 252,237,12288
AR 25,236
Mavv 100,216,176
Ta 254,237,14336
buffer_load_dwordx4 a[152:155], v244, s[28:31], s25 offen offset:1024 sc1
Mavv 108,216,180
Tv 220,238,12288
v_lshlrev_b32 v24, 16, v25
WL 5
Maav 112,240,176
Tv 222,238,14336
buffer_load_dwordx4 a[156:159], v244, s[28:31], s25 offen offset:3072 sc1
Maav 120,240,180
Tv 212,239,12288
v_and_b32 v25, 0xffff0000, v25
Maav 116,244,176
Tv 214,239,14336
AR 27,237
Maav 124,244,180
v_lshlrev_b32 v26, 16, v27
WL 4
Maav 96,248,184
v_and_b32 v27, 0xffff0000, v27
AR 29,238
v_lshlrev_b32 v28, 16, v29
Maav 104,248,188
v_and_b32 v29, 0xffff0000, v29
Maav 100,252,184
AR 31,239
v_lshlrev_b32 v30, 16, v31
Maav 108,252,188
s_waitcnt vmcnt(12) lgkmcnt(0)
s_barrier
v_add_u32 v236, 0x18000, v236
v_add_u32 v237, 0x18000, v237
v_add_u32 v238, 0x18000, v238
v_add_u32 v239, 0x18000, v239
Tv 216,236,32768
Mavv 112,220,184
Tv 218,236,34816
Ta 240,237,32768
Ta 242,237,34816
Ta 244,238,32768
Ta 246,238,34816
Mavv 120,220,188
Ta 248,239,32768
v_and_b32 v31, 0xffff0000, v31
Mavv 116,212,184
Ta 250,239,34816
Mavv 124,212,188
Ta 252,236,36864
WL 5
Mvvv 0,216,128
Ta 254,236,38912
Mvvv 8,216,132
Tv 220,237,36864
buffer_load_dword v225, v224, s[28:31], s16 offen sc1
Mvav 4,240,128
Tv 222,237,38912
Mvav 12,240,132
Tv 212,238,36864
AR 64,96
AR 65,97
WL 5
Mvav 16,244,128
Tv 214,238,38912
CV 64,64,65
AR 66,98
AR 67,99
Mvav 24,244,132
Tv 216,239,36864
CV 65,66,67
AR 68,100
Mvav 20,248,128
Tv 218,239,38912
AR 69,101
CV 66,68,69
Mvav 28,248,132
Ta 240,236,40960
AR 70,102
AR 71,103
CV 67,70,71
WL 5
Mvav 0,252,136
Ta 242,236,43008
s_mul_i32 s61, s43, 112
s_add_u32 s61, s61, s39
buffer_store_dwordx4 v[64:67], v244, s[28:31], s61 offen offset:0 sc1
Mvav 8,252,140
Ta 244,237,40960
AR 72,104
Mvvv 4,220,136
Ta 246,237,43008
AR 73,105
CV 72,72,73
AR 74,106
Mvvv 12,220,140
Ta 248,238,40960
AR 75,107
CV 73,74,75
WL 5
Mvvv 16,212,136
Ta 250,238,43008
AR 76,108
AR 77,109
CV 74,76,77
Mvvv 24,212,140
Ta 252,239,40960
AR 78,110
AR 79,111
Mvvv 20,216,136
Ta 254,239,43008
CV 75,78,79
buffer_store_dwordx4 v[72:75], v244, s[28:31], s61 offen offset:2048 sc1
Mvvv 28,216,140
Tv 220,236,45056
AR 80,112
AR 81,113
WL 5
Mvav 0,240,144
Tv 222,236,47104
CV 80,80,81
AR 82,114
AR 83,115
Mvav 8,240,148
Tv 212,237,45056
CV 81,82,83
AR 84,116
Mvav 4,244,144
Tv 214,237,47104
AR 85,117
CV 82,84,85
AR 86,118
Mvav 12,244,148
Tv 216,238,45056
AR 87,119
CV 83,86,87
WL 5
Mvav 16,248,144
Tv 218,238,47104
buffer_store_dwordx4 v[80:83], v244, s[28:31], s61 offen offset:1024 sc1
AR 88,120
Mvav 24,248,148
Ta 240,239,45056
AR 89,121
CV 88,88,89
AR 90,122
Mvav 20,252,144
Ta 242,239,47104
AR 91,123
CV 89,90,91
Mvav 28,252,148
v_add_u32 v236, 0xffff8000, v236
v_add_u32 v237, 0xffff8000, v237
v_add_u32 v238, 0xffff8000, v238
v_add_u32 v239, 0xffff8000, v239
Ta 244,236,16384
AR 92,124
AR 93,125
WL 5
Mvvv 0,220,152
Ta 246,236,18432
CV 90,92,93
AR 94,126
AR 95,127
Mvvv 8,220,156
Ta 248,237,16384
CV 91,94,95
buffer_store_dwordx4 v[88:91], v244, s[28:31], s61 offen offset:3072 sc1
Mvvv 4,212,152
Ta 250,237,18432
Mvvv 12,212,156
Ta 252,238,16384
WL 5
Mvvv 16,216,152
Ta 254,238,18432
Mvvv 24,216,156
Tv 220,239,16384
Mvav 20,240,152
Tv 222,239,18432
Mvav 28,240,156
Tv 212,236,20480
WL 5
Mvav 0,244,160
Tv 214,236,22528
Mvav 8,244,164
Tv 216,237,20480
Mvav 4,248,160
Tv 218,237,22528
Mvav 12,248,164
Ta 240,238,20480
s_waitcnt vmcnt(4)
v_cmp_ne_u32 vcc, 0, v225
s_nop 1
s_andn2_b32 s18, vcc_lo, s15
s_sub_u32 s17, s22, 3
s_cselect_b32 s21, 7, 0
s_add_u32 s17, s17, s21
s_mul_i32 s26, s17, 100352
s_add_u32 s26, s26, s19
s_bitcmp1_b32 s18, s17
s_cselect_b32 s26, s26, 0x7f000000
s_cselect_b32 s17, 4, 0
s_or_b32 s23, s23, s17
s_sub_u32 s17, s22, 4
s_cselect_b32 s21, 7, 0
s_add_u32 s17, s17, s21
s_mul_i32 s27, s17, 100352
s_add_u32 s27, s27, s19
s_bitcmp1_b32 s18, s17
s_cselect_b32 s27, s27, 0x7f000000
s_cselect_b32 s17, 8, 0
s_or_b32 s23, s23, s17
WL 5
Mvav 16,252,160
Ta 242,238,22528
Mvav 24,252,164
Ta 244,239,20480
Mvvv 20,220,160
Ta 246,239,22528
buffer_load_dwordx4 a[160:163], v244, s[28:31], s26 offen offset:0 sc1
Mvvv 28,220,164
Ta 248,236,24576
WL 5
Mvvv 0,212,168
Ta 250,236,26624
buffer_load_dwordx4 a[164:167], v244, s[28:31], s26 offen offset:2048 sc1
Mvvv 8,212,172
Ta 252,237,24576
Mvvv 4,216,168
Ta 254,237,26624
buffer_load_dwordx4 a[168:171], v244, s[28:31], s26 offen offset:1024 sc1
Mvvv 12,216,172
Tv 220,238,24576
WL 5
Mvav 16,240,168
Tv 222,238,26624
buffer_load_dwordx4 a[172:175], v244, s[28:31], s26 offen offset:3072 sc1
Mvav 24,240,172
Tv 212,239,24576
Mvav 20,244,168
Tv 214,239,26624
buffer_load_dwordx4 a[176:179], v244, s[28:31], s27 offen offset:0 sc1
Mvav 28,244,172
Tv 216,236,28672
WL 5
Mvav 0,248,176
Tv 218,236,30720
buffer_load_dwordx4 a[180:183], v244, s[28:31], s27 offen offset:2048 sc1
Mvav 8,248,180
Ta 240,237,28672
Mvav 4,252,176
Ta 242,237,30720
buffer_load_dwordx4 a[184:187], v244, s[28:31], s27 offen offset:1024 sc1
Mvav 12,252,180
Ta 244,238,28672
WL 5
Mvvv 16,220,176
Ta 246,238,30720
buffer_load_dwordx4 a[188:191], v244, s[28:31], s27 offen offset:3072 sc1
Mvvv 24,220,180
Ta 248,239,28672
Mvvv 20,212,176
Ta 250,239,30720
Mvvv 28,212,180
WL 4
Mvvv 0,216,184
Mvvv 8,216,188
buffer_load_dword v225, v224, s[28:31], s16 offen sc1
Mvav 4,240,184
Mvav 12,240,188
WL 2
Mvav 16,244,184
Mvav 24,244,188
WL 0
Mvav 20,248,184
Mvav 28,248,188
s_cmp_lg_u32 s15, 0
s_cbranch_scc1 LA_wg7
s_waitcnt vmcnt(16)
s_barrier
s_waitcnt vmcnt(9)
s_barrier
s_waitcnt vmcnt(0)
v_cmp_ne_u32 vcc, 0, v225
s_nop 1
s_mov_b32 s18, vcc_lo
s_bitcmp1_b32 s23, 0
s_cbranch_scc1 LA_m0
s_sub_u32 s17, s22, 1
s_cselect_b32 s21, 7, 0
s_add_u32 s17, s17, s21
LA_w0:
s_bitcmp0_b32 s18, s17
s_cbranch_scc1 LA_sp0
s_mul_i32 s24, s17, 100352
s_add_u32 s24, s24, s19
buffer_load_dwordx4 a[128:131], v244, s[28:31], s24 offen offset:0 sc1
buffer_load_dwordx4 a[132:135], v244, s[28:31], s24 offen offset:2048 sc1
buffer_load_dwordx4 a[136:139], v244, s[28:31], s24 offen offset:1024 sc1
buffer_load_dwordx4 a[140:143], v244, s[28:31], s24 offen offset:3072 sc1
LA_m0:
s_bitcmp1_b32 s23, 1
s_cbranch_scc1 LA_m1
s_sub_u32 s17, s22, 2
s_cselect_b32 s21, 7, 0
s_add_u32 s17, s17, s21
LA_w1:
s_bitcmp0_b32 s18, s17
s_cbranch_scc1 LA_sp1
s_mul_i32 s25, s17, 100352
s_add_u32 s25, s25, s19
buffer_load_dwordx4 a[144:147], v244, s[28:31], s25 offen offset:0 sc1
buffer_load_dwordx4 a[148:151], v244, s[28:31], s25 offen offset:2048 sc1
buffer_load_dwordx4 a[152:155], v244, s[28:31], s25 offen offset:1024 sc1
buffer_load_dwordx4 a[156:159], v244, s[28:31], s25 offen offset:3072 sc1
LA_m1:
s_bitcmp1_b32 s23, 2
s_cbranch_scc1 LA_m2
s_sub_u32 s17, s22, 3
s_cselect_b32 s21, 7, 0
s_add_u32 s17, s17, s21
LA_w2:
s_bitcmp0_b32 s18, s17
s_cbranch_scc1 LA_sp2
s_mul_i32 s26, s17, 100352
s_add_u32 s26, s26, s19
buffer_load_dwordx4 a[160:163], v244, s[28:31], s26 offen offset:0 sc1
buffer_load_dwordx4 a[164:167], v244, s[28:31], s26 offen offset:2048 sc1
buffer_load_dwordx4 a[168:171], v244, s[28:31], s26 offen offset:1024 sc1
buffer_load_dwordx4 a[172:175], v244, s[28:31], s26 offen offset:3072 sc1
LA_m2:
s_bitcmp1_b32 s23, 3
s_cbranch_scc1 LA_m3
s_sub_u32 s17, s22, 4
s_cselect_b32 s21, 7, 0
s_add_u32 s17, s17, s21
LA_w3:
s_bitcmp0_b32 s18, s17
s_cbranch_scc1 LA_sp3
s_mul_i32 s27, s17, 100352
s_add_u32 s27, s27, s19
buffer_load_dwordx4 a[176:179], v244, s[28:31], s27 offen offset:0 sc1
buffer_load_dwordx4 a[180:183], v244, s[28:31], s27 offen offset:2048 sc1
buffer_load_dwordx4 a[184:187], v244, s[28:31], s27 offen offset:1024 sc1
buffer_load_dwordx4 a[188:191], v244, s[28:31], s27 offen offset:3072 sc1
LA_m3:
s_sub_u32 s17, s22, 5
s_cselect_b32 s21, 7, 0
s_add_u32 s17, s17, s21
LA_w4:
s_bitcmp0_b32 s18, s17
s_cbranch_scc1 LA_sp4
s_mul_i32 s24, s17, 100352
s_add_u32 s24, s24, s19
buffer_load_dwordx4 v[64:67], v244, s[28:31], s24 offen offset:0 sc1
buffer_load_dwordx4 v[68:71], v244, s[28:31], s24 offen offset:2048 sc1
buffer_load_dwordx4 v[72:75], v244, s[28:31], s24 offen offset:1024 sc1
buffer_load_dwordx4 v[76:79], v244, s[28:31], s24 offen offset:3072 sc1
s_sub_u32 s17, s22, 6
s_cselect_b32 s21, 7, 0
s_add_u32 s17, s17, s21
s_lshl_b32 s21, 1, s17
s_or_b32 s21, s21, 0x80
s_and_b32 s20, s18, s21
s_cmp_eq_u32 s20, s21
s_cbranch_scc0 LA_slowp
s_mul_i32 s25, s17, 100352
s_add_u32 s25, s25, s19
buffer_load_dwordx4 v[80:83], v244, s[28:31], s25 offen offset:0 sc1
buffer_load_dwordx4 v[84:87], v244, s[28:31], s25 offen offset:2048 sc1
buffer_load_dwordx4 v[88:91], v244, s[28:31], s25 offen offset:1024 sc1
buffer_load_dwordx4 v[92:95], v244, s[28:31], s25 offen offset:3072 sc1
s_mov_b32 s17, 7
s_mul_i32 s26, s17, 100352
s_add_u32 s26, s26, s19
buffer_load_dwordx4 v[192:195], v244, s[28:31], s26 offen offset:0 sc1
buffer_load_dwordx4 v[196:199], v244, s[28:31], s26 offen offset:2048 sc1
buffer_load_dwordx4 v[200:203], v244, s[28:31], s26 offen offset:1024 sc1
buffer_load_dwordx4 v[204:207], v244, s[28:31], s26 offen offset:3072 sc1
s_waitcnt vmcnt(12)
Mvva 0,230,128
Mvva 4,228,128
Mvva 8,230,132
Mvva 12,228,132
Mvva 16,230,136
Mvva 20,228,136
Mvva 24,230,140
Mvva 28,228,140
Mvva 0,230,144
Mvva 4,228,144
Mvva 8,230,148
Mvva 12,228,148
Mvva 16,230,152
Mvva 20,228,152
Mvva 24,230,156
Mvva 28,228,156
Mvva 0,230,160
Mvva 4,228,160
Mvva 8,230,164
Mvva 12,228,164
Mvva 16,230,168
Mvva 20,228,168
Mvva 24,230,172
Mvva 28,228,172
Mvva 0,230,176
Mvva 4,228,176
Mvva 8,230,180
Mvva 12,228,180
Mvva 16,230,184
Mvva 20,228,184
Mvva 24,230,188
Mvva 28,228,188
s_branch LA_join
LA_slowp:
s_waitcnt vmcnt(4)
Mvva 0,230,128
Mvva 4,228,128
Mvva 8,230,132
Mvva 12,228,132
Mvva 16,230,136
Mvva 20,228,136
Mvva 24,230,140
Mvva 28,228,140
Mvva 0,230,144
Mvva 4,228,144
Mvva 8,230,148
Mvva 12,228,148
Mvva 16,230,152
Mvva 20,228,152
Mvva 24,230,156
Mvva 28,228,156
Mvva 0,230,160
Mvva 4,228,160
Mvva 8,230,164
Mvva 12,228,164
Mvva 16,230,168
Mvva 20,228,168
Mvva 24,230,172
Mvva 28,228,172
Mvva 0,230,176
Mvva 4,228,176
Mvva 8,230,180
Mvva 12,228,180
Mvva 16,230,184
Mvva 20,228,184
Mvva 24,230,188
Mvva 28,228,188
s_sub_u32 s17, s22, 6
s_cselect_b32 s21, 7, 0
s_add_u32 s17, s17, s21
LA_w5:
s_bitcmp0_b32 s18, s17
s_cbranch_scc1 LA_sp5
s_mul_i32 s25, s17, 100352
s_add_u32 s25, s25, s19
buffer_load_dwordx4 v[80:83], v244, s[28:31], s25 offen offset:0 sc1
buffer_load_dwordx4 v[84:87], v244, s[28:31], s25 offen offset:2048 sc1
buffer_load_dwordx4 v[88:91], v244, s[28:31], s25 offen offset:1024 sc1
buffer_load_dwordx4 v[92:95], v244, s[28:31], s25 offen offset:3072 sc1
s_mov_b32 s17, 7
LA_w6:
s_bitcmp0_b32 s18, s17
s_cbranch_scc1 LA_sp6
s_mul_i32 s26, s17, 100352
s_add_u32 s26, s26, s19
buffer_load_dwordx4 v[192:195], v244, s[28:31], s26 offen offset:0 sc1
buffer_load_dwordx4 v[196:199], v244, s[28:31], s26 offen offset:2048 sc1
buffer_load_dwordx4 v[200:203], v244, s[28:31], s26 offen offset:1024 sc1
buffer_load_dwordx4 v[204:207], v244, s[28:31], s26 offen offset:3072 sc1
LA_join:
s_waitcnt vmcnt(8)
Mvvv 0,230,64
Mvvv 4,228,64
Mvvv 8,230,68
Mvvv 12,228,68
Mvvv 16,230,72
Mvvv 20,228,72
Mvvv 24,230,76
Mvvv 28,228,76
s_waitcnt vmcnt(4)
Mvvv 0,230,80
Mvvv 4,228,80
Mvvv 8,230,84
Mvvv 12,228,84
Mvvv 16,230,88
Mvvv 20,228,88
Mvvv 24,230,92
Mvvv 28,228,92
s_waitcnt vmcnt(0)
Mvvv 0,230,192
Mvvv 4,228,192
Mvvv 8,230,196
Mvvv 12,228,196
Mvvv 16,230,200
Mvvv 20,228,200
Mvvv 24,230,204
Mvvv 28,228,204
LA_out:
s_nop 7
CV 32,0,1
CV 33,2,3
CV 34,4,5
CV 35,6,7
s_nop 0
v_permlane32_swap_b32 v32, v34
v_permlane32_swap_b32 v33, v35
s_nop 0
v_permlane16_swap_b32 v32, v34
v_permlane16_swap_b32 v33, v35
buffer_store_dwordx4 v[32:35], v226, s[8:11], s12 offen offset:0 sc1
CV 36,8,9
CV 37,10,11
CV 38,12,13
CV 39,14,15
s_nop 0
v_permlane32_swap_b32 v36, v38
v_permlane32_swap_b32 v37, v39
s_nop 0
v_permlane16_swap_b32 v36, v38
v_permlane16_swap_b32 v37, v39
buffer_store_dwordx4 v[36:39], v226, s[8:11], s13 offen offset:0 sc1
CV 40,16,17
CV 41,18,19
CV 42,20,21
CV 43,22,23
s_nop 0
v_permlane32_swap_b32 v40, v42
v_permlane32_swap_b32 v41, v43
s_nop 0
v_permlane16_swap_b32 v40, v42
v_permlane16_swap_b32 v41, v43
buffer_store_dwordx4 v[40:43], v226, s[8:11], s12 offen offset:64 sc1
CV 44,24,25
CV 45,26,27
CV 46,28,29
CV 47,30,31
s_nop 0
v_permlane32_swap_b32 v44, v46
v_permlane32_swap_b32 v45, v47
s_nop 0
v_permlane16_swap_b32 v44, v46
v_permlane16_swap_b32 v45, v47
buffer_store_dwordx4 v[44:47], v226, s[8:11], s13 offen offset:64 sc1
s_branch LA_fin
LA_sp0:
buffer_load_dword v225, v224, s[28:31], s16 offen sc1
s_waitcnt vmcnt(0)
v_cmp_ne_u32 vcc, 0, v225
s_sub_u32 s14, s14, 1
s_cselect_b32 s18, -1, vcc_lo
s_branch LA_w0
LA_sp1:
buffer_load_dword v225, v224, s[28:31], s16 offen sc1
s_waitcnt vmcnt(0)
v_cmp_ne_u32 vcc, 0, v225
s_sub_u32 s14, s14, 1
s_cselect_b32 s18, -1, vcc_lo
s_branch LA_w1
LA_sp2:
buffer_load_dword v225, v224, s[28:31], s16 offen sc1
s_waitcnt vmcnt(0)
v_cmp_ne_u32 vcc, 0, v225
s_sub_u32 s14, s14, 1
s_cselect_b32 s18, -1, vcc_lo
s_branch LA_w2
LA_sp3:
buffer_load_dword v225, v224, s[28:31], s16 offen sc1
s_waitcnt vmcnt(0)
v_cmp_ne_u32 vcc, 0, v225
s_sub_u32 s14, s14, 1
s_cselect_b32 s18, -1, vcc_lo
s_branch LA_w3
LA_sp4:
buffer_load_dword v225, v224, s[28:31], s16 offen sc1
s_waitcnt vmcnt(0)
v_cmp_ne_u32 vcc, 0, v225
s_sub_u32 s14, s14, 1
s_cselect_b32 s18, -1, vcc_lo
s_branch LA_w4
LA_sp5:
buffer_load_dword v225, v224, s[28:31], s16 offen sc1
s_waitcnt vmcnt(0)
v_cmp_ne_u32 vcc, 0, v225
s_sub_u32 s14, s14, 1
s_cselect_b32 s18, -1, vcc_lo
s_branch LA_w5
LA_sp6:
buffer_load_dword v225, v224, s[28:31], s16 offen sc1
s_waitcnt vmcnt(0)
v_cmp_ne_u32 vcc, 0, v225
s_sub_u32 s14, s14, 1
s_cselect_b32 s18, -1, vcc_lo
s_branch LA_w6
LA_wg7:
s_nop 7
CV 0,0,1
CV 1,2,3
CV 2,4,5
CV 3,6,7
s_mul_i32 s61, s42, 112
s_add_u32 s61, s61, s39
buffer_store_dwordx4 v[0:3], v244, s[28:31], s61 offen offset:0 sc1
CV 8,8,9
CV 9,10,11
CV 10,12,13
CV 11,14,15
buffer_store_dwordx4 v[8:11], v244, s[28:31], s61 offen offset:2048 sc1
CV 16,16,17
CV 17,18,19
CV 18,20,21
CV 19,22,23
buffer_store_dwordx4 v[16:19], v244, s[28:31], s61 offen offset:1024 sc1
CV 24,24,25
CV 25,26,27
CV 26,28,29
CV 27,30,31
buffer_store_dwordx4 v[24:27], v244, s[28:31], s61 offen offset:3072 sc1
s_waitcnt vmcnt(4)
s_barrier
s_waitcnt vmcnt(0)
s_barrier
LA_fin:
LA_end:
s_endpgm
LA_hs:
s_mov_b32 s63, 0x40000
s_lshr_b32 s5, s2, 3
s_lshl_b32 s5, s5, 2
v_mov_b32 v253, 0
LA_hs2:
buffer_load_dword v254, v253, s[52:55], s5 offen offset:128 sc1
s_waitcnt vmcnt(0)
v_readfirstlane_b32 s7, v254
s_nop 0
s_sub_u32 s63, s63, 1
s_cbranch_scc1 LA_hsb
s_cmp_lt_u32 s7, 8
s_cbranch_scc1 LA_hs2
s_branch LA_hsb
LA_ra1:
s_call_b64 s[56:57], LA_newmax1
s_branch LA_rb1
LA_ra2:
s_call_b64 s[56:57], LA_rescale
s_branch LA_rb2
LA_ra3:
s_call_b64 s[56:57], LA_newmax0
s_branch LA_rb3
LA_ra4:
s_call_b64 s[56:57], LA_rescale
s_branch LA_rb4
LA_ra5:
s_call_b64 s[56:57], LA_newmax1
s_branch LA_rb5
LA_ra6:
s_call_b64 s[56:57], LA_rescale
s_branch LA_rb6
LA_ra7:
s_call_b64 s[56:57], LA_newmax0
s_branch LA_rb7
LA_ra8:
s_call_b64 s[56:57], LA_rescale
s_branch LA_rb8
LA_ra9:
s_call_b64 s[56:57], LA_newmax1
s_branch LA_rb9
LA_ra10:
s_call_b64 s[56:57], LA_rescale
s_branch LA_rb10
LA_ra11:
s_call_b64 s[56:57], LA_newmax0
s_branch LA_rb11
LA_ra12:
s_call_b64 s[56:57], LA_rescale
s_branch LA_rb12
LA_ra13:
s_call_b64 s[56:57], LA_newmax1
s_branch LA_rb13
LA_ra14:
s_call_b64 s[56:57], LA_rescale
s_branch LA_rb14
LA_ra15:
s_call_b64 s[56:57], LA_newmax0
s_branch LA_rb15
LA_ra16:
s_call_b64 s[56:57], LA_rescale
s_branch LA_rb16
LA_ra17:
s_call_b64 s[56:57], LA_newmax1
s_branch LA_rb17
LA_ra18:
s_call_b64 s[56:57], LA_rescale
s_branch LA_rb18
LA_ra19:
s_call_b64 s[56:57], LA_newmax0
s_branch LA_rb19
LA_ra20:
s_call_b64 s[56:57], LA_rescale
s_branch LA_rb20
LA_ra21:
s_call_b64 s[56:57], LA_newmax1
s_branch LA_rb21
LA_ra22:
s_call_b64 s[56:57], LA_rescale
s_branch LA_rb22
LA_ra23:
s_call_b64 s[56:57], LA_newmax0
s_branch LA_rb23
LA_ra24:
s_call_b64 s[56:57], LA_rescale
s_branch LA_rb24
LA_ra25:
s_call_b64 s[56:57], LA_newmax1
s_branch LA_rb25
LA_ra26:
s_call_b64 s[56:57], LA_rescale
s_branch LA_rb26
LA_ra27:
s_call_b64 s[56:57], LA_newmax0
s_branch LA_rb27
LA_ra28:
s_call_b64 s[56:57], LA_rescale
s_branch LA_rb28
LA_ra29:
s_call_b64 s[56:57], LA_newmax1
s_branch LA_rb29
LA_ra30:
s_call_b64 s[56:57], LA_rescale
s_branch LA_rb30
LA_ra31:
s_call_b64 s[56:57], LA_newmax1
s_branch LA_rb31
LA_ra32:
s_call_b64 s[56:57], LA_rescale
s_branch LA_rb32
LA_ra33:
s_call_b64 s[56:57], LA_newmax0
s_branch LA_rb33
LA_ra34:
s_call_b64 s[56:57], LA_rescale
s_branch LA_rb34
LA_ra35:
s_call_b64 s[56:57], LA_newmax1
s_branch LA_rb35
LA_ra36:
s_call_b64 s[56:57], LA_rescale
s_branch LA_rb36
LA_ra37:
s_call_b64 s[56:57], LA_newmax0
s_branch LA_rb37
LA_ra38:
s_call_b64 s[56:57], LA_rescale
s_branch LA_rb38
LA_ra39:
s_call_b64 s[56:57], LA_newmax1
s_branch LA_rb39
LA_ra40:
s_call_b64 s[56:57], LA_rescale
s_branch LA_rb40
LA_ra41:
s_call_b64 s[56:57], LA_newmax0
s_branch LA_rb41
LA_ra42:
s_call_b64 s[56:57], LA_rescale
s_branch LA_rb42
LA_ra43:
s_call_b64 s[56:57], LA_newmax1
s_branch LA_rb43
LA_ra44:
s_call_b64 s[56:57], LA_rescale
s_branch LA_rb44
LA_ra45:
s_call_b64 s[56:57], LA_newmax0
s_branch LA_rb45
LA_ra46:
s_call_b64 s[56:57], LA_rescale
s_branch LA_rb46
LA_ra47:
s_call_b64 s[56:57], LA_newmax1
s_branch LA_rb47
LA_ra48:
s_call_b64 s[56:57], LA_rescale
s_branch LA_rb48
LA_ra49:
s_call_b64 s[56:57], LA_newmax0
s_branch LA_rb49
LA_ra50:
s_call_b64 s[56:57], LA_rescale
s_branch LA_rb50
LA_ra51:
s_call_b64 s[56:57], LA_newmax1
s_branch LA_rb51
LA_ra52:
s_call_b64 s[56:57], LA_rescale
s_branch LA_rb52
LA_ra53:
s_call_b64 s[56:57], LA_newmax0
s_branch LA_rb53
LA_ra54:
s_call_b64 s[56:57], LA_rescale
s_branch LA_rb54
LA_ra55:
s_call_b64 s[56:57], LA_newmax1
s_branch LA_rb55
LA_ra56:
s_call_b64 s[56:57], LA_rescale
s_branch LA_rb56
LA_ra57:
s_call_b64 s[56:57], LA_newmax0
s_branch LA_rb57
LA_ra58:
s_call_b64 s[56:57], LA_rescale
s_branch LA_rb58
LA_ra59:
s_call_b64 s[56:57], LA_newmax1
s_branch LA_rb59
LA_ra60:
s_call_b64 s[56:57], LA_rescale
s_branch LA_rb60
LA_newmax0:
v_max3_f32 v251, v192, v193, v194
v_max3_f32 v251, v251, v195, v196
v_max3_f32 v251, v251, v197, v198
v_max3_f32 v251, v251, v199, 0
v_mov_b32 v252, v251
s_nop 1
v_permlane32_swap_b32 v251, v252
v_max_f32 v251, v251, v252
v_mov_b32 v252, v251
s_nop 1
v_permlane16_swap_b32 v251, v252
v_max_f32 v251, v251, v252
v_add_f32 v245, v245, v251
v_sub_f32 v192, v192, v251
v_sub_f32 v193, v193, v251
v_sub_f32 v194, v194, v251
v_sub_f32 v195, v195, v251
v_sub_f32 v196, v196, v251
v_sub_f32 v197, v197, v251
v_sub_f32 v198, v198, v251
v_sub_f32 v199, v199, v251
v_sub_f32 v251, 0, v251
v_exp_f32 v249, v251
s_nop 0
v_mul_f32 v247, v247, v249
v_max3_f32 v251, v200, v201, v202
v_max3_f32 v251, v251, v203, v204
v_max3_f32 v251, v251, v205, v206
v_max3_f32 v251, v251, v207, 0
v_mov_b32 v252, v251
s_nop 1
v_permlane32_swap_b32 v251, v252
v_max_f32 v251, v251, v252
v_mov_b32 v252, v251
s_nop 1
v_permlane16_swap_b32 v251, v252
v_max_f32 v251, v251, v252
v_add_f32 v246, v246, v251
v_sub_f32 v200, v200, v251
v_sub_f32 v201, v201, v251
v_sub_f32 v202, v202, v251
v_sub_f32 v203, v203, v251
v_sub_f32 v204, v204, v251
v_sub_f32 v205, v205, v251
v_sub_f32 v206, v206, v251
v_sub_f32 v207, v207, v251
v_sub_f32 v251, 0, v251
v_exp_f32 v250, v251
s_nop 0
v_mul_f32 v248, v248, v250
s_mov_b32 s49, 1
s_setpc_b64 s[56:57]
LA_newmax1:
v_max3_f32 v251, v208, v209, v210
v_max3_f32 v251, v251, v211, v212
v_max3_f32 v251, v251, v213, v214
v_max3_f32 v251, v251, v215, 0
v_mov_b32 v252, v251
s_nop 1
v_permlane32_swap_b32 v251, v252
v_max_f32 v251, v251, v252
v_mov_b32 v252, v251
s_nop 1
v_permlane16_swap_b32 v251, v252
v_max_f32 v251, v251, v252
v_add_f32 v245, v245, v251
v_sub_f32 v208, v208, v251
v_sub_f32 v209, v209, v251
v_sub_f32 v210, v210, v251
v_sub_f32 v211, v211, v251
v_sub_f32 v212, v212, v251
v_sub_f32 v213, v213, v251
v_sub_f32 v214, v214, v251
v_sub_f32 v215, v215, v251
v_sub_f32 v251, 0, v251
v_exp_f32 v249, v251
s_nop 0
v_mul_f32 v247, v247, v249
v_max3_f32 v251, v216, v217, v218
v_max3_f32 v251, v251, v219, v220
v_max3_f32 v251, v251, v221, v222
v_max3_f32 v251, v251, v223, 0
v_mov_b32 v252, v251
s_nop 1
v_permlane32_swap_b32 v251, v252
v_max_f32 v251, v251, v252
v_mov_b32 v252, v251
s_nop 1
v_permlane16_swap_b32 v251, v252
v_max_f32 v251, v251, v252
v_add_f32 v246, v246, v251
v_sub_f32 v216, v216, v251
v_sub_f32 v217, v217, v251
v_sub_f32 v218, v218, v251
v_sub_f32 v219, v219, v251
v_sub_f32 v220, v220, v251
v_sub_f32 v221, v221, v251
v_sub_f32 v222, v222, v251
v_sub_f32 v223, v223, v251
v_sub_f32 v251, 0, v251
v_exp_f32 v250, v251
s_nop 0
v_mul_f32 v248, v248, v250
s_mov_b32 s49, 1
s_setpc_b64 s[56:57]
LA_rescale:
s_nop 7
v_mul_f32 v0, v0, v249
v_mul_f32 v1, v1, v249
v_mul_f32 v2, v2, v249
v_mul_f32 v3, v3, v249
v_mul_f32 v4, v4, v249
v_mul_f32 v5, v5, v249
v_mul_f32 v6, v6, v249
v_mul_f32 v7, v7, v249
v_mul_f32 v8, v8, v250
v_mul_f32 v9, v9, v250
v_mul_f32 v10, v10, v250
v_mul_f32 v11, v11, v250
v_mul_f32 v12, v12, v250
v_mul_f32 v13, v13, v250
v_mul_f32 v14, v14, v250
v_mul_f32 v15, v15, v250
v_mul_f32 v16, v16, v249
v_mul_f32 v17, v17, v249
v_mul_f32 v18, v18, v249
v_mul_f32 v19, v19, v249
v_mul_f32 v20, v20, v249
v_mul_f32 v21, v21, v249
v_mul_f32 v22, v22, v249
v_mul_f32 v23, v23, v249
v_mul_f32 v24, v24, v250
v_mul_f32 v25, v25, v250
v_mul_f32 v26, v26, v250
v_mul_f32 v27, v27, v250
v_mul_f32 v28, v28, v250
v_mul_f32 v29, v29, v250
v_mul_f32 v30, v30, v250
v_mul_f32 v31, v31, v250
v_mul_f32 v32, v32, v249
v_mul_f32 v33, v33, v249
v_mul_f32 v34, v34, v249
v_mul_f32 v35, v35, v249
v_mul_f32 v36, v36, v249
v_mul_f32 v37, v37, v249
v_mul_f32 v38, v38, v249
v_mul_f32 v39, v39, v249
v_mul_f32 v40, v40, v250
v_mul_f32 v41, v41, v250
v_mul_f32 v42, v42, v250
v_mul_f32 v43, v43, v250
v_mul_f32 v44, v44, v250
v_mul_f32 v45, v45, v250
v_mul_f32 v46, v46, v250
v_mul_f32 v47, v47, v250
v_mul_f32 v48, v48, v249
v_mul_f32 v49, v49, v249
v_mul_f32 v50, v50, v249
v_mul_f32 v51, v51, v249
v_mul_f32 v52, v52, v249
v_mul_f32 v53, v53, v249
v_mul_f32 v54, v54, v249
v_mul_f32 v55, v55, v249
v_mul_f32 v56, v56, v250
v_mul_f32 v57, v57, v250
v_mul_f32 v58, v58, v250
v_mul_f32 v59, v59, v250
v_mul_f32 v60, v60, v250
v_mul_f32 v61, v61, v250
v_mul_f32 v62, v62, v250
v_mul_f32 v63, v63, v250
v_mul_f32 v64, v64, v249
v_mul_f32 v65, v65, v249
v_mul_f32 v66, v66, v249
v_mul_f32 v67, v67, v249
v_mul_f32 v68, v68, v249
v_mul_f32 v69, v69, v249
v_mul_f32 v70, v70, v249
v_mul_f32 v71, v71, v249
v_mul_f32 v72, v72, v250
v_mul_f32 v73, v73, v250
v_mul_f32 v74, v74, v250
v_mul_f32 v75, v75, v250
v_mul_f32 v76, v76, v250
v_mul_f32 v77, v77, v250
v_mul_f32 v78, v78, v250
v_mul_f32 v79, v79, v250
v_mul_f32 v80, v80, v249
v_mul_f32 v81, v81, v249
v_mul_f32 v82, v82, v249
v_mul_f32 v83, v83, v249
v_mul_f32 v84, v84, v249
v_mul_f32 v85, v85, v249
v_mul_f32 v86, v86, v249
v_mul_f32 v87, v87, v249
v_mul_f32 v88, v88, v250
v_mul_f32 v89, v89, v250
v_mul_f32 v90, v90, v250
v_mul_f32 v91, v91, v250
v_mul_f32 v92, v92, v250
v_mul_f32 v93, v93, v250
v_mul_f32 v94, v94, v250
v_mul_f32 v95, v95, v250
v_mul_f32 v96, v96, v249
v_mul_f32 v97, v97, v249
v_mul_f32 v98, v98, v249
v_mul_f32 v99, v99, v249
v_mul_f32 v100, v100, v249
v_mul_f32 v101, v101, v249
v_mul_f32 v102, v102, v249
v_mul_f32 v103, v103, v249
v_mul_f32 v104, v104, v250
v_mul_f32 v105, v105, v250
v_mul_f32 v106, v106, v250
v_mul_f32 v107, v107, v250
v_mul_f32 v108, v108, v250
v_mul_f32 v109, v109, v250
v_mul_f32 v110, v110, v250
v_mul_f32 v111, v111, v250
v_mul_f32 v112, v112, v249
v_mul_f32 v113, v113, v249
v_mul_f32 v114, v114, v249
v_mul_f32 v115, v115, v249
v_mul_f32 v116, v116, v249
v_mul_f32 v117, v117, v249
v_mul_f32 v118, v118, v249
v_mul_f32 v119, v119, v249
v_mul_f32 v120, v120, v250
v_mul_f32 v121, v121, v250
v_mul_f32 v122, v122, v250
v_mul_f32 v123, v123, v250
v_mul_f32 v124, v124, v250
v_mul_f32 v125, v125, v250
v_mul_f32 v126, v126, v250
v_mul_f32 v127, v127, v250
s_mov_b32 s49, 0
s_nop 1
s_setpc_b64 s[56:57]
.section .rodata,"a"
.p2align 6
.amdhsa_kernel concat_heads__mha_block_cached__gqa_block_cached__near_ridge_kernel
  .amdhsa_next_free_vgpr 512
  .amdhsa_next_free_sgpr 102
  .amdhsa_accum_offset 256
  .amdhsa_group_segment_fixed_size 0
  .amdhsa_kernarg_size 104
  .amdhsa_user_sgpr_count 2
  .amdhsa_user_sgpr_kernarg_segment_ptr 1
  .amdhsa_system_sgpr_workgroup_id_x 1
.end_amdhsa_kernel
```
